```python
import torch

def _softmax(x, axis=-1):
    return torch.softmax(x, dim=axis)

def _gelu(x):
    return torch.nn.functional.gelu(x, approximate='tanh')

def _silu(x):
    return torch.nn.functional.silu(x)

def _sigmoid(x):
    return torch.sigmoid(x)

def _layernorm(x, axis=-1, eps=1e-05):
    m = x.mean(dim=axis, keepdim=True)
    v = x.var(dim=axis, keepdim=True, unbiased=False)
    return (x - m) / torch.sqrt(v + eps)

def _scatter_add(tgt, idx, src, axis=0):
    return tgt.clone().index_add_(axis, idx, src)

def _segment_sum(src, seg, n):
    out = torch.zeros((n,) + src.shape[1:], dtype=src.dtype)
    return out.index_add_(0, seg, src)

def _pad(x, pw):
    flat = tuple((v for pair in reversed(pw) for v in pair))
    return torch.nn.functional.pad(x, flat)
kernel_name = 'standalone__autoregressive_conv_wavernn__speech'

def setup_inputs():

    _w = lambda a: (lambda t: t.to(torch.bfloat16) if t.is_floating_point() else t)(torch.as_tensor(a))
    B, T, D, K = (2, 16000, 256, 15)
    return {'x': _w((lambda *s: torch.randn(*s, dtype=torch.bfloat16) * 0.1)(B, T, D)), 'w': _w((lambda *s: torch.randn(*s, dtype=torch.bfloat16) * 0.1)(K, D, 2 * D))}

def reference(x, w):
    B, T, D = x.shape
    K = w.shape[0]
    dil = 2
    pad = (K - 1) * dil
    xp = _pad(x, ((0, 0), (pad, 0), (0, 0)))
    h = torch.einsum('btd,de->bte', xp[:, 0:T, :], w[0])
    for i in range(1, K):
        h = h + torch.einsum('btd,de->bte', xp[:, i * dil:i * dil + T, :], w[i])
    f, g = (h[..., :D].clone(), h[..., D:].clone())
    return torch.tanh(f) * _sigmoid(g)
```

```asm
; @launch grid=(256,1,1) block=(256,1,1) lds=163840
.amdgcn_target "amdgcn-amd-amdhsa--gfx950"
.text
.globl standalone__autoregressive_conv_wavernn__speech_kernel
.p2align 8
.type standalone__autoregressive_conv_wavernn__speech_kernel,@function
standalone__autoregressive_conv_wavernn__speech_kernel:
s_cmp_lt_u32 s2, 256
s_cbranch_scc1 Lm_go
s_endpgm
Lm_go:
s_load_dwordx2 s[20:21], s[0:1], 8
s_load_dwordx2 s[4:5], s[0:1], 0
s_load_dwordx2 s[8:9], s[0:1], 32
s_load_dwordx2 s[12:13], s[0:1], 16
s_load_dwordx2 s[34:35], s[0:1], 24
s_memrealtime s[32:33]
v_lshrrev_b32 v215, 6, v0
s_getpc_b64 s[46:47]
Lm_pc:
v_readfirstlane_b32 s17, v215
s_bfe_u32 s18, s2, 0x20003
s_sub_u32 s31, s17, s18
s_and_b32 s31, s31, 3
v_bfe_u32 v216, v0, 2, 4
v_and_b32 v217, 3, v0
s_lshl_b32 s36, s31, 16
v_lshl_add_u32 v244, v216, 9, s36
v_lshl_add_u32 v244, v217, 4, v244
s_mov_b32 s22, 3932160
s_mov_b32 s23, 0x20000
s_lshl_b32 s49, s17, 12
s_cmp_lg_u32 s31, 0
s_cbranch_scc1 Lm_w0
s_and_b32 s36, s2, 3
s_lshl_b32 s36, s36, 7
s_bfe_u32 s37, s2, 0x10003
s_lshl_b32 s37, s37, 6
s_add_u32 s36, s36, s37
s_lshr_b32 s37, s2, 5
s_lshl_b32 s37, s37, 13
s_add_u32 s36, s36, s37
s_and_b32 s37, s2, 4
s_lshl_b32 s37, s37, 18
s_add_u32 s36, s36, s37
s_and_b32 s37, s2, 16
s_lshl_b32 s37, s37, 17
s_add_u32 s36, s36, s37
s_add_u32 m0, s49, 132224
s_waitcnt lgkmcnt(0)
s_nop 0
buffer_load_dwordx4 v244, s[20:23], s36 offen offset:0 lds
s_add_u32 s36, s36, 261120
buffer_load_dwordx4 v244, s[20:23], s36 offen offset:1024 lds
s_add_u32 s36, s36, 261120
buffer_load_dwordx4 v244, s[20:23], s36 offen offset:2048 lds
s_add_u32 s36, s36, 261120
buffer_load_dwordx4 v244, s[20:23], s36 offen offset:3072 lds
s_branch Lm_w01
Lm_w0:
s_cmp_lg_u32 s31, 2
s_cbranch_scc1 Lm_vq
s_lshr_b32 s40, s2, 3
s_mul_i32 s40, s40, 2560
s_add_u32 s40, s40, 8192
v_and_b32 v220, 63, v0
v_min_u32 v220, 39, v220
v_lshl_add_u32 v220, v220, 6, s40
global_load_dword v252, v220, s[46:47]
Lm_vq:
s_cmp_lg_u32 s31, 3
s_cbranch_scc1 Lm_vp
v_and_b32 v220, 63, v0
v_lshlrev_b32 v220, 6, v220
global_load_dword v252, v220, s[46:47] offset:256
v_add_u32 v220, 4096, v220
global_load_dword v252, v220, s[46:47] offset:256
Lm_vp:
s_lshl_b32 s36, s31, 7
s_add_u32 s46, s46, s36
s_addc_u32 s47, s47, 0
s_waitcnt lgkmcnt(0)
s_cmp_lg_u32 s31, 1
s_cbranch_scc1 Lm_w01
v_mov_b32 v245, 0
s_call_b64 s[46:47], Lu_dry
Lm_w01:
s_and_b32 s3, s2, 7
s_lshl_b32 s3, s3, 3
s_lshr_b32 s37, s2, 5
s_add_u32 s3, s3, s37
s_lshr_b32 s48, s3, 5
s_mul_i32 s48, s48, 8192000
s_bfe_u32 s38, s3, 0x10004
s_lshl_b32 s38, s38, 9
s_add_u32 s48, s48, s38
s_and_b32 s16, s3, 15
s_mul_i32 s16, s16, 512000
s_sub_u32 s39, s16, 14336
s_sub_u32 s6, 16384000, s48
s_mov_b32 s7, 0x20000
v_lshrrev_b32 v212, 3, v0
v_and_b32 v213, 7, v0
v_lshlrev_b32 v218, 14, v212
v_lshl_add_u32 v218, v213, 4, v218
v_add_u32 v1, s39, v218
v_add_u32 v2, 2048, v1
v_add_u32 v3, 6144, v1
v_add_u32 v4, 10240, v1
v_add_u32 v5, 14336, v1
v_add_u32 v6, 18432, v1
s_add_u32 s4, s4, s48
s_addc_u32 s5, s5, 0
s_mov_b32 s10, 20348928
s_mov_b32 s11, 0x20000
s_cmp_lg_u32 s31, 2
s_cbranch_scc1 Lm_tl
v_mov_b32 v221, 64
s_mov_b32 s40, 130944
buffer_load_dword v252, off, s[8:11], s40
global_load_dword v252, v221, s[34:35] offset:128 sc1
Lm_tl:
buffer_load_dwordx4 v[20:23], v1, s[4:7], 0 offen offset:1024
buffer_load_dwordx4 v[24:27], v2, s[4:7], 0 offen offset:0
buffer_load_dwordx4 v[28:31], v2, s[4:7], 0 offen offset:1024
buffer_load_dwordx4 v[32:35], v2, s[4:7], 0 offen offset:2048
buffer_load_dwordx4 v[36:39], v2, s[4:7], 0 offen offset:3072
buffer_load_dwordx4 v[40:43], v3, s[4:7], 0 offen offset:0
buffer_load_dwordx4 v[44:47], v3, s[4:7], 0 offen offset:1024
buffer_load_dwordx4 v[48:51], v3, s[4:7], 0 offen offset:2048
buffer_load_dwordx4 v[52:55], v3, s[4:7], 0 offen offset:3072
s_cmp_eq_u32 s31, 0
s_cbranch_scc1 Lm_x0
buffer_load_dwordx4 v[56:59], v4, s[4:7], 0 offen offset:0
buffer_load_dwordx4 v[60:63], v4, s[4:7], 0 offen offset:1024
buffer_load_dwordx4 v[64:67], v4, s[4:7], 0 offen offset:2048
buffer_load_dwordx4 v[68:71], v4, s[4:7], 0 offen offset:3072
buffer_load_dwordx4 v[72:75], v5, s[4:7], 0 offen offset:0
buffer_load_dwordx4 v[76:79], v5, s[4:7], 0 offen offset:1024
buffer_load_dwordx4 v[80:83], v5, s[4:7], 0 offen offset:2048
buffer_load_dwordx4 v[148:151], v5, s[4:7], 0 offen offset:3072
s_and_b32 s36, s2, 3
s_lshl_b32 s36, s36, 7
s_bfe_u32 s37, s2, 0x10003
s_lshl_b32 s37, s37, 6
s_add_u32 s36, s36, s37
s_lshr_b32 s37, s2, 5
s_lshl_b32 s37, s37, 13
s_add_u32 s36, s36, s37
s_and_b32 s37, s2, 4
s_lshl_b32 s37, s37, 18
s_add_u32 s36, s36, s37
s_and_b32 s37, s2, 16
s_lshl_b32 s37, s37, 17
s_add_u32 s36, s36, s37
s_add_u32 m0, s49, 132224
s_nop 0
buffer_load_dwordx4 v244, s[20:23], s36 offen offset:0 lds
s_add_u32 s36, s36, 261120
buffer_load_dwordx4 v244, s[20:23], s36 offen offset:1024 lds
s_add_u32 s36, s36, 261120
buffer_load_dwordx4 v244, s[20:23], s36 offen offset:2048 lds
s_add_u32 s36, s36, 261120
buffer_load_dwordx4 v244, s[20:23], s36 offen offset:3072 lds
Lm_x0:
v_and_b32 v214, 63, v0
v_lshrrev_b32 v216, 5, v214
v_and_b32 v218, 15, v0
v_bfe_u32 v219, v0, 4, 2
v_bfe_u32 v220, v0, 4, 1
v_lshl_add_u32 v220, v220, 1, v216
v_mul_u32_u24 v255, 33792, v220
v_lshl_add_u32 v255, v218, 4, v255
v_cvt_f32_u32 v221, v216
v_add_f32 v221, -2.0, v221
v_mul_f32 v236, 0xbee3aa86, v221
v_mul_f32 v237, 0xbe465919, v221
v_mul_f32 v238, 0x3f9ac777, v221
v_mul_f32 v239, 0x3f4eec22, v221
v_mul_f32 v240, 0x3cf64896, v221
v_mul_f32 v241, 0x40800000, v221
v_mul_f32 v242, 0xc0800000, v221
v_bfe_u32 v220, v0, 2, 2
v_lshlrev_b32 v245, 12, v215
v_lshl_add_u32 v245, v220, 7, v245
v_lshl_add_u32 v245, v219, 5, v245
v_lshl_add_u32 v245, v217, 3, v245
v_add_u32 v245, 132224, v245
v_mov_b32 v250, 0
s_mov_b32 s50, 0xffff0000
s_mov_b32 s51, 0xc0317218
s_mov_b32 s52, 0xbf9813a9
s_mov_b32 s53, 0xbf8b851f
s_mov_b32 s54, 0xbf0d0c9b
s_mov_b32 s55, 0x3eb8aa3b
s_mov_b32 s56, 0xbfbeef1b
s_mov_b32 s57, 0x3f09bad2
s_mov_b32 s58, 0xbeb8aa3b
s_mov_b32 s59, 0xbe053526
s_mov_b32 s60, 0xbe9b6dc6
s_mov_b32 s61, 0x3f9813a9
s_mov_b32 s62, 0x3f0d0c9b
s_mov_b32 s63, 0x3e2b463b
s_mov_b32 s64, 0x3f8b851f
s_mov_b32 s65, 0x3e9b6dc6
s_mov_b32 s66, 0x3f6adcc5
s_mov_b32 s67, 0x41f00000
s_mov_b32 s68, 0x40317218
s_mov_b32 s69, 0x40f5fdf0
s_and_b32 s36, s2, 3
s_lshl_b32 s36, s36, 1
s_bfe_u32 s37, s2, 0x10003
s_add_u32 s36, s36, s37
s_mul_i32 s36, s36, 135168
s_bfe_u32 s37, s2, 0x20005
s_lshl_b32 s37, s37, 8
s_add_u32 s36, s36, s37
s_and_b32 s37, s2, 4
s_lshl_b32 s37, s37, 8
s_add_u32 s36, s36, s37
s_and_b32 s37, s2, 16
s_lshl_b32 s37, s37, 7
s_add_u32 s36, s36, s37
s_lshr_b32 s37, s2, 7
s_mul_i32 s39, s31, 1081344
s_mul_i32 s40, s37, 4096
s_add_u32 s39, s39, s40
s_add_u32 s39, s39, s36
s_add_u32 s24, s39, 131072
s_add_u32 s25, s39, 139264
s_add_u32 s26, s39, 147456
s_add_u32 s27, s39, 155648
s_mul_i32 s39, s31, 8192
s_mul_i32 s40, s37, 4096
s_add_u32 s39, s39, s40
s_add_u32 s39, s39, s36
s_add_u32 s28, s39, 4456448
s_add_u32 s29, s39, 5537792
s_mul_i32 s39, s31, 6144
s_mul_i32 s40, s37, 3072
s_add_u32 s39, s39, s40
s_add_u32 s39, s39, s36
s_add_u32 s30, s39, 6619136
s_and_b32 s37, s2, 20
s_cmp_eq_u32 s37, 20
s_cselect_b32 s30, 0x40000000, s30
s_or_b32 s36, s2, s17
s_cmp_lg_u32 s36, 0
s_cbranch_scc1 Lm_nn
s_or_b32 s32, s32, 1
v_mov_b32 v248, s32
v_mov_b32 v249, s33
s_mov_b64 exec, 1
global_store_dwordx2 v250, v[248:249], s[34:35] sc1
s_mov_b64 exec, -1
Lm_nn:
s_mov_b32 s19, 0
s_cmp_lg_u32 s31, 0
s_cbranch_scc1 Lm_r0
s_waitcnt vmcnt(9)
s_call_b64 s[46:47], Lu_sub
buffer_store_dwordx4 v[108:111], v255, s[8:11], s24 offen sc1
buffer_store_dwordx4 v[112:115], v255, s[8:11], s25 offen sc1
buffer_store_dwordx4 v[116:119], v255, s[8:11], s26 offen sc1
buffer_store_dwordx4 v[120:123], v255, s[8:11], s27 offen sc1
global_load_dwordx2 v[248:249], v250, s[34:35] sc1
s_branch Lm_r0
Lu_sub:
ds_read_b64_tr_b16 v[92:93], v245 offset:0
ds_read_b64_tr_b16 v[96:97], v245 offset:1024
ds_read_b64_tr_b16 v[100:101], v245 offset:2048
ds_read_b64_tr_b16 v[104:105], v245 offset:3072
ds_read_b64_tr_b16 v[94:95], v245 offset:512
ds_read_b64_tr_b16 v[98:99], v245 offset:1536
ds_read_b64_tr_b16 v[102:103], v245 offset:2560
ds_read_b64_tr_b16 v[106:107], v245 offset:3584
s_waitcnt lgkmcnt(0)
Lu_dry:
v_lshlrev_b32 v90, 16, v104
v_and_b32 v91, s50, v104
v_lshlrev_b32 v88, 16, v100
v_and_b32 v89, s50, v100
v_lshlrev_b32 v86, 16, v96
v_and_b32 v87, s50, v96
v_lshlrev_b32 v84, 16, v92
v_and_b32 v85, s50, v92
v_pk_fma_f32 v[136:137], v[88:89], s[52:53], v[84:85] op_sel:[0,0,0] op_sel_hi:[1,0,1] neg_lo:[1,0,0] neg_hi:[1,0,0]
v_pk_fma_f32 v[138:139], v[90:91], s[52:53], v[86:87] op_sel:[0,0,0] op_sel_hi:[1,0,1] neg_lo:[1,0,0] neg_hi:[1,0,0]
v_pk_fma_f32 v[140:141], v[138:139], s[52:53], v[136:137] op_sel:[0,1,0] op_sel_hi:[1,1,1] neg_lo:[1,0,0] neg_hi:[1,0,0]
v_pk_fma_f32 v[142:143], v[138:139], s[52:53], v[136:137] op_sel:[0,1,0] op_sel_hi:[1,1,1] neg_lo:[0,0,0] neg_hi:[0,0,0]
v_pk_mul_f32 v[146:147], v[140:141], v[236:237] op_sel:[0,0] op_sel_hi:[1,0]
v_cvt_pk_bf16_f32 v108, v146, v147
v_pk_mul_f32 v[146:147], v[142:143], v[236:237] op_sel:[0,1] op_sel_hi:[1,1]
v_cvt_pk_bf16_f32 v112, v146, v147
v_pk_fma_f32 v[136:137], v[88:89], s[60:61], v[84:85] op_sel:[0,0,0] op_sel_hi:[1,0,1] neg_lo:[1,0,0] neg_hi:[1,0,0]
v_pk_fma_f32 v[138:139], v[90:91], s[60:61], v[86:87] op_sel:[0,0,0] op_sel_hi:[1,0,1] neg_lo:[1,0,0] neg_hi:[1,0,0]
v_pk_fma_f32 v[140:141], v[138:139], s[54:55], v[136:137] op_sel:[0,0,0] op_sel_hi:[1,0,1] neg_lo:[1,0,0] neg_hi:[1,0,0]
v_pk_fma_f32 v[142:143], v[138:139], s[54:55], v[136:137] op_sel:[0,0,0] op_sel_hi:[1,0,1] neg_lo:[0,0,0] neg_hi:[0,0,0]
v_pk_mul_f32 v[146:147], v[140:141], v[238:239] op_sel:[0,0] op_sel_hi:[1,0]
v_cvt_pk_bf16_f32 v116, v146, v147
v_pk_mul_f32 v[146:147], v[142:143], v[238:239] op_sel:[0,1] op_sel_hi:[1,1]
v_cvt_pk_bf16_f32 v120, v146, v147
v_pk_fma_f32 v[144:145], v[90:91], s[50:51], v[88:89] op_sel:[0,1,0] op_sel_hi:[1,1,1] neg_lo:[1,0,0] neg_hi:[1,0,0]
v_pk_fma_f32 v[144:145], v[144:145], s[50:51], v[86:87] op_sel:[0,1,0] op_sel_hi:[1,1,1] neg_lo:[1,0,0] neg_hi:[1,0,0]
v_pk_fma_f32 v[144:145], v[144:145], s[50:51], v[84:85] op_sel:[0,1,0] op_sel_hi:[1,1,1] neg_lo:[1,0,0] neg_hi:[1,0,0]
v_pk_mul_f32 v[146:147], v[144:145], v[240:241] op_sel:[0,0] op_sel_hi:[1,0]
v_cvt_pk_bf16_f32 v124, v146, v147
v_pk_mul_f32 v[146:147], v[84:85], v[240:241] op_sel:[0,1] op_sel_hi:[1,1]
v_cvt_pk_bf16_f32 v128, v146, v147
v_pk_mul_f32 v[146:147], v[90:91], v[242:243] op_sel:[0,0] op_sel_hi:[1,0]
v_cvt_pk_bf16_f32 v132, v146, v147
v_lshlrev_b32 v90, 16, v105
v_and_b32 v91, s50, v105
v_lshlrev_b32 v88, 16, v101
v_and_b32 v89, s50, v101
v_lshlrev_b32 v86, 16, v97
v_and_b32 v87, s50, v97
v_lshlrev_b32 v84, 16, v93
v_and_b32 v85, s50, v93
v_pk_fma_f32 v[136:137], v[88:89], s[52:53], v[84:85] op_sel:[0,0,0] op_sel_hi:[1,0,1] neg_lo:[1,0,0] neg_hi:[1,0,0]
v_pk_fma_f32 v[138:139], v[90:91], s[52:53], v[86:87] op_sel:[0,0,0] op_sel_hi:[1,0,1] neg_lo:[1,0,0] neg_hi:[1,0,0]
v_pk_fma_f32 v[140:141], v[138:139], s[52:53], v[136:137] op_sel:[0,1,0] op_sel_hi:[1,1,1] neg_lo:[1,0,0] neg_hi:[1,0,0]
v_pk_fma_f32 v[142:143], v[138:139], s[52:53], v[136:137] op_sel:[0,1,0] op_sel_hi:[1,1,1] neg_lo:[0,0,0] neg_hi:[0,0,0]
v_pk_mul_f32 v[146:147], v[140:141], v[236:237] op_sel:[0,0] op_sel_hi:[1,0]
v_cvt_pk_bf16_f32 v109, v146, v147
v_pk_mul_f32 v[146:147], v[142:143], v[236:237] op_sel:[0,1] op_sel_hi:[1,1]
v_cvt_pk_bf16_f32 v113, v146, v147
v_pk_fma_f32 v[136:137], v[88:89], s[60:61], v[84:85] op_sel:[0,0,0] op_sel_hi:[1,0,1] neg_lo:[1,0,0] neg_hi:[1,0,0]
v_pk_fma_f32 v[138:139], v[90:91], s[60:61], v[86:87] op_sel:[0,0,0] op_sel_hi:[1,0,1] neg_lo:[1,0,0] neg_hi:[1,0,0]
v_pk_fma_f32 v[140:141], v[138:139], s[54:55], v[136:137] op_sel:[0,0,0] op_sel_hi:[1,0,1] neg_lo:[1,0,0] neg_hi:[1,0,0]
v_pk_fma_f32 v[142:143], v[138:139], s[54:55], v[136:137] op_sel:[0,0,0] op_sel_hi:[1,0,1] neg_lo:[0,0,0] neg_hi:[0,0,0]
v_pk_mul_f32 v[146:147], v[140:141], v[238:239] op_sel:[0,0] op_sel_hi:[1,0]
v_cvt_pk_bf16_f32 v117, v146, v147
v_pk_mul_f32 v[146:147], v[142:143], v[238:239] op_sel:[0,1] op_sel_hi:[1,1]
v_cvt_pk_bf16_f32 v121, v146, v147
v_pk_fma_f32 v[144:145], v[90:91], s[50:51], v[88:89] op_sel:[0,1,0] op_sel_hi:[1,1,1] neg_lo:[1,0,0] neg_hi:[1,0,0]
v_pk_fma_f32 v[144:145], v[144:145], s[50:51], v[86:87] op_sel:[0,1,0] op_sel_hi:[1,1,1] neg_lo:[1,0,0] neg_hi:[1,0,0]
v_pk_fma_f32 v[144:145], v[144:145], s[50:51], v[84:85] op_sel:[0,1,0] op_sel_hi:[1,1,1] neg_lo:[1,0,0] neg_hi:[1,0,0]
v_pk_mul_f32 v[146:147], v[144:145], v[240:241] op_sel:[0,0] op_sel_hi:[1,0]
v_cvt_pk_bf16_f32 v125, v146, v147
v_pk_mul_f32 v[146:147], v[84:85], v[240:241] op_sel:[0,1] op_sel_hi:[1,1]
v_cvt_pk_bf16_f32 v129, v146, v147
v_pk_mul_f32 v[146:147], v[90:91], v[242:243] op_sel:[0,0] op_sel_hi:[1,0]
v_cvt_pk_bf16_f32 v133, v146, v147
v_lshlrev_b32 v90, 16, v106
v_and_b32 v91, s50, v106
v_lshlrev_b32 v88, 16, v102
v_and_b32 v89, s50, v102
v_lshlrev_b32 v86, 16, v98
v_and_b32 v87, s50, v98
v_lshlrev_b32 v84, 16, v94
v_and_b32 v85, s50, v94
v_pk_fma_f32 v[136:137], v[88:89], s[52:53], v[84:85] op_sel:[0,0,0] op_sel_hi:[1,0,1] neg_lo:[1,0,0] neg_hi:[1,0,0]
v_pk_fma_f32 v[138:139], v[90:91], s[52:53], v[86:87] op_sel:[0,0,0] op_sel_hi:[1,0,1] neg_lo:[1,0,0] neg_hi:[1,0,0]
v_pk_fma_f32 v[140:141], v[138:139], s[52:53], v[136:137] op_sel:[0,1,0] op_sel_hi:[1,1,1] neg_lo:[1,0,0] neg_hi:[1,0,0]
v_pk_fma_f32 v[142:143], v[138:139], s[52:53], v[136:137] op_sel:[0,1,0] op_sel_hi:[1,1,1] neg_lo:[0,0,0] neg_hi:[0,0,0]
v_pk_mul_f32 v[146:147], v[140:141], v[236:237] op_sel:[0,0] op_sel_hi:[1,0]
v_cvt_pk_bf16_f32 v110, v146, v147
v_pk_mul_f32 v[146:147], v[142:143], v[236:237] op_sel:[0,1] op_sel_hi:[1,1]
v_cvt_pk_bf16_f32 v114, v146, v147
v_pk_fma_f32 v[136:137], v[88:89], s[60:61], v[84:85] op_sel:[0,0,0] op_sel_hi:[1,0,1] neg_lo:[1,0,0] neg_hi:[1,0,0]
v_pk_fma_f32 v[138:139], v[90:91], s[60:61], v[86:87] op_sel:[0,0,0] op_sel_hi:[1,0,1] neg_lo:[1,0,0] neg_hi:[1,0,0]
v_pk_fma_f32 v[140:141], v[138:139], s[54:55], v[136:137] op_sel:[0,0,0] op_sel_hi:[1,0,1] neg_lo:[1,0,0] neg_hi:[1,0,0]
v_pk_fma_f32 v[142:143], v[138:139], s[54:55], v[136:137] op_sel:[0,0,0] op_sel_hi:[1,0,1] neg_lo:[0,0,0] neg_hi:[0,0,0]
v_pk_mul_f32 v[146:147], v[140:141], v[238:239] op_sel:[0,0] op_sel_hi:[1,0]
v_cvt_pk_bf16_f32 v118, v146, v147
v_pk_mul_f32 v[146:147], v[142:143], v[238:239] op_sel:[0,1] op_sel_hi:[1,1]
v_cvt_pk_bf16_f32 v122, v146, v147
v_pk_fma_f32 v[144:145], v[90:91], s[50:51], v[88:89] op_sel:[0,1,0] op_sel_hi:[1,1,1] neg_lo:[1,0,0] neg_hi:[1,0,0]
v_pk_fma_f32 v[144:145], v[144:145], s[50:51], v[86:87] op_sel:[0,1,0] op_sel_hi:[1,1,1] neg_lo:[1,0,0] neg_hi:[1,0,0]
v_pk_fma_f32 v[144:145], v[144:145], s[50:51], v[84:85] op_sel:[0,1,0] op_sel_hi:[1,1,1] neg_lo:[1,0,0] neg_hi:[1,0,0]
v_pk_mul_f32 v[146:147], v[144:145], v[240:241] op_sel:[0,0] op_sel_hi:[1,0]
v_cvt_pk_bf16_f32 v126, v146, v147
v_pk_mul_f32 v[146:147], v[84:85], v[240:241] op_sel:[0,1] op_sel_hi:[1,1]
v_cvt_pk_bf16_f32 v130, v146, v147
v_pk_mul_f32 v[146:147], v[90:91], v[242:243] op_sel:[0,0] op_sel_hi:[1,0]
v_cvt_pk_bf16_f32 v134, v146, v147
v_lshlrev_b32 v90, 16, v107
v_and_b32 v91, s50, v107
v_lshlrev_b32 v88, 16, v103
v_and_b32 v89, s50, v103
v_lshlrev_b32 v86, 16, v99
v_and_b32 v87, s50, v99
v_lshlrev_b32 v84, 16, v95
v_and_b32 v85, s50, v95
v_pk_fma_f32 v[136:137], v[88:89], s[52:53], v[84:85] op_sel:[0,0,0] op_sel_hi:[1,0,1] neg_lo:[1,0,0] neg_hi:[1,0,0]
v_pk_fma_f32 v[138:139], v[90:91], s[52:53], v[86:87] op_sel:[0,0,0] op_sel_hi:[1,0,1] neg_lo:[1,0,0] neg_hi:[1,0,0]
v_pk_fma_f32 v[140:141], v[138:139], s[52:53], v[136:137] op_sel:[0,1,0] op_sel_hi:[1,1,1] neg_lo:[1,0,0] neg_hi:[1,0,0]
v_pk_fma_f32 v[142:143], v[138:139], s[52:53], v[136:137] op_sel:[0,1,0] op_sel_hi:[1,1,1] neg_lo:[0,0,0] neg_hi:[0,0,0]
v_pk_mul_f32 v[146:147], v[140:141], v[236:237] op_sel:[0,0] op_sel_hi:[1,0]
v_cvt_pk_bf16_f32 v111, v146, v147
v_pk_mul_f32 v[146:147], v[142:143], v[236:237] op_sel:[0,1] op_sel_hi:[1,1]
v_cvt_pk_bf16_f32 v115, v146, v147
v_pk_fma_f32 v[136:137], v[88:89], s[60:61], v[84:85] op_sel:[0,0,0] op_sel_hi:[1,0,1] neg_lo:[1,0,0] neg_hi:[1,0,0]
v_pk_fma_f32 v[138:139], v[90:91], s[60:61], v[86:87] op_sel:[0,0,0] op_sel_hi:[1,0,1] neg_lo:[1,0,0] neg_hi:[1,0,0]
v_pk_fma_f32 v[140:141], v[138:139], s[54:55], v[136:137] op_sel:[0,0,0] op_sel_hi:[1,0,1] neg_lo:[1,0,0] neg_hi:[1,0,0]
v_pk_fma_f32 v[142:143], v[138:139], s[54:55], v[136:137] op_sel:[0,0,0] op_sel_hi:[1,0,1] neg_lo:[0,0,0] neg_hi:[0,0,0]
v_pk_mul_f32 v[146:147], v[140:141], v[238:239] op_sel:[0,0] op_sel_hi:[1,0]
v_cvt_pk_bf16_f32 v119, v146, v147
v_pk_mul_f32 v[146:147], v[142:143], v[238:239] op_sel:[0,1] op_sel_hi:[1,1]
v_cvt_pk_bf16_f32 v123, v146, v147
v_pk_fma_f32 v[144:145], v[90:91], s[50:51], v[88:89] op_sel:[0,1,0] op_sel_hi:[1,1,1] neg_lo:[1,0,0] neg_hi:[1,0,0]
v_pk_fma_f32 v[144:145], v[144:145], s[50:51], v[86:87] op_sel:[0,1,0] op_sel_hi:[1,1,1] neg_lo:[1,0,0] neg_hi:[1,0,0]
v_pk_fma_f32 v[144:145], v[144:145], s[50:51], v[84:85] op_sel:[0,1,0] op_sel_hi:[1,1,1] neg_lo:[1,0,0] neg_hi:[1,0,0]
v_pk_mul_f32 v[146:147], v[144:145], v[240:241] op_sel:[0,0] op_sel_hi:[1,0]
v_cvt_pk_bf16_f32 v127, v146, v147
v_pk_mul_f32 v[146:147], v[84:85], v[240:241] op_sel:[0,1] op_sel_hi:[1,1]
v_cvt_pk_bf16_f32 v131, v146, v147
v_pk_mul_f32 v[146:147], v[90:91], v[242:243] op_sel:[0,0] op_sel_hi:[1,0]
v_cvt_pk_bf16_f32 v135, v146, v147
s_setpc_b64 s[46:47]
Lm_r0:
s_add_u32 s12, s12, s48
s_addc_u32 s13, s13, 0
s_add_u32 s14, s16, 511488
s_mov_b32 s15, 0x20000
s_lshl_b32 s40, s3, 9
s_add_u32 s40, s40, 65536
v_lshl_add_u32 v19, v217, 7, s40
s_mul_i32 s3, s3, 197632
s_add_u32 s3, s3, 7700480
s_lshl_b32 s39, s18, 7
s_add_u32 s39, s39, s16
v_bfe_u32 v220, v0, 3, 3
v_xor_b32 v17, v220, v213
v_lshlrev_b32 v17, 4, v17
v_bfe_u32 v220, v0, 3, 4
v_lshl_add_u32 v17, v220, 15, v17
v_lshrrev_b32 v220, 7, v0
v_lshl_add_u32 v17, v220, 12, v17
v_add_u32 v17, s39, v17
v_mul_u32_u24 v15, 2064, v219
v_lshl_add_u32 v15, v218, 5, v15
v_add_u32 v16, 66048, v15
v_mul_u32_u24 v7, 2064, v213
v_and_b32 v220, 1, v212
v_lshl_add_u32 v7, v220, 10, v7
v_lshrrev_b32 v221, 1, v212
v_lshl_add_u32 v7, v221, 5, v7
v_add_u32 v8, 66048, v7
s_lshl_b32 s39, s18, 12
v_add_u32 v9, s39, v1
v_add_u32 v10, s39, v2
v_add_u32 v11, s39, v3
v_lshrrev_b32 v12, 2, v212
v_xor_b32 v12, v12, v213
v_lshlrev_b32 v12, 4, v12
v_lshl_add_u32 v12, v221, 7, v12
v_lshl_add_u32 v12, v220, 13, v12
s_lshl_b32 s39, s18, 11
v_add_u32 v12, s39, v12
v_lshl_add_u32 v18, v214, 4, s49
s_lshl_b32 s39, s18, 2
v_add_u32 v220, s39, v215
v_mul_u32_u24 v220, 67584, v220
v_lshl_add_u32 v13, v214, 4, v220
v_add_u32 v14, 33792, v13
s_lshl_b32 s39, s18, 13
s_add_u32 s39, s39, 0
v_lshl_add_u32 v254, v214, 7, s39
s_mov_b32 s16, 131072
v_lshl_add_u32 v251, v215, 2, 0
v_add_u32 v251, 132160, v251
ds_write_b32 v251, v250
s_waitcnt vmcnt(13)
v_lshlrev_b32 v212, 16, v20
v_and_b32 v213, s50, v20
s_waitcnt vmcnt(12)
v_lshlrev_b32 v214, 16, v24
v_and_b32 v215, s50, v24
s_waitcnt vmcnt(11)
v_lshlrev_b32 v216, 16, v28
v_and_b32 v217, s50, v28
s_waitcnt vmcnt(10)
v_lshlrev_b32 v218, 16, v32
v_and_b32 v219, s50, v32
s_waitcnt vmcnt(9)
v_lshlrev_b32 v220, 16, v36
v_and_b32 v221, s50, v36
v_pk_fma_f32 v[222:223], v[218:219], s[50:51], v[220:221] op_sel:[0,1,0] op_sel_hi:[1,1,1] neg_lo:[0,0,0] neg_hi:[0,0,0]
v_pk_fma_f32 v[218:219], v[216:217], s[50:51], v[218:219] op_sel:[0,1,0] op_sel_hi:[1,1,1] neg_lo:[0,0,0] neg_hi:[0,0,0]
v_pk_fma_f32 v[216:217], v[214:215], s[50:51], v[216:217] op_sel:[0,1,0] op_sel_hi:[1,1,1] neg_lo:[0,0,0] neg_hi:[0,0,0]
v_pk_fma_f32 v[214:215], v[212:213], s[50:51], v[214:215] op_sel:[0,1,0] op_sel_hi:[1,1,1] neg_lo:[0,0,0] neg_hi:[0,0,0]
v_pk_fma_f32 v[212:213], v[214:215], s[60:61], v[218:219] op_sel:[0,0,0] op_sel_hi:[1,0,1] neg_lo:[0,0,0] neg_hi:[0,0,0]
v_pk_fma_f32 v[224:225], v[216:217], s[60:61], v[222:223] op_sel:[0,0,0] op_sel_hi:[1,0,1] neg_lo:[0,0,0] neg_hi:[0,0,0]
v_pk_fma_f32 v[218:219], v[214:215], s[52:53], v[218:219] op_sel:[0,0,0] op_sel_hi:[1,0,1] neg_lo:[0,0,0] neg_hi:[0,0,0]
v_pk_fma_f32 v[222:223], v[216:217], s[52:53], v[222:223] op_sel:[0,0,0] op_sel_hi:[1,0,1] neg_lo:[0,0,0] neg_hi:[0,0,0]
v_pk_fma_f32 v[214:215], v[212:213], s[52:53], v[224:225] op_sel:[0,1,0] op_sel_hi:[1,1,1] neg_lo:[1,0,0] neg_hi:[1,0,0]
v_pk_fma_f32 v[224:225], v[212:213], s[52:53], v[224:225] op_sel:[0,1,0] op_sel_hi:[1,1,1] neg_lo:[0,0,0] neg_hi:[0,0,0]
v_pk_fma_f32 v[216:217], v[218:219], s[54:55], v[222:223] op_sel:[0,0,0] op_sel_hi:[1,0,1] neg_lo:[1,0,0] neg_hi:[1,0,0]
v_pk_fma_f32 v[222:223], v[218:219], s[54:55], v[222:223] op_sel:[0,0,0] op_sel_hi:[1,0,1] neg_lo:[0,0,0] neg_hi:[0,0,0]
v_cvt_pk_bf16_f32 v196, v214, v215
v_cvt_pk_bf16_f32 v200, v224, v225
v_cvt_pk_bf16_f32 v204, v216, v217
v_cvt_pk_bf16_f32 v208, v222, v223
v_lshlrev_b32 v226, 16, v21
v_and_b32 v227, s50, v21
v_lshlrev_b32 v228, 16, v25
v_and_b32 v229, s50, v25
v_lshlrev_b32 v230, 16, v29
v_and_b32 v231, s50, v29
v_lshlrev_b32 v232, 16, v33
v_and_b32 v233, s50, v33
v_lshlrev_b32 v234, 16, v37
v_and_b32 v235, s50, v37
v_pk_fma_f32 v[212:213], v[232:233], s[50:51], v[234:235] op_sel:[0,1,0] op_sel_hi:[1,1,1] neg_lo:[0,0,0] neg_hi:[0,0,0]
v_pk_fma_f32 v[232:233], v[230:231], s[50:51], v[232:233] op_sel:[0,1,0] op_sel_hi:[1,1,1] neg_lo:[0,0,0] neg_hi:[0,0,0]
v_pk_fma_f32 v[230:231], v[228:229], s[50:51], v[230:231] op_sel:[0,1,0] op_sel_hi:[1,1,1] neg_lo:[0,0,0] neg_hi:[0,0,0]
v_pk_fma_f32 v[228:229], v[226:227], s[50:51], v[228:229] op_sel:[0,1,0] op_sel_hi:[1,1,1] neg_lo:[0,0,0] neg_hi:[0,0,0]
v_pk_fma_f32 v[226:227], v[228:229], s[60:61], v[232:233] op_sel:[0,0,0] op_sel_hi:[1,0,1] neg_lo:[0,0,0] neg_hi:[0,0,0]
v_pk_fma_f32 v[218:219], v[230:231], s[60:61], v[212:213] op_sel:[0,0,0] op_sel_hi:[1,0,1] neg_lo:[0,0,0] neg_hi:[0,0,0]
v_pk_fma_f32 v[232:233], v[228:229], s[52:53], v[232:233] op_sel:[0,0,0] op_sel_hi:[1,0,1] neg_lo:[0,0,0] neg_hi:[0,0,0]
v_pk_fma_f32 v[212:213], v[230:231], s[52:53], v[212:213] op_sel:[0,0,0] op_sel_hi:[1,0,1] neg_lo:[0,0,0] neg_hi:[0,0,0]
v_pk_fma_f32 v[228:229], v[226:227], s[52:53], v[218:219] op_sel:[0,1,0] op_sel_hi:[1,1,1] neg_lo:[1,0,0] neg_hi:[1,0,0]
v_pk_fma_f32 v[218:219], v[226:227], s[52:53], v[218:219] op_sel:[0,1,0] op_sel_hi:[1,1,1] neg_lo:[0,0,0] neg_hi:[0,0,0]
v_pk_fma_f32 v[230:231], v[232:233], s[54:55], v[212:213] op_sel:[0,0,0] op_sel_hi:[1,0,1] neg_lo:[1,0,0] neg_hi:[1,0,0]
v_pk_fma_f32 v[212:213], v[232:233], s[54:55], v[212:213] op_sel:[0,0,0] op_sel_hi:[1,0,1] neg_lo:[0,0,0] neg_hi:[0,0,0]
v_cvt_pk_bf16_f32 v197, v228, v229
v_cvt_pk_bf16_f32 v201, v218, v219
v_cvt_pk_bf16_f32 v205, v230, v231
v_cvt_pk_bf16_f32 v209, v212, v213
v_lshlrev_b32 v214, 16, v22
v_and_b32 v215, s50, v22
v_lshlrev_b32 v224, 16, v26
v_and_b32 v225, s50, v26
v_lshlrev_b32 v216, 16, v30
v_and_b32 v217, s50, v30
v_lshlrev_b32 v222, 16, v34
v_and_b32 v223, s50, v34
v_lshlrev_b32 v226, 16, v38
v_and_b32 v227, s50, v38
v_pk_fma_f32 v[232:233], v[222:223], s[50:51], v[226:227] op_sel:[0,1,0] op_sel_hi:[1,1,1] neg_lo:[0,0,0] neg_hi:[0,0,0]
v_pk_fma_f32 v[222:223], v[216:217], s[50:51], v[222:223] op_sel:[0,1,0] op_sel_hi:[1,1,1] neg_lo:[0,0,0] neg_hi:[0,0,0]
v_pk_fma_f32 v[216:217], v[224:225], s[50:51], v[216:217] op_sel:[0,1,0] op_sel_hi:[1,1,1] neg_lo:[0,0,0] neg_hi:[0,0,0]
v_pk_fma_f32 v[224:225], v[214:215], s[50:51], v[224:225] op_sel:[0,1,0] op_sel_hi:[1,1,1] neg_lo:[0,0,0] neg_hi:[0,0,0]
v_pk_fma_f32 v[214:215], v[224:225], s[60:61], v[222:223] op_sel:[0,0,0] op_sel_hi:[1,0,1] neg_lo:[0,0,0] neg_hi:[0,0,0]
v_pk_fma_f32 v[228:229], v[216:217], s[60:61], v[232:233] op_sel:[0,0,0] op_sel_hi:[1,0,1] neg_lo:[0,0,0] neg_hi:[0,0,0]
v_pk_fma_f32 v[222:223], v[224:225], s[52:53], v[222:223] op_sel:[0,0,0] op_sel_hi:[1,0,1] neg_lo:[0,0,0] neg_hi:[0,0,0]
v_pk_fma_f32 v[232:233], v[216:217], s[52:53], v[232:233] op_sel:[0,0,0] op_sel_hi:[1,0,1] neg_lo:[0,0,0] neg_hi:[0,0,0]
v_pk_fma_f32 v[224:225], v[214:215], s[52:53], v[228:229] op_sel:[0,1,0] op_sel_hi:[1,1,1] neg_lo:[1,0,0] neg_hi:[1,0,0]
v_pk_fma_f32 v[228:229], v[214:215], s[52:53], v[228:229] op_sel:[0,1,0] op_sel_hi:[1,1,1] neg_lo:[0,0,0] neg_hi:[0,0,0]
v_pk_fma_f32 v[216:217], v[222:223], s[54:55], v[232:233] op_sel:[0,0,0] op_sel_hi:[1,0,1] neg_lo:[1,0,0] neg_hi:[1,0,0]
v_pk_fma_f32 v[232:233], v[222:223], s[54:55], v[232:233] op_sel:[0,0,0] op_sel_hi:[1,0,1] neg_lo:[0,0,0] neg_hi:[0,0,0]
v_cvt_pk_bf16_f32 v198, v224, v225
v_cvt_pk_bf16_f32 v202, v228, v229
v_cvt_pk_bf16_f32 v206, v216, v217
v_cvt_pk_bf16_f32 v210, v232, v233
v_lshlrev_b32 v218, 16, v23
v_and_b32 v219, s50, v23
v_lshlrev_b32 v230, 16, v27
v_and_b32 v231, s50, v27
v_lshlrev_b32 v212, 16, v31
v_and_b32 v213, s50, v31
v_lshlrev_b32 v214, 16, v35
v_and_b32 v215, s50, v35
v_lshlrev_b32 v222, 16, v39
v_and_b32 v223, s50, v39
v_pk_fma_f32 v[224:225], v[214:215], s[50:51], v[222:223] op_sel:[0,1,0] op_sel_hi:[1,1,1] neg_lo:[0,0,0] neg_hi:[0,0,0]
v_pk_fma_f32 v[214:215], v[212:213], s[50:51], v[214:215] op_sel:[0,1,0] op_sel_hi:[1,1,1] neg_lo:[0,0,0] neg_hi:[0,0,0]
v_pk_fma_f32 v[212:213], v[230:231], s[50:51], v[212:213] op_sel:[0,1,0] op_sel_hi:[1,1,1] neg_lo:[0,0,0] neg_hi:[0,0,0]
v_pk_fma_f32 v[230:231], v[218:219], s[50:51], v[230:231] op_sel:[0,1,0] op_sel_hi:[1,1,1] neg_lo:[0,0,0] neg_hi:[0,0,0]
v_pk_fma_f32 v[218:219], v[230:231], s[60:61], v[214:215] op_sel:[0,0,0] op_sel_hi:[1,0,1] neg_lo:[0,0,0] neg_hi:[0,0,0]
v_pk_fma_f32 v[228:229], v[212:213], s[60:61], v[224:225] op_sel:[0,0,0] op_sel_hi:[1,0,1] neg_lo:[0,0,0] neg_hi:[0,0,0]
v_pk_fma_f32 v[214:215], v[230:231], s[52:53], v[214:215] op_sel:[0,0,0] op_sel_hi:[1,0,1] neg_lo:[0,0,0] neg_hi:[0,0,0]
v_pk_fma_f32 v[224:225], v[212:213], s[52:53], v[224:225] op_sel:[0,0,0] op_sel_hi:[1,0,1] neg_lo:[0,0,0] neg_hi:[0,0,0]
v_pk_fma_f32 v[230:231], v[218:219], s[52:53], v[228:229] op_sel:[0,1,0] op_sel_hi:[1,1,1] neg_lo:[1,0,0] neg_hi:[1,0,0]
v_pk_fma_f32 v[228:229], v[218:219], s[52:53], v[228:229] op_sel:[0,1,0] op_sel_hi:[1,1,1] neg_lo:[0,0,0] neg_hi:[0,0,0]
v_pk_fma_f32 v[212:213], v[214:215], s[54:55], v[224:225] op_sel:[0,0,0] op_sel_hi:[1,0,1] neg_lo:[1,0,0] neg_hi:[1,0,0]
v_pk_fma_f32 v[224:225], v[214:215], s[54:55], v[224:225] op_sel:[0,0,0] op_sel_hi:[1,0,1] neg_lo:[0,0,0] neg_hi:[0,0,0]
v_cvt_pk_bf16_f32 v199, v230, v231
v_cvt_pk_bf16_f32 v203, v228, v229
v_cvt_pk_bf16_f32 v207, v212, v213
v_cvt_pk_bf16_f32 v211, v224, v225
ds_write_b128 v7, v[196:199] offset:0
ds_write_b128 v7, v[200:203] offset:16512
ds_write_b128 v7, v[204:207] offset:33024
ds_write_b128 v7, v[208:211] offset:49536
s_cmp_lg_u32 s31, 0
s_cbranch_scc1 Lm_fd0
s_waitcnt vmcnt(0)
s_mov_b32 s36, 0
Lm_nw0:
v_readfirstlane_b32 s32, v248
v_readfirstlane_b32 s33, v249
s_cmp_lg_u32 s32, 0
s_cbranch_scc1 Lm_ng0
s_add_u32 s36, s36, 1
s_cmp_gt_u32 s36, 400
s_cbranch_scc1 Lm_nf0
global_load_dwordx2 v[248:249], v250, s[34:35] sc1
s_waitcnt vmcnt(0)
s_branch Lm_nw0
Lm_nf0:
s_mov_b32 s19, 1
s_branch Lm_fd0
Lm_ng0:
s_and_b32 s38, s2, 3
s_lshl_b32 s38, s38, 13
s_lshr_b32 s39, s2, 2
s_lshl_b32 s39, s39, 7
s_add_u32 s38, s38, s39
s_add_u32 s38, s38, 0
s_mov_b64 exec, 1
buffer_store_dwordx2 v[248:249], off, s[8:11], s38 sc1
s_mov_b64 exec, -1
Lm_fd0:
s_cmp_lg_u32 s31, 0
s_cbranch_scc1 Lm_x2
buffer_load_dwordx4 v[56:59], v4, s[4:7], 0 offen offset:0
buffer_load_dwordx4 v[60:63], v4, s[4:7], 0 offen offset:1024
buffer_load_dwordx4 v[64:67], v4, s[4:7], 0 offen offset:2048
buffer_load_dwordx4 v[68:71], v4, s[4:7], 0 offen offset:3072
buffer_load_dwordx4 v[72:75], v5, s[4:7], 0 offen offset:0
buffer_load_dwordx4 v[76:79], v5, s[4:7], 0 offen offset:1024
buffer_load_dwordx4 v[80:83], v5, s[4:7], 0 offen offset:2048
buffer_load_dwordx4 v[148:151], v5, s[4:7], 0 offen offset:3072
buffer_load_dword v252, off, s[20:23], 0
buffer_load_dword v252, off, s[20:23], 0
buffer_load_dword v252, off, s[20:23], 0
buffer_load_dword v252, off, s[20:23], 0
Lm_x2:
global_load_dwordx2 v[248:249], v250, s[34:35] sc1
v_lshlrev_b32 v216, 16, v40
v_and_b32 v217, s50, v40
v_lshlrev_b32 v232, 16, v44
v_and_b32 v233, s50, v44
v_lshlrev_b32 v218, 16, v48
v_and_b32 v219, s50, v48
v_lshlrev_b32 v214, 16, v52
v_and_b32 v215, s50, v52
v_pk_fma_f32 v[230:231], v[218:219], s[50:51], v[214:215] op_sel:[0,1,0] op_sel_hi:[1,1,1] neg_lo:[0,0,0] neg_hi:[0,0,0]
v_pk_fma_f32 v[218:219], v[232:233], s[50:51], v[218:219] op_sel:[0,1,0] op_sel_hi:[1,1,1] neg_lo:[0,0,0] neg_hi:[0,0,0]
v_pk_fma_f32 v[232:233], v[216:217], s[50:51], v[232:233] op_sel:[0,1,0] op_sel_hi:[1,1,1] neg_lo:[0,0,0] neg_hi:[0,0,0]
v_pk_fma_f32 v[216:217], v[220:221], s[50:51], v[216:217] op_sel:[0,1,0] op_sel_hi:[1,1,1] neg_lo:[0,0,0] neg_hi:[0,0,0]
v_pk_fma_f32 v[220:221], v[216:217], s[60:61], v[218:219] op_sel:[0,0,0] op_sel_hi:[1,0,1] neg_lo:[0,0,0] neg_hi:[0,0,0]
v_pk_fma_f32 v[228:229], v[232:233], s[60:61], v[230:231] op_sel:[0,0,0] op_sel_hi:[1,0,1] neg_lo:[0,0,0] neg_hi:[0,0,0]
v_pk_fma_f32 v[218:219], v[216:217], s[52:53], v[218:219] op_sel:[0,0,0] op_sel_hi:[1,0,1] neg_lo:[0,0,0] neg_hi:[0,0,0]
v_pk_fma_f32 v[230:231], v[232:233], s[52:53], v[230:231] op_sel:[0,0,0] op_sel_hi:[1,0,1] neg_lo:[0,0,0] neg_hi:[0,0,0]
v_pk_fma_f32 v[216:217], v[220:221], s[52:53], v[228:229] op_sel:[0,1,0] op_sel_hi:[1,1,1] neg_lo:[1,0,0] neg_hi:[1,0,0]
v_pk_fma_f32 v[228:229], v[220:221], s[52:53], v[228:229] op_sel:[0,1,0] op_sel_hi:[1,1,1] neg_lo:[0,0,0] neg_hi:[0,0,0]
v_pk_fma_f32 v[232:233], v[218:219], s[54:55], v[230:231] op_sel:[0,0,0] op_sel_hi:[1,0,1] neg_lo:[1,0,0] neg_hi:[1,0,0]
v_pk_fma_f32 v[230:231], v[218:219], s[54:55], v[230:231] op_sel:[0,0,0] op_sel_hi:[1,0,1] neg_lo:[0,0,0] neg_hi:[0,0,0]
v_cvt_pk_bf16_f32 v196, v216, v217
v_cvt_pk_bf16_f32 v200, v228, v229
v_cvt_pk_bf16_f32 v204, v232, v233
v_cvt_pk_bf16_f32 v208, v230, v231
v_lshlrev_b32 v212, 16, v41
v_and_b32 v213, s50, v41
v_lshlrev_b32 v224, 16, v45
v_and_b32 v225, s50, v45
v_lshlrev_b32 v220, 16, v49
v_and_b32 v221, s50, v49
v_lshlrev_b32 v218, 16, v53
v_and_b32 v219, s50, v53
v_pk_fma_f32 v[216:217], v[220:221], s[50:51], v[218:219] op_sel:[0,1,0] op_sel_hi:[1,1,1] neg_lo:[0,0,0] neg_hi:[0,0,0]
v_pk_fma_f32 v[220:221], v[224:225], s[50:51], v[220:221] op_sel:[0,1,0] op_sel_hi:[1,1,1] neg_lo:[0,0,0] neg_hi:[0,0,0]
v_pk_fma_f32 v[224:225], v[212:213], s[50:51], v[224:225] op_sel:[0,1,0] op_sel_hi:[1,1,1] neg_lo:[0,0,0] neg_hi:[0,0,0]
v_pk_fma_f32 v[212:213], v[234:235], s[50:51], v[212:213] op_sel:[0,1,0] op_sel_hi:[1,1,1] neg_lo:[0,0,0] neg_hi:[0,0,0]
v_pk_fma_f32 v[234:235], v[212:213], s[60:61], v[220:221] op_sel:[0,0,0] op_sel_hi:[1,0,1] neg_lo:[0,0,0] neg_hi:[0,0,0]
v_pk_fma_f32 v[228:229], v[224:225], s[60:61], v[216:217] op_sel:[0,0,0] op_sel_hi:[1,0,1] neg_lo:[0,0,0] neg_hi:[0,0,0]
v_pk_fma_f32 v[220:221], v[212:213], s[52:53], v[220:221] op_sel:[0,0,0] op_sel_hi:[1,0,1] neg_lo:[0,0,0] neg_hi:[0,0,0]
v_pk_fma_f32 v[216:217], v[224:225], s[52:53], v[216:217] op_sel:[0,0,0] op_sel_hi:[1,0,1] neg_lo:[0,0,0] neg_hi:[0,0,0]
v_pk_fma_f32 v[212:213], v[234:235], s[52:53], v[228:229] op_sel:[0,1,0] op_sel_hi:[1,1,1] neg_lo:[1,0,0] neg_hi:[1,0,0]
v_pk_fma_f32 v[228:229], v[234:235], s[52:53], v[228:229] op_sel:[0,1,0] op_sel_hi:[1,1,1] neg_lo:[0,0,0] neg_hi:[0,0,0]
v_pk_fma_f32 v[224:225], v[220:221], s[54:55], v[216:217] op_sel:[0,0,0] op_sel_hi:[1,0,1] neg_lo:[1,0,0] neg_hi:[1,0,0]
v_pk_fma_f32 v[216:217], v[220:221], s[54:55], v[216:217] op_sel:[0,0,0] op_sel_hi:[1,0,1] neg_lo:[0,0,0] neg_hi:[0,0,0]
v_cvt_pk_bf16_f32 v197, v212, v213
v_cvt_pk_bf16_f32 v201, v228, v229
v_cvt_pk_bf16_f32 v205, v224, v225
v_cvt_pk_bf16_f32 v209, v216, v217
v_lshlrev_b32 v232, 16, v42
v_and_b32 v233, s50, v42
v_lshlrev_b32 v230, 16, v46
v_and_b32 v231, s50, v46
v_lshlrev_b32 v234, 16, v50
v_and_b32 v235, s50, v50
v_lshlrev_b32 v220, 16, v54
v_and_b32 v221, s50, v54
v_pk_fma_f32 v[212:213], v[234:235], s[50:51], v[220:221] op_sel:[0,1,0] op_sel_hi:[1,1,1] neg_lo:[0,0,0] neg_hi:[0,0,0]
v_pk_fma_f32 v[234:235], v[230:231], s[50:51], v[234:235] op_sel:[0,1,0] op_sel_hi:[1,1,1] neg_lo:[0,0,0] neg_hi:[0,0,0]
v_pk_fma_f32 v[230:231], v[232:233], s[50:51], v[230:231] op_sel:[0,1,0] op_sel_hi:[1,1,1] neg_lo:[0,0,0] neg_hi:[0,0,0]
v_pk_fma_f32 v[232:233], v[226:227], s[50:51], v[232:233] op_sel:[0,1,0] op_sel_hi:[1,1,1] neg_lo:[0,0,0] neg_hi:[0,0,0]
v_pk_fma_f32 v[226:227], v[232:233], s[60:61], v[234:235] op_sel:[0,0,0] op_sel_hi:[1,0,1] neg_lo:[0,0,0] neg_hi:[0,0,0]
v_pk_fma_f32 v[228:229], v[230:231], s[60:61], v[212:213] op_sel:[0,0,0] op_sel_hi:[1,0,1] neg_lo:[0,0,0] neg_hi:[0,0,0]
v_pk_fma_f32 v[234:235], v[232:233], s[52:53], v[234:235] op_sel:[0,0,0] op_sel_hi:[1,0,1] neg_lo:[0,0,0] neg_hi:[0,0,0]
v_pk_fma_f32 v[212:213], v[230:231], s[52:53], v[212:213] op_sel:[0,0,0] op_sel_hi:[1,0,1] neg_lo:[0,0,0] neg_hi:[0,0,0]
v_pk_fma_f32 v[232:233], v[226:227], s[52:53], v[228:229] op_sel:[0,1,0] op_sel_hi:[1,1,1] neg_lo:[1,0,0] neg_hi:[1,0,0]
v_pk_fma_f32 v[228:229], v[226:227], s[52:53], v[228:229] op_sel:[0,1,0] op_sel_hi:[1,1,1] neg_lo:[0,0,0] neg_hi:[0,0,0]
v_pk_fma_f32 v[230:231], v[234:235], s[54:55], v[212:213] op_sel:[0,0,0] op_sel_hi:[1,0,1] neg_lo:[1,0,0] neg_hi:[1,0,0]
v_pk_fma_f32 v[212:213], v[234:235], s[54:55], v[212:213] op_sel:[0,0,0] op_sel_hi:[1,0,1] neg_lo:[0,0,0] neg_hi:[0,0,0]
v_cvt_pk_bf16_f32 v198, v232, v233
v_cvt_pk_bf16_f32 v202, v228, v229
v_cvt_pk_bf16_f32 v206, v230, v231
v_cvt_pk_bf16_f32 v210, v212, v213
v_lshlrev_b32 v224, 16, v43
v_and_b32 v225, s50, v43
v_lshlrev_b32 v216, 16, v47
v_and_b32 v217, s50, v47
v_lshlrev_b32 v226, 16, v51
v_and_b32 v227, s50, v51
v_lshlrev_b32 v234, 16, v55
v_and_b32 v235, s50, v55
v_pk_fma_f32 v[232:233], v[226:227], s[50:51], v[234:235] op_sel:[0,1,0] op_sel_hi:[1,1,1] neg_lo:[0,0,0] neg_hi:[0,0,0]
v_pk_fma_f32 v[226:227], v[216:217], s[50:51], v[226:227] op_sel:[0,1,0] op_sel_hi:[1,1,1] neg_lo:[0,0,0] neg_hi:[0,0,0]
v_pk_fma_f32 v[216:217], v[224:225], s[50:51], v[216:217] op_sel:[0,1,0] op_sel_hi:[1,1,1] neg_lo:[0,0,0] neg_hi:[0,0,0]
v_pk_fma_f32 v[224:225], v[222:223], s[50:51], v[224:225] op_sel:[0,1,0] op_sel_hi:[1,1,1] neg_lo:[0,0,0] neg_hi:[0,0,0]
v_pk_fma_f32 v[222:223], v[224:225], s[60:61], v[226:227] op_sel:[0,0,0] op_sel_hi:[1,0,1] neg_lo:[0,0,0] neg_hi:[0,0,0]
v_pk_fma_f32 v[228:229], v[216:217], s[60:61], v[232:233] op_sel:[0,0,0] op_sel_hi:[1,0,1] neg_lo:[0,0,0] neg_hi:[0,0,0]
v_pk_fma_f32 v[226:227], v[224:225], s[52:53], v[226:227] op_sel:[0,0,0] op_sel_hi:[1,0,1] neg_lo:[0,0,0] neg_hi:[0,0,0]
v_pk_fma_f32 v[232:233], v[216:217], s[52:53], v[232:233] op_sel:[0,0,0] op_sel_hi:[1,0,1] neg_lo:[0,0,0] neg_hi:[0,0,0]
v_pk_fma_f32 v[224:225], v[222:223], s[52:53], v[228:229] op_sel:[0,1,0] op_sel_hi:[1,1,1] neg_lo:[1,0,0] neg_hi:[1,0,0]
v_pk_fma_f32 v[228:229], v[222:223], s[52:53], v[228:229] op_sel:[0,1,0] op_sel_hi:[1,1,1] neg_lo:[0,0,0] neg_hi:[0,0,0]
v_pk_fma_f32 v[216:217], v[226:227], s[54:55], v[232:233] op_sel:[0,0,0] op_sel_hi:[1,0,1] neg_lo:[1,0,0] neg_hi:[1,0,0]
v_pk_fma_f32 v[232:233], v[226:227], s[54:55], v[232:233] op_sel:[0,0,0] op_sel_hi:[1,0,1] neg_lo:[0,0,0] neg_hi:[0,0,0]
v_cvt_pk_bf16_f32 v199, v224, v225
v_cvt_pk_bf16_f32 v203, v228, v229
v_cvt_pk_bf16_f32 v207, v216, v217
v_cvt_pk_bf16_f32 v211, v232, v233
ds_write_b128 v7, v[196:199] offset:16
ds_write_b128 v7, v[200:203] offset:16528
ds_write_b128 v7, v[204:207] offset:33040
ds_write_b128 v7, v[208:211] offset:49552
buffer_load_dwordx4 v[20:23], v9, s[4:7], 0 offen offset:1024
buffer_load_dwordx4 v[24:27], v10, s[4:7], 0 offen offset:1024
buffer_load_dwordx4 v[28:31], v10, s[4:7], 0 offen offset:3072
buffer_load_dwordx4 v[32:35], v11, s[4:7], 0 offen offset:0
buffer_load_dwordx4 v[36:39], v10, s[4:7], 0 offen offset:2048
buffer_load_dwordx4 v[40:43], v10, s[4:7], 0 offen offset:0
buffer_load_dwordx4 v[44:47], v9, s[4:7], 0 offen offset:0
s_waitcnt vmcnt(19)
v_lshlrev_b32 v230, 16, v56
v_and_b32 v231, s50, v56
s_waitcnt vmcnt(18)
v_lshlrev_b32 v212, 16, v60
v_and_b32 v213, s50, v60
s_waitcnt vmcnt(17)
v_lshlrev_b32 v222, 16, v64
v_and_b32 v223, s50, v64
s_waitcnt vmcnt(16)
v_lshlrev_b32 v226, 16, v68
v_and_b32 v227, s50, v68
v_pk_fma_f32 v[224:225], v[222:223], s[50:51], v[226:227] op_sel:[0,1,0] op_sel_hi:[1,1,1] neg_lo:[0,0,0] neg_hi:[0,0,0]
v_pk_fma_f32 v[222:223], v[212:213], s[50:51], v[222:223] op_sel:[0,1,0] op_sel_hi:[1,1,1] neg_lo:[0,0,0] neg_hi:[0,0,0]
v_pk_fma_f32 v[212:213], v[230:231], s[50:51], v[212:213] op_sel:[0,1,0] op_sel_hi:[1,1,1] neg_lo:[0,0,0] neg_hi:[0,0,0]
v_pk_fma_f32 v[230:231], v[214:215], s[50:51], v[230:231] op_sel:[0,1,0] op_sel_hi:[1,1,1] neg_lo:[0,0,0] neg_hi:[0,0,0]
v_pk_fma_f32 v[214:215], v[230:231], s[60:61], v[222:223] op_sel:[0,0,0] op_sel_hi:[1,0,1] neg_lo:[0,0,0] neg_hi:[0,0,0]
v_pk_fma_f32 v[228:229], v[212:213], s[60:61], v[224:225] op_sel:[0,0,0] op_sel_hi:[1,0,1] neg_lo:[0,0,0] neg_hi:[0,0,0]
v_pk_fma_f32 v[222:223], v[230:231], s[52:53], v[222:223] op_sel:[0,0,0] op_sel_hi:[1,0,1] neg_lo:[0,0,0] neg_hi:[0,0,0]
v_pk_fma_f32 v[224:225], v[212:213], s[52:53], v[224:225] op_sel:[0,0,0] op_sel_hi:[1,0,1] neg_lo:[0,0,0] neg_hi:[0,0,0]
v_pk_fma_f32 v[230:231], v[214:215], s[52:53], v[228:229] op_sel:[0,1,0] op_sel_hi:[1,1,1] neg_lo:[1,0,0] neg_hi:[1,0,0]
v_pk_fma_f32 v[228:229], v[214:215], s[52:53], v[228:229] op_sel:[0,1,0] op_sel_hi:[1,1,1] neg_lo:[0,0,0] neg_hi:[0,0,0]
v_pk_fma_f32 v[212:213], v[222:223], s[54:55], v[224:225] op_sel:[0,0,0] op_sel_hi:[1,0,1] neg_lo:[1,0,0] neg_hi:[1,0,0]
v_pk_fma_f32 v[224:225], v[222:223], s[54:55], v[224:225] op_sel:[0,0,0] op_sel_hi:[1,0,1] neg_lo:[0,0,0] neg_hi:[0,0,0]
v_cvt_pk_bf16_f32 v196, v230, v231
v_cvt_pk_bf16_f32 v200, v228, v229
v_cvt_pk_bf16_f32 v204, v212, v213
v_cvt_pk_bf16_f32 v208, v224, v225
v_lshlrev_b32 v216, 16, v57
v_and_b32 v217, s50, v57
v_lshlrev_b32 v232, 16, v61
v_and_b32 v233, s50, v61
v_lshlrev_b32 v214, 16, v65
v_and_b32 v215, s50, v65
v_lshlrev_b32 v222, 16, v69
v_and_b32 v223, s50, v69
v_pk_fma_f32 v[230:231], v[214:215], s[50:51], v[222:223] op_sel:[0,1,0] op_sel_hi:[1,1,1] neg_lo:[0,0,0] neg_hi:[0,0,0]
v_pk_fma_f32 v[214:215], v[232:233], s[50:51], v[214:215] op_sel:[0,1,0] op_sel_hi:[1,1,1] neg_lo:[0,0,0] neg_hi:[0,0,0]
v_pk_fma_f32 v[232:233], v[216:217], s[50:51], v[232:233] op_sel:[0,1,0] op_sel_hi:[1,1,1] neg_lo:[0,0,0] neg_hi:[0,0,0]
v_pk_fma_f32 v[216:217], v[218:219], s[50:51], v[216:217] op_sel:[0,1,0] op_sel_hi:[1,1,1] neg_lo:[0,0,0] neg_hi:[0,0,0]
v_pk_fma_f32 v[218:219], v[216:217], s[60:61], v[214:215] op_sel:[0,0,0] op_sel_hi:[1,0,1] neg_lo:[0,0,0] neg_hi:[0,0,0]
v_pk_fma_f32 v[228:229], v[232:233], s[60:61], v[230:231] op_sel:[0,0,0] op_sel_hi:[1,0,1] neg_lo:[0,0,0] neg_hi:[0,0,0]
v_pk_fma_f32 v[214:215], v[216:217], s[52:53], v[214:215] op_sel:[0,0,0] op_sel_hi:[1,0,1] neg_lo:[0,0,0] neg_hi:[0,0,0]
v_pk_fma_f32 v[230:231], v[232:233], s[52:53], v[230:231] op_sel:[0,0,0] op_sel_hi:[1,0,1] neg_lo:[0,0,0] neg_hi:[0,0,0]
v_pk_fma_f32 v[216:217], v[218:219], s[52:53], v[228:229] op_sel:[0,1,0] op_sel_hi:[1,1,1] neg_lo:[1,0,0] neg_hi:[1,0,0]
v_pk_fma_f32 v[228:229], v[218:219], s[52:53], v[228:229] op_sel:[0,1,0] op_sel_hi:[1,1,1] neg_lo:[0,0,0] neg_hi:[0,0,0]
v_pk_fma_f32 v[232:233], v[214:215], s[54:55], v[230:231] op_sel:[0,0,0] op_sel_hi:[1,0,1] neg_lo:[1,0,0] neg_hi:[1,0,0]
v_pk_fma_f32 v[230:231], v[214:215], s[54:55], v[230:231] op_sel:[0,0,0] op_sel_hi:[1,0,1] neg_lo:[0,0,0] neg_hi:[0,0,0]
v_cvt_pk_bf16_f32 v197, v216, v217
v_cvt_pk_bf16_f32 v201, v228, v229
v_cvt_pk_bf16_f32 v205, v232, v233
v_cvt_pk_bf16_f32 v209, v230, v231
v_lshlrev_b32 v212, 16, v58
v_and_b32 v213, s50, v58
v_lshlrev_b32 v224, 16, v62
v_and_b32 v225, s50, v62
v_lshlrev_b32 v218, 16, v66
v_and_b32 v219, s50, v66
v_lshlrev_b32 v214, 16, v70
v_and_b32 v215, s50, v70
v_pk_fma_f32 v[216:217], v[218:219], s[50:51], v[214:215] op_sel:[0,1,0] op_sel_hi:[1,1,1] neg_lo:[0,0,0] neg_hi:[0,0,0]
v_pk_fma_f32 v[218:219], v[224:225], s[50:51], v[218:219] op_sel:[0,1,0] op_sel_hi:[1,1,1] neg_lo:[0,0,0] neg_hi:[0,0,0]
v_pk_fma_f32 v[224:225], v[212:213], s[50:51], v[224:225] op_sel:[0,1,0] op_sel_hi:[1,1,1] neg_lo:[0,0,0] neg_hi:[0,0,0]
v_pk_fma_f32 v[212:213], v[220:221], s[50:51], v[212:213] op_sel:[0,1,0] op_sel_hi:[1,1,1] neg_lo:[0,0,0] neg_hi:[0,0,0]
v_pk_fma_f32 v[220:221], v[212:213], s[60:61], v[218:219] op_sel:[0,0,0] op_sel_hi:[1,0,1] neg_lo:[0,0,0] neg_hi:[0,0,0]
v_pk_fma_f32 v[228:229], v[224:225], s[60:61], v[216:217] op_sel:[0,0,0] op_sel_hi:[1,0,1] neg_lo:[0,0,0] neg_hi:[0,0,0]
v_pk_fma_f32 v[218:219], v[212:213], s[52:53], v[218:219] op_sel:[0,0,0] op_sel_hi:[1,0,1] neg_lo:[0,0,0] neg_hi:[0,0,0]
v_pk_fma_f32 v[216:217], v[224:225], s[52:53], v[216:217] op_sel:[0,0,0] op_sel_hi:[1,0,1] neg_lo:[0,0,0] neg_hi:[0,0,0]
v_pk_fma_f32 v[212:213], v[220:221], s[52:53], v[228:229] op_sel:[0,1,0] op_sel_hi:[1,1,1] neg_lo:[1,0,0] neg_hi:[1,0,0]
v_pk_fma_f32 v[228:229], v[220:221], s[52:53], v[228:229] op_sel:[0,1,0] op_sel_hi:[1,1,1] neg_lo:[0,0,0] neg_hi:[0,0,0]
v_pk_fma_f32 v[224:225], v[218:219], s[54:55], v[216:217] op_sel:[0,0,0] op_sel_hi:[1,0,1] neg_lo:[1,0,0] neg_hi:[1,0,0]
v_pk_fma_f32 v[216:217], v[218:219], s[54:55], v[216:217] op_sel:[0,0,0] op_sel_hi:[1,0,1] neg_lo:[0,0,0] neg_hi:[0,0,0]
v_cvt_pk_bf16_f32 v198, v212, v213
v_cvt_pk_bf16_f32 v202, v228, v229
v_cvt_pk_bf16_f32 v206, v224, v225
v_cvt_pk_bf16_f32 v210, v216, v217
v_lshlrev_b32 v232, 16, v59
v_and_b32 v233, s50, v59
v_lshlrev_b32 v230, 16, v63
v_and_b32 v231, s50, v63
v_lshlrev_b32 v220, 16, v67
v_and_b32 v221, s50, v67
v_lshlrev_b32 v218, 16, v71
v_and_b32 v219, s50, v71
v_pk_fma_f32 v[212:213], v[220:221], s[50:51], v[218:219] op_sel:[0,1,0] op_sel_hi:[1,1,1] neg_lo:[0,0,0] neg_hi:[0,0,0]
v_pk_fma_f32 v[220:221], v[230:231], s[50:51], v[220:221] op_sel:[0,1,0] op_sel_hi:[1,1,1] neg_lo:[0,0,0] neg_hi:[0,0,0]
v_pk_fma_f32 v[230:231], v[232:233], s[50:51], v[230:231] op_sel:[0,1,0] op_sel_hi:[1,1,1] neg_lo:[0,0,0] neg_hi:[0,0,0]
v_pk_fma_f32 v[232:233], v[234:235], s[50:51], v[232:233] op_sel:[0,1,0] op_sel_hi:[1,1,1] neg_lo:[0,0,0] neg_hi:[0,0,0]
v_pk_fma_f32 v[234:235], v[232:233], s[60:61], v[220:221] op_sel:[0,0,0] op_sel_hi:[1,0,1] neg_lo:[0,0,0] neg_hi:[0,0,0]
v_pk_fma_f32 v[228:229], v[230:231], s[60:61], v[212:213] op_sel:[0,0,0] op_sel_hi:[1,0,1] neg_lo:[0,0,0] neg_hi:[0,0,0]
v_pk_fma_f32 v[220:221], v[232:233], s[52:53], v[220:221] op_sel:[0,0,0] op_sel_hi:[1,0,1] neg_lo:[0,0,0] neg_hi:[0,0,0]
v_pk_fma_f32 v[212:213], v[230:231], s[52:53], v[212:213] op_sel:[0,0,0] op_sel_hi:[1,0,1] neg_lo:[0,0,0] neg_hi:[0,0,0]
v_pk_fma_f32 v[232:233], v[234:235], s[52:53], v[228:229] op_sel:[0,1,0] op_sel_hi:[1,1,1] neg_lo:[1,0,0] neg_hi:[1,0,0]
v_pk_fma_f32 v[228:229], v[234:235], s[52:53], v[228:229] op_sel:[0,1,0] op_sel_hi:[1,1,1] neg_lo:[0,0,0] neg_hi:[0,0,0]
v_pk_fma_f32 v[230:231], v[220:221], s[54:55], v[212:213] op_sel:[0,0,0] op_sel_hi:[1,0,1] neg_lo:[1,0,0] neg_hi:[1,0,0]
v_pk_fma_f32 v[212:213], v[220:221], s[54:55], v[212:213] op_sel:[0,0,0] op_sel_hi:[1,0,1] neg_lo:[0,0,0] neg_hi:[0,0,0]
v_cvt_pk_bf16_f32 v199, v232, v233
v_cvt_pk_bf16_f32 v203, v228, v229
v_cvt_pk_bf16_f32 v207, v230, v231
v_cvt_pk_bf16_f32 v211, v212, v213
ds_write_b128 v7, v[196:199] offset:512
ds_write_b128 v7, v[200:203] offset:17024
ds_write_b128 v7, v[204:207] offset:33536
ds_write_b128 v7, v[208:211] offset:50048
buffer_load_dwordx4 v[152:155], v1, s[4:7], 0 offen offset:1152
buffer_load_dwordx4 v[156:159], v2, s[4:7], 0 offen offset:128
buffer_load_dwordx4 v[160:163], v2, s[4:7], 0 offen offset:1152
buffer_load_dwordx4 v[164:167], v2, s[4:7], 0 offen offset:2176
buffer_load_dwordx4 v[168:171], v2, s[4:7], 0 offen offset:3200
buffer_load_dwordx4 v[172:175], v3, s[4:7], 0 offen offset:128
buffer_load_dwordx4 v[176:179], v3, s[4:7], 0 offen offset:1152
buffer_load_dwordx4 v[180:183], v3, s[4:7], 0 offen offset:2176
buffer_load_dwordx4 v[184:187], v3, s[4:7], 0 offen offset:3200
buffer_load_dwordx4 v[188:191], v9, s[4:7], 0 offen offset:1152
buffer_load_dwordx4 v[192:195], v10, s[4:7], 0 offen offset:1152
s_waitcnt vmcnt(26)
v_lshlrev_b32 v224, 16, v72
v_and_b32 v225, s50, v72
s_waitcnt vmcnt(25)
v_lshlrev_b32 v216, 16, v76
v_and_b32 v217, s50, v76
s_waitcnt vmcnt(24)
v_lshlrev_b32 v234, 16, v80
v_and_b32 v235, s50, v80
s_waitcnt vmcnt(23)
v_lshlrev_b32 v220, 16, v148
v_and_b32 v221, s50, v148
v_pk_fma_f32 v[232:233], v[234:235], s[50:51], v[220:221] op_sel:[0,1,0] op_sel_hi:[1,1,1] neg_lo:[0,0,0] neg_hi:[0,0,0]
v_pk_fma_f32 v[234:235], v[216:217], s[50:51], v[234:235] op_sel:[0,1,0] op_sel_hi:[1,1,1] neg_lo:[0,0,0] neg_hi:[0,0,0]
v_pk_fma_f32 v[216:217], v[224:225], s[50:51], v[216:217] op_sel:[0,1,0] op_sel_hi:[1,1,1] neg_lo:[0,0,0] neg_hi:[0,0,0]
v_pk_fma_f32 v[224:225], v[226:227], s[50:51], v[224:225] op_sel:[0,1,0] op_sel_hi:[1,1,1] neg_lo:[0,0,0] neg_hi:[0,0,0]
v_pk_fma_f32 v[226:227], v[224:225], s[60:61], v[234:235] op_sel:[0,0,0] op_sel_hi:[1,0,1] neg_lo:[0,0,0] neg_hi:[0,0,0]
v_pk_fma_f32 v[228:229], v[216:217], s[60:61], v[232:233] op_sel:[0,0,0] op_sel_hi:[1,0,1] neg_lo:[0,0,0] neg_hi:[0,0,0]
v_pk_fma_f32 v[234:235], v[224:225], s[52:53], v[234:235] op_sel:[0,0,0] op_sel_hi:[1,0,1] neg_lo:[0,0,0] neg_hi:[0,0,0]
v_pk_fma_f32 v[232:233], v[216:217], s[52:53], v[232:233] op_sel:[0,0,0] op_sel_hi:[1,0,1] neg_lo:[0,0,0] neg_hi:[0,0,0]
v_pk_fma_f32 v[224:225], v[226:227], s[52:53], v[228:229] op_sel:[0,1,0] op_sel_hi:[1,1,1] neg_lo:[1,0,0] neg_hi:[1,0,0]
v_pk_fma_f32 v[228:229], v[226:227], s[52:53], v[228:229] op_sel:[0,1,0] op_sel_hi:[1,1,1] neg_lo:[0,0,0] neg_hi:[0,0,0]
v_pk_fma_f32 v[216:217], v[234:235], s[54:55], v[232:233] op_sel:[0,0,0] op_sel_hi:[1,0,1] neg_lo:[1,0,0] neg_hi:[1,0,0]
v_pk_fma_f32 v[232:233], v[234:235], s[54:55], v[232:233] op_sel:[0,0,0] op_sel_hi:[1,0,1] neg_lo:[0,0,0] neg_hi:[0,0,0]
v_cvt_pk_bf16_f32 v196, v224, v225
v_cvt_pk_bf16_f32 v200, v228, v229
v_cvt_pk_bf16_f32 v204, v216, v217
v_cvt_pk_bf16_f32 v208, v232, v233
v_lshlrev_b32 v230, 16, v73
v_and_b32 v231, s50, v73
v_lshlrev_b32 v212, 16, v77
v_and_b32 v213, s50, v77
v_lshlrev_b32 v226, 16, v81
v_and_b32 v227, s50, v81
v_lshlrev_b32 v234, 16, v149
v_and_b32 v235, s50, v149
v_pk_fma_f32 v[224:225], v[226:227], s[50:51], v[234:235] op_sel:[0,1,0] op_sel_hi:[1,1,1] neg_lo:[0,0,0] neg_hi:[0,0,0]
v_pk_fma_f32 v[226:227], v[212:213], s[50:51], v[226:227] op_sel:[0,1,0] op_sel_hi:[1,1,1] neg_lo:[0,0,0] neg_hi:[0,0,0]
v_pk_fma_f32 v[212:213], v[230:231], s[50:51], v[212:213] op_sel:[0,1,0] op_sel_hi:[1,1,1] neg_lo:[0,0,0] neg_hi:[0,0,0]
v_pk_fma_f32 v[230:231], v[222:223], s[50:51], v[230:231] op_sel:[0,1,0] op_sel_hi:[1,1,1] neg_lo:[0,0,0] neg_hi:[0,0,0]
v_pk_fma_f32 v[222:223], v[230:231], s[60:61], v[226:227] op_sel:[0,0,0] op_sel_hi:[1,0,1] neg_lo:[0,0,0] neg_hi:[0,0,0]
v_pk_fma_f32 v[228:229], v[212:213], s[60:61], v[224:225] op_sel:[0,0,0] op_sel_hi:[1,0,1] neg_lo:[0,0,0] neg_hi:[0,0,0]
v_pk_fma_f32 v[226:227], v[230:231], s[52:53], v[226:227] op_sel:[0,0,0] op_sel_hi:[1,0,1] neg_lo:[0,0,0] neg_hi:[0,0,0]
v_pk_fma_f32 v[224:225], v[212:213], s[52:53], v[224:225] op_sel:[0,0,0] op_sel_hi:[1,0,1] neg_lo:[0,0,0] neg_hi:[0,0,0]
v_pk_fma_f32 v[230:231], v[222:223], s[52:53], v[228:229] op_sel:[0,1,0] op_sel_hi:[1,1,1] neg_lo:[1,0,0] neg_hi:[1,0,0]
v_pk_fma_f32 v[228:229], v[222:223], s[52:53], v[228:229] op_sel:[0,1,0] op_sel_hi:[1,1,1] neg_lo:[0,0,0] neg_hi:[0,0,0]
v_pk_fma_f32 v[212:213], v[226:227], s[54:55], v[224:225] op_sel:[0,0,0] op_sel_hi:[1,0,1] neg_lo:[1,0,0] neg_hi:[1,0,0]
v_pk_fma_f32 v[224:225], v[226:227], s[54:55], v[224:225] op_sel:[0,0,0] op_sel_hi:[1,0,1] neg_lo:[0,0,0] neg_hi:[0,0,0]
v_cvt_pk_bf16_f32 v197, v230, v231
v_cvt_pk_bf16_f32 v201, v228, v229
v_cvt_pk_bf16_f32 v205, v212, v213
v_cvt_pk_bf16_f32 v209, v224, v225
v_lshlrev_b32 v216, 16, v74
v_and_b32 v217, s50, v74
v_lshlrev_b32 v232, 16, v78
v_and_b32 v233, s50, v78
v_lshlrev_b32 v222, 16, v82
v_and_b32 v223, s50, v82
v_lshlrev_b32 v226, 16, v150
v_and_b32 v227, s50, v150
v_pk_fma_f32 v[230:231], v[222:223], s[50:51], v[226:227] op_sel:[0,1,0] op_sel_hi:[1,1,1] neg_lo:[0,0,0] neg_hi:[0,0,0]
v_pk_fma_f32 v[222:223], v[232:233], s[50:51], v[222:223] op_sel:[0,1,0] op_sel_hi:[1,1,1] neg_lo:[0,0,0] neg_hi:[0,0,0]
v_pk_fma_f32 v[232:233], v[216:217], s[50:51], v[232:233] op_sel:[0,1,0] op_sel_hi:[1,1,1] neg_lo:[0,0,0] neg_hi:[0,0,0]
v_pk_fma_f32 v[216:217], v[214:215], s[50:51], v[216:217] op_sel:[0,1,0] op_sel_hi:[1,1,1] neg_lo:[0,0,0] neg_hi:[0,0,0]
v_pk_fma_f32 v[214:215], v[216:217], s[60:61], v[222:223] op_sel:[0,0,0] op_sel_hi:[1,0,1] neg_lo:[0,0,0] neg_hi:[0,0,0]
v_pk_fma_f32 v[228:229], v[232:233], s[60:61], v[230:231] op_sel:[0,0,0] op_sel_hi:[1,0,1] neg_lo:[0,0,0] neg_hi:[0,0,0]
v_pk_fma_f32 v[222:223], v[216:217], s[52:53], v[222:223] op_sel:[0,0,0] op_sel_hi:[1,0,1] neg_lo:[0,0,0] neg_hi:[0,0,0]
v_pk_fma_f32 v[230:231], v[232:233], s[52:53], v[230:231] op_sel:[0,0,0] op_sel_hi:[1,0,1] neg_lo:[0,0,0] neg_hi:[0,0,0]
v_pk_fma_f32 v[216:217], v[214:215], s[52:53], v[228:229] op_sel:[0,1,0] op_sel_hi:[1,1,1] neg_lo:[1,0,0] neg_hi:[1,0,0]
v_pk_fma_f32 v[228:229], v[214:215], s[52:53], v[228:229] op_sel:[0,1,0] op_sel_hi:[1,1,1] neg_lo:[0,0,0] neg_hi:[0,0,0]
v_pk_fma_f32 v[232:233], v[222:223], s[54:55], v[230:231] op_sel:[0,0,0] op_sel_hi:[1,0,1] neg_lo:[1,0,0] neg_hi:[1,0,0]
v_pk_fma_f32 v[230:231], v[222:223], s[54:55], v[230:231] op_sel:[0,0,0] op_sel_hi:[1,0,1] neg_lo:[0,0,0] neg_hi:[0,0,0]
v_cvt_pk_bf16_f32 v198, v216, v217
v_cvt_pk_bf16_f32 v202, v228, v229
v_cvt_pk_bf16_f32 v206, v232, v233
v_cvt_pk_bf16_f32 v210, v230, v231
v_lshlrev_b32 v212, 16, v75
v_and_b32 v213, s50, v75
v_lshlrev_b32 v224, 16, v79
v_and_b32 v225, s50, v79
v_lshlrev_b32 v214, 16, v83
v_and_b32 v215, s50, v83
v_lshlrev_b32 v222, 16, v151
v_and_b32 v223, s50, v151
v_pk_fma_f32 v[216:217], v[214:215], s[50:51], v[222:223] op_sel:[0,1,0] op_sel_hi:[1,1,1] neg_lo:[0,0,0] neg_hi:[0,0,0]
v_pk_fma_f32 v[214:215], v[224:225], s[50:51], v[214:215] op_sel:[0,1,0] op_sel_hi:[1,1,1] neg_lo:[0,0,0] neg_hi:[0,0,0]
v_pk_fma_f32 v[224:225], v[212:213], s[50:51], v[224:225] op_sel:[0,1,0] op_sel_hi:[1,1,1] neg_lo:[0,0,0] neg_hi:[0,0,0]
v_pk_fma_f32 v[212:213], v[218:219], s[50:51], v[212:213] op_sel:[0,1,0] op_sel_hi:[1,1,1] neg_lo:[0,0,0] neg_hi:[0,0,0]
v_pk_fma_f32 v[218:219], v[212:213], s[60:61], v[214:215] op_sel:[0,0,0] op_sel_hi:[1,0,1] neg_lo:[0,0,0] neg_hi:[0,0,0]
v_pk_fma_f32 v[228:229], v[224:225], s[60:61], v[216:217] op_sel:[0,0,0] op_sel_hi:[1,0,1] neg_lo:[0,0,0] neg_hi:[0,0,0]
v_pk_fma_f32 v[214:215], v[212:213], s[52:53], v[214:215] op_sel:[0,0,0] op_sel_hi:[1,0,1] neg_lo:[0,0,0] neg_hi:[0,0,0]
v_pk_fma_f32 v[216:217], v[224:225], s[52:53], v[216:217] op_sel:[0,0,0] op_sel_hi:[1,0,1] neg_lo:[0,0,0] neg_hi:[0,0,0]
v_pk_fma_f32 v[212:213], v[218:219], s[52:53], v[228:229] op_sel:[0,1,0] op_sel_hi:[1,1,1] neg_lo:[1,0,0] neg_hi:[1,0,0]
v_pk_fma_f32 v[228:229], v[218:219], s[52:53], v[228:229] op_sel:[0,1,0] op_sel_hi:[1,1,1] neg_lo:[0,0,0] neg_hi:[0,0,0]
v_pk_fma_f32 v[224:225], v[214:215], s[54:55], v[216:217] op_sel:[0,0,0] op_sel_hi:[1,0,1] neg_lo:[1,0,0] neg_hi:[1,0,0]
v_pk_fma_f32 v[216:217], v[214:215], s[54:55], v[216:217] op_sel:[0,0,0] op_sel_hi:[1,0,1] neg_lo:[0,0,0] neg_hi:[0,0,0]
v_cvt_pk_bf16_f32 v199, v212, v213
v_cvt_pk_bf16_f32 v203, v228, v229
v_cvt_pk_bf16_f32 v207, v224, v225
v_cvt_pk_bf16_f32 v211, v216, v217
ds_write_b128 v7, v[196:199] offset:528
ds_write_b128 v7, v[200:203] offset:17040
s_waitcnt lgkmcnt(14)
ds_write_b128 v7, v[204:207] offset:33552
s_waitcnt lgkmcnt(14)
ds_write_b128 v7, v[208:211] offset:50064
s_waitcnt vmcnt(18)
s_cmp_eq_u32 s31, 0
s_cbranch_scc1 Lm_fd1
s_call_b64 s[46:47], Lu_sub
s_mov_b32 s36, 0
Lm_nw1:
v_readfirstlane_b32 s32, v248
v_readfirstlane_b32 s33, v249
s_cmp_lg_u32 s32, 0
s_cbranch_scc1 Lm_ng1
s_add_u32 s36, s36, 1
s_cmp_gt_u32 s36, 400
s_cbranch_scc1 Lm_nf1
global_load_dwordx2 v[248:249], v250, s[34:35] sc1
s_waitcnt vmcnt(0)
s_branch Lm_nw1
Lm_nf1:
s_mov_b32 s19, 1
s_branch Lm_fd1
Lm_ng1:
Lm_fd1:
buffer_load_dwordx2 v[252:253], v254, s[8:11], 0 offen sc1
s_waitcnt vmcnt(17)
v_lshlrev_b32 v232, 16, v20
v_and_b32 v233, s50, v20
s_waitcnt vmcnt(16)
v_lshlrev_b32 v230, 16, v24
v_and_b32 v231, s50, v24
s_waitcnt vmcnt(15)
v_lshlrev_b32 v218, 16, v28
v_and_b32 v219, s50, v28
v_pk_fma_f32 v[218:219], v[230:231], s[56:57], v[218:219] op_sel:[0,0,0] op_sel_hi:[1,0,1] neg_lo:[0,0,0] neg_hi:[0,0,0]
v_pk_fma_f32 v[218:219], v[232:233], s[54:55], v[218:219] op_sel:[0,1,0] op_sel_hi:[1,1,1] neg_lo:[0,0,0] neg_hi:[0,0,0]
v_lshlrev_b32 v214, 16, v21
v_and_b32 v215, s50, v21
v_lshlrev_b32 v212, 16, v25
v_and_b32 v213, s50, v25
v_lshlrev_b32 v228, 16, v29
v_and_b32 v229, s50, v29
v_pk_fma_f32 v[228:229], v[212:213], s[56:57], v[228:229] op_sel:[0,0,0] op_sel_hi:[1,0,1] neg_lo:[0,0,0] neg_hi:[0,0,0]
v_pk_fma_f32 v[228:229], v[214:215], s[54:55], v[228:229] op_sel:[0,1,0] op_sel_hi:[1,1,1] neg_lo:[0,0,0] neg_hi:[0,0,0]
v_lshlrev_b32 v224, 16, v22
v_and_b32 v225, s50, v22
v_lshlrev_b32 v216, 16, v26
v_and_b32 v217, s50, v26
v_lshlrev_b32 v220, 16, v30
v_and_b32 v221, s50, v30
v_pk_fma_f32 v[220:221], v[216:217], s[56:57], v[220:221] op_sel:[0,0,0] op_sel_hi:[1,0,1] neg_lo:[0,0,0] neg_hi:[0,0,0]
v_pk_fma_f32 v[220:221], v[224:225], s[54:55], v[220:221] op_sel:[0,1,0] op_sel_hi:[1,1,1] neg_lo:[0,0,0] neg_hi:[0,0,0]
v_lshlrev_b32 v234, 16, v23
v_and_b32 v235, s50, v23
v_lshlrev_b32 v226, 16, v27
v_and_b32 v227, s50, v27
v_lshlrev_b32 v222, 16, v31
v_and_b32 v223, s50, v31
v_pk_fma_f32 v[222:223], v[226:227], s[56:57], v[222:223] op_sel:[0,0,0] op_sel_hi:[1,0,1] neg_lo:[0,0,0] neg_hi:[0,0,0]
v_pk_fma_f32 v[222:223], v[234:235], s[54:55], v[222:223] op_sel:[0,1,0] op_sel_hi:[1,1,1] neg_lo:[0,0,0] neg_hi:[0,0,0]
s_waitcnt vmcnt(14)
v_lshlrev_b32 v232, 16, v32
v_and_b32 v233, s50, v32
s_waitcnt vmcnt(13)
v_lshlrev_b32 v230, 16, v36
v_and_b32 v231, s50, v36
v_pk_fma_f32 v[232:233], v[232:233], s[58:59], v[218:219] op_sel:[0,0,0] op_sel_hi:[1,0,1] neg_lo:[0,0,0] neg_hi:[0,0,0]
v_pk_fma_f32 v[232:233], v[230:231], s[56:57], v[232:233] op_sel:[0,1,0] op_sel_hi:[1,1,1] neg_lo:[0,0,0] neg_hi:[0,0,0]
v_pk_fma_f32 v[230:231], v[218:219], s[58:59], v[230:231] op_sel:[0,0,0] op_sel_hi:[1,0,1] neg_lo:[0,0,0] neg_hi:[0,0,0]
v_cvt_pk_bf16_f32 v88, v218, v219
s_waitcnt vmcnt(12)
v_lshlrev_b32 v214, 16, v40
v_and_b32 v215, s50, v40
s_waitcnt vmcnt(11)
v_lshlrev_b32 v212, 16, v44
v_and_b32 v213, s50, v44
v_pk_fma_f32 v[232:233], v[214:215], s[58:59], v[232:233] op_sel:[0,1,0] op_sel_hi:[1,1,1] neg_lo:[0,0,0] neg_hi:[0,0,0]
v_pk_fma_f32 v[230:231], v[214:215], s[56:57], v[230:231] op_sel:[0,0,0] op_sel_hi:[1,0,1] neg_lo:[0,0,0] neg_hi:[0,0,0]
v_pk_fma_f32 v[230:231], v[212:213], s[54:55], v[230:231] op_sel:[0,1,0] op_sel_hi:[1,1,1] neg_lo:[0,0,0] neg_hi:[0,0,0]
v_cvt_pk_bf16_f32 v92, v230, v231
v_cvt_pk_bf16_f32 v96, v232, v233
v_lshlrev_b32 v224, 16, v33
v_and_b32 v225, s50, v33
v_lshlrev_b32 v216, 16, v37
v_and_b32 v217, s50, v37
v_pk_fma_f32 v[224:225], v[224:225], s[58:59], v[228:229] op_sel:[0,0,0] op_sel_hi:[1,0,1] neg_lo:[0,0,0] neg_hi:[0,0,0]
v_pk_fma_f32 v[224:225], v[216:217], s[56:57], v[224:225] op_sel:[0,1,0] op_sel_hi:[1,1,1] neg_lo:[0,0,0] neg_hi:[0,0,0]
v_pk_fma_f32 v[216:217], v[228:229], s[58:59], v[216:217] op_sel:[0,0,0] op_sel_hi:[1,0,1] neg_lo:[0,0,0] neg_hi:[0,0,0]
v_cvt_pk_bf16_f32 v89, v228, v229
v_lshlrev_b32 v234, 16, v41
v_and_b32 v235, s50, v41
v_lshlrev_b32 v226, 16, v45
v_and_b32 v227, s50, v45
v_pk_fma_f32 v[224:225], v[234:235], s[58:59], v[224:225] op_sel:[0,1,0] op_sel_hi:[1,1,1] neg_lo:[0,0,0] neg_hi:[0,0,0]
v_pk_fma_f32 v[216:217], v[234:235], s[56:57], v[216:217] op_sel:[0,0,0] op_sel_hi:[1,0,1] neg_lo:[0,0,0] neg_hi:[0,0,0]
v_pk_fma_f32 v[216:217], v[226:227], s[54:55], v[216:217] op_sel:[0,1,0] op_sel_hi:[1,1,1] neg_lo:[0,0,0] neg_hi:[0,0,0]
v_cvt_pk_bf16_f32 v93, v216, v217
v_cvt_pk_bf16_f32 v97, v224, v225
v_lshlrev_b32 v218, 16, v34
v_and_b32 v219, s50, v34
v_lshlrev_b32 v212, 16, v38
v_and_b32 v213, s50, v38
v_pk_fma_f32 v[218:219], v[218:219], s[58:59], v[220:221] op_sel:[0,0,0] op_sel_hi:[1,0,1] neg_lo:[0,0,0] neg_hi:[0,0,0]
v_pk_fma_f32 v[218:219], v[212:213], s[56:57], v[218:219] op_sel:[0,1,0] op_sel_hi:[1,1,1] neg_lo:[0,0,0] neg_hi:[0,0,0]
v_pk_fma_f32 v[212:213], v[220:221], s[58:59], v[212:213] op_sel:[0,0,0] op_sel_hi:[1,0,1] neg_lo:[0,0,0] neg_hi:[0,0,0]
v_cvt_pk_bf16_f32 v90, v220, v221
v_lshlrev_b32 v214, 16, v42
v_and_b32 v215, s50, v42
v_lshlrev_b32 v230, 16, v46
v_and_b32 v231, s50, v46
v_pk_fma_f32 v[218:219], v[214:215], s[58:59], v[218:219] op_sel:[0,1,0] op_sel_hi:[1,1,1] neg_lo:[0,0,0] neg_hi:[0,0,0]
v_pk_fma_f32 v[212:213], v[214:215], s[56:57], v[212:213] op_sel:[0,0,0] op_sel_hi:[1,0,1] neg_lo:[0,0,0] neg_hi:[0,0,0]
v_pk_fma_f32 v[212:213], v[230:231], s[54:55], v[212:213] op_sel:[0,1,0] op_sel_hi:[1,1,1] neg_lo:[0,0,0] neg_hi:[0,0,0]
v_cvt_pk_bf16_f32 v94, v212, v213
v_cvt_pk_bf16_f32 v98, v218, v219
v_lshlrev_b32 v232, 16, v35
v_and_b32 v233, s50, v35
v_lshlrev_b32 v228, 16, v39
v_and_b32 v229, s50, v39
v_pk_fma_f32 v[232:233], v[232:233], s[58:59], v[222:223] op_sel:[0,0,0] op_sel_hi:[1,0,1] neg_lo:[0,0,0] neg_hi:[0,0,0]
v_pk_fma_f32 v[232:233], v[228:229], s[56:57], v[232:233] op_sel:[0,1,0] op_sel_hi:[1,1,1] neg_lo:[0,0,0] neg_hi:[0,0,0]
v_pk_fma_f32 v[228:229], v[222:223], s[58:59], v[228:229] op_sel:[0,0,0] op_sel_hi:[1,0,1] neg_lo:[0,0,0] neg_hi:[0,0,0]
v_cvt_pk_bf16_f32 v91, v222, v223
v_lshlrev_b32 v226, 16, v43
v_and_b32 v227, s50, v43
v_lshlrev_b32 v234, 16, v47
v_and_b32 v235, s50, v47
v_pk_fma_f32 v[232:233], v[226:227], s[58:59], v[232:233] op_sel:[0,1,0] op_sel_hi:[1,1,1] neg_lo:[0,0,0] neg_hi:[0,0,0]
v_pk_fma_f32 v[228:229], v[226:227], s[56:57], v[228:229] op_sel:[0,0,0] op_sel_hi:[1,0,1] neg_lo:[0,0,0] neg_hi:[0,0,0]
v_pk_fma_f32 v[228:229], v[234:235], s[54:55], v[228:229] op_sel:[0,1,0] op_sel_hi:[1,1,1] neg_lo:[0,0,0] neg_hi:[0,0,0]
v_cvt_pk_bf16_f32 v95, v228, v229
v_cvt_pk_bf16_f32 v99, v232, v233
s_cmp_lg_u32 s19, 0
s_cbranch_scc1 Lm_pf
s_mov_b32 s36, 0
s_branch Lm_pw1
Lm_pw:
buffer_load_dwordx2 v[252:253], v254, s[8:11], 0 offen sc1
Lm_pw1:
s_waitcnt vmcnt(0)
v_cmp_ne_u64 vcc, s[32:33], v[252:253]
s_nop 1
s_cmp_eq_u64 vcc, 0
s_cbranch_scc1 Lm_pg
s_add_u32 s36, s36, 1
s_cmp_le_u32 s36, 400
s_cbranch_scc1 Lm_pw
Lm_pf:
v_mov_b32 v250, 1
ds_write_b32 v251, v250
s_waitcnt vmcnt(0)
s_branch Lm_ps
Lm_pg:
buffer_load_dwordx4 a[160:163], v13, s[8:11], s16 offen offset:0 sc1
buffer_load_dwordx4 a[164:167], v14, s[8:11], s16 offen offset:0 sc1
buffer_load_dwordx4 a[168:171], v13, s[8:11], s16 offen offset:1024 sc1
buffer_load_dwordx4 a[172:175], v14, s[8:11], s16 offen offset:1024 sc1
buffer_load_dwordx4 a[176:179], v13, s[8:11], s16 offen offset:2048 sc1
buffer_load_dwordx4 a[180:183], v14, s[8:11], s16 offen offset:2048 sc1
buffer_load_dwordx4 a[184:187], v13, s[8:11], s16 offen offset:3072 sc1
buffer_load_dwordx4 a[188:191], v14, s[8:11], s16 offen offset:3072 sc1
s_add_u32 s16, s16, 4096
buffer_load_dwordx4 a[192:195], v13, s[8:11], s16 offen offset:0 sc1
buffer_load_dwordx4 a[196:199], v14, s[8:11], s16 offen offset:0 sc1
buffer_load_dwordx4 a[200:203], v13, s[8:11], s16 offen offset:1024 sc1
buffer_load_dwordx4 a[204:207], v14, s[8:11], s16 offen offset:1024 sc1
buffer_load_dwordx4 a[208:211], v13, s[8:11], s16 offen offset:2048 sc1
buffer_load_dwordx4 a[212:215], v14, s[8:11], s16 offen offset:2048 sc1
buffer_load_dwordx4 a[216:219], v13, s[8:11], s16 offen offset:3072 sc1
buffer_load_dwordx4 a[220:223], v14, s[8:11], s16 offen offset:3072 sc1
s_add_u32 s16, s16, 4096
Lm_ps:
s_waitcnt lgkmcnt(0)
s_barrier
v_mov_b32 v251, 132160
ds_read_b128 v[20:23], v251
s_waitcnt lgkmcnt(0)
v_or3_b32 v20, v20, v21, v22
v_or_b32 v20, v20, v23
s_nop 0
v_readfirstlane_b32 s45, v20
s_cmp_lg_u32 s45, 0
s_cbranch_scc1 Lm_fall
Lm_resume:
s_cmp_eq_u32 s31, 0
s_cselect_b32 s24, 0x40000000, s24
s_cselect_b32 s25, 0x40000000, s25
s_cselect_b32 s26, 0x40000000, s26
s_cselect_b32 s27, 0x40000000, s27
ds_read_b128 a[128:131], v15 offset:0
ds_read_b128 a[132:135], v15 offset:16
ds_read_b128 a[136:139], v15 offset:512
ds_read_b128 a[140:143], v15 offset:528
ds_read_b128 a[144:147], v15 offset:1024
ds_read_b128 a[148:151], v15 offset:1040
s_add_u32 s40, s3, 196608
buffer_load_dword v252, off, s[8:11], s40
s_waitcnt vmcnt(16) lgkmcnt(5)
v_mfma_f32_16x16x32_bf16 a[0:3], a[160:163], a[128:131], 0
v_lshlrev_b32 v216, 16, v152
s_waitcnt vmcnt(14) lgkmcnt(4)
v_mfma_f32_16x16x32_bf16 a[0:3], a[168:171], a[132:135], a[0:3]
ds_read_b128 a[152:155], v15 offset:1536
s_waitcnt vmcnt(12) lgkmcnt(4)
v_mfma_f32_16x16x32_bf16 a[0:3], a[176:179], a[136:139], a[0:3]
v_and_b32 v217, s50, v152
s_waitcnt vmcnt(10) lgkmcnt(3)
v_mfma_f32_16x16x32_bf16 a[0:3], a[184:187], a[140:143], a[0:3]
v_lshlrev_b32 v224, 16, v156
s_waitcnt vmcnt(9)
v_mfma_f32_16x16x32_bf16 a[4:7], a[188:191], a[140:143], 0
buffer_load_dwordx4 a[224:227], v13, s[8:11], s16 offen offset:0 sc1
v_mfma_f32_16x16x32_bf16 a[4:7], a[180:183], a[136:139], a[4:7]
buffer_load_dwordx4 v[148:151], v10, s[4:7], 0 offen offset:3200
v_mfma_f32_16x16x32_bf16 a[4:7], a[172:175], a[132:135], a[4:7]
buffer_load_dwordx4 a[228:231], v14, s[8:11], s16 offen offset:0 sc1
v_mfma_f32_16x16x32_bf16 a[4:7], a[164:167], a[128:131], a[4:7]
v_and_b32 v225, s50, v156
v_lshlrev_b32 v220, 16, v160
v_mfma_f32_16x16x32_bf16 a[12:15], a[164:167], a[132:135], 0
v_and_b32 v221, s50, v160
v_lshlrev_b32 v230, 16, v164
v_mfma_f32_16x16x32_bf16 a[12:15], a[172:175], a[136:139], a[12:15]
ds_read_b128 a[156:159], v15 offset:1552
v_and_b32 v231, s50, v164
v_mfma_f32_16x16x32_bf16 a[12:15], a[180:183], a[140:143], a[12:15]
v_lshlrev_b32 v214, 16, v168
s_waitcnt lgkmcnt(1)
v_mfma_f32_16x16x32_bf16 a[12:15], a[188:191], a[144:147], a[12:15]
v_and_b32 v215, s50, v168
v_fma_f32 v212, v230, s51, v214
v_mfma_f32_16x16x32_bf16 a[8:11], a[184:187], a[144:147], 0
v_fma_f32 v213, v231, s51, v215
v_fmac_f32 v230, s51, v220
v_mfma_f32_16x16x32_bf16 a[8:11], a[176:179], a[140:143], a[8:11]
v_fmac_f32 v231, s51, v221
v_fmac_f32 v220, s51, v224
v_mfma_f32_16x16x32_bf16 a[8:11], a[168:171], a[136:139], a[8:11]
buffer_load_dwordx4 a[232:235], v13, s[8:11], s16 offen offset:1024 sc1
v_mfma_f32_16x16x32_bf16 a[8:11], a[160:163], a[132:135], a[8:11]
v_fmac_f32 v221, s51, v225
v_fmac_f32 v224, s51, v216
v_mfma_f32_16x16x32_bf16 a[16:19], a[160:163], a[136:139], 0
v_fmac_f32 v225, s51, v217
v_fma_f32 v216, v224, s60, v230
v_mfma_f32_16x16x32_bf16 a[16:19], a[168:171], a[140:143], a[16:19]
ds_read_b128 a[128:131], v15 offset:32
v_fma_f32 v217, v225, s60, v231
v_mfma_f32_16x16x32_bf16 a[16:19], a[176:179], a[144:147], a[16:19]
v_fma_f32 v218, v220, s60, v212
v_fma_f32 v219, v221, s60, v213
v_mfma_f32_16x16x32_bf16 a[16:19], a[184:187], a[148:151], a[16:19]
v_fmac_f32 v230, s52, v224
v_fmac_f32 v231, s52, v225
v_mfma_f32_16x16x32_bf16 a[20:23], a[188:191], a[148:151], 0
v_fmac_f32 v212, s52, v220
v_fmac_f32 v213, s52, v221
v_mfma_f32_16x16x32_bf16 a[20:23], a[180:183], a[144:147], a[20:23]
v_fma_f32 v224, -v216, s53, v218
v_fma_f32 v225, -v217, s53, v219
v_mfma_f32_16x16x32_bf16 a[20:23], a[172:175], a[140:143], a[20:23]
buffer_load_dwordx4 a[236:239], v14, s[8:11], s16 offen offset:1024 sc1
v_mfma_f32_16x16x32_bf16 a[20:23], a[164:167], a[136:139], a[20:23]
v_fmac_f32 v218, s53, v216
v_fmac_f32 v219, s53, v217
v_mfma_f32_16x16x32_bf16 a[28:31], a[164:167], a[140:143], 0
v_fma_f32 v220, -v230, s54, v212
v_fma_f32 v221, -v231, s54, v213
v_mfma_f32_16x16x32_bf16 a[28:31], a[172:175], a[144:147], a[28:31]
ds_read_b128 a[132:135], v15 offset:48
v_fmac_f32 v212, s54, v230
v_mfma_f32_16x16x32_bf16 a[28:31], a[180:183], a[148:151], a[28:31]
v_fmac_f32 v213, s54, v231
v_cvt_pk_bf16_f32 v196, v224, v225
v_mfma_f32_16x16x32_bf16 a[28:31], a[188:191], a[152:155], a[28:31]
v_cvt_pk_bf16_f32 v200, v218, v219
v_cvt_pk_bf16_f32 v204, v220, v221
v_mfma_f32_16x16x32_bf16 a[24:27], a[184:187], a[152:155], 0
v_cvt_pk_bf16_f32 v208, v212, v213
v_lshlrev_b32 v222, 16, v153
v_mfma_f32_16x16x32_bf16 a[24:27], a[176:179], a[148:151], a[24:27]
v_and_b32 v223, s50, v153
v_lshlrev_b32 v234, 16, v157
v_mfma_f32_16x16x32_bf16 a[24:27], a[168:171], a[144:147], a[24:27]
buffer_load_dwordx4 a[240:243], v13, s[8:11], s16 offen offset:2048 sc1
v_mfma_f32_16x16x32_bf16 a[24:27], a[160:163], a[140:143], a[24:27]
buffer_store_dwordx4 v[108:111], v255, s[8:11], s24 offen sc1
v_mfma_f32_16x16x32_bf16 a[32:35], a[160:163], a[144:147], 0
buffer_store_dwordx4 v[112:115], v255, s[8:11], s25 offen sc1
v_mfma_f32_16x16x32_bf16 a[32:35], a[168:171], a[148:151], a[32:35]
ds_read_b128 a[136:139], v15 offset:544
v_and_b32 v235, s50, v157
v_mfma_f32_16x16x32_bf16 a[32:35], a[176:179], a[152:155], a[32:35]
v_lshlrev_b32 v226, 16, v161
s_waitcnt lgkmcnt(1)
v_mfma_f32_16x16x32_bf16 a[32:35], a[184:187], a[156:159], a[32:35]
buffer_store_dwordx4 v[116:119], v255, s[8:11], s26 offen sc1
v_mfma_f32_16x16x32_bf16 a[36:39], a[188:191], a[156:159], 0
buffer_store_dwordx4 v[120:123], v255, s[8:11], s27 offen sc1
v_mfma_f32_16x16x32_bf16 a[36:39], a[180:183], a[152:155], a[36:39]
v_and_b32 v227, s50, v161
v_lshlrev_b32 v228, 16, v165
v_mfma_f32_16x16x32_bf16 a[36:39], a[172:175], a[148:151], a[36:39]
ds_read_b128 a[140:143], v15 offset:8256
v_and_b32 v229, s50, v165
v_mfma_f32_16x16x32_bf16 a[36:39], a[164:167], a[144:147], a[36:39]
ds_read_b128 a[144:147], v15 offset:8272
v_lshlrev_b32 v232, 16, v169
v_mfma_f32_16x16x32_bf16 a[44:47], a[164:167], a[148:151], 0
buffer_load_dwordx4 a[244:247], v14, s[8:11], s16 offen offset:2048 sc1
v_mfma_f32_16x16x32_bf16 a[44:47], a[172:175], a[152:155], a[44:47]
buffer_store_dwordx4 v[124:127], v255, s[8:11], s28 offen sc1
v_mfma_f32_16x16x32_bf16 a[44:47], a[180:183], a[156:159], a[44:47]
buffer_store_dwordx4 v[128:131], v255, s[8:11], s29 offen sc1
v_mfma_f32_16x16x32_bf16 a[44:47], a[188:191], a[128:131], a[44:47]
buffer_store_dwordx4 v[132:135], v255, s[8:11], s30 offen sc1
v_mfma_f32_16x16x32_bf16 a[40:43], a[184:187], a[128:131], 0
v_and_b32 v233, s50, v169
v_fma_f32 v216, v228, s51, v232
v_mfma_f32_16x16x32_bf16 a[40:43], a[176:179], a[156:159], a[40:43]
v_fma_f32 v217, v229, s51, v233
v_fmac_f32 v228, s51, v226
v_mfma_f32_16x16x32_bf16 a[40:43], a[168:171], a[152:155], a[40:43]
buffer_load_dwordx4 a[248:251], v13, s[8:11], s16 offen offset:3072 sc1
v_mfma_f32_16x16x32_bf16 a[40:43], a[160:163], a[148:151], a[40:43]
ds_read_b128 a[148:151], v15 offset:8768
v_fmac_f32 v229, s51, v227
v_mfma_f32_16x16x32_bf16 a[48:51], a[160:163], a[152:155], 0
v_fmac_f32 v226, s51, v234
v_fmac_f32 v227, s51, v235
v_mfma_f32_16x16x32_bf16 a[48:51], a[168:171], a[156:159], a[48:51]
v_fmac_f32 v234, s51, v222
v_fmac_f32 v235, s51, v223
v_mfma_f32_16x16x32_bf16 a[48:51], a[176:179], a[128:131], a[48:51]
v_fma_f32 v222, v234, s60, v228
v_fma_f32 v223, v235, s60, v229
v_mfma_f32_16x16x32_bf16 a[48:51], a[184:187], a[132:135], a[48:51]
v_fma_f32 v230, v226, s60, v216
v_fma_f32 v231, v227, s60, v217
v_mfma_f32_16x16x32_bf16 a[52:55], a[188:191], a[132:135], 0
v_fmac_f32 v228, s52, v234
v_fmac_f32 v229, s52, v235
v_mfma_f32_16x16x32_bf16 a[52:55], a[180:183], a[128:131], a[52:55]
v_fmac_f32 v216, s52, v226
v_fmac_f32 v217, s52, v227
v_mfma_f32_16x16x32_bf16 a[52:55], a[172:175], a[156:159], a[52:55]
buffer_load_dwordx4 a[252:255], v14, s[8:11], s16 offen offset:3072 sc1
v_mfma_f32_16x16x32_bf16 a[52:55], a[164:167], a[152:155], a[52:55]
ds_read_b128 a[152:155], v15 offset:8784
s_add_u32 s16, s16, 4096
v_mfma_f32_16x16x32_bf16 a[60:63], a[164:167], a[156:159], 0
v_fma_f32 v234, -v222, s53, v230
v_fma_f32 v235, -v223, s53, v231
v_mfma_f32_16x16x32_bf16 a[60:63], a[172:175], a[128:131], a[60:63]
v_fmac_f32 v230, s53, v222
v_fmac_f32 v231, s53, v223
v_mfma_f32_16x16x32_bf16 a[60:63], a[180:183], a[132:135], a[60:63]
v_fma_f32 v226, -v228, s54, v216
s_waitcnt vmcnt(16) lgkmcnt(1)
v_mfma_f32_16x16x32_bf16 a[60:63], a[188:191], a[136:139], a[60:63]
v_fma_f32 v227, -v229, s54, v217
v_fmac_f32 v216, s54, v228
v_mfma_f32_16x16x32_bf16 a[56:59], a[184:187], a[136:139], 0
v_fmac_f32 v217, s54, v229
v_cvt_pk_bf16_f32 v197, v234, v235
v_mfma_f32_16x16x32_bf16 a[56:59], a[176:179], a[132:135], a[56:59]
v_cvt_pk_bf16_f32 v201, v230, v231
v_cvt_pk_bf16_f32 v205, v226, v227
v_mfma_f32_16x16x32_bf16 a[56:59], a[168:171], a[128:131], a[56:59]
v_cvt_pk_bf16_f32 v209, v216, v217
v_lshlrev_b32 v224, 16, v154
v_mfma_f32_16x16x32_bf16 a[56:59], a[160:163], a[156:159], a[56:59]
ds_read_b128 a[156:159], v15 offset:9280
v_and_b32 v225, s50, v154
v_mfma_f32_16x16x32_bf16 a[0:3], a[192:195], a[140:143], a[0:3]
ds_read_b128 a[128:131], v15 offset:9296
v_lshlrev_b32 v218, 16, v158
v_mfma_f32_16x16x32_bf16 a[0:3], a[200:203], a[144:147], a[0:3]
ds_read_b128 a[132:135], v15 offset:9792
v_and_b32 v219, s50, v158
v_mfma_f32_16x16x32_bf16 a[0:3], a[208:211], a[148:151], a[0:3]
v_lshlrev_b32 v220, 16, v162
s_waitcnt vmcnt(15) lgkmcnt(3)
v_mfma_f32_16x16x32_bf16 a[0:3], a[216:219], a[152:155], a[0:3]
buffer_load_dwordx4 a[160:163], v13, s[8:11], s16 offen offset:0 sc1
v_mfma_f32_16x16x32_bf16 a[4:7], a[220:223], a[152:155], a[4:7]
v_and_b32 v221, s50, v162
v_lshlrev_b32 v212, 16, v166
v_mfma_f32_16x16x32_bf16 a[4:7], a[212:215], a[148:151], a[4:7]
v_and_b32 v213, s50, v166
v_lshlrev_b32 v222, 16, v170
v_mfma_f32_16x16x32_bf16 a[4:7], a[204:207], a[144:147], a[4:7]
buffer_load_dwordx4 a[164:167], v14, s[8:11], s16 offen offset:0 sc1
v_mfma_f32_16x16x32_bf16 a[4:7], a[196:199], a[140:143], a[4:7]
v_and_b32 v223, s50, v170
v_fma_f32 v228, v212, s51, v222
v_mfma_f32_16x16x32_bf16 a[12:15], a[196:199], a[144:147], a[12:15]
v_fma_f32 v229, v213, s51, v223
v_fmac_f32 v212, s51, v220
v_mfma_f32_16x16x32_bf16 a[12:15], a[204:207], a[148:151], a[12:15]
ds_read_b128 a[136:139], v15 offset:9808
v_fmac_f32 v213, s51, v221
v_mfma_f32_16x16x32_bf16 a[12:15], a[212:215], a[152:155], a[12:15]
v_fmac_f32 v220, s51, v218
s_waitcnt lgkmcnt(1)
v_mfma_f32_16x16x32_bf16 a[12:15], a[220:223], a[156:159], a[12:15]
v_fmac_f32 v221, s51, v219
v_fmac_f32 v218, s51, v224
v_mfma_f32_16x16x32_bf16 a[8:11], a[216:219], a[156:159], a[8:11]
v_fmac_f32 v219, s51, v225
v_fma_f32 v224, v218, s60, v212
v_mfma_f32_16x16x32_bf16 a[8:11], a[208:211], a[152:155], a[8:11]
v_fma_f32 v225, v219, s60, v213
v_fma_f32 v234, v220, s60, v228
v_mfma_f32_16x16x32_bf16 a[8:11], a[200:203], a[148:151], a[8:11]
buffer_load_dwordx4 a[168:171], v13, s[8:11], s16 offen offset:1024 sc1
v_mfma_f32_16x16x32_bf16 a[8:11], a[192:195], a[144:147], a[8:11]
v_fma_f32 v235, v221, s60, v229
v_fmac_f32 v212, s52, v218
v_mfma_f32_16x16x32_bf16 a[16:19], a[192:195], a[148:151], a[16:19]
v_fmac_f32 v213, s52, v219
v_fmac_f32 v228, s52, v220
v_mfma_f32_16x16x32_bf16 a[16:19], a[200:203], a[152:155], a[16:19]
ds_read_b128 a[140:143], v15 offset:8288
v_fmac_f32 v229, s52, v221
v_mfma_f32_16x16x32_bf16 a[16:19], a[208:211], a[156:159], a[16:19]
v_fma_f32 v218, -v224, s53, v234
v_fma_f32 v219, -v225, s53, v235
v_mfma_f32_16x16x32_bf16 a[16:19], a[216:219], a[128:131], a[16:19]
v_fmac_f32 v234, s53, v224
v_fmac_f32 v235, s53, v225
v_mfma_f32_16x16x32_bf16 a[20:23], a[220:223], a[128:131], a[20:23]
v_fma_f32 v220, -v212, s54, v228
v_fma_f32 v221, -v213, s54, v229
v_mfma_f32_16x16x32_bf16 a[20:23], a[212:215], a[156:159], a[20:23]
v_fmac_f32 v228, s54, v212
v_fmac_f32 v229, s54, v213
v_mfma_f32_16x16x32_bf16 a[20:23], a[204:207], a[152:155], a[20:23]
buffer_load_dwordx4 a[172:175], v14, s[8:11], s16 offen offset:1024 sc1
v_mfma_f32_16x16x32_bf16 a[20:23], a[196:199], a[148:151], a[20:23]
v_cvt_pk_bf16_f32 v198, v218, v219
v_cvt_pk_bf16_f32 v202, v234, v235
v_mfma_f32_16x16x32_bf16 a[28:31], a[196:199], a[152:155], a[28:31]
v_cvt_pk_bf16_f32 v206, v220, v221
v_cvt_pk_bf16_f32 v210, v228, v229
v_mfma_f32_16x16x32_bf16 a[28:31], a[204:207], a[156:159], a[28:31]
ds_read_b128 a[144:147], v15 offset:8304
v_lshlrev_b32 v230, 16, v155
v_mfma_f32_16x16x32_bf16 a[28:31], a[212:215], a[128:131], a[28:31]
v_and_b32 v231, s50, v155
v_lshlrev_b32 v226, 16, v159
v_mfma_f32_16x16x32_bf16 a[28:31], a[220:223], a[132:135], a[28:31]
v_and_b32 v227, s50, v159
v_lshlrev_b32 v216, 16, v163
v_mfma_f32_16x16x32_bf16 a[24:27], a[216:219], a[132:135], a[24:27]
v_and_b32 v217, s50, v163
v_lshlrev_b32 v224, 16, v167
v_mfma_f32_16x16x32_bf16 a[24:27], a[208:211], a[128:131], a[24:27]
v_and_b32 v225, s50, v167
v_lshlrev_b32 v212, 16, v171
v_mfma_f32_16x16x32_bf16 a[24:27], a[200:203], a[156:159], a[24:27]
buffer_load_dwordx4 a[176:179], v13, s[8:11], s16 offen offset:2048 sc1
v_mfma_f32_16x16x32_bf16 a[24:27], a[192:195], a[152:155], a[24:27]
v_and_b32 v213, s50, v171
v_fma_f32 v218, v224, s51, v212
v_mfma_f32_16x16x32_bf16 a[32:35], a[192:195], a[156:159], a[32:35]
v_fma_f32 v219, v225, s51, v213
v_fmac_f32 v224, s51, v216
v_mfma_f32_16x16x32_bf16 a[32:35], a[200:203], a[128:131], a[32:35]
ds_read_b128 a[148:151], v15 offset:8800
v_fmac_f32 v225, s51, v217
v_mfma_f32_16x16x32_bf16 a[32:35], a[208:211], a[132:135], a[32:35]
v_fmac_f32 v216, s51, v226
s_waitcnt lgkmcnt(1)
v_mfma_f32_16x16x32_bf16 a[32:35], a[216:219], a[136:139], a[32:35]
v_fmac_f32 v217, s51, v227
v_fmac_f32 v226, s51, v230
v_mfma_f32_16x16x32_bf16 a[36:39], a[220:223], a[136:139], a[36:39]
s_add_u32 s36, s3, 0
v_fmac_f32 v227, s51, v231
v_mfma_f32_16x16x32_bf16 a[36:39], a[212:215], a[132:135], a[36:39]
buffer_store_dwordx4 v[88:91], v12, s[8:11], s36 offen sc1
v_mfma_f32_16x16x32_bf16 a[36:39], a[204:207], a[128:131], a[36:39]
ds_read_b128 a[152:155], v15 offset:16512
s_add_u32 s36, s3, 65536
v_mfma_f32_16x16x32_bf16 a[36:39], a[196:199], a[156:159], a[36:39]
ds_read_b128 a[156:159], v15 offset:16528
v_fma_f32 v230, v226, s60, v224
v_fma_f32 v231, v227, s60, v225
v_fma_f32 v234, v216, s60, v218
v_mfma_f32_16x16x32_bf16 a[44:47], a[196:199], a[128:131], a[44:47]
buffer_load_dwordx4 a[180:183], v14, s[8:11], s16 offen offset:2048 sc1
v_mfma_f32_16x16x32_bf16 a[44:47], a[204:207], a[132:135], a[44:47]
v_fma_f32 v235, v217, s60, v219
v_fmac_f32 v224, s52, v226
v_mfma_f32_16x16x32_bf16 a[44:47], a[212:215], a[136:139], a[44:47]
v_fmac_f32 v225, s52, v227
v_fmac_f32 v218, s52, v216
v_mfma_f32_16x16x32_bf16 a[44:47], a[220:223], a[140:143], a[44:47]
v_fmac_f32 v219, s52, v217
v_fma_f32 v226, -v230, s53, v234
v_fma_f32 v227, -v231, s53, v235
v_fmac_f32 v234, s53, v230
v_mfma_f32_16x16x32_bf16 a[40:43], a[216:219], a[140:143], a[40:43]
v_fmac_f32 v235, s53, v231
v_fma_f32 v216, -v224, s54, v218
v_mfma_f32_16x16x32_bf16 a[40:43], a[208:211], a[136:139], a[40:43]
v_fma_f32 v217, -v225, s54, v219
v_fmac_f32 v218, s54, v224
v_mfma_f32_16x16x32_bf16 a[40:43], a[200:203], a[132:135], a[40:43]
buffer_load_dwordx4 a[184:187], v13, s[8:11], s16 offen offset:3072 sc1
v_mfma_f32_16x16x32_bf16 a[40:43], a[192:195], a[128:131], a[40:43]
ds_read_b128 a[128:131], v15 offset:17024
v_fmac_f32 v219, s54, v225
v_cvt_pk_bf16_f32 v199, v226, v227
v_mfma_f32_16x16x32_bf16 a[48:51], a[192:195], a[132:135], a[48:51]
v_cvt_pk_bf16_f32 v203, v234, v235
v_cvt_pk_bf16_f32 v207, v216, v217
v_mfma_f32_16x16x32_bf16 a[48:51], a[200:203], a[136:139], a[48:51]
v_cvt_pk_bf16_f32 v211, v218, v219
v_mfma_f32_16x16x32_bf16 a[48:51], a[208:211], a[140:143], a[48:51]
ds_write_b128 v8, v[196:199] offset:0
v_mfma_f32_16x16x32_bf16 a[48:51], a[216:219], a[144:147], a[48:51]
ds_write_b128 v8, v[200:203] offset:16512
v_mfma_f32_16x16x32_bf16 a[52:55], a[220:223], a[144:147], a[52:55]
ds_write_b128 v8, v[204:207] offset:33024
v_mfma_f32_16x16x32_bf16 a[52:55], a[212:215], a[140:143], a[52:55]
ds_write_b128 v8, v[208:211] offset:49536
v_mfma_f32_16x16x32_bf16 a[52:55], a[204:207], a[136:139], a[52:55]
buffer_load_dwordx4 a[188:191], v14, s[8:11], s16 offen offset:3072 sc1
v_mfma_f32_16x16x32_bf16 a[52:55], a[196:199], a[132:135], a[52:55]
ds_read_b128 a[132:135], v15 offset:17040
s_add_u32 s16, s16, 4096
v_lshlrev_b32 v220, 16, v172
v_and_b32 v221, s50, v172
v_mfma_f32_16x16x32_bf16 a[60:63], a[196:199], a[136:139], a[60:63]
v_lshlrev_b32 v228, 16, v176
v_and_b32 v229, s50, v176
v_mfma_f32_16x16x32_bf16 a[60:63], a[204:207], a[140:143], a[60:63]
v_lshlrev_b32 v230, 16, v180
v_and_b32 v231, s50, v180
v_mfma_f32_16x16x32_bf16 a[60:63], a[212:215], a[144:147], a[60:63]
v_lshlrev_b32 v224, 16, v184
s_waitcnt vmcnt(19) lgkmcnt(5)
v_mfma_f32_16x16x32_bf16 a[60:63], a[220:223], a[148:151], a[60:63]
v_and_b32 v225, s50, v184
v_fma_f32 v226, v230, s51, v224
v_mfma_f32_16x16x32_bf16 a[56:59], a[216:219], a[148:151], a[56:59]
v_fma_f32 v227, v231, s51, v225
v_fmac_f32 v230, s51, v228
v_mfma_f32_16x16x32_bf16 a[56:59], a[208:211], a[144:147], a[56:59]
v_fmac_f32 v231, s51, v229
v_fmac_f32 v228, s51, v220
v_mfma_f32_16x16x32_bf16 a[56:59], a[200:203], a[140:143], a[56:59]
v_fmac_f32 v229, s51, v221
v_fmac_f32 v220, s51, v214
v_mfma_f32_16x16x32_bf16 a[56:59], a[192:195], a[136:139], a[56:59]
ds_read_b128 a[136:139], v15 offset:17536
v_fmac_f32 v221, s51, v215
v_mfma_f32_16x16x32_bf16 v[20:23], a[224:227], a[152:155], 0
ds_read_b128 a[140:143], v15 offset:17552
v_fma_f32 v214, v220, s60, v230
v_mfma_f32_16x16x32_bf16 v[20:23], a[232:235], a[156:159], v[20:23]
ds_read_b128 a[144:147], v15 offset:18048
v_fma_f32 v215, v221, s60, v231
v_mfma_f32_16x16x32_bf16 v[20:23], a[240:243], a[128:131], v[20:23]
s_waitcnt vmcnt(7) lgkmcnt(3)
s_barrier
v_mfma_f32_16x16x32_bf16 v[20:23], a[248:251], a[132:135], v[20:23]
buffer_load_dwordx4 a[192:195], v13, s[8:11], s16 offen offset:0 sc1
v_fma_f32 v234, v228, s60, v226
v_fma_f32 v235, v229, s60, v227
v_mfma_f32_16x16x32_bf16 v[24:27], a[252:255], a[132:135], 0
s_cmp_eq_u32 s31, 0
s_cbranch_scc1 Lu_pub
Lu_pubr:
v_mfma_f32_16x16x32_bf16 v[24:27], a[244:247], a[128:131], v[24:27]
buffer_load_dwordx4 v[152:155], v11, s[4:7], 0 offen offset:128
v_mfma_f32_16x16x32_bf16 v[24:27], a[236:239], a[156:159], v[24:27]
buffer_load_dwordx4 a[196:199], v14, s[8:11], s16 offen offset:0 sc1
v_mfma_f32_16x16x32_bf16 v[24:27], a[228:231], a[152:155], v[24:27]
buffer_load_dwordx4 v[156:159], v10, s[4:7], 0 offen offset:2176
v_fmac_f32 v230, s52, v220
v_fmac_f32 v231, s52, v221
v_mfma_f32_16x16x32_bf16 v[32:35], a[228:231], a[156:159], 0
buffer_load_dwordx4 v[160:163], v10, s[4:7], 0 offen offset:128
v_mfma_f32_16x16x32_bf16 v[32:35], a[236:239], a[128:131], v[32:35]
ds_read_b128 a[148:151], v15 offset:18064
v_fmac_f32 v226, s52, v228
v_mfma_f32_16x16x32_bf16 v[32:35], a[244:247], a[132:135], v[32:35]
v_fmac_f32 v227, s52, v229
s_waitcnt vmcnt(11) lgkmcnt(1)
v_mfma_f32_16x16x32_bf16 v[32:35], a[252:255], a[136:139], v[32:35]
buffer_load_dwordx4 v[164:167], v9, s[4:7], 0 offen offset:128
v_fma_f32 v220, -v214, s53, v234
v_fma_f32 v221, -v215, s53, v235
v_mfma_f32_16x16x32_bf16 v[28:31], a[248:251], a[136:139], 0
s_mov_b32 s24, 0
s_mov_b32 s25, 4096
v_mfma_f32_16x16x32_bf16 v[28:31], a[240:243], a[132:135], v[28:31]
s_mov_b32 s26, 8192
s_mov_b32 s27, 12288
v_mfma_f32_16x16x32_bf16 v[28:31], a[232:235], a[128:131], v[28:31]
buffer_load_dwordx4 a[200:203], v13, s[8:11], s16 offen offset:1024 sc1
v_mfma_f32_16x16x32_bf16 v[28:31], a[224:227], a[156:159], v[28:31]
s_mov_b32 s28, 16384
s_mov_b32 s29, 20480
v_fmac_f32 v234, s53, v214
v_fmac_f32 v235, s53, v215
v_mfma_f32_16x16x32_bf16 v[36:39], a[224:227], a[128:131], 0
s_mov_b32 s30, 24576
s_mov_b32 s31, 28672
v_mfma_f32_16x16x32_bf16 v[36:39], a[232:235], a[132:135], v[36:39]
ds_read_b128 a[152:155], v15 offset:16544
v_fma_f32 v228, -v230, s54, v226
v_mfma_f32_16x16x32_bf16 v[36:39], a[240:243], a[136:139], v[36:39]
buffer_load_dwordx4 v[168:171], v4, s[4:7], 0 offen offset:128
v_mfma_f32_16x16x32_bf16 v[36:39], a[248:251], a[140:143], v[36:39]
v_fma_f32 v229, -v231, s54, v227
v_fmac_f32 v226, s54, v230
v_fmac_f32 v227, s54, v231
v_cvt_pk_bf16_f32 v196, v220, v221
v_mfma_f32_16x16x32_bf16 v[40:43], a[252:255], a[140:143], 0
v_cvt_pk_bf16_f32 v200, v234, v235
v_cvt_pk_bf16_f32 v204, v228, v229
v_mfma_f32_16x16x32_bf16 v[40:43], a[244:247], a[136:139], v[40:43]
v_cvt_pk_bf16_f32 v208, v226, v227
v_lshlrev_b32 v216, 16, v173
v_mfma_f32_16x16x32_bf16 v[40:43], a[236:239], a[132:135], v[40:43]
buffer_load_dwordx4 a[204:207], v14, s[8:11], s16 offen offset:1024 sc1
v_mfma_f32_16x16x32_bf16 v[40:43], a[228:231], a[128:131], v[40:43]
v_and_b32 v217, s50, v173
v_lshlrev_b32 v218, 16, v177
v_and_b32 v219, s50, v177
v_lshlrev_b32 v214, 16, v181
v_mfma_f32_16x16x32_bf16 v[48:51], a[228:231], a[132:135], 0
v_and_b32 v215, s50, v181
v_lshlrev_b32 v230, 16, v185
v_mfma_f32_16x16x32_bf16 v[48:51], a[236:239], a[136:139], v[48:51]
ds_read_b128 a[156:159], v15 offset:16560
v_and_b32 v231, s50, v185
v_mfma_f32_16x16x32_bf16 v[48:51], a[244:247], a[140:143], v[48:51]
v_fma_f32 v220, v214, s51, v230
v_fma_f32 v221, v215, s51, v231
v_mfma_f32_16x16x32_bf16 v[48:51], a[252:255], a[144:147], v[48:51]
v_fmac_f32 v214, s51, v218
v_fmac_f32 v215, s51, v219
v_fmac_f32 v218, s51, v216
v_fmac_f32 v219, s51, v217
v_mfma_f32_16x16x32_bf16 v[44:47], a[248:251], a[144:147], 0
v_fmac_f32 v216, s51, v232
v_fmac_f32 v217, s51, v233
v_mfma_f32_16x16x32_bf16 v[44:47], a[240:243], a[140:143], v[44:47]
v_fma_f32 v232, v216, s60, v214
v_fma_f32 v233, v217, s60, v215
v_mfma_f32_16x16x32_bf16 v[44:47], a[232:235], a[136:139], v[44:47]
buffer_load_dwordx4 a[208:211], v13, s[8:11], s16 offen offset:2048 sc1
v_mfma_f32_16x16x32_bf16 v[44:47], a[224:227], a[132:135], v[44:47]
v_fma_f32 v234, v218, s60, v220
v_fma_f32 v235, v219, s60, v221
v_fmac_f32 v214, s52, v216
v_fmac_f32 v215, s52, v217
v_mfma_f32_16x16x32_bf16 v[52:55], a[224:227], a[136:139], 0
v_fmac_f32 v220, s52, v218
v_fmac_f32 v221, s52, v219
v_mfma_f32_16x16x32_bf16 v[52:55], a[232:235], a[140:143], v[52:55]
ds_read_b128 a[128:131], v15 offset:17056
v_fma_f32 v216, -v232, s53, v234
v_mfma_f32_16x16x32_bf16 v[52:55], a[240:243], a[144:147], v[52:55]
v_fma_f32 v217, -v233, s53, v235
s_waitcnt vmcnt(14) lgkmcnt(1)
v_mfma_f32_16x16x32_bf16 v[52:55], a[248:251], a[148:151], v[52:55]
v_fmac_f32 v234, s53, v232
v_fmac_f32 v235, s53, v233
v_fma_f32 v218, -v214, s54, v220
v_fma_f32 v219, -v215, s54, v221
v_mfma_f32_16x16x32_bf16 v[56:59], a[252:255], a[148:151], 0
v_fmac_f32 v220, s54, v214
v_fmac_f32 v221, s54, v215
v_mfma_f32_16x16x32_bf16 v[56:59], a[244:247], a[144:147], v[56:59]
v_cvt_pk_bf16_f32 v197, v216, v217
v_cvt_pk_bf16_f32 v201, v234, v235
v_mfma_f32_16x16x32_bf16 v[56:59], a[236:239], a[140:143], v[56:59]
ds_read_b128 a[132:135], v15 offset:24768
v_cvt_pk_bf16_f32 v205, v218, v219
v_mfma_f32_16x16x32_bf16 v[56:59], a[228:231], a[136:139], v[56:59]
ds_read_b128 a[136:139], v15 offset:24784
v_cvt_pk_bf16_f32 v209, v220, v221
v_lshlrev_b32 v228, 16, v174
v_and_b32 v229, s50, v174
v_mfma_f32_16x16x32_bf16 v[64:67], a[228:231], a[140:143], 0
buffer_load_dwordx4 a[212:215], v14, s[8:11], s16 offen offset:2048 sc1
v_mfma_f32_16x16x32_bf16 v[64:67], a[236:239], a[144:147], v[64:67]
v_lshlrev_b32 v226, 16, v178
v_and_b32 v227, s50, v178
v_mfma_f32_16x16x32_bf16 v[64:67], a[244:247], a[148:151], v[64:67]
v_lshlrev_b32 v232, 16, v182
v_and_b32 v233, s50, v182
v_mfma_f32_16x16x32_bf16 v[64:67], a[252:255], a[152:155], v[64:67]
v_lshlrev_b32 v214, 16, v186
v_and_b32 v215, s50, v186
v_fma_f32 v216, v232, s51, v214
v_fma_f32 v217, v233, s51, v215
v_mfma_f32_16x16x32_bf16 v[60:63], a[248:251], a[152:155], 0
v_fmac_f32 v232, s51, v226
v_fmac_f32 v233, s51, v227
v_mfma_f32_16x16x32_bf16 v[60:63], a[240:243], a[148:151], v[60:63]
v_fmac_f32 v226, s51, v228
v_fmac_f32 v227, s51, v229
v_mfma_f32_16x16x32_bf16 v[60:63], a[232:235], a[144:147], v[60:63]
buffer_load_dwordx4 a[216:219], v13, s[8:11], s16 offen offset:3072 sc1
v_mfma_f32_16x16x32_bf16 v[60:63], a[224:227], a[140:143], v[60:63]
ds_read_b128 a[140:143], v15 offset:25280
v_fmac_f32 v228, s51, v222
v_fmac_f32 v229, s51, v223
v_fma_f32 v222, v228, s60, v232
v_mfma_f32_16x16x32_bf16 v[68:71], a[224:227], a[144:147], 0
v_fma_f32 v223, v229, s60, v233
v_fma_f32 v234, v226, s60, v216
v_mfma_f32_16x16x32_bf16 v[68:71], a[232:235], a[148:151], v[68:71]
v_fma_f32 v235, v227, s60, v217
v_fmac_f32 v232, s52, v228
v_mfma_f32_16x16x32_bf16 v[68:71], a[240:243], a[152:155], v[68:71]
v_fmac_f32 v233, s52, v229
v_fmac_f32 v216, s52, v226
v_mfma_f32_16x16x32_bf16 v[68:71], a[248:251], a[156:159], v[68:71]
v_fmac_f32 v217, s52, v227
v_fma_f32 v228, -v222, s53, v234
v_fma_f32 v229, -v223, s53, v235
v_fmac_f32 v234, s53, v222
v_mfma_f32_16x16x32_bf16 v[72:75], a[252:255], a[156:159], 0
v_fmac_f32 v235, s53, v223
v_fma_f32 v226, -v232, s54, v216
v_mfma_f32_16x16x32_bf16 v[72:75], a[244:247], a[152:155], v[72:75]
v_fma_f32 v227, -v233, s54, v217
v_fmac_f32 v216, s54, v232
v_mfma_f32_16x16x32_bf16 v[72:75], a[236:239], a[148:151], v[72:75]
buffer_load_dwordx4 a[220:223], v14, s[8:11], s16 offen offset:3072 sc1
v_mfma_f32_16x16x32_bf16 v[72:75], a[228:231], a[144:147], v[72:75]
ds_read_b128 a[144:147], v15 offset:25296
s_add_u32 s16, s16, 4096
v_fmac_f32 v217, s54, v233
v_cvt_pk_bf16_f32 v198, v228, v229
v_mfma_f32_16x16x32_bf16 v[80:83], a[228:231], a[148:151], 0
v_cvt_pk_bf16_f32 v202, v234, v235
v_cvt_pk_bf16_f32 v206, v226, v227
v_mfma_f32_16x16x32_bf16 v[80:83], a[236:239], a[152:155], v[80:83]
v_cvt_pk_bf16_f32 v210, v216, v217
v_lshlrev_b32 v218, 16, v175
v_mfma_f32_16x16x32_bf16 v[80:83], a[244:247], a[156:159], v[80:83]
v_and_b32 v219, s50, v175
s_waitcnt lgkmcnt(1)
v_mfma_f32_16x16x32_bf16 v[80:83], a[252:255], a[128:131], v[80:83]
v_lshlrev_b32 v220, 16, v179
v_and_b32 v221, s50, v179
v_lshlrev_b32 v222, 16, v183
v_mfma_f32_16x16x32_bf16 v[76:79], a[248:251], a[128:131], 0
v_and_b32 v223, s50, v183
v_lshlrev_b32 v232, 16, v187
v_mfma_f32_16x16x32_bf16 v[76:79], a[240:243], a[156:159], v[76:79]
v_and_b32 v233, s50, v187
v_fma_f32 v228, v222, s51, v232
v_mfma_f32_16x16x32_bf16 v[76:79], a[232:235], a[152:155], v[76:79]
v_fma_f32 v229, v223, s51, v233
v_fmac_f32 v222, s51, v220
v_mfma_f32_16x16x32_bf16 v[76:79], a[224:227], a[148:151], v[76:79]
ds_read_b128 a[148:151], v15 offset:25792
v_fmac_f32 v223, s51, v221
v_mfma_f32_16x16x32_bf16 v[20:23], a[160:163], a[132:135], v[20:23]
ds_read_b128 a[152:155], v15 offset:25808
v_fmac_f32 v220, s51, v218
v_mfma_f32_16x16x32_bf16 v[20:23], a[168:171], a[136:139], v[20:23]
ds_read_b128 a[156:159], v15 offset:26304
v_fmac_f32 v221, s51, v219
v_mfma_f32_16x16x32_bf16 v[20:23], a[176:179], a[140:143], v[20:23]
v_fmac_f32 v218, s51, v212
s_waitcnt vmcnt(12) lgkmcnt(3)
v_mfma_f32_16x16x32_bf16 v[20:23], a[184:187], a[144:147], v[20:23]
buffer_load_dwordx4 a[224:227], v13, s[8:11], s16 offen offset:0 sc1
v_fmac_f32 v219, s51, v213
v_fma_f32 v212, v218, s60, v222
v_mfma_f32_16x16x32_bf16 v[24:27], a[188:191], a[144:147], v[24:27]
buffer_store_dwordx4 v[92:95], v12, s[8:11], s36 offen sc1
v_mfma_f32_16x16x32_bf16 v[24:27], a[180:183], a[140:143], v[24:27]
s_add_u32 s36, s3, 131072
v_fma_f32 v213, v219, s60, v223
v_mfma_f32_16x16x32_bf16 v[24:27], a[172:175], a[136:139], v[24:27]
buffer_load_dwordx4 a[228:231], v14, s[8:11], s16 offen offset:0 sc1
v_mfma_f32_16x16x32_bf16 v[24:27], a[164:167], a[132:135], v[24:27]
v_fma_f32 v234, v220, s60, v228
v_fma_f32 v235, v221, s60, v229
v_fmac_f32 v222, s52, v218
v_fmac_f32 v223, s52, v219
v_mfma_f32_16x16x32_bf16 v[32:35], a[164:167], a[136:139], v[32:35]
v_fmac_f32 v228, s52, v220
v_fmac_f32 v229, s52, v221
v_mfma_f32_16x16x32_bf16 v[32:35], a[172:175], a[140:143], v[32:35]
ds_read_b128 a[128:131], v15 offset:26320
v_fma_f32 v218, -v212, s53, v234
v_mfma_f32_16x16x32_bf16 v[32:35], a[180:183], a[144:147], v[32:35]
v_fma_f32 v219, -v213, s53, v235
s_waitcnt lgkmcnt(1)
v_mfma_f32_16x16x32_bf16 v[32:35], a[188:191], a[148:151], v[32:35]
v_fmac_f32 v234, s53, v212
v_fmac_f32 v235, s53, v213
v_fma_f32 v220, -v222, s54, v228
v_fma_f32 v221, -v223, s54, v229
v_mfma_f32_16x16x32_bf16 v[28:31], a[184:187], a[148:151], v[28:31]
v_fmac_f32 v228, s54, v222
v_fmac_f32 v229, s54, v223
v_mfma_f32_16x16x32_bf16 v[28:31], a[176:179], a[144:147], v[28:31]
v_cvt_pk_bf16_f32 v199, v218, v219
v_cvt_pk_bf16_f32 v203, v234, v235
v_mfma_f32_16x16x32_bf16 v[28:31], a[168:171], a[140:143], v[28:31]
buffer_load_dwordx4 a[232:235], v13, s[8:11], s16 offen offset:1024 sc1
v_mfma_f32_16x16x32_bf16 v[28:31], a[160:163], a[136:139], v[28:31]
v_cvt_pk_bf16_f32 v207, v220, v221
v_cvt_pk_bf16_f32 v211, v228, v229
v_mfma_f32_16x16x32_bf16 v[36:39], a[160:163], a[140:143], v[36:39]
ds_write_b128 v8, v[196:199] offset:16
v_mfma_f32_16x16x32_bf16 v[36:39], a[168:171], a[144:147], v[36:39]
ds_read_b128 a[132:135], v15 offset:24800
v_mfma_f32_16x16x32_bf16 v[36:39], a[176:179], a[148:151], v[36:39]
ds_write_b128 v8, v[200:203] offset:16528
v_mfma_f32_16x16x32_bf16 v[36:39], a[184:187], a[152:155], v[36:39]
ds_write_b128 v8, v[204:207] offset:33040
v_mfma_f32_16x16x32_bf16 v[40:43], a[188:191], a[152:155], v[40:43]
ds_write_b128 v8, v[208:211] offset:49552
v_mfma_f32_16x16x32_bf16 v[40:43], a[180:183], a[148:151], v[40:43]
v_lshlrev_b32 v226, 16, v188
v_and_b32 v227, s50, v188
v_mfma_f32_16x16x32_bf16 v[40:43], a[172:175], a[144:147], v[40:43]
buffer_load_dwordx4 a[236:239], v14, s[8:11], s16 offen offset:1024 sc1
v_mfma_f32_16x16x32_bf16 v[40:43], a[164:167], a[140:143], v[40:43]
v_lshlrev_b32 v216, 16, v192
v_and_b32 v217, s50, v192
v_lshlrev_b32 v212, 16, v148
v_and_b32 v213, s50, v148
v_mfma_f32_16x16x32_bf16 v[48:51], a[164:167], a[144:147], v[48:51]
v_fmac_f32 v212, s56, v216
v_fmac_f32 v213, s56, v217
v_mfma_f32_16x16x32_bf16 v[48:51], a[172:175], a[148:151], v[48:51]
ds_read_b128 a[136:139], v15 offset:24816
v_fmac_f32 v212, s55, v226
v_mfma_f32_16x16x32_bf16 v[48:51], a[180:183], a[152:155], v[48:51]
v_fmac_f32 v213, s55, v227
v_lshlrev_b32 v222, 16, v189
v_mfma_f32_16x16x32_bf16 v[48:51], a[188:191], a[156:159], v[48:51]
v_and_b32 v223, s50, v189
v_lshlrev_b32 v218, 16, v193
v_and_b32 v219, s50, v193
v_mfma_f32_16x16x32_bf16 v[44:47], a[184:187], a[156:159], v[44:47]
v_lshlrev_b32 v234, 16, v149
v_and_b32 v235, s50, v149
v_mfma_f32_16x16x32_bf16 v[44:47], a[176:179], a[152:155], v[44:47]
v_fmac_f32 v234, s56, v218
v_fmac_f32 v235, s56, v219
v_mfma_f32_16x16x32_bf16 v[44:47], a[168:171], a[148:151], v[44:47]
buffer_load_dwordx4 a[240:243], v13, s[8:11], s16 offen offset:2048 sc1
v_mfma_f32_16x16x32_bf16 v[44:47], a[160:163], a[144:147], v[44:47]
v_fmac_f32 v234, s55, v222
v_fmac_f32 v235, s55, v223
v_mfma_f32_16x16x32_bf16 v[52:55], a[160:163], a[148:151], v[52:55]
v_lshlrev_b32 v220, 16, v190
v_and_b32 v221, s50, v190
v_mfma_f32_16x16x32_bf16 v[52:55], a[168:171], a[152:155], v[52:55]
ds_read_b128 a[140:143], v15 offset:25312
v_lshlrev_b32 v228, 16, v194
v_mfma_f32_16x16x32_bf16 v[52:55], a[176:179], a[156:159], v[52:55]
v_and_b32 v229, s50, v194
s_waitcnt lgkmcnt(1)
v_mfma_f32_16x16x32_bf16 v[52:55], a[184:187], a[128:131], v[52:55]
buffer_load_dwordx4 v[172:175], v4, s[4:7], 0 offen offset:1152
v_lshlrev_b32 v226, 16, v150
v_and_b32 v227, s50, v150
v_mfma_f32_16x16x32_bf16 v[56:59], a[188:191], a[128:131], v[56:59]
buffer_load_dwordx4 v[176:179], v4, s[4:7], 0 offen offset:2176
v_mfma_f32_16x16x32_bf16 v[56:59], a[180:183], a[156:159], v[56:59]
buffer_load_dwordx4 v[180:183], v4, s[4:7], 0 offen offset:3200
v_mfma_f32_16x16x32_bf16 v[56:59], a[172:175], a[152:155], v[56:59]
ds_read_b128 a[144:147], v15 offset:33024
v_fmac_f32 v226, s56, v228
v_mfma_f32_16x16x32_bf16 v[56:59], a[164:167], a[148:151], v[56:59]
ds_read_b128 a[148:151], v15 offset:33040
v_fmac_f32 v227, s56, v229
v_fmac_f32 v226, s55, v220
v_fmac_f32 v227, s55, v221
v_mfma_f32_16x16x32_bf16 v[64:67], a[164:167], a[152:155], v[64:67]
buffer_load_dwordx4 a[244:247], v14, s[8:11], s16 offen offset:2048 sc1
v_mfma_f32_16x16x32_bf16 v[64:67], a[172:175], a[156:159], v[64:67]
buffer_load_dwordx4 v[184:187], v5, s[4:7], 0 offen offset:128
v_mfma_f32_16x16x32_bf16 v[64:67], a[180:183], a[128:131], v[64:67]
v_lshlrev_b32 v216, 16, v191
v_and_b32 v217, s50, v191
v_mfma_f32_16x16x32_bf16 v[64:67], a[188:191], a[132:135], v[64:67]
v_lshlrev_b32 v222, 16, v195
v_and_b32 v223, s50, v195
v_lshlrev_b32 v218, 16, v151
v_and_b32 v219, s50, v151
v_mfma_f32_16x16x32_bf16 v[60:63], a[184:187], a[132:135], v[60:63]
v_fmac_f32 v218, s56, v222
v_fmac_f32 v219, s56, v223
v_mfma_f32_16x16x32_bf16 v[60:63], a[176:179], a[128:131], v[60:63]
v_fmac_f32 v218, s55, v216
v_fmac_f32 v219, s55, v217
v_mfma_f32_16x16x32_bf16 v[60:63], a[168:171], a[156:159], v[60:63]
buffer_load_dwordx4 a[248:251], v13, s[8:11], s16 offen offset:3072 sc1
v_mfma_f32_16x16x32_bf16 v[60:63], a[160:163], a[152:155], v[60:63]
ds_read_b128 a[152:155], v15 offset:33536
v_mfma_f32_16x16x32_bf16 v[68:71], a[160:163], a[156:159], v[68:71]
buffer_load_dwordx4 v[188:191], v5, s[4:7], 0 offen offset:1152
v_mfma_f32_16x16x32_bf16 v[68:71], a[168:171], a[128:131], v[68:71]
buffer_load_dwordx4 v[192:195], v5, s[4:7], 0 offen offset:2176
v_mfma_f32_16x16x32_bf16 v[68:71], a[176:179], a[132:135], v[68:71]
buffer_load_dwordx4 v[148:151], v5, s[4:7], 0 offen offset:3200
v_mfma_f32_16x16x32_bf16 v[68:71], a[184:187], a[136:139], v[68:71]
s_waitcnt vmcnt(25) lgkmcnt(1)
v_lshlrev_b32 v220, 16, v152
v_and_b32 v221, s50, v152
v_mfma_f32_16x16x32_bf16 v[72:75], a[188:191], a[136:139], v[72:75]
s_waitcnt vmcnt(24)
v_lshlrev_b32 v228, 16, v156
v_mfma_f32_16x16x32_bf16 v[72:75], a[180:183], a[132:135], v[72:75]
v_and_b32 v229, s50, v156
v_fma_f32 v220, v220, s58, v212
v_mfma_f32_16x16x32_bf16 v[72:75], a[172:175], a[128:131], v[72:75]
buffer_load_dwordx4 a[252:255], v14, s[8:11], s16 offen offset:3072 sc1
v_mfma_f32_16x16x32_bf16 v[72:75], a[164:167], a[156:159], v[72:75]
ds_read_b128 a[156:159], v15 offset:33552
s_add_u32 s16, s16, 4096
v_fma_f32 v221, v221, s58, v213
v_fmac_f32 v220, s57, v228
v_mfma_f32_16x16x32_bf16 v[80:83], a[164:167], a[128:131], v[80:83]
v_fmac_f32 v221, s57, v229
v_fmac_f32 v228, s58, v212
v_mfma_f32_16x16x32_bf16 v[80:83], a[172:175], a[132:135], v[80:83]
v_fmac_f32 v229, s58, v213
v_cvt_pk_bf16_f32 v236, v212, v213
v_mfma_f32_16x16x32_bf16 v[80:83], a[180:183], a[136:139], v[80:83]
s_waitcnt vmcnt(22) lgkmcnt(1)
v_lshlrev_b32 v216, 16, v160
v_mfma_f32_16x16x32_bf16 v[80:83], a[188:191], a[140:143], v[80:83]
v_and_b32 v217, s50, v160
v_lshlrev_b32 v222, 16, v164
v_and_b32 v223, s50, v164
v_fmac_f32 v220, s59, v216
v_mfma_f32_16x16x32_bf16 v[76:79], a[184:187], a[140:143], v[76:79]
v_fmac_f32 v221, s59, v217
v_fmac_f32 v228, s56, v216
v_mfma_f32_16x16x32_bf16 v[76:79], a[176:179], a[136:139], v[76:79]
v_fmac_f32 v229, s56, v217
v_fmac_f32 v228, s55, v222
v_mfma_f32_16x16x32_bf16 v[76:79], a[168:171], a[132:135], v[76:79]
v_fmac_f32 v229, s55, v223
v_cvt_pk_bf16_f32 v240, v228, v229
v_mfma_f32_16x16x32_bf16 v[76:79], a[160:163], a[128:131], v[76:79]
ds_read_b128 a[128:131], v15 offset:34048
v_cvt_pk_bf16_f32 v244, v220, v221
v_lshlrev_b32 v212, 16, v153
v_and_b32 v213, s50, v153
v_mfma_f32_16x16x32_bf16 a[64:67], a[192:195], a[144:147], 0
ds_read_b128 a[132:135], v15 offset:34064
v_lshlrev_b32 v222, 16, v157
v_mfma_f32_16x16x32_bf16 a[64:67], a[200:203], a[148:151], a[64:67]
ds_read_b128 a[136:139], v15 offset:34560
s_waitcnt vmcnt(15) lgkmcnt(3)
v_mfma_f32_16x16x32_bf16 a[64:67], a[208:211], a[152:155], a[64:67]
buffer_load_dwordx4 a[160:163], v13, s[8:11], s16 offen offset:0 sc1
v_mfma_f32_16x16x32_bf16 a[64:67], a[216:219], a[156:159], a[64:67]
v_and_b32 v223, s50, v157
v_fma_f32 v212, v212, s58, v234
v_fma_f32 v213, v213, s58, v235
v_fmac_f32 v212, s57, v222
v_mfma_f32_16x16x32_bf16 a[68:71], a[220:223], a[156:159], 0
v_fmac_f32 v213, s57, v223
v_fmac_f32 v222, s58, v234
v_mfma_f32_16x16x32_bf16 a[68:71], a[212:215], a[152:155], a[68:71]
v_fmac_f32 v223, s58, v235
v_cvt_pk_bf16_f32 v237, v234, v235
v_mfma_f32_16x16x32_bf16 a[68:71], a[204:207], a[148:151], a[68:71]
buffer_load_dwordx4 a[164:167], v14, s[8:11], s16 offen offset:0 sc1
v_mfma_f32_16x16x32_bf16 a[68:71], a[196:199], a[144:147], a[68:71]
v_lshlrev_b32 v216, 16, v161
v_and_b32 v217, s50, v161
v_lshlrev_b32 v228, 16, v165
v_and_b32 v229, s50, v165
v_mfma_f32_16x16x32_bf16 a[76:79], a[196:199], a[148:151], 0
v_fmac_f32 v212, s59, v216
v_fmac_f32 v213, s59, v217
v_mfma_f32_16x16x32_bf16 a[76:79], a[204:207], a[152:155], a[76:79]
ds_read_b128 a[140:143], v15 offset:34576
v_fmac_f32 v222, s56, v216
v_mfma_f32_16x16x32_bf16 a[76:79], a[212:215], a[156:159], a[76:79]
v_fmac_f32 v223, s56, v217
s_waitcnt lgkmcnt(1)
v_mfma_f32_16x16x32_bf16 a[76:79], a[220:223], a[128:131], a[76:79]
v_fmac_f32 v222, s55, v228
v_fmac_f32 v223, s55, v229
v_cvt_pk_bf16_f32 v241, v222, v223
v_cvt_pk_bf16_f32 v245, v212, v213
v_mfma_f32_16x16x32_bf16 a[72:75], a[216:219], a[128:131], 0
v_lshlrev_b32 v220, 16, v154
v_and_b32 v221, s50, v154
v_mfma_f32_16x16x32_bf16 a[72:75], a[208:211], a[156:159], a[72:75]
v_lshlrev_b32 v234, 16, v158
v_and_b32 v235, s50, v158
v_mfma_f32_16x16x32_bf16 a[72:75], a[200:203], a[152:155], a[72:75]
buffer_load_dwordx4 a[168:171], v13, s[8:11], s16 offen offset:1024 sc1
v_mfma_f32_16x16x32_bf16 a[72:75], a[192:195], a[148:151], a[72:75]
v_fma_f32 v220, v220, s58, v226
v_fma_f32 v221, v221, s58, v227
v_fmac_f32 v220, s57, v234
v_fmac_f32 v221, s57, v235
v_mfma_f32_16x16x32_bf16 a[80:83], a[192:195], a[152:155], 0
v_fmac_f32 v234, s58, v226
v_fmac_f32 v235, s58, v227
v_mfma_f32_16x16x32_bf16 a[80:83], a[200:203], a[156:159], a[80:83]
ds_read_b128 a[144:147], v15 offset:33056
v_cvt_pk_bf16_f32 v238, v226, v227
v_mfma_f32_16x16x32_bf16 a[80:83], a[208:211], a[128:131], a[80:83]
v_lshlrev_b32 v228, 16, v162
v_and_b32 v229, s50, v162
v_mfma_f32_16x16x32_bf16 a[80:83], a[216:219], a[132:135], a[80:83]
v_lshlrev_b32 v216, 16, v166
v_and_b32 v217, s50, v166
v_fmac_f32 v220, s59, v228
v_fmac_f32 v221, s59, v229
v_mfma_f32_16x16x32_bf16 a[84:87], a[220:223], a[132:135], 0
v_fmac_f32 v234, s56, v228
v_fmac_f32 v235, s56, v229
v_mfma_f32_16x16x32_bf16 a[84:87], a[212:215], a[128:131], a[84:87]
v_fmac_f32 v234, s55, v216
v_fmac_f32 v235, s55, v217
v_mfma_f32_16x16x32_bf16 a[84:87], a[204:207], a[156:159], a[84:87]
buffer_load_dwordx4 a[172:175], v14, s[8:11], s16 offen offset:1024 sc1
v_mfma_f32_16x16x32_bf16 a[84:87], a[196:199], a[152:155], a[84:87]
v_cvt_pk_bf16_f32 v242, v234, v235
v_cvt_pk_bf16_f32 v246, v220, v221
v_lshlrev_b32 v222, 16, v155
v_and_b32 v223, s50, v155
v_mfma_f32_16x16x32_bf16 a[92:95], a[196:199], a[156:159], 0
v_and_b32 v254, 63, v0
v_lshlrev_b32 v254, 4, v254
v_mfma_f32_16x16x32_bf16 a[92:95], a[204:207], a[128:131], a[92:95]
ds_read_b128 a[148:151], v15 offset:33072
s_lshl_b32 s38, s18, 13
v_mfma_f32_16x16x32_bf16 a[92:95], a[212:215], a[132:135], a[92:95]
v_lshlrev_b32 v212, 16, v159
v_and_b32 v213, s50, v159
v_mfma_f32_16x16x32_bf16 a[92:95], a[220:223], a[136:139], a[92:95]
v_fma_f32 v222, v222, s58, v218
v_fma_f32 v223, v223, s58, v219
v_fmac_f32 v222, s57, v212
v_fmac_f32 v223, s57, v213
v_mfma_f32_16x16x32_bf16 a[88:91], a[216:219], a[136:139], 0
v_fmac_f32 v212, s58, v218
v_fmac_f32 v213, s58, v219
v_mfma_f32_16x16x32_bf16 a[88:91], a[208:211], a[132:135], a[88:91]
v_cvt_pk_bf16_f32 v239, v218, v219
v_lshlrev_b32 v226, 16, v163
v_mfma_f32_16x16x32_bf16 a[88:91], a[200:203], a[128:131], a[88:91]
buffer_load_dwordx4 a[176:179], v13, s[8:11], s16 offen offset:2048 sc1
v_mfma_f32_16x16x32_bf16 a[88:91], a[192:195], a[156:159], a[88:91]
buffer_store_dwordx4 v[96:99], v12, s[8:11], s36 offen sc1
v_and_b32 v227, s50, v163
v_lshlrev_b32 v216, 16, v167
v_mfma_f32_16x16x32_bf16 a[96:99], a[192:195], a[128:131], 0
v_and_b32 v217, s50, v167
v_fmac_f32 v222, s59, v226
v_mfma_f32_16x16x32_bf16 a[96:99], a[200:203], a[132:135], a[96:99]
ds_read_b128 a[152:155], v15 offset:33568
v_fmac_f32 v223, s59, v227
v_mfma_f32_16x16x32_bf16 a[96:99], a[208:211], a[136:139], a[96:99]
s_add_u32 s38, s38, 32768
s_waitcnt lgkmcnt(1)
v_mfma_f32_16x16x32_bf16 a[96:99], a[216:219], a[140:143], a[96:99]
buffer_load_dwordx2 v[252:253], v254, s[8:11], s38 offen sc1
v_fmac_f32 v212, s56, v226
v_fmac_f32 v213, s56, v227
v_mfma_f32_16x16x32_bf16 a[100:103], a[220:223], a[140:143], 0
v_fmac_f32 v212, s55, v216
v_fmac_f32 v213, s55, v217
v_mfma_f32_16x16x32_bf16 a[100:103], a[212:215], a[136:139], a[100:103]
v_cvt_pk_bf16_f32 v243, v212, v213
v_cvt_pk_bf16_f32 v247, v222, v223
v_mfma_f32_16x16x32_bf16 a[100:103], a[204:207], a[132:135], a[100:103]
ds_read_b128 a[156:159], v15 offset:41280
s_add_u32 s36, s3, 16384
v_mfma_f32_16x16x32_bf16 a[100:103], a[196:199], a[128:131], a[100:103]
ds_read_b128 a[128:131], v15 offset:41296
v_lshlrev_b32 v228, 16, v168
v_and_b32 v229, s50, v168
v_mfma_f32_16x16x32_bf16 a[108:111], a[196:199], a[132:135], 0
buffer_load_dwordx4 a[180:183], v14, s[8:11], s16 offen offset:2048 sc1
v_mfma_f32_16x16x32_bf16 a[108:111], a[204:207], a[136:139], a[108:111]
s_waitcnt vmcnt(17)
v_lshlrev_b32 v234, 16, v172
v_mfma_f32_16x16x32_bf16 a[108:111], a[212:215], a[140:143], a[108:111]
v_and_b32 v235, s50, v172
v_mfma_f32_16x16x32_bf16 a[108:111], a[220:223], a[144:147], a[108:111]
s_waitcnt vmcnt(16) lgkmcnt(2)
v_lshlrev_b32 v220, 16, v176
v_and_b32 v221, s50, v176
v_mfma_f32_16x16x32_bf16 a[104:107], a[216:219], a[144:147], 0
s_waitcnt vmcnt(14)
v_lshlrev_b32 v218, 16, v180
v_mfma_f32_16x16x32_bf16 a[104:107], a[208:211], a[140:143], a[104:107]
v_and_b32 v219, s50, v180
v_fma_f32 v216, v220, s51, v218
v_mfma_f32_16x16x32_bf16 a[104:107], a[200:203], a[136:139], a[104:107]
buffer_load_dwordx4 a[184:187], v13, s[8:11], s16 offen offset:3072 sc1
v_mfma_f32_16x16x32_bf16 a[104:107], a[192:195], a[132:135], a[104:107]
ds_read_b128 a[132:135], v15 offset:41792
v_fma_f32 v217, v221, s51, v219
v_fmac_f32 v220, s51, v234
v_fmac_f32 v221, s51, v235
v_mfma_f32_16x16x32_bf16 a[112:115], a[192:195], a[136:139], 0
v_fmac_f32 v234, s51, v228
v_fmac_f32 v235, s51, v229
v_mfma_f32_16x16x32_bf16 a[112:115], a[200:203], a[140:143], a[112:115]
v_fmac_f32 v228, s51, v224
v_fmac_f32 v229, s51, v225
v_mfma_f32_16x16x32_bf16 a[112:115], a[208:211], a[144:147], a[112:115]
v_fma_f32 v224, v228, s60, v220
v_fma_f32 v225, v229, s60, v221
v_mfma_f32_16x16x32_bf16 a[112:115], a[216:219], a[148:151], a[112:115]
v_fma_f32 v226, v234, s60, v216
v_fma_f32 v227, v235, s60, v217
v_fmac_f32 v220, s52, v228
v_fmac_f32 v221, s52, v229
v_mfma_f32_16x16x32_bf16 a[116:119], a[220:223], a[148:151], 0
v_fmac_f32 v216, s52, v234
v_fmac_f32 v217, s52, v235
v_mfma_f32_16x16x32_bf16 a[116:119], a[212:215], a[144:147], a[116:119]
v_fma_f32 v228, -v224, s53, v226
v_fma_f32 v229, -v225, s53, v227
v_mfma_f32_16x16x32_bf16 a[116:119], a[204:207], a[140:143], a[116:119]
buffer_load_dwordx4 a[188:191], v14, s[8:11], s16 offen offset:3072 sc1
v_mfma_f32_16x16x32_bf16 a[116:119], a[196:199], a[136:139], a[116:119]
ds_read_b128 a[136:139], v15 offset:41808
s_add_u32 s16, s16, 4096
v_fmac_f32 v226, s53, v224
v_fmac_f32 v227, s53, v225
v_mfma_f32_16x16x32_bf16 a[124:127], a[196:199], a[140:143], 0
v_fma_f32 v234, -v220, s54, v216
v_fma_f32 v235, -v221, s54, v217
v_mfma_f32_16x16x32_bf16 a[124:127], a[204:207], a[144:147], a[124:127]
v_fmac_f32 v216, s54, v220
v_fmac_f32 v217, s54, v221
v_mfma_f32_16x16x32_bf16 a[124:127], a[212:215], a[148:151], a[124:127]
v_cvt_pk_bf16_f32 v196, v228, v229
v_cvt_pk_bf16_f32 v200, v226, v227
v_mfma_f32_16x16x32_bf16 a[124:127], a[220:223], a[152:155], a[124:127]
v_cvt_pk_bf16_f32 v204, v234, v235
v_cvt_pk_bf16_f32 v208, v216, v217
v_lshlrev_b32 v212, 16, v169
v_and_b32 v213, s50, v169
v_mfma_f32_16x16x32_bf16 a[120:123], a[216:219], a[152:155], 0
v_lshlrev_b32 v222, 16, v173
v_and_b32 v223, s50, v173
v_mfma_f32_16x16x32_bf16 a[120:123], a[208:211], a[148:151], a[120:123]
buffer_load_dwordx4 v[152:155], v1, s[4:7], 0 offen offset:1280
v_mfma_f32_16x16x32_bf16 a[120:123], a[200:203], a[144:147], a[120:123]
buffer_load_dwordx4 v[156:159], v2, s[4:7], 0 offen offset:256
v_mfma_f32_16x16x32_bf16 a[120:123], a[192:195], a[140:143], a[120:123]
ds_read_b128 a[140:143], v15 offset:42304
v_lshlrev_b32 v224, 16, v177
v_and_b32 v225, s50, v177
s_waitcnt lgkmcnt(2)
v_mfma_f32_16x16x32_bf16 a[64:67], a[224:227], a[156:159], a[64:67]
ds_read_b128 a[144:147], v15 offset:42320
v_lshlrev_b32 v220, 16, v181
v_mfma_f32_16x16x32_bf16 a[64:67], a[232:235], a[128:131], a[64:67]
ds_read_b128 a[148:151], v15 offset:42816
v_and_b32 v221, s50, v181
v_mfma_f32_16x16x32_bf16 a[64:67], a[240:243], a[132:135], a[64:67]
v_fma_f32 v228, v224, s51, v220
s_waitcnt vmcnt(16) lgkmcnt(3)
v_mfma_f32_16x16x32_bf16 a[64:67], a[248:251], a[136:139], a[64:67]
v_fma_f32 v229, v225, s51, v221
v_fmac_f32 v224, s51, v222
v_fmac_f32 v225, s51, v223
s_waitcnt vmcnt(10)
v_mfma_f32_16x16x32_bf16 a[68:71], a[252:255], a[136:139], a[68:71]
buffer_load_dwordx4 a[192:195], v13, s[8:11], s16 offen offset:0 sc1
v_mfma_f32_16x16x32_bf16 a[68:71], a[244:247], a[132:135], a[68:71]
buffer_load_dwordx4 v[160:163], v2, s[4:7], 0 offen offset:1280
v_mfma_f32_16x16x32_bf16 a[68:71], a[236:239], a[128:131], a[68:71]
buffer_load_dwordx4 a[196:199], v14, s[8:11], s16 offen offset:0 sc1
v_mfma_f32_16x16x32_bf16 a[68:71], a[228:231], a[156:159], a[68:71]
buffer_load_dwordx4 v[164:167], v2, s[4:7], 0 offen offset:2304
v_fmac_f32 v222, s51, v212
v_fmac_f32 v223, s51, v213
v_mfma_f32_16x16x32_bf16 a[76:79], a[228:231], a[128:131], a[76:79]
v_fmac_f32 v212, s51, v230
v_fmac_f32 v213, s51, v231
v_mfma_f32_16x16x32_bf16 a[76:79], a[236:239], a[132:135], a[76:79]
ds_read_b128 a[152:155], v15 offset:42832
v_fma_f32 v230, v212, s60, v224
v_mfma_f32_16x16x32_bf16 a[76:79], a[244:247], a[136:139], a[76:79]
v_fma_f32 v231, v213, s60, v225
s_waitcnt vmcnt(13) lgkmcnt(1)
v_mfma_f32_16x16x32_bf16 a[76:79], a[252:255], a[140:143], a[76:79]
v_fma_f32 v226, v222, s60, v228
v_fma_f32 v227, v223, s60, v229
v_fmac_f32 v224, s52, v212
v_fmac_f32 v225, s52, v213
v_mfma_f32_16x16x32_bf16 a[72:75], a[248:251], a[140:143], a[72:75]
v_fmac_f32 v228, s52, v222
v_fmac_f32 v229, s52, v223
v_mfma_f32_16x16x32_bf16 a[72:75], a[240:243], a[136:139], a[72:75]
v_fma_f32 v212, -v230, s53, v226
v_fma_f32 v213, -v231, s53, v227
v_mfma_f32_16x16x32_bf16 a[72:75], a[232:235], a[132:135], a[72:75]
buffer_load_dwordx4 a[200:203], v13, s[8:11], s16 offen offset:1024 sc1
v_mfma_f32_16x16x32_bf16 a[72:75], a[224:227], a[128:131], a[72:75]
v_fmac_f32 v226, s53, v230
v_fmac_f32 v227, s53, v231
v_fma_f32 v222, -v224, s54, v228
v_fma_f32 v223, -v225, s54, v229
v_mfma_f32_16x16x32_bf16 a[80:83], a[224:227], a[132:135], a[80:83]
v_fmac_f32 v228, s54, v224
v_fmac_f32 v229, s54, v225
v_mfma_f32_16x16x32_bf16 a[80:83], a[232:235], a[136:139], a[80:83]
ds_read_b128 a[156:159], v15 offset:41312
v_cvt_pk_bf16_f32 v197, v212, v213
v_mfma_f32_16x16x32_bf16 a[80:83], a[240:243], a[140:143], a[80:83]
v_cvt_pk_bf16_f32 v201, v226, v227
v_cvt_pk_bf16_f32 v205, v222, v223
v_mfma_f32_16x16x32_bf16 a[80:83], a[248:251], a[144:147], a[80:83]
v_cvt_pk_bf16_f32 v209, v228, v229
v_lshlrev_b32 v234, 16, v170
v_and_b32 v235, s50, v170
v_lshlrev_b32 v216, 16, v174
v_mfma_f32_16x16x32_bf16 a[84:87], a[252:255], a[144:147], a[84:87]
v_and_b32 v217, s50, v174
v_lshlrev_b32 v230, 16, v178
v_mfma_f32_16x16x32_bf16 a[84:87], a[244:247], a[140:143], a[84:87]
v_and_b32 v231, s50, v178
v_lshlrev_b32 v224, 16, v182
v_mfma_f32_16x16x32_bf16 a[84:87], a[236:239], a[136:139], a[84:87]
buffer_load_dwordx4 a[204:207], v14, s[8:11], s16 offen offset:1024 sc1
v_mfma_f32_16x16x32_bf16 a[84:87], a[228:231], a[132:135], a[84:87]
v_and_b32 v225, s50, v182
v_fma_f32 v212, v230, s51, v224
v_fma_f32 v213, v231, s51, v225
v_fmac_f32 v230, s51, v216
v_mfma_f32_16x16x32_bf16 a[92:95], a[228:231], a[136:139], a[92:95]
v_fmac_f32 v231, s51, v217
v_fmac_f32 v216, s51, v234
v_mfma_f32_16x16x32_bf16 a[92:95], a[236:239], a[140:143], a[92:95]
ds_read_b128 a[128:131], v15 offset:41328
v_fmac_f32 v217, s51, v235
v_mfma_f32_16x16x32_bf16 a[92:95], a[244:247], a[144:147], a[92:95]
v_fmac_f32 v234, s51, v214
v_fmac_f32 v235, s51, v215
v_mfma_f32_16x16x32_bf16 a[92:95], a[252:255], a[148:151], a[92:95]
s_waitcnt vmcnt(11) lgkmcnt(1)
v_cmp_ne_u64 vcc, s[32:33], v[252:253]
v_fma_f32 v214, v234, s60, v230
v_fma_f32 v215, v235, s60, v231
v_mfma_f32_16x16x32_bf16 a[88:91], a[248:251], a[148:151], a[88:91]
s_cmp_lg_u64 vcc, 0
s_cbranch_scc1 Lu_spin
Lu_spinr:
v_mfma_f32_16x16x32_bf16 a[88:91], a[240:243], a[144:147], a[88:91]
v_fma_f32 v226, v216, s60, v212
v_fma_f32 v227, v217, s60, v213
v_mfma_f32_16x16x32_bf16 a[88:91], a[232:235], a[140:143], a[88:91]
buffer_load_dwordx4 a[208:211], v13, s[8:11], s16 offen offset:2048 sc1
v_mfma_f32_16x16x32_bf16 a[88:91], a[224:227], a[136:139], a[88:91]
v_fmac_f32 v230, s52, v234
v_fmac_f32 v231, s52, v235
v_fmac_f32 v212, s52, v216
v_fmac_f32 v213, s52, v217
v_mfma_f32_16x16x32_bf16 a[96:99], a[224:227], a[140:143], a[96:99]
v_fma_f32 v234, -v214, s53, v226
v_fma_f32 v235, -v215, s53, v227
v_mfma_f32_16x16x32_bf16 a[96:99], a[232:235], a[144:147], a[96:99]
ds_read_b128 a[132:135], v15 offset:41824
v_fmac_f32 v226, s53, v214
v_mfma_f32_16x16x32_bf16 a[96:99], a[240:243], a[148:151], a[96:99]
v_fmac_f32 v227, s53, v215
v_fma_f32 v216, -v230, s54, v212
v_mfma_f32_16x16x32_bf16 a[96:99], a[248:251], a[152:155], a[96:99]
v_fma_f32 v217, -v231, s54, v213
v_fmac_f32 v212, s54, v230
v_fmac_f32 v213, s54, v231
v_mfma_f32_16x16x32_bf16 a[100:103], a[252:255], a[152:155], a[100:103]
v_cvt_pk_bf16_f32 v198, v234, v235
v_cvt_pk_bf16_f32 v202, v226, v227
v_mfma_f32_16x16x32_bf16 a[100:103], a[244:247], a[148:151], a[100:103]
v_cvt_pk_bf16_f32 v206, v216, v217
v_cvt_pk_bf16_f32 v210, v212, v213
v_mfma_f32_16x16x32_bf16 a[100:103], a[236:239], a[144:147], a[100:103]
ds_read_b128 a[136:139], v15 offset:49536
v_lshlrev_b32 v222, 16, v171
v_mfma_f32_16x16x32_bf16 a[100:103], a[228:231], a[140:143], a[100:103]
ds_read_b128 a[140:143], v15 offset:49552
v_and_b32 v223, s50, v171
v_mfma_f32_16x16x32_bf16 a[108:111], a[228:231], a[144:147], a[108:111]
buffer_load_dwordx4 a[212:215], v14, s[8:11], s16 offen offset:2048 sc1
v_mfma_f32_16x16x32_bf16 a[108:111], a[236:239], a[148:151], a[108:111]
v_lshlrev_b32 v228, 16, v175
v_and_b32 v229, s50, v175
v_mfma_f32_16x16x32_bf16 a[108:111], a[244:247], a[152:155], a[108:111]
v_lshlrev_b32 v214, 16, v179
v_and_b32 v215, s50, v179
v_mfma_f32_16x16x32_bf16 a[108:111], a[252:255], a[156:159], a[108:111]
v_lshlrev_b32 v230, 16, v183
v_and_b32 v231, s50, v183
v_fma_f32 v234, v214, s51, v230
v_mfma_f32_16x16x32_bf16 a[104:107], a[248:251], a[156:159], a[104:107]
v_fma_f32 v235, v215, s51, v231
v_fmac_f32 v214, s51, v228
v_mfma_f32_16x16x32_bf16 a[104:107], a[240:243], a[152:155], a[104:107]
v_fmac_f32 v215, s51, v229
v_fmac_f32 v228, s51, v222
v_mfma_f32_16x16x32_bf16 a[104:107], a[232:235], a[148:151], a[104:107]
buffer_load_dwordx4 a[216:219], v13, s[8:11], s16 offen offset:3072 sc1
v_mfma_f32_16x16x32_bf16 a[104:107], a[224:227], a[144:147], a[104:107]
ds_read_b128 a[144:147], v15 offset:50048
v_fmac_f32 v229, s51, v223
v_fmac_f32 v222, s51, v232
v_mfma_f32_16x16x32_bf16 a[112:115], a[224:227], a[148:151], a[112:115]
v_fmac_f32 v223, s51, v233
v_fma_f32 v232, v222, s60, v214
v_mfma_f32_16x16x32_bf16 a[112:115], a[232:235], a[152:155], a[112:115]
v_fma_f32 v233, v223, s60, v215
v_fma_f32 v226, v228, s60, v234
v_mfma_f32_16x16x32_bf16 a[112:115], a[240:243], a[156:159], a[112:115]
v_fma_f32 v227, v229, s60, v235
s_waitcnt vmcnt(11) lgkmcnt(1)
v_mfma_f32_16x16x32_bf16 a[112:115], a[248:251], a[128:131], a[112:115]
v_fmac_f32 v214, s52, v222
v_fmac_f32 v215, s52, v223
v_mfma_f32_16x16x32_bf16 a[116:119], a[252:255], a[128:131], a[116:119]
buffer_store_dwordx4 v[236:239], v12, s[8:11], s36 offen sc1
v_mfma_f32_16x16x32_bf16 a[116:119], a[244:247], a[156:159], a[116:119]
s_add_u32 s36, s3, 81920
v_fmac_f32 v234, s52, v228
v_mfma_f32_16x16x32_bf16 a[116:119], a[236:239], a[152:155], a[116:119]
buffer_load_dwordx4 a[220:223], v14, s[8:11], s16 offen offset:3072 sc1
v_mfma_f32_16x16x32_bf16 a[116:119], a[228:231], a[148:151], a[116:119]
ds_read_b128 a[148:151], v15 offset:50064
s_add_u32 s16, s16, 1052672
v_fmac_f32 v235, s52, v229
v_fma_f32 v222, -v232, s53, v226
v_mfma_f32_16x16x32_bf16 a[124:127], a[228:231], a[152:155], a[124:127]
v_fma_f32 v223, -v233, s53, v227
v_fmac_f32 v226, s53, v232
v_mfma_f32_16x16x32_bf16 a[124:127], a[236:239], a[156:159], a[124:127]
v_fmac_f32 v227, s53, v233
v_fma_f32 v228, -v214, s54, v234
v_mfma_f32_16x16x32_bf16 a[124:127], a[244:247], a[128:131], a[124:127]
v_fma_f32 v229, -v215, s54, v235
v_fmac_f32 v234, s54, v214
v_mfma_f32_16x16x32_bf16 a[124:127], a[252:255], a[132:135], a[124:127]
v_fmac_f32 v235, s54, v215
v_cvt_pk_bf16_f32 v199, v222, v223
v_cvt_pk_bf16_f32 v203, v226, v227
v_cvt_pk_bf16_f32 v207, v228, v229
v_mfma_f32_16x16x32_bf16 a[120:123], a[248:251], a[132:135], a[120:123]
v_cvt_pk_bf16_f32 v211, v234, v235
v_mfma_f32_16x16x32_bf16 a[120:123], a[240:243], a[128:131], a[120:123]
ds_write_b128 v8, v[196:199] offset:512
v_mfma_f32_16x16x32_bf16 a[120:123], a[232:235], a[156:159], a[120:123]
ds_write_b128 v8, v[200:203] offset:17024
v_mfma_f32_16x16x32_bf16 a[120:123], a[224:227], a[152:155], a[120:123]
ds_read_b128 a[152:155], v15 offset:50560
v_mfma_f32_16x16x32_bf16 v[84:87], a[160:163], a[136:139], 0
ds_read_b128 a[156:159], v15 offset:50576
v_mfma_f32_16x16x32_bf16 v[84:87], a[168:171], a[140:143], v[84:87]
ds_read_b128 a[128:131], v15 offset:51072
s_waitcnt lgkmcnt(5)
v_mfma_f32_16x16x32_bf16 v[84:87], a[176:179], a[144:147], v[84:87]
buffer_load_dwordx4 a[224:227], v13, s[8:11], s16 offen offset:0 sc1
v_mfma_f32_16x16x32_bf16 v[84:87], a[184:187], a[148:151], v[84:87]
ds_write_b128 v8, v[204:207] offset:33536
v_mfma_f32_16x16x32_bf16 v[88:91], a[188:191], a[148:151], 0
ds_write_b128 v8, v[208:211] offset:50048
v_mfma_f32_16x16x32_bf16 v[88:91], a[180:183], a[144:147], v[88:91]
v_lshlrev_b32 v216, 16, v184
v_and_b32 v217, s50, v184
v_mfma_f32_16x16x32_bf16 v[88:91], a[172:175], a[140:143], v[88:91]
buffer_load_dwordx4 a[228:231], v14, s[8:11], s16 offen offset:0 sc1
v_mfma_f32_16x16x32_bf16 v[88:91], a[164:167], a[136:139], v[88:91]
s_lshr_b32 s44, s2, 3
s_lshl_b32 s44, s44, 10
v_lshlrev_b32 v212, 16, v188
v_and_b32 v213, s50, v188
v_mfma_f32_16x16x32_bf16 v[96:99], a[164:167], a[140:143], 0
v_lshl_add_u32 v255, v0, 2, s44
v_lshlrev_b32 v232, 16, v192
v_mfma_f32_16x16x32_bf16 v[96:99], a[172:175], a[144:147], v[96:99]
ds_read_b128 a[132:135], v15 offset:51088
v_and_b32 v233, s50, v192
v_mfma_f32_16x16x32_bf16 v[96:99], a[180:183], a[148:151], v[96:99]
v_lshlrev_b32 v214, 16, v148
s_waitcnt lgkmcnt(3)
v_mfma_f32_16x16x32_bf16 v[96:99], a[188:191], a[152:155], v[96:99]
v_and_b32 v215, s50, v148
v_fma_f32 v222, v232, s51, v214
v_fma_f32 v223, v233, s51, v215
v_fmac_f32 v232, s51, v212
v_mfma_f32_16x16x32_bf16 v[92:95], a[184:187], a[152:155], 0
v_fmac_f32 v233, s51, v213
v_fmac_f32 v212, s51, v216
v_mfma_f32_16x16x32_bf16 v[92:95], a[176:179], a[148:151], v[92:95]
v_fmac_f32 v213, s51, v217
v_fmac_f32 v216, s51, v218
v_mfma_f32_16x16x32_bf16 v[92:95], a[168:171], a[144:147], v[92:95]
buffer_load_dwordx4 a[232:235], v13, s[8:11], s16 offen offset:1024 sc1
v_mfma_f32_16x16x32_bf16 v[92:95], a[160:163], a[140:143], v[92:95]
v_fmac_f32 v217, s51, v219
v_fma_f32 v218, v216, s60, v232
v_fma_f32 v219, v217, s60, v233
v_fma_f32 v226, v212, s60, v222
v_mfma_f32_16x16x32_bf16 v[100:103], a[160:163], a[144:147], 0
s_getpc_b64 s[46:47]
v_fma_f32 v227, v213, s60, v223
v_mfma_f32_16x16x32_bf16 v[100:103], a[168:171], a[148:151], v[100:103]
ds_read_b128 a[136:139], v15 offset:49568
v_fmac_f32 v232, s52, v216
v_mfma_f32_16x16x32_bf16 v[100:103], a[176:179], a[152:155], v[100:103]
global_load_dword v252, v255, s[46:47] offset:2048
v_mfma_f32_16x16x32_bf16 v[100:103], a[184:187], a[156:159], v[100:103]
buffer_load_dwordx4 v[168:171], v2, s[4:7], 0 offen offset:3328
v_fmac_f32 v233, s52, v217
v_fmac_f32 v222, s52, v212
v_mfma_f32_16x16x32_bf16 v[104:107], a[188:191], a[156:159], 0
buffer_load_dwordx4 v[172:175], v3, s[4:7], 0 offen offset:256
v_mfma_f32_16x16x32_bf16 v[104:107], a[180:183], a[152:155], v[104:107]
buffer_load_dwordx4 v[176:179], v3, s[4:7], 0 offen offset:1280
v_mfma_f32_16x16x32_bf16 v[104:107], a[172:175], a[148:151], v[104:107]
buffer_load_dwordx4 a[236:239], v14, s[8:11], s16 offen offset:1024 sc1
v_mfma_f32_16x16x32_bf16 v[104:107], a[164:167], a[144:147], v[104:107]
buffer_load_dwordx4 v[180:183], v3, s[4:7], 0 offen offset:2304
v_fmac_f32 v223, s52, v213
v_fma_f32 v216, -v218, s53, v226
v_mfma_f32_16x16x32_bf16 v[112:115], a[164:167], a[148:151], 0
v_fma_f32 v217, -v219, s53, v227
v_fmac_f32 v226, s53, v218
v_mfma_f32_16x16x32_bf16 v[112:115], a[172:175], a[152:155], v[112:115]
ds_read_b128 a[140:143], v15 offset:49584
v_fmac_f32 v227, s53, v219
v_mfma_f32_16x16x32_bf16 v[112:115], a[180:183], a[156:159], v[112:115]
v_fma_f32 v212, -v232, s54, v222
v_fma_f32 v213, -v233, s54, v223
v_mfma_f32_16x16x32_bf16 v[112:115], a[188:191], a[128:131], v[112:115]
v_fmac_f32 v222, s54, v232
v_fmac_f32 v223, s54, v233
v_cvt_pk_bf16_f32 v196, v216, v217
v_cvt_pk_bf16_f32 v200, v226, v227
v_mfma_f32_16x16x32_bf16 v[108:111], a[184:187], a[128:131], 0
v_cvt_pk_bf16_f32 v204, v212, v213
v_cvt_pk_bf16_f32 v208, v222, v223
v_mfma_f32_16x16x32_bf16 v[108:111], a[176:179], a[156:159], v[108:111]
v_lshlrev_b32 v228, 16, v185
v_and_b32 v229, s50, v185
v_mfma_f32_16x16x32_bf16 v[108:111], a[168:171], a[152:155], v[108:111]
buffer_load_dwordx4 a[240:243], v13, s[8:11], s16 offen offset:2048 sc1
v_mfma_f32_16x16x32_bf16 v[108:111], a[160:163], a[148:151], v[108:111]
v_lshlrev_b32 v234, 16, v189
v_and_b32 v235, s50, v189
v_lshlrev_b32 v218, 16, v193
v_and_b32 v219, s50, v193
v_mfma_f32_16x16x32_bf16 v[116:119], a[160:163], a[152:155], 0
v_lshlrev_b32 v232, 16, v149
v_and_b32 v233, s50, v149
v_mfma_f32_16x16x32_bf16 v[116:119], a[168:171], a[156:159], v[116:119]
ds_read_b128 a[144:147], v15 offset:50080
v_fma_f32 v216, v218, s51, v232
v_mfma_f32_16x16x32_bf16 v[116:119], a[176:179], a[128:131], v[116:119]
v_fma_f32 v217, v219, s51, v233
s_waitcnt lgkmcnt(1)
v_mfma_f32_16x16x32_bf16 v[116:119], a[184:187], a[132:135], v[116:119]
v_fmac_f32 v218, s51, v234
v_fmac_f32 v219, s51, v235
v_fmac_f32 v234, s51, v228
v_fmac_f32 v235, s51, v229
v_mfma_f32_16x16x32_bf16 v[120:123], a[188:191], a[132:135], 0
v_fmac_f32 v228, s51, v220
v_fmac_f32 v229, s51, v221
v_mfma_f32_16x16x32_bf16 v[120:123], a[180:183], a[128:131], v[120:123]
v_fma_f32 v220, v228, s60, v218
v_fma_f32 v221, v229, s60, v219
v_mfma_f32_16x16x32_bf16 v[120:123], a[172:175], a[156:159], v[120:123]
ds_read_b128 a[148:151], v15 offset:57792
v_fma_f32 v226, v234, s60, v216
v_mfma_f32_16x16x32_bf16 v[120:123], a[164:167], a[152:155], v[120:123]
ds_read_b128 a[152:155], v15 offset:57808
v_fma_f32 v227, v235, s60, v217
v_fmac_f32 v218, s52, v228
v_fmac_f32 v219, s52, v229
v_mfma_f32_16x16x32_bf16 v[128:131], a[164:167], a[156:159], 0
buffer_load_dwordx4 a[244:247], v14, s[8:11], s16 offen offset:2048 sc1
v_mfma_f32_16x16x32_bf16 v[128:131], a[172:175], a[128:131], v[128:131]
v_fmac_f32 v216, s52, v234
v_fmac_f32 v217, s52, v235
v_mfma_f32_16x16x32_bf16 v[128:131], a[180:183], a[132:135], v[128:131]
v_fma_f32 v228, -v220, s53, v226
v_fma_f32 v229, -v221, s53, v227
v_mfma_f32_16x16x32_bf16 v[128:131], a[188:191], a[136:139], v[128:131]
v_fmac_f32 v226, s53, v220
v_fmac_f32 v227, s53, v221
v_fma_f32 v234, -v218, s54, v216
v_fma_f32 v235, -v219, s54, v217
v_mfma_f32_16x16x32_bf16 v[124:127], a[184:187], a[136:139], 0
v_fmac_f32 v216, s54, v218
v_fmac_f32 v217, s54, v219
v_mfma_f32_16x16x32_bf16 v[124:127], a[176:179], a[132:135], v[124:127]
v_cvt_pk_bf16_f32 v197, v228, v229
v_cvt_pk_bf16_f32 v201, v226, v227
v_mfma_f32_16x16x32_bf16 v[124:127], a[168:171], a[128:131], v[124:127]
buffer_load_dwordx4 a[248:251], v13, s[8:11], s16 offen offset:3072 sc1
v_mfma_f32_16x16x32_bf16 v[124:127], a[160:163], a[156:159], v[124:127]
ds_read_b128 a[156:159], v15 offset:58304
v_cvt_pk_bf16_f32 v205, v234, v235
v_cvt_pk_bf16_f32 v209, v216, v217
v_lshlrev_b32 v212, 16, v186
v_mfma_f32_16x16x32_bf16 v[132:135], a[160:163], a[128:131], 0
v_and_b32 v213, s50, v186
v_lshlrev_b32 v222, 16, v190
v_mfma_f32_16x16x32_bf16 v[132:135], a[168:171], a[132:135], v[132:135]
v_and_b32 v223, s50, v190
v_lshlrev_b32 v220, 16, v194
v_mfma_f32_16x16x32_bf16 v[132:135], a[176:179], a[136:139], v[132:135]
v_and_b32 v221, s50, v194
v_lshlrev_b32 v218, 16, v150
v_mfma_f32_16x16x32_bf16 v[132:135], a[184:187], a[140:143], v[132:135]
v_and_b32 v219, s50, v150
v_fma_f32 v228, v220, s51, v218
v_fma_f32 v229, v221, s51, v219
v_mfma_f32_16x16x32_bf16 v[136:139], a[188:191], a[140:143], 0
v_fmac_f32 v220, s51, v222
v_fmac_f32 v221, s51, v223
v_mfma_f32_16x16x32_bf16 v[136:139], a[180:183], a[136:139], v[136:139]
v_fmac_f32 v222, s51, v212
v_fmac_f32 v223, s51, v213
v_mfma_f32_16x16x32_bf16 v[136:139], a[172:175], a[132:135], v[136:139]
buffer_load_dwordx4 a[252:255], v14, s[8:11], s16 offen offset:3072 sc1
v_mfma_f32_16x16x32_bf16 v[136:139], a[164:167], a[128:131], v[136:139]
ds_read_b128 a[128:131], v15 offset:58320
s_add_u32 s16, s16, 4096
v_fmac_f32 v212, s51, v224
v_fmac_f32 v213, s51, v225
v_mfma_f32_16x16x32_bf16 v[144:147], a[164:167], a[132:135], 0
v_fma_f32 v224, v212, s60, v220
v_fma_f32 v225, v213, s60, v221
v_mfma_f32_16x16x32_bf16 v[144:147], a[172:175], a[136:139], v[144:147]
v_fma_f32 v226, v222, s60, v228
v_fma_f32 v227, v223, s60, v229
v_mfma_f32_16x16x32_bf16 v[144:147], a[180:183], a[140:143], v[144:147]
v_fmac_f32 v220, s52, v212
s_waitcnt vmcnt(15) lgkmcnt(1)
v_mfma_f32_16x16x32_bf16 v[144:147], a[188:191], a[144:147], v[144:147]
v_fmac_f32 v221, s52, v213
v_fmac_f32 v228, s52, v222
v_mfma_f32_16x16x32_bf16 v[140:143], a[184:187], a[144:147], 0
v_fmac_f32 v229, s52, v223
v_fma_f32 v212, -v224, s53, v226
v_mfma_f32_16x16x32_bf16 v[140:143], a[176:179], a[140:143], v[140:143]
v_fma_f32 v213, -v225, s53, v227
v_fmac_f32 v226, s53, v224
v_mfma_f32_16x16x32_bf16 v[140:143], a[168:171], a[136:139], v[140:143]
v_fmac_f32 v227, s53, v225
v_fma_f32 v222, -v220, s54, v228
v_mfma_f32_16x16x32_bf16 v[140:143], a[160:163], a[132:135], v[140:143]
ds_read_b128 a[132:135], v15 offset:58816
v_fma_f32 v223, -v221, s54, v229
v_mfma_f32_16x16x32_bf16 v[84:87], a[192:195], a[148:151], v[84:87]
ds_read_b128 a[136:139], v15 offset:58832
v_fmac_f32 v228, s54, v220
v_mfma_f32_16x16x32_bf16 v[84:87], a[200:203], a[152:155], v[84:87]
ds_read_b128 a[140:143], v15 offset:59328
v_fmac_f32 v229, s54, v221
v_mfma_f32_16x16x32_bf16 v[84:87], a[208:211], a[156:159], v[84:87]
v_cvt_pk_bf16_f32 v198, v212, v213
s_waitcnt lgkmcnt(3)
v_mfma_f32_16x16x32_bf16 v[84:87], a[216:219], a[128:131], v[84:87]
v_cvt_pk_bf16_f32 v202, v226, v227
v_cvt_pk_bf16_f32 v206, v222, v223
v_cvt_pk_bf16_f32 v210, v228, v229
s_waitcnt vmcnt(11)
v_mfma_f32_16x16x32_bf16 v[88:91], a[220:223], a[128:131], v[88:91]
buffer_load_dwordx4 a[160:163], v13, s[8:11], s16 offen offset:0 sc1
v_mfma_f32_16x16x32_bf16 v[88:91], a[212:215], a[156:159], v[88:91]
buffer_store_dwordx4 v[240:243], v12, s[8:11], s36 offen sc1
v_mfma_f32_16x16x32_bf16 v[88:91], a[204:207], a[152:155], v[88:91]
buffer_load_dwordx4 a[164:167], v14, s[8:11], s16 offen offset:0 sc1
v_mfma_f32_16x16x32_bf16 v[88:91], a[196:199], a[148:151], v[88:91]
s_add_u32 s36, s3, 147456
v_lshlrev_b32 v234, 16, v187
v_and_b32 v235, s50, v187
v_lshlrev_b32 v216, 16, v191
v_mfma_f32_16x16x32_bf16 v[96:99], a[196:199], a[152:155], v[96:99]
v_and_b32 v217, s50, v191
v_lshlrev_b32 v224, 16, v195
v_mfma_f32_16x16x32_bf16 v[96:99], a[204:207], a[156:159], v[96:99]
ds_read_b128 a[144:147], v15 offset:59344
v_and_b32 v225, s50, v195
v_mfma_f32_16x16x32_bf16 v[96:99], a[212:215], a[128:131], v[96:99]
v_lshlrev_b32 v220, 16, v151
s_waitcnt vmcnt(12) lgkmcnt(1)
v_mfma_f32_16x16x32_bf16 v[96:99], a[220:223], a[132:135], v[96:99]
v_and_b32 v221, s50, v151
v_fma_f32 v212, v224, s51, v220
v_fma_f32 v213, v225, s51, v221
v_fmac_f32 v224, s51, v216
v_mfma_f32_16x16x32_bf16 v[92:95], a[216:219], a[132:135], v[92:95]
v_fmac_f32 v225, s51, v217
v_fmac_f32 v216, s51, v234
v_mfma_f32_16x16x32_bf16 v[92:95], a[208:211], a[128:131], v[92:95]
v_fmac_f32 v217, s51, v235
v_fmac_f32 v234, s51, v230
v_mfma_f32_16x16x32_bf16 v[92:95], a[200:203], a[156:159], v[92:95]
buffer_load_dwordx4 a[168:171], v13, s[8:11], s16 offen offset:1024 sc1
v_mfma_f32_16x16x32_bf16 v[92:95], a[192:195], a[152:155], v[92:95]
v_fmac_f32 v235, s51, v231
v_fma_f32 v230, v234, s60, v224
v_fma_f32 v231, v235, s60, v225
v_fma_f32 v226, v216, s60, v212
v_mfma_f32_16x16x32_bf16 v[100:103], a[192:195], a[156:159], v[100:103]
v_fma_f32 v227, v217, s60, v213
v_fmac_f32 v224, s52, v234
v_mfma_f32_16x16x32_bf16 v[100:103], a[200:203], a[128:131], v[100:103]
ds_read_b128 a[148:151], v15 offset:57824
v_fmac_f32 v225, s52, v235
v_mfma_f32_16x16x32_bf16 v[100:103], a[208:211], a[132:135], v[100:103]
v_fmac_f32 v212, s52, v216
v_fmac_f32 v213, s52, v217
v_mfma_f32_16x16x32_bf16 v[100:103], a[216:219], a[136:139], v[100:103]
v_fma_f32 v234, -v230, s53, v226
v_fma_f32 v235, -v231, s53, v227
v_fmac_f32 v226, s53, v230
v_mfma_f32_16x16x32_bf16 v[104:107], a[220:223], a[136:139], v[104:107]
v_fmac_f32 v227, s53, v231
v_fma_f32 v216, -v224, s54, v212
v_mfma_f32_16x16x32_bf16 v[104:107], a[212:215], a[132:135], v[104:107]
v_fma_f32 v217, -v225, s54, v213
v_fmac_f32 v212, s54, v224
v_mfma_f32_16x16x32_bf16 v[104:107], a[204:207], a[128:131], v[104:107]
buffer_load_dwordx4 a[172:175], v14, s[8:11], s16 offen offset:1024 sc1
v_mfma_f32_16x16x32_bf16 v[104:107], a[196:199], a[156:159], v[104:107]
v_fmac_f32 v213, s54, v225
v_cvt_pk_bf16_f32 v199, v234, v235
v_mfma_f32_16x16x32_bf16 v[112:115], a[196:199], a[128:131], v[112:115]
v_cvt_pk_bf16_f32 v203, v226, v227
v_cvt_pk_bf16_f32 v207, v216, v217
v_mfma_f32_16x16x32_bf16 v[112:115], a[204:207], a[132:135], v[112:115]
ds_read_b128 a[152:155], v15 offset:57840
v_cvt_pk_bf16_f32 v211, v212, v213
v_mfma_f32_16x16x32_bf16 v[112:115], a[212:215], a[136:139], v[112:115]
ds_write_b128 v8, v[196:199] offset:528
v_mfma_f32_16x16x32_bf16 v[112:115], a[220:223], a[140:143], v[112:115]
ds_write_b128 v8, v[200:203] offset:17040
v_mfma_f32_16x16x32_bf16 v[108:111], a[216:219], a[140:143], v[108:111]
ds_write_b128 v8, v[204:207] offset:33552
v_mfma_f32_16x16x32_bf16 v[108:111], a[208:211], a[136:139], v[108:111]
ds_write_b128 v8, v[208:211] offset:50064
v_mfma_f32_16x16x32_bf16 v[108:111], a[200:203], a[132:135], v[108:111]
buffer_load_dwordx4 a[176:179], v13, s[8:11], s16 offen offset:2048 sc1
v_mfma_f32_16x16x32_bf16 v[108:111], a[192:195], a[128:131], v[108:111]
v_lshlrev_b32 v222, 16, v152
v_and_b32 v223, s50, v152
v_mfma_f32_16x16x32_bf16 v[116:119], a[192:195], a[132:135], v[116:119]
v_lshlrev_b32 v228, 16, v156
v_and_b32 v229, s50, v156
v_mfma_f32_16x16x32_bf16 v[116:119], a[200:203], a[136:139], v[116:119]
ds_read_b128 a[156:159], v15 offset:58336
v_lshlrev_b32 v230, 16, v160
v_mfma_f32_16x16x32_bf16 v[116:119], a[208:211], a[140:143], v[116:119]
v_and_b32 v231, s50, v160
s_waitcnt lgkmcnt(5)
v_mfma_f32_16x16x32_bf16 v[116:119], a[216:219], a[144:147], v[116:119]
buffer_load_dwordx4 v[184:187], v3, s[4:7], 0 offen offset:3328
v_mfma_f32_16x16x32_bf16 v[120:123], a[220:223], a[144:147], v[120:123]
buffer_load_dwordx4 v[188:191], v9, s[4:7], 0 offen offset:1280
v_mfma_f32_16x16x32_bf16 v[120:123], a[212:215], a[140:143], v[120:123]
buffer_load_dwordx4 v[192:195], v10, s[4:7], 0 offen offset:1280
v_mfma_f32_16x16x32_bf16 v[120:123], a[204:207], a[136:139], v[120:123]
buffer_load_dwordx4 a[180:183], v14, s[8:11], s16 offen offset:2048 sc1
v_mfma_f32_16x16x32_bf16 v[120:123], a[196:199], a[132:135], v[120:123]
buffer_load_dwordx4 v[148:151], v10, s[4:7], 0 offen offset:3328
v_mfma_f32_16x16x32_bf16 v[128:131], a[196:199], a[136:139], v[128:131]
s_waitcnt lgkmcnt(0)
s_barrier
v_mfma_f32_16x16x32_bf16 v[128:131], a[204:207], a[140:143], v[128:131]
ds_read_b128 a[128:131], v16 offset:0
v_lshlrev_b32 v224, 16, v164
v_mfma_f32_16x16x32_bf16 v[128:131], a[212:215], a[144:147], v[128:131]
ds_read_b128 a[132:135], v16 offset:16
v_and_b32 v225, s50, v164
v_mfma_f32_16x16x32_bf16 v[128:131], a[220:223], a[148:151], v[128:131]
s_waitcnt vmcnt(19)
v_lshlrev_b32 v234, 16, v168
v_mfma_f32_16x16x32_bf16 v[124:127], a[216:219], a[148:151], v[124:127]
v_and_b32 v235, s50, v168
v_fma_f32 v226, v224, s51, v234
v_mfma_f32_16x16x32_bf16 v[124:127], a[208:211], a[144:147], v[124:127]
v_fma_f32 v227, v225, s51, v235
v_fmac_f32 v224, s51, v230
v_mfma_f32_16x16x32_bf16 v[124:127], a[200:203], a[140:143], v[124:127]
buffer_load_dwordx4 a[184:187], v13, s[8:11], s16 offen offset:3072 sc1
v_mfma_f32_16x16x32_bf16 v[124:127], a[192:195], a[136:139], v[124:127]
ds_read_b128 a[136:139], v16 offset:512
v_fmac_f32 v225, s51, v231
v_mfma_f32_16x16x32_bf16 v[132:135], a[192:195], a[140:143], v[132:135]
v_fmac_f32 v230, s51, v228
v_fmac_f32 v231, s51, v229
v_mfma_f32_16x16x32_bf16 v[132:135], a[200:203], a[144:147], v[132:135]
v_fmac_f32 v228, s51, v222
v_fmac_f32 v229, s51, v223
v_mfma_f32_16x16x32_bf16 v[132:135], a[208:211], a[148:151], v[132:135]
v_fma_f32 v222, v228, s60, v224
v_fma_f32 v223, v229, s60, v225
v_mfma_f32_16x16x32_bf16 v[132:135], a[216:219], a[152:155], v[132:135]
v_fma_f32 v216, v230, s60, v226
v_fma_f32 v217, v231, s60, v227
v_mfma_f32_16x16x32_bf16 v[136:139], a[220:223], a[152:155], v[136:139]
v_fmac_f32 v224, s52, v228
v_fmac_f32 v225, s52, v229
v_mfma_f32_16x16x32_bf16 v[136:139], a[212:215], a[148:151], v[136:139]
v_fmac_f32 v226, s52, v230
v_fmac_f32 v227, s52, v231
v_mfma_f32_16x16x32_bf16 v[136:139], a[204:207], a[144:147], v[136:139]
buffer_load_dwordx4 a[188:191], v14, s[8:11], s16 offen offset:3072 sc1
v_mfma_f32_16x16x32_bf16 v[136:139], a[196:199], a[140:143], v[136:139]
ds_read_b128 a[140:143], v16 offset:528
s_add_u32 s16, s16, 4096
v_mfma_f32_16x16x32_bf16 v[144:147], a[196:199], a[144:147], v[144:147]
v_fma_f32 v228, -v222, s53, v216
v_fma_f32 v229, -v223, s53, v217
v_mfma_f32_16x16x32_bf16 v[144:147], a[204:207], a[148:151], v[144:147]
v_fmac_f32 v216, s53, v222
v_fmac_f32 v217, s53, v223
v_mfma_f32_16x16x32_bf16 v[144:147], a[212:215], a[152:155], v[144:147]
v_fma_f32 v230, -v224, s54, v226
v_fma_f32 v231, -v225, s54, v227
v_mfma_f32_16x16x32_bf16 v[144:147], a[220:223], a[156:159], v[144:147]
v_fmac_f32 v226, s54, v224
v_fmac_f32 v227, s54, v225
v_mfma_f32_16x16x32_bf16 v[140:143], a[216:219], a[156:159], v[140:143]
v_cvt_pk_bf16_f32 v196, v228, v229
v_cvt_pk_bf16_f32 v200, v216, v217
v_mfma_f32_16x16x32_bf16 v[140:143], a[208:211], a[152:155], v[140:143]
v_cvt_pk_bf16_f32 v204, v230, v231
v_cvt_pk_bf16_f32 v208, v226, v227
v_mfma_f32_16x16x32_bf16 v[140:143], a[200:203], a[148:151], v[140:143]
v_lshlrev_b32 v212, 16, v153
v_and_b32 v213, s50, v153
v_mfma_f32_16x16x32_bf16 v[140:143], a[192:195], a[144:147], v[140:143]
ds_read_b128 a[144:147], v16 offset:1024
s_waitcnt lgkmcnt(2)
v_mfma_f32_16x16x32_bf16 a[0:3], a[224:227], a[128:131], a[0:3]
ds_read_b128 a[148:151], v16 offset:1040
v_lshlrev_b32 v214, 16, v157
v_mfma_f32_16x16x32_bf16 a[0:3], a[232:235], a[132:135], a[0:3]
ds_read_b128 a[152:155], v16 offset:1536
s_waitcnt vmcnt(12) lgkmcnt(3)
v_mfma_f32_16x16x32_bf16 a[0:3], a[240:243], a[136:139], a[0:3]
buffer_load_dwordx4 a[192:195], v13, s[8:11], s16 offen offset:0 sc1
v_mfma_f32_16x16x32_bf16 a[0:3], a[248:251], a[140:143], a[0:3]
v_and_b32 v215, s50, v157
v_lshlrev_b32 v232, 16, v161
v_mfma_f32_16x16x32_bf16 a[4:7], a[252:255], a[140:143], a[4:7]
v_and_b32 v233, s50, v161
v_lshlrev_b32 v218, 16, v165
v_mfma_f32_16x16x32_bf16 a[4:7], a[244:247], a[136:139], a[4:7]
v_and_b32 v219, s50, v165
v_lshlrev_b32 v220, 16, v169
v_mfma_f32_16x16x32_bf16 a[4:7], a[236:239], a[132:135], a[4:7]
buffer_load_dwordx4 a[196:199], v14, s[8:11], s16 offen offset:0 sc1
v_mfma_f32_16x16x32_bf16 a[4:7], a[228:231], a[128:131], a[4:7]
v_and_b32 v221, s50, v169
v_fma_f32 v222, v218, s51, v220
v_mfma_f32_16x16x32_bf16 a[12:15], a[228:231], a[132:135], a[12:15]
v_fma_f32 v223, v219, s51, v221
v_fmac_f32 v218, s51, v232
v_mfma_f32_16x16x32_bf16 a[12:15], a[236:239], a[136:139], a[12:15]
ds_read_b128 a[156:159], v16 offset:1552
v_fmac_f32 v219, s51, v233
v_mfma_f32_16x16x32_bf16 a[12:15], a[244:247], a[140:143], a[12:15]
v_fmac_f32 v232, s51, v214
s_waitcnt lgkmcnt(1)
v_mfma_f32_16x16x32_bf16 a[12:15], a[252:255], a[144:147], a[12:15]
v_fmac_f32 v233, s51, v215
v_fmac_f32 v214, s51, v212
v_mfma_f32_16x16x32_bf16 a[8:11], a[248:251], a[144:147], a[8:11]
v_fmac_f32 v215, s51, v213
v_fma_f32 v212, v214, s60, v218
v_mfma_f32_16x16x32_bf16 a[8:11], a[240:243], a[140:143], a[8:11]
v_fma_f32 v213, v215, s60, v219
v_fma_f32 v224, v232, s60, v222
v_mfma_f32_16x16x32_bf16 a[8:11], a[232:235], a[136:139], a[8:11]
buffer_load_dwordx4 a[200:203], v13, s[8:11], s16 offen offset:1024 sc1
v_mfma_f32_16x16x32_bf16 a[8:11], a[224:227], a[132:135], a[8:11]
v_fma_f32 v225, v233, s60, v223
v_fmac_f32 v218, s52, v214
v_mfma_f32_16x16x32_bf16 a[16:19], a[224:227], a[136:139], a[16:19]
v_fmac_f32 v219, s52, v215
v_fmac_f32 v222, s52, v232
v_mfma_f32_16x16x32_bf16 a[16:19], a[232:235], a[140:143], a[16:19]
ds_read_b128 a[128:131], v16 offset:32
v_fmac_f32 v223, s52, v233
v_mfma_f32_16x16x32_bf16 a[16:19], a[240:243], a[144:147], a[16:19]
v_fma_f32 v214, -v212, s53, v224
v_fma_f32 v215, -v213, s53, v225
v_mfma_f32_16x16x32_bf16 a[16:19], a[248:251], a[148:151], a[16:19]
v_fmac_f32 v224, s53, v212
v_fmac_f32 v225, s53, v213
v_mfma_f32_16x16x32_bf16 a[20:23], a[252:255], a[148:151], a[20:23]
buffer_store_dwordx4 v[244:247], v12, s[8:11], s36 offen sc1
v_mfma_f32_16x16x32_bf16 a[20:23], a[244:247], a[144:147], a[20:23]
v_fma_f32 v232, -v218, s54, v222
v_fma_f32 v233, -v219, s54, v223
v_mfma_f32_16x16x32_bf16 a[20:23], a[236:239], a[140:143], a[20:23]
buffer_load_dwordx4 a[204:207], v14, s[8:11], s16 offen offset:1024 sc1
v_mfma_f32_16x16x32_bf16 a[20:23], a[228:231], a[136:139], a[20:23]
v_fmac_f32 v222, s54, v218
v_fmac_f32 v223, s54, v219
v_mfma_f32_16x16x32_bf16 a[28:31], a[228:231], a[140:143], a[28:31]
v_cvt_pk_bf16_f32 v197, v214, v215
v_cvt_pk_bf16_f32 v201, v224, v225
v_mfma_f32_16x16x32_bf16 a[28:31], a[236:239], a[144:147], a[28:31]
ds_read_b128 a[132:135], v16 offset:48
v_cvt_pk_bf16_f32 v205, v232, v233
v_mfma_f32_16x16x32_bf16 a[28:31], a[244:247], a[148:151], a[28:31]
v_cvt_pk_bf16_f32 v209, v222, v223
v_lshlrev_b32 v228, 16, v154
v_mfma_f32_16x16x32_bf16 a[28:31], a[252:255], a[152:155], a[28:31]
v_and_b32 v229, s50, v154
v_lshlrev_b32 v216, 16, v158
v_mfma_f32_16x16x32_bf16 a[24:27], a[248:251], a[152:155], a[24:27]
v_and_b32 v217, s50, v158
v_lshlrev_b32 v230, 16, v162
v_mfma_f32_16x16x32_bf16 a[24:27], a[240:243], a[148:151], a[24:27]
v_and_b32 v231, s50, v162
v_lshlrev_b32 v226, 16, v166
v_mfma_f32_16x16x32_bf16 a[24:27], a[232:235], a[144:147], a[24:27]
buffer_load_dwordx4 a[208:211], v13, s[8:11], s16 offen offset:2048 sc1
v_mfma_f32_16x16x32_bf16 a[24:27], a[224:227], a[140:143], a[24:27]
v_and_b32 v227, s50, v166
v_lshlrev_b32 v212, 16, v170
v_mfma_f32_16x16x32_bf16 a[32:35], a[224:227], a[144:147], a[32:35]
v_and_b32 v213, s50, v170
v_fma_f32 v218, v226, s51, v212
v_mfma_f32_16x16x32_bf16 a[32:35], a[232:235], a[148:151], a[32:35]
ds_read_b128 a[136:139], v16 offset:544
v_fma_f32 v219, v227, s51, v213
v_mfma_f32_16x16x32_bf16 a[32:35], a[240:243], a[152:155], a[32:35]
v_fmac_f32 v226, s51, v230
s_waitcnt lgkmcnt(1)
v_mfma_f32_16x16x32_bf16 a[32:35], a[248:251], a[156:159], a[32:35]
v_fmac_f32 v227, s51, v231
v_fmac_f32 v230, s51, v216
v_mfma_f32_16x16x32_bf16 a[36:39], a[252:255], a[156:159], a[36:39]
v_fmac_f32 v231, s51, v217
v_fmac_f32 v216, s51, v228
v_mfma_f32_16x16x32_bf16 a[36:39], a[244:247], a[152:155], a[36:39]
v_fmac_f32 v217, s51, v229
v_fma_f32 v228, v216, s60, v226
v_mfma_f32_16x16x32_bf16 a[36:39], a[236:239], a[148:151], a[36:39]
ds_read_b128 a[140:143], v16 offset:8256
v_fma_f32 v229, v217, s60, v227
v_mfma_f32_16x16x32_bf16 a[36:39], a[228:231], a[144:147], a[36:39]
ds_read_b128 a[144:147], v16 offset:8272
v_fma_f32 v214, v230, s60, v218
v_mfma_f32_16x16x32_bf16 a[44:47], a[228:231], a[148:151], a[44:47]
buffer_load_dwordx4 a[212:215], v14, s[8:11], s16 offen offset:2048 sc1
v_mfma_f32_16x16x32_bf16 a[44:47], a[236:239], a[152:155], a[44:47]
v_fma_f32 v215, v231, s60, v219
v_fmac_f32 v226, s52, v216
v_mfma_f32_16x16x32_bf16 a[44:47], a[244:247], a[156:159], a[44:47]
v_fmac_f32 v227, s52, v217
v_fmac_f32 v218, s52, v230
v_mfma_f32_16x16x32_bf16 a[44:47], a[252:255], a[128:131], a[44:47]
v_fmac_f32 v219, s52, v231
v_fma_f32 v216, -v228, s53, v214
v_mfma_f32_16x16x32_bf16 a[40:43], a[248:251], a[128:131], a[40:43]
v_fma_f32 v217, -v229, s53, v215
v_fmac_f32 v214, s53, v228
v_mfma_f32_16x16x32_bf16 a[40:43], a[240:243], a[156:159], a[40:43]
v_fmac_f32 v215, s53, v229
v_fma_f32 v230, -v226, s54, v218
v_mfma_f32_16x16x32_bf16 a[40:43], a[232:235], a[152:155], a[40:43]
buffer_load_dwordx4 a[216:219], v13, s[8:11], s16 offen offset:3072 sc1
v_mfma_f32_16x16x32_bf16 a[40:43], a[224:227], a[148:151], a[40:43]
ds_read_b128 a[148:151], v16 offset:8768
v_fma_f32 v231, -v227, s54, v219
v_mfma_f32_16x16x32_bf16 a[48:51], a[224:227], a[152:155], a[48:51]
v_fmac_f32 v218, s54, v226
v_fmac_f32 v219, s54, v227
v_mfma_f32_16x16x32_bf16 a[48:51], a[232:235], a[156:159], a[48:51]
v_cvt_pk_bf16_f32 v198, v216, v217
v_cvt_pk_bf16_f32 v202, v214, v215
v_mfma_f32_16x16x32_bf16 a[48:51], a[240:243], a[128:131], a[48:51]
v_cvt_pk_bf16_f32 v206, v230, v231
v_cvt_pk_bf16_f32 v210, v218, v219
v_mfma_f32_16x16x32_bf16 a[48:51], a[248:251], a[132:135], a[48:51]
v_lshlrev_b32 v224, 16, v155
v_and_b32 v225, s50, v155
v_mfma_f32_16x16x32_bf16 a[52:55], a[252:255], a[132:135], a[52:55]
v_lshlrev_b32 v232, 16, v159
v_and_b32 v233, s50, v159
v_mfma_f32_16x16x32_bf16 a[52:55], a[244:247], a[128:131], a[52:55]
v_lshlrev_b32 v222, 16, v163
v_and_b32 v223, s50, v163
v_mfma_f32_16x16x32_bf16 a[52:55], a[236:239], a[156:159], a[52:55]
buffer_load_dwordx4 a[220:223], v14, s[8:11], s16 offen offset:3072 sc1
v_mfma_f32_16x16x32_bf16 a[52:55], a[228:231], a[152:155], a[52:55]
ds_read_b128 a[152:155], v16 offset:8784
s_add_u32 s16, s16, 4096
v_mfma_f32_16x16x32_bf16 a[60:63], a[228:231], a[156:159], a[60:63]
v_lshlrev_b32 v228, 16, v167
v_and_b32 v229, s50, v167
v_mfma_f32_16x16x32_bf16 a[60:63], a[236:239], a[128:131], a[60:63]
v_lshlrev_b32 v226, 16, v171
v_and_b32 v227, s50, v171
v_mfma_f32_16x16x32_bf16 a[60:63], a[244:247], a[132:135], a[60:63]
v_fma_f32 v216, v228, s51, v226
s_waitcnt vmcnt(16) lgkmcnt(1)
v_mfma_f32_16x16x32_bf16 a[60:63], a[252:255], a[136:139], a[60:63]
v_fma_f32 v217, v229, s51, v227
v_fmac_f32 v228, s51, v222
v_mfma_f32_16x16x32_bf16 a[56:59], a[248:251], a[136:139], a[56:59]
v_fmac_f32 v229, s51, v223
v_fmac_f32 v222, s51, v232
v_mfma_f32_16x16x32_bf16 a[56:59], a[240:243], a[132:135], a[56:59]
v_fmac_f32 v223, s51, v233
v_fmac_f32 v232, s51, v224
v_mfma_f32_16x16x32_bf16 a[56:59], a[232:235], a[128:131], a[56:59]
v_fmac_f32 v233, s51, v225
v_fma_f32 v224, v232, s60, v228
v_mfma_f32_16x16x32_bf16 a[56:59], a[224:227], a[156:159], a[56:59]
ds_read_b128 a[156:159], v16 offset:9280
v_fma_f32 v225, v233, s60, v229
v_mfma_f32_16x16x32_bf16 a[0:3], a[160:163], a[140:143], a[0:3]
ds_read_b128 a[128:131], v16 offset:9296
v_fma_f32 v214, v222, s60, v216
v_mfma_f32_16x16x32_bf16 a[0:3], a[168:171], a[144:147], a[0:3]
ds_read_b128 a[132:135], v16 offset:9792
v_fma_f32 v215, v223, s60, v217
v_mfma_f32_16x16x32_bf16 a[0:3], a[176:179], a[148:151], a[0:3]
v_fmac_f32 v228, s52, v232
s_waitcnt vmcnt(7) lgkmcnt(3)
v_mfma_f32_16x16x32_bf16 a[0:3], a[184:187], a[152:155], a[0:3]
buffer_load_dwordx4 a[224:227], v13, s[8:11], s16 offen offset:0 sc1
v_mfma_f32_16x16x32_bf16 a[4:7], a[188:191], a[152:155], a[4:7]
v_fmac_f32 v229, s52, v233
v_fmac_f32 v216, s52, v222
v_mfma_f32_16x16x32_bf16 a[4:7], a[180:183], a[148:151], a[4:7]
v_fmac_f32 v217, s52, v223
v_fma_f32 v232, -v224, s53, v214
v_mfma_f32_16x16x32_bf16 a[4:7], a[172:175], a[144:147], a[4:7]
buffer_load_dwordx4 a[228:231], v14, s[8:11], s16 offen offset:0 sc1
v_mfma_f32_16x16x32_bf16 a[4:7], a[164:167], a[140:143], a[4:7]
v_fma_f32 v233, -v225, s53, v215
v_fmac_f32 v214, s53, v224
v_mfma_f32_16x16x32_bf16 a[12:15], a[164:167], a[144:147], a[12:15]
v_fmac_f32 v215, s53, v225
v_fma_f32 v222, -v228, s54, v216
v_mfma_f32_16x16x32_bf16 a[12:15], a[172:175], a[148:151], a[12:15]
ds_read_b128 a[136:139], v16 offset:9808
v_fma_f32 v223, -v229, s54, v217
v_mfma_f32_16x16x32_bf16 a[12:15], a[180:183], a[152:155], a[12:15]
v_fmac_f32 v216, s54, v228
s_waitcnt vmcnt(8) lgkmcnt(1)
v_mfma_f32_16x16x32_bf16 a[12:15], a[188:191], a[156:159], a[12:15]
v_fmac_f32 v217, s54, v229
v_cvt_pk_bf16_f32 v199, v232, v233
v_mfma_f32_16x16x32_bf16 a[8:11], a[184:187], a[156:159], a[8:11]
v_cvt_pk_bf16_f32 v203, v214, v215
v_cvt_pk_bf16_f32 v207, v222, v223
v_mfma_f32_16x16x32_bf16 a[8:11], a[176:179], a[152:155], a[8:11]
v_cvt_pk_bf16_f32 v211, v216, v217
v_mfma_f32_16x16x32_bf16 a[8:11], a[168:171], a[148:151], a[8:11]
buffer_load_dwordx4 a[232:235], v13, s[8:11], s16 offen offset:1024 sc1
v_mfma_f32_16x16x32_bf16 a[8:11], a[160:163], a[144:147], a[8:11]
buffer_load_dwordx4 v[152:155], v11, s[4:7], 0 offen offset:256
v_mfma_f32_16x16x32_bf16 a[16:19], a[160:163], a[148:151], a[16:19]
buffer_load_dwordx4 v[156:159], v10, s[4:7], 0 offen offset:2304
v_mfma_f32_16x16x32_bf16 a[16:19], a[168:171], a[152:155], a[16:19]
ds_read_b128 a[140:143], v16 offset:8288
v_mfma_f32_16x16x32_bf16 a[16:19], a[176:179], a[156:159], a[16:19]
buffer_load_dwordx4 v[160:163], v10, s[4:7], 0 offen offset:256
v_mfma_f32_16x16x32_bf16 a[16:19], a[184:187], a[128:131], a[16:19]
buffer_load_dwordx4 v[164:167], v9, s[4:7], 0 offen offset:256
v_mfma_f32_16x16x32_bf16 a[20:23], a[188:191], a[128:131], a[20:23]
buffer_load_dwordx4 v[168:171], v4, s[4:7], 0 offen offset:256
v_mfma_f32_16x16x32_bf16 a[20:23], a[180:183], a[156:159], a[20:23]
ds_write_b128 v7, v[196:199] offset:0
v_mfma_f32_16x16x32_bf16 a[20:23], a[172:175], a[152:155], a[20:23]
buffer_load_dwordx4 a[236:239], v14, s[8:11], s16 offen offset:1024 sc1
v_mfma_f32_16x16x32_bf16 a[20:23], a[164:167], a[148:151], a[20:23]
ds_write_b128 v7, v[200:203] offset:16512
v_mfma_f32_16x16x32_bf16 a[28:31], a[164:167], a[152:155], a[28:31]
ds_write_b128 v7, v[204:207] offset:33024
v_mfma_f32_16x16x32_bf16 a[28:31], a[172:175], a[156:159], a[28:31]
ds_read_b128 a[144:147], v16 offset:8304
v_mfma_f32_16x16x32_bf16 a[28:31], a[180:183], a[128:131], a[28:31]
ds_write_b128 v7, v[208:211] offset:49536
v_mfma_f32_16x16x32_bf16 a[28:31], a[188:191], a[132:135], a[28:31]
v_lshlrev_b32 v230, 16, v172
v_and_b32 v231, s50, v172
v_mfma_f32_16x16x32_bf16 a[24:27], a[184:187], a[132:135], a[24:27]
v_lshlrev_b32 v218, 16, v176
v_and_b32 v219, s50, v176
v_mfma_f32_16x16x32_bf16 a[24:27], a[176:179], a[128:131], a[24:27]
v_lshlrev_b32 v224, 16, v180
v_and_b32 v225, s50, v180
v_mfma_f32_16x16x32_bf16 a[24:27], a[168:171], a[156:159], a[24:27]
buffer_load_dwordx4 a[240:243], v13, s[8:11], s16 offen offset:2048 sc1
v_mfma_f32_16x16x32_bf16 a[24:27], a[160:163], a[152:155], a[24:27]
v_lshlrev_b32 v228, 16, v184
v_and_b32 v229, s50, v184
v_mfma_f32_16x16x32_bf16 a[32:35], a[160:163], a[156:159], a[32:35]
v_fma_f32 v232, v224, s51, v228
v_fma_f32 v233, v225, s51, v229
v_mfma_f32_16x16x32_bf16 a[32:35], a[168:171], a[128:131], a[32:35]
ds_read_b128 a[148:151], v16 offset:8800
v_fmac_f32 v224, s51, v218
v_mfma_f32_16x16x32_bf16 a[32:35], a[176:179], a[132:135], a[32:35]
v_fmac_f32 v225, s51, v219
s_waitcnt lgkmcnt(2)
v_mfma_f32_16x16x32_bf16 a[32:35], a[184:187], a[136:139], a[32:35]
v_fmac_f32 v218, s51, v230
v_fmac_f32 v219, s51, v231
v_mfma_f32_16x16x32_bf16 a[36:39], a[188:191], a[136:139], a[36:39]
v_fmac_f32 v230, s51, v234
v_fmac_f32 v231, s51, v235
v_mfma_f32_16x16x32_bf16 a[36:39], a[180:183], a[132:135], a[36:39]
v_fma_f32 v234, v230, s60, v224
v_fma_f32 v235, v231, s60, v225
v_mfma_f32_16x16x32_bf16 a[36:39], a[172:175], a[128:131], a[36:39]
ds_read_b128 a[152:155], v16 offset:16512
v_fma_f32 v214, v218, s60, v232
v_mfma_f32_16x16x32_bf16 a[36:39], a[164:167], a[156:159], a[36:39]
ds_read_b128 a[156:159], v16 offset:16528
v_fma_f32 v215, v219, s60, v233
v_mfma_f32_16x16x32_bf16 a[44:47], a[164:167], a[128:131], a[44:47]
buffer_load_dwordx4 a[244:247], v14, s[8:11], s16 offen offset:2048 sc1
v_mfma_f32_16x16x32_bf16 a[44:47], a[172:175], a[132:135], a[44:47]
v_fmac_f32 v224, s52, v230
v_fmac_f32 v225, s52, v231
v_mfma_f32_16x16x32_bf16 a[44:47], a[180:183], a[136:139], a[44:47]
v_fmac_f32 v232, s52, v218
v_fmac_f32 v233, s52, v219
v_mfma_f32_16x16x32_bf16 a[44:47], a[188:191], a[140:143], a[44:47]
v_fma_f32 v230, -v234, s53, v214
v_fma_f32 v231, -v235, s53, v215
v_mfma_f32_16x16x32_bf16 a[40:43], a[184:187], a[140:143], a[40:43]
v_fmac_f32 v214, s53, v234
v_fmac_f32 v215, s53, v235
v_mfma_f32_16x16x32_bf16 a[40:43], a[176:179], a[136:139], a[40:43]
v_fma_f32 v218, -v224, s54, v232
v_fma_f32 v219, -v225, s54, v233
v_mfma_f32_16x16x32_bf16 a[40:43], a[168:171], a[132:135], a[40:43]
buffer_load_dwordx4 a[248:251], v13, s[8:11], s16 offen offset:3072 sc1
v_mfma_f32_16x16x32_bf16 a[40:43], a[160:163], a[128:131], a[40:43]
ds_read_b128 a[128:131], v16 offset:17024
v_fmac_f32 v232, s54, v224
v_mfma_f32_16x16x32_bf16 a[48:51], a[160:163], a[132:135], a[48:51]
v_fmac_f32 v233, s54, v225
v_cvt_pk_bf16_f32 v196, v230, v231
v_mfma_f32_16x16x32_bf16 a[48:51], a[168:171], a[136:139], a[48:51]
v_cvt_pk_bf16_f32 v200, v214, v215
v_cvt_pk_bf16_f32 v204, v218, v219
v_mfma_f32_16x16x32_bf16 a[48:51], a[176:179], a[140:143], a[48:51]
v_cvt_pk_bf16_f32 v208, v232, v233
v_lshlrev_b32 v222, 16, v173
v_mfma_f32_16x16x32_bf16 a[48:51], a[184:187], a[144:147], a[48:51]
v_and_b32 v223, s50, v173
v_lshlrev_b32 v216, 16, v177
v_mfma_f32_16x16x32_bf16 a[52:55], a[188:191], a[144:147], a[52:55]
v_and_b32 v217, s50, v177
v_lshlrev_b32 v234, 16, v181
v_mfma_f32_16x16x32_bf16 a[52:55], a[180:183], a[140:143], a[52:55]
v_and_b32 v235, s50, v181
v_lshlrev_b32 v224, 16, v185
v_mfma_f32_16x16x32_bf16 a[52:55], a[172:175], a[136:139], a[52:55]
buffer_load_dwordx4 a[252:255], v14, s[8:11], s16 offen offset:3072 sc1
v_mfma_f32_16x16x32_bf16 a[52:55], a[164:167], a[132:135], a[52:55]
ds_read_b128 a[132:135], v16 offset:17040
s_add_u32 s16, s16, 4096
v_mfma_f32_16x16x32_bf16 a[60:63], a[164:167], a[136:139], a[60:63]
v_and_b32 v225, s50, v185
v_fma_f32 v230, v234, s51, v224
v_mfma_f32_16x16x32_bf16 a[60:63], a[172:175], a[140:143], a[60:63]
v_fma_f32 v231, v235, s51, v225
v_fmac_f32 v234, s51, v216
v_mfma_f32_16x16x32_bf16 a[60:63], a[180:183], a[144:147], a[60:63]
v_fmac_f32 v235, s51, v217
s_waitcnt lgkmcnt(1)
v_mfma_f32_16x16x32_bf16 a[60:63], a[188:191], a[148:151], a[60:63]
v_fmac_f32 v216, s51, v222
v_fmac_f32 v217, s51, v223
v_mfma_f32_16x16x32_bf16 a[56:59], a[184:187], a[148:151], a[56:59]
v_fmac_f32 v222, s51, v220
v_fmac_f32 v223, s51, v221
v_mfma_f32_16x16x32_bf16 a[56:59], a[176:179], a[144:147], a[56:59]
v_fma_f32 v220, v222, s60, v234
v_fma_f32 v221, v223, s60, v235
v_mfma_f32_16x16x32_bf16 a[56:59], a[168:171], a[140:143], a[56:59]
v_fma_f32 v214, v216, s60, v230
v_fma_f32 v215, v217, s60, v231
v_mfma_f32_16x16x32_bf16 a[56:59], a[160:163], a[136:139], a[56:59]
ds_read_b128 a[136:139], v16 offset:17536
v_fmac_f32 v234, s52, v222
v_mfma_f32_16x16x32_bf16 v[20:23], a[192:195], a[152:155], v[20:23]
ds_read_b128 a[140:143], v16 offset:17552
v_fmac_f32 v235, s52, v223
v_mfma_f32_16x16x32_bf16 v[20:23], a[200:203], a[156:159], v[20:23]
ds_read_b128 a[144:147], v16 offset:18048
s_waitcnt vmcnt(11) lgkmcnt(3)
v_mfma_f32_16x16x32_bf16 v[20:23], a[208:211], a[128:131], v[20:23]
buffer_load_dwordx4 a[160:163], v13, s[8:11], s16 offen offset:0 sc1
v_mfma_f32_16x16x32_bf16 v[20:23], a[216:219], a[132:135], v[20:23]
v_fmac_f32 v230, s52, v216
v_fmac_f32 v231, s52, v217
v_mfma_f32_16x16x32_bf16 v[24:27], a[220:223], a[132:135], v[24:27]
v_fma_f32 v222, -v220, s53, v214
v_fma_f32 v223, -v221, s53, v215
v_mfma_f32_16x16x32_bf16 v[24:27], a[212:215], a[128:131], v[24:27]
v_fmac_f32 v214, s53, v220
v_fmac_f32 v215, s53, v221
v_mfma_f32_16x16x32_bf16 v[24:27], a[204:207], a[156:159], v[24:27]
buffer_load_dwordx4 a[164:167], v14, s[8:11], s16 offen offset:0 sc1
v_mfma_f32_16x16x32_bf16 v[24:27], a[196:199], a[152:155], v[24:27]
v_fma_f32 v216, -v234, s54, v230
v_fma_f32 v217, -v235, s54, v231
v_mfma_f32_16x16x32_bf16 v[32:35], a[196:199], a[156:159], v[32:35]
v_fmac_f32 v230, s54, v234
v_fmac_f32 v231, s54, v235
v_mfma_f32_16x16x32_bf16 v[32:35], a[204:207], a[128:131], v[32:35]
ds_read_b128 a[148:151], v16 offset:18064
v_cvt_pk_bf16_f32 v197, v222, v223
v_mfma_f32_16x16x32_bf16 v[32:35], a[212:215], a[132:135], v[32:35]
s_getpc_b64 s[46:47]
s_waitcnt vmcnt(12) lgkmcnt(1)
v_mfma_f32_16x16x32_bf16 v[32:35], a[220:223], a[136:139], v[32:35]
global_load_dword v252, v255, s[46:47] offset:2048
v_mfma_f32_16x16x32_bf16 v[28:31], a[216:219], a[136:139], v[28:31]
v_cvt_pk_bf16_f32 v201, v214, v215
v_cvt_pk_bf16_f32 v205, v216, v217
v_mfma_f32_16x16x32_bf16 v[28:31], a[208:211], a[132:135], v[28:31]
v_cvt_pk_bf16_f32 v209, v230, v231
v_lshlrev_b32 v218, 16, v174
v_mfma_f32_16x16x32_bf16 v[28:31], a[200:203], a[128:131], v[28:31]
buffer_load_dwordx4 a[168:171], v13, s[8:11], s16 offen offset:1024 sc1
v_mfma_f32_16x16x32_bf16 v[28:31], a[192:195], a[156:159], v[28:31]
v_and_b32 v219, s50, v174
v_lshlrev_b32 v232, 16, v178
v_mfma_f32_16x16x32_bf16 v[36:39], a[192:195], a[128:131], v[36:39]
v_and_b32 v233, s50, v178
v_lshlrev_b32 v220, 16, v182
v_mfma_f32_16x16x32_bf16 v[36:39], a[200:203], a[132:135], v[36:39]
ds_read_b128 a[152:155], v16 offset:16544
v_and_b32 v221, s50, v182
v_mfma_f32_16x16x32_bf16 v[36:39], a[208:211], a[136:139], v[36:39]
v_lshlrev_b32 v234, 16, v186
v_and_b32 v235, s50, v186
v_mfma_f32_16x16x32_bf16 v[36:39], a[216:219], a[140:143], v[36:39]
v_fma_f32 v222, v220, s51, v234
v_fma_f32 v223, v221, s51, v235
v_mfma_f32_16x16x32_bf16 v[40:43], a[220:223], a[140:143], v[40:43]
v_fmac_f32 v220, s51, v232
v_fmac_f32 v221, s51, v233
v_mfma_f32_16x16x32_bf16 v[40:43], a[212:215], a[136:139], v[40:43]
v_fmac_f32 v232, s51, v218
v_fmac_f32 v233, s51, v219
v_mfma_f32_16x16x32_bf16 v[40:43], a[204:207], a[132:135], v[40:43]
buffer_load_dwordx4 a[172:175], v14, s[8:11], s16 offen offset:1024 sc1
v_mfma_f32_16x16x32_bf16 v[40:43], a[196:199], a[128:131], v[40:43]
v_fmac_f32 v218, s51, v212
v_fmac_f32 v219, s51, v213
v_mfma_f32_16x16x32_bf16 v[48:51], a[196:199], a[132:135], v[48:51]
v_fma_f32 v212, v218, s60, v220
v_fma_f32 v213, v219, s60, v221
v_mfma_f32_16x16x32_bf16 v[48:51], a[204:207], a[136:139], v[48:51]
ds_read_b128 a[156:159], v16 offset:16560
v_fma_f32 v214, v232, s60, v222
v_mfma_f32_16x16x32_bf16 v[48:51], a[212:215], a[140:143], v[48:51]
v_fma_f32 v215, v233, s60, v223
v_fmac_f32 v220, s52, v218
v_mfma_f32_16x16x32_bf16 v[48:51], a[220:223], a[144:147], v[48:51]
v_fmac_f32 v221, s52, v219
v_fmac_f32 v222, s52, v232
v_mfma_f32_16x16x32_bf16 v[44:47], a[216:219], a[144:147], v[44:47]
v_fmac_f32 v223, s52, v233
v_fma_f32 v218, -v212, s53, v214
v_mfma_f32_16x16x32_bf16 v[44:47], a[208:211], a[140:143], v[44:47]
v_fma_f32 v219, -v213, s53, v215
v_fmac_f32 v214, s53, v212
v_mfma_f32_16x16x32_bf16 v[44:47], a[200:203], a[136:139], v[44:47]
buffer_load_dwordx4 a[176:179], v13, s[8:11], s16 offen offset:2048 sc1
v_mfma_f32_16x16x32_bf16 v[44:47], a[192:195], a[132:135], v[44:47]
v_fmac_f32 v215, s53, v213
v_fma_f32 v232, -v220, s54, v222
v_mfma_f32_16x16x32_bf16 v[52:55], a[192:195], a[136:139], v[52:55]
v_fma_f32 v233, -v221, s54, v223
v_fmac_f32 v222, s54, v220
v_mfma_f32_16x16x32_bf16 v[52:55], a[200:203], a[140:143], v[52:55]
ds_read_b128 a[128:131], v16 offset:17056
v_fmac_f32 v223, s54, v221
v_mfma_f32_16x16x32_bf16 v[52:55], a[208:211], a[144:147], v[52:55]
v_cvt_pk_bf16_f32 v198, v218, v219
s_waitcnt lgkmcnt(1)
v_mfma_f32_16x16x32_bf16 v[52:55], a[216:219], a[148:151], v[52:55]
v_cvt_pk_bf16_f32 v202, v214, v215
v_cvt_pk_bf16_f32 v206, v232, v233
v_mfma_f32_16x16x32_bf16 v[56:59], a[220:223], a[148:151], v[56:59]
v_cvt_pk_bf16_f32 v210, v222, v223
v_lshlrev_b32 v216, 16, v175
v_mfma_f32_16x16x32_bf16 v[56:59], a[212:215], a[144:147], v[56:59]
v_and_b32 v217, s50, v175
v_lshlrev_b32 v230, 16, v179
v_mfma_f32_16x16x32_bf16 v[56:59], a[204:207], a[140:143], v[56:59]
ds_read_b128 a[132:135], v16 offset:24768
v_and_b32 v231, s50, v179
v_mfma_f32_16x16x32_bf16 v[56:59], a[196:199], a[136:139], v[56:59]
ds_read_b128 a[136:139], v16 offset:24784
v_lshlrev_b32 v212, 16, v183
v_mfma_f32_16x16x32_bf16 v[64:67], a[196:199], a[140:143], v[64:67]
buffer_load_dwordx4 a[180:183], v14, s[8:11], s16 offen offset:2048 sc1
v_mfma_f32_16x16x32_bf16 v[64:67], a[204:207], a[144:147], v[64:67]
v_and_b32 v213, s50, v183
v_lshlrev_b32 v220, 16, v187
v_mfma_f32_16x16x32_bf16 v[64:67], a[212:215], a[148:151], v[64:67]
v_and_b32 v221, s50, v187
v_fma_f32 v218, v212, s51, v220
v_mfma_f32_16x16x32_bf16 v[64:67], a[220:223], a[152:155], v[64:67]
v_fma_f32 v219, v213, s51, v221
v_fmac_f32 v212, s51, v230
v_mfma_f32_16x16x32_bf16 v[60:63], a[216:219], a[152:155], v[60:63]
v_fmac_f32 v213, s51, v231
v_fmac_f32 v230, s51, v216
v_mfma_f32_16x16x32_bf16 v[60:63], a[208:211], a[148:151], v[60:63]
v_fmac_f32 v231, s51, v217
v_fmac_f32 v216, s51, v226
v_mfma_f32_16x16x32_bf16 v[60:63], a[200:203], a[144:147], v[60:63]
buffer_load_dwordx4 a[184:187], v13, s[8:11], s16 offen offset:3072 sc1
v_mfma_f32_16x16x32_bf16 v[60:63], a[192:195], a[140:143], v[60:63]
ds_read_b128 a[140:143], v16 offset:25280
v_fmac_f32 v217, s51, v227
v_mfma_f32_16x16x32_bf16 v[68:71], a[192:195], a[144:147], v[68:71]
v_fma_f32 v226, v216, s60, v212
v_fma_f32 v227, v217, s60, v213
v_mfma_f32_16x16x32_bf16 v[68:71], a[200:203], a[148:151], v[68:71]
v_fma_f32 v214, v230, s60, v218
v_fma_f32 v215, v231, s60, v219
v_mfma_f32_16x16x32_bf16 v[68:71], a[208:211], a[152:155], v[68:71]
v_fmac_f32 v212, s52, v216
v_fmac_f32 v213, s52, v217
v_mfma_f32_16x16x32_bf16 v[68:71], a[216:219], a[156:159], v[68:71]
v_fmac_f32 v218, s52, v230
v_fmac_f32 v219, s52, v231
v_mfma_f32_16x16x32_bf16 v[72:75], a[220:223], a[156:159], v[72:75]
v_fma_f32 v216, -v226, s53, v214
v_fma_f32 v217, -v227, s53, v215
v_mfma_f32_16x16x32_bf16 v[72:75], a[212:215], a[152:155], v[72:75]
v_fmac_f32 v214, s53, v226
v_fmac_f32 v215, s53, v227
v_mfma_f32_16x16x32_bf16 v[72:75], a[204:207], a[148:151], v[72:75]
buffer_load_dwordx4 a[188:191], v14, s[8:11], s16 offen offset:3072 sc1
v_mfma_f32_16x16x32_bf16 v[72:75], a[196:199], a[144:147], v[72:75]
ds_read_b128 a[144:147], v16 offset:25296
s_add_u32 s16, s16, 4096
v_mfma_f32_16x16x32_bf16 v[80:83], a[196:199], a[148:151], v[80:83]
v_fma_f32 v230, -v212, s54, v218
v_fma_f32 v231, -v213, s54, v219
v_mfma_f32_16x16x32_bf16 v[80:83], a[204:207], a[152:155], v[80:83]
v_fmac_f32 v218, s54, v212
v_fmac_f32 v219, s54, v213
v_mfma_f32_16x16x32_bf16 v[80:83], a[212:215], a[156:159], v[80:83]
v_cvt_pk_bf16_f32 v199, v216, v217
s_waitcnt lgkmcnt(1)
v_mfma_f32_16x16x32_bf16 v[80:83], a[220:223], a[128:131], v[80:83]
v_cvt_pk_bf16_f32 v203, v214, v215
v_cvt_pk_bf16_f32 v207, v230, v231
v_mfma_f32_16x16x32_bf16 v[76:79], a[216:219], a[128:131], v[76:79]
v_cvt_pk_bf16_f32 v211, v218, v219
v_mfma_f32_16x16x32_bf16 v[76:79], a[208:211], a[156:159], v[76:79]
buffer_load_dwordx4 v[172:175], v4, s[4:7], 0 offen offset:1280
v_mfma_f32_16x16x32_bf16 v[76:79], a[200:203], a[152:155], v[76:79]
buffer_load_dwordx4 v[176:179], v4, s[4:7], 0 offen offset:2304
v_mfma_f32_16x16x32_bf16 v[76:79], a[192:195], a[148:151], v[76:79]
ds_read_b128 a[148:151], v16 offset:25792
v_mfma_f32_16x16x32_bf16 v[20:23], a[224:227], a[132:135], v[20:23]
ds_read_b128 a[152:155], v16 offset:25808
v_mfma_f32_16x16x32_bf16 v[20:23], a[232:235], a[136:139], v[20:23]
ds_read_b128 a[156:159], v16 offset:26304
s_waitcnt vmcnt(9) lgkmcnt(3)
v_mfma_f32_16x16x32_bf16 v[20:23], a[240:243], a[140:143], v[20:23]
buffer_load_dwordx4 a[192:195], v13, s[8:11], s16 offen offset:0 sc1
v_mfma_f32_16x16x32_bf16 v[20:23], a[248:251], a[144:147], v[20:23]
buffer_load_dwordx4 v[180:183], v4, s[4:7], 0 offen offset:3328
v_mfma_f32_16x16x32_bf16 v[24:27], a[252:255], a[144:147], v[24:27]
buffer_load_dwordx4 v[184:187], v5, s[4:7], 0 offen offset:256
v_mfma_f32_16x16x32_bf16 v[24:27], a[244:247], a[140:143], v[24:27]
ds_write_b128 v7, v[196:199] offset:16
v_mfma_f32_16x16x32_bf16 v[24:27], a[236:239], a[136:139], v[24:27]
buffer_load_dwordx4 a[196:199], v14, s[8:11], s16 offen offset:0 sc1
v_mfma_f32_16x16x32_bf16 v[24:27], a[228:231], a[132:135], v[24:27]
ds_write_b128 v7, v[200:203] offset:16528
v_mfma_f32_16x16x32_bf16 v[32:35], a[228:231], a[136:139], v[32:35]
ds_write_b128 v7, v[204:207] offset:33040
v_mfma_f32_16x16x32_bf16 v[32:35], a[236:239], a[140:143], v[32:35]
ds_read_b128 a[128:131], v16 offset:26320
v_mfma_f32_16x16x32_bf16 v[32:35], a[244:247], a[144:147], v[32:35]
s_waitcnt vmcnt(11) lgkmcnt(4)
v_mfma_f32_16x16x32_bf16 v[32:35], a[252:255], a[148:151], v[32:35]
ds_write_b128 v7, v[208:211] offset:49552
v_lshlrev_b32 v232, 16, v188
v_and_b32 v233, s50, v188
v_mfma_f32_16x16x32_bf16 v[28:31], a[248:251], a[148:151], v[28:31]
v_lshlrev_b32 v222, 16, v192
v_and_b32 v223, s50, v192
v_mfma_f32_16x16x32_bf16 v[28:31], a[240:243], a[144:147], v[28:31]
v_lshlrev_b32 v226, 16, v148
v_and_b32 v227, s50, v148
v_mfma_f32_16x16x32_bf16 v[28:31], a[232:235], a[140:143], v[28:31]
buffer_load_dwordx4 a[200:203], v13, s[8:11], s16 offen offset:1024 sc1
v_mfma_f32_16x16x32_bf16 v[28:31], a[224:227], a[136:139], v[28:31]
v_fmac_f32 v226, s56, v222
v_fmac_f32 v227, s56, v223
v_fmac_f32 v226, s55, v232
v_fmac_f32 v227, s55, v233
v_mfma_f32_16x16x32_bf16 v[36:39], a[224:227], a[140:143], v[36:39]
v_lshlrev_b32 v212, 16, v189
v_and_b32 v213, s50, v189
v_mfma_f32_16x16x32_bf16 v[36:39], a[232:235], a[144:147], v[36:39]
ds_read_b128 a[132:135], v16 offset:24800
v_lshlrev_b32 v216, 16, v193
v_mfma_f32_16x16x32_bf16 v[36:39], a[240:243], a[148:151], v[36:39]
v_and_b32 v217, s50, v193
v_lshlrev_b32 v214, 16, v149
v_mfma_f32_16x16x32_bf16 v[36:39], a[248:251], a[152:155], v[36:39]
v_and_b32 v215, s50, v149
v_fmac_f32 v214, s56, v216
v_fmac_f32 v215, s56, v217
v_fmac_f32 v214, s55, v212
v_mfma_f32_16x16x32_bf16 v[40:43], a[252:255], a[152:155], v[40:43]
v_fmac_f32 v215, s55, v213
v_lshlrev_b32 v230, 16, v190
v_mfma_f32_16x16x32_bf16 v[40:43], a[244:247], a[148:151], v[40:43]
v_and_b32 v231, s50, v190
v_lshlrev_b32 v218, 16, v194
v_mfma_f32_16x16x32_bf16 v[40:43], a[236:239], a[144:147], v[40:43]
buffer_load_dwordx4 a[204:207], v14, s[8:11], s16 offen offset:1024 sc1
v_mfma_f32_16x16x32_bf16 v[40:43], a[228:231], a[140:143], v[40:43]
v_and_b32 v219, s50, v194
v_lshlrev_b32 v232, 16, v150
v_and_b32 v233, s50, v150
v_fmac_f32 v232, s56, v218
v_mfma_f32_16x16x32_bf16 v[48:51], a[228:231], a[144:147], v[48:51]
v_fmac_f32 v233, s56, v219
v_fmac_f32 v232, s55, v230
v_mfma_f32_16x16x32_bf16 v[48:51], a[236:239], a[148:151], v[48:51]
ds_read_b128 a[136:139], v16 offset:24816
v_fmac_f32 v233, s55, v231
v_mfma_f32_16x16x32_bf16 v[48:51], a[244:247], a[152:155], v[48:51]
v_lshlrev_b32 v222, 16, v191
v_and_b32 v223, s50, v191
v_mfma_f32_16x16x32_bf16 v[48:51], a[252:255], a[156:159], v[48:51]
v_lshlrev_b32 v212, 16, v195
v_and_b32 v213, s50, v195
v_mfma_f32_16x16x32_bf16 v[44:47], a[248:251], a[156:159], v[44:47]
v_lshlrev_b32 v216, 16, v151
v_and_b32 v217, s50, v151
v_mfma_f32_16x16x32_bf16 v[44:47], a[240:243], a[152:155], v[44:47]
v_fmac_f32 v216, s56, v212
v_fmac_f32 v217, s56, v213
v_mfma_f32_16x16x32_bf16 v[44:47], a[232:235], a[148:151], v[44:47]
buffer_load_dwordx4 a[208:211], v13, s[8:11], s16 offen offset:2048 sc1
v_mfma_f32_16x16x32_bf16 v[44:47], a[224:227], a[144:147], v[44:47]
v_fmac_f32 v216, s55, v222
v_fmac_f32 v217, s55, v223
v_mfma_f32_16x16x32_bf16 v[52:55], a[224:227], a[148:151], v[52:55]
buffer_load_dwordx4 v[188:191], v5, s[4:7], 0 offen offset:1280
v_mfma_f32_16x16x32_bf16 v[52:55], a[232:235], a[152:155], v[52:55]
ds_read_b128 a[140:143], v16 offset:25312
v_lshlrev_b32 v230, 16, v152
v_mfma_f32_16x16x32_bf16 v[52:55], a[240:243], a[156:159], v[52:55]
v_and_b32 v231, s50, v152
s_waitcnt vmcnt(12) lgkmcnt(1)
v_mfma_f32_16x16x32_bf16 v[52:55], a[248:251], a[128:131], v[52:55]
buffer_load_dwordx4 v[192:195], v5, s[4:7], 0 offen offset:2304
v_lshlrev_b32 v218, 16, v156
v_and_b32 v219, s50, v156
v_mfma_f32_16x16x32_bf16 v[56:59], a[252:255], a[128:131], v[56:59]
buffer_load_dwordx4 v[148:151], v5, s[4:7], 0 offen offset:3328
v_mfma_f32_16x16x32_bf16 v[56:59], a[244:247], a[156:159], v[56:59]
v_fma_f32 v230, v230, s58, v226
v_fma_f32 v231, v231, s58, v227
v_mfma_f32_16x16x32_bf16 v[56:59], a[236:239], a[152:155], v[56:59]
ds_read_b128 a[144:147], v16 offset:33024
v_fmac_f32 v230, s57, v218
v_mfma_f32_16x16x32_bf16 v[56:59], a[228:231], a[148:151], v[56:59]
ds_read_b128 a[148:151], v16 offset:33040
v_fmac_f32 v231, s57, v219
v_fmac_f32 v218, s58, v226
v_fmac_f32 v219, s58, v227
v_mfma_f32_16x16x32_bf16 v[64:67], a[228:231], a[152:155], v[64:67]
buffer_load_dwordx4 a[212:215], v14, s[8:11], s16 offen offset:2048 sc1
v_mfma_f32_16x16x32_bf16 v[64:67], a[236:239], a[156:159], v[64:67]
v_cvt_pk_bf16_f32 v236, v226, v227
v_lshlrev_b32 v222, 16, v160
v_mfma_f32_16x16x32_bf16 v[64:67], a[244:247], a[128:131], v[64:67]
v_and_b32 v223, s50, v160
v_lshlrev_b32 v212, 16, v164
v_mfma_f32_16x16x32_bf16 v[64:67], a[252:255], a[132:135], v[64:67]
v_and_b32 v213, s50, v164
v_fmac_f32 v230, s59, v222
v_fmac_f32 v231, s59, v223
v_fmac_f32 v218, s56, v222
v_mfma_f32_16x16x32_bf16 v[60:63], a[248:251], a[132:135], v[60:63]
v_fmac_f32 v219, s56, v223
v_fmac_f32 v218, s55, v212
v_mfma_f32_16x16x32_bf16 v[60:63], a[240:243], a[128:131], v[60:63]
v_fmac_f32 v219, s55, v213
v_cvt_pk_bf16_f32 v240, v218, v219
v_mfma_f32_16x16x32_bf16 v[60:63], a[232:235], a[156:159], v[60:63]
buffer_load_dwordx4 a[216:219], v13, s[8:11], s16 offen offset:3072 sc1
v_mfma_f32_16x16x32_bf16 v[60:63], a[224:227], a[152:155], v[60:63]
ds_read_b128 a[152:155], v16 offset:33536
v_cvt_pk_bf16_f32 v244, v230, v231
v_lshlrev_b32 v226, 16, v153
v_and_b32 v227, s50, v153
v_mfma_f32_16x16x32_bf16 v[68:71], a[224:227], a[156:159], v[68:71]
v_lshlrev_b32 v212, 16, v157
v_and_b32 v213, s50, v157
v_mfma_f32_16x16x32_bf16 v[68:71], a[232:235], a[128:131], v[68:71]
v_fma_f32 v226, v226, s58, v214
v_fma_f32 v227, v227, s58, v215
v_mfma_f32_16x16x32_bf16 v[68:71], a[240:243], a[132:135], v[68:71]
v_fmac_f32 v226, s57, v212
v_fmac_f32 v227, s57, v213
v_mfma_f32_16x16x32_bf16 v[68:71], a[248:251], a[136:139], v[68:71]
v_fmac_f32 v212, s58, v214
v_fmac_f32 v213, s58, v215
v_mfma_f32_16x16x32_bf16 v[72:75], a[252:255], a[136:139], v[72:75]
v_cvt_pk_bf16_f32 v237, v214, v215
v_lshlrev_b32 v222, 16, v161
v_mfma_f32_16x16x32_bf16 v[72:75], a[244:247], a[132:135], v[72:75]
v_and_b32 v223, s50, v161
v_lshlrev_b32 v218, 16, v165
v_mfma_f32_16x16x32_bf16 v[72:75], a[236:239], a[128:131], v[72:75]
buffer_load_dwordx4 a[220:223], v14, s[8:11], s16 offen offset:3072 sc1
v_mfma_f32_16x16x32_bf16 v[72:75], a[228:231], a[156:159], v[72:75]
ds_read_b128 a[156:159], v16 offset:33552
s_add_u32 s16, s16, 4096
v_mfma_f32_16x16x32_bf16 v[80:83], a[228:231], a[128:131], v[80:83]
v_and_b32 v219, s50, v165
v_fmac_f32 v226, s59, v222
v_mfma_f32_16x16x32_bf16 v[80:83], a[236:239], a[132:135], v[80:83]
v_fmac_f32 v227, s59, v223
v_fmac_f32 v212, s56, v222
v_mfma_f32_16x16x32_bf16 v[80:83], a[244:247], a[136:139], v[80:83]
v_fmac_f32 v213, s56, v223
s_waitcnt vmcnt(15) lgkmcnt(1)
v_mfma_f32_16x16x32_bf16 v[80:83], a[252:255], a[140:143], v[80:83]
v_fmac_f32 v212, s55, v218
v_fmac_f32 v213, s55, v219
v_mfma_f32_16x16x32_bf16 v[76:79], a[248:251], a[140:143], v[76:79]
v_cvt_pk_bf16_f32 v241, v212, v213
v_cvt_pk_bf16_f32 v245, v226, v227
v_mfma_f32_16x16x32_bf16 v[76:79], a[240:243], a[136:139], v[76:79]
v_lshlrev_b32 v230, 16, v154
v_and_b32 v231, s50, v154
v_mfma_f32_16x16x32_bf16 v[76:79], a[232:235], a[132:135], v[76:79]
v_lshlrev_b32 v214, 16, v158
v_and_b32 v215, s50, v158
v_mfma_f32_16x16x32_bf16 v[76:79], a[224:227], a[128:131], v[76:79]
ds_read_b128 a[128:131], v16 offset:34048
v_fma_f32 v230, v230, s58, v232
v_mfma_f32_16x16x32_bf16 a[64:67], a[160:163], a[144:147], a[64:67]
ds_read_b128 a[132:135], v16 offset:34064
v_fma_f32 v231, v231, s58, v233
v_mfma_f32_16x16x32_bf16 a[64:67], a[168:171], a[148:151], a[64:67]
ds_read_b128 a[136:139], v16 offset:34560
v_fmac_f32 v230, s57, v214
v_mfma_f32_16x16x32_bf16 a[64:67], a[176:179], a[152:155], a[64:67]
v_fmac_f32 v231, s57, v215
s_waitcnt lgkmcnt(3)
v_mfma_f32_16x16x32_bf16 a[64:67], a[184:187], a[156:159], a[64:67]
buffer_load_dwordx4 a[224:227], v13, s[8:11], s16 offen offset:0 sc1
v_fmac_f32 v214, s58, v232
v_fmac_f32 v215, s58, v233
v_mfma_f32_16x16x32_bf16 a[68:71], a[188:191], a[156:159], a[68:71]
v_cvt_pk_bf16_f32 v238, v232, v233
v_lshlrev_b32 v218, 16, v162
v_mfma_f32_16x16x32_bf16 a[68:71], a[180:183], a[152:155], a[68:71]
v_and_b32 v219, s50, v162
v_lshlrev_b32 v222, 16, v166
v_mfma_f32_16x16x32_bf16 a[68:71], a[172:175], a[148:151], a[68:71]
buffer_load_dwordx4 a[228:231], v14, s[8:11], s16 offen offset:0 sc1
v_mfma_f32_16x16x32_bf16 a[68:71], a[164:167], a[144:147], a[68:71]
v_and_b32 v223, s50, v166
v_fmac_f32 v230, s59, v218
v_mfma_f32_16x16x32_bf16 a[76:79], a[164:167], a[148:151], a[76:79]
v_fmac_f32 v231, s59, v219
v_fmac_f32 v214, s56, v218
v_mfma_f32_16x16x32_bf16 a[76:79], a[172:175], a[152:155], a[76:79]
ds_read_b128 a[140:143], v16 offset:34576
v_fmac_f32 v215, s56, v219
v_mfma_f32_16x16x32_bf16 a[76:79], a[180:183], a[156:159], a[76:79]
v_fmac_f32 v214, s55, v222
s_waitcnt lgkmcnt(1)
v_mfma_f32_16x16x32_bf16 a[76:79], a[188:191], a[128:131], a[76:79]
v_fmac_f32 v215, s55, v223
v_cvt_pk_bf16_f32 v242, v214, v215
v_mfma_f32_16x16x32_bf16 a[72:75], a[184:187], a[128:131], a[72:75]
v_cvt_pk_bf16_f32 v246, v230, v231
v_lshlrev_b32 v212, 16, v155
v_mfma_f32_16x16x32_bf16 a[72:75], a[176:179], a[156:159], a[72:75]
v_and_b32 v213, s50, v155
v_lshlrev_b32 v226, 16, v159
v_mfma_f32_16x16x32_bf16 a[72:75], a[168:171], a[152:155], a[72:75]
buffer_load_dwordx4 a[232:235], v13, s[8:11], s16 offen offset:1024 sc1
v_mfma_f32_16x16x32_bf16 a[72:75], a[160:163], a[148:151], a[72:75]
v_and_b32 v227, s50, v159
v_fma_f32 v212, v212, s58, v216
v_fma_f32 v213, v213, s58, v217
v_mfma_f32_16x16x32_bf16 a[80:83], a[160:163], a[152:155], a[80:83]
v_fmac_f32 v212, s57, v226
v_fmac_f32 v213, s57, v227
v_mfma_f32_16x16x32_bf16 a[80:83], a[168:171], a[156:159], a[80:83]
ds_read_b128 a[144:147], v16 offset:33056
v_fmac_f32 v226, s58, v216
v_mfma_f32_16x16x32_bf16 a[80:83], a[176:179], a[128:131], a[80:83]
v_fmac_f32 v227, s58, v217
v_cvt_pk_bf16_f32 v239, v216, v217
v_mfma_f32_16x16x32_bf16 a[80:83], a[184:187], a[132:135], a[80:83]
v_lshlrev_b32 v232, 16, v163
v_and_b32 v233, s50, v163
v_mfma_f32_16x16x32_bf16 a[84:87], a[188:191], a[132:135], a[84:87]
v_lshlrev_b32 v222, 16, v167
v_and_b32 v223, s50, v167
v_mfma_f32_16x16x32_bf16 a[84:87], a[180:183], a[128:131], a[84:87]
v_fmac_f32 v212, s59, v232
v_fmac_f32 v213, s59, v233
v_mfma_f32_16x16x32_bf16 a[84:87], a[172:175], a[156:159], a[84:87]
buffer_load_dwordx4 a[236:239], v14, s[8:11], s16 offen offset:1024 sc1
v_mfma_f32_16x16x32_bf16 a[84:87], a[164:167], a[152:155], a[84:87]
v_fmac_f32 v226, s56, v232
v_fmac_f32 v227, s56, v233
v_mfma_f32_16x16x32_bf16 a[92:95], a[164:167], a[156:159], a[92:95]
v_fmac_f32 v226, s55, v222
v_fmac_f32 v227, s55, v223
v_mfma_f32_16x16x32_bf16 a[92:95], a[172:175], a[128:131], a[92:95]
ds_read_b128 a[148:151], v16 offset:33072
v_cvt_pk_bf16_f32 v243, v226, v227
v_mfma_f32_16x16x32_bf16 a[92:95], a[180:183], a[132:135], a[92:95]
v_cvt_pk_bf16_f32 v247, v212, v213
s_add_u32 s36, s3, 32768
v_mfma_f32_16x16x32_bf16 a[92:95], a[188:191], a[136:139], a[92:95]
buffer_store_dwordx4 v[236:239], v12, s[8:11], s36 offen sc1
v_lshlrev_b32 v218, 16, v168
v_mfma_f32_16x16x32_bf16 a[88:91], a[184:187], a[136:139], a[88:91]
s_add_u32 s36, s3, 98304
v_and_b32 v219, s50, v168
v_mfma_f32_16x16x32_bf16 a[88:91], a[176:179], a[132:135], a[88:91]
s_waitcnt vmcnt(19) lgkmcnt(1)
v_lshlrev_b32 v214, 16, v172
v_mfma_f32_16x16x32_bf16 a[88:91], a[168:171], a[128:131], a[88:91]
buffer_load_dwordx4 a[240:243], v13, s[8:11], s16 offen offset:2048 sc1
v_mfma_f32_16x16x32_bf16 a[88:91], a[160:163], a[156:159], a[88:91]
v_and_b32 v215, s50, v172
v_mfma_f32_16x16x32_bf16 a[96:99], a[160:163], a[128:131], a[96:99]
s_waitcnt vmcnt(18)
v_lshlrev_b32 v230, 16, v176
v_mfma_f32_16x16x32_bf16 a[96:99], a[168:171], a[132:135], a[96:99]
ds_read_b128 a[152:155], v16 offset:33568
v_and_b32 v231, s50, v176
v_mfma_f32_16x16x32_bf16 a[96:99], a[176:179], a[136:139], a[96:99]
s_waitcnt vmcnt(17) lgkmcnt(1)
v_lshlrev_b32 v216, 16, v180
v_mfma_f32_16x16x32_bf16 a[96:99], a[184:187], a[140:143], a[96:99]
v_and_b32 v217, s50, v180
v_fma_f32 v222, v230, s51, v216
v_fma_f32 v223, v231, s51, v217
v_fmac_f32 v230, s51, v214
v_mfma_f32_16x16x32_bf16 a[100:103], a[188:191], a[140:143], a[100:103]
v_fmac_f32 v231, s51, v215
v_fmac_f32 v214, s51, v218
v_mfma_f32_16x16x32_bf16 a[100:103], a[180:183], a[136:139], a[100:103]
v_fmac_f32 v215, s51, v219
v_fmac_f32 v218, s51, v228
v_mfma_f32_16x16x32_bf16 a[100:103], a[172:175], a[132:135], a[100:103]
ds_read_b128 a[156:159], v16 offset:41280
v_fmac_f32 v219, s51, v229
v_mfma_f32_16x16x32_bf16 a[100:103], a[164:167], a[128:131], a[100:103]
ds_read_b128 a[128:131], v16 offset:41296
v_fma_f32 v228, v218, s60, v230
v_fma_f32 v229, v219, s60, v231
v_fma_f32 v232, v214, s60, v222
v_mfma_f32_16x16x32_bf16 a[108:111], a[164:167], a[132:135], a[108:111]
buffer_load_dwordx4 a[244:247], v14, s[8:11], s16 offen offset:2048 sc1
v_mfma_f32_16x16x32_bf16 a[108:111], a[172:175], a[136:139], a[108:111]
v_fma_f32 v233, v215, s60, v223
v_fmac_f32 v230, s52, v218
v_mfma_f32_16x16x32_bf16 a[108:111], a[180:183], a[140:143], a[108:111]
v_fmac_f32 v231, s52, v219
v_fmac_f32 v222, s52, v214
v_mfma_f32_16x16x32_bf16 a[108:111], a[188:191], a[144:147], a[108:111]
v_fmac_f32 v223, s52, v215
v_fma_f32 v218, -v228, s53, v232
v_fma_f32 v219, -v229, s53, v233
v_mfma_f32_16x16x32_bf16 a[104:107], a[184:187], a[144:147], a[104:107]
v_fmac_f32 v232, s53, v228
v_fmac_f32 v233, s53, v229
v_mfma_f32_16x16x32_bf16 a[104:107], a[176:179], a[140:143], a[104:107]
v_fma_f32 v214, -v230, s54, v222
v_fma_f32 v215, -v231, s54, v223
v_mfma_f32_16x16x32_bf16 a[104:107], a[168:171], a[136:139], a[104:107]
buffer_load_dwordx4 a[248:251], v13, s[8:11], s16 offen offset:3072 sc1
v_mfma_f32_16x16x32_bf16 a[104:107], a[160:163], a[132:135], a[104:107]
ds_read_b128 a[132:135], v16 offset:41792
v_fmac_f32 v222, s54, v230
v_fmac_f32 v223, s54, v231
v_mfma_f32_16x16x32_bf16 a[112:115], a[160:163], a[136:139], a[112:115]
v_cvt_pk_bf16_f32 v196, v218, v219
v_cvt_pk_bf16_f32 v200, v232, v233
v_mfma_f32_16x16x32_bf16 a[112:115], a[168:171], a[140:143], a[112:115]
v_cvt_pk_bf16_f32 v204, v214, v215
v_cvt_pk_bf16_f32 v208, v222, v223
v_mfma_f32_16x16x32_bf16 a[112:115], a[176:179], a[144:147], a[112:115]
v_lshlrev_b32 v226, 16, v169
v_and_b32 v227, s50, v169
v_mfma_f32_16x16x32_bf16 a[112:115], a[184:187], a[148:151], a[112:115]
v_lshlrev_b32 v212, 16, v173
v_and_b32 v213, s50, v173
v_mfma_f32_16x16x32_bf16 a[116:119], a[188:191], a[148:151], a[116:119]
v_lshlrev_b32 v228, 16, v177
v_and_b32 v229, s50, v177
v_mfma_f32_16x16x32_bf16 a[116:119], a[180:183], a[144:147], a[116:119]
v_lshlrev_b32 v230, 16, v181
v_and_b32 v231, s50, v181
v_mfma_f32_16x16x32_bf16 a[116:119], a[172:175], a[140:143], a[116:119]
buffer_load_dwordx4 a[252:255], v14, s[8:11], s16 offen offset:3072 sc1
v_mfma_f32_16x16x32_bf16 a[116:119], a[164:167], a[136:139], a[116:119]
ds_read_b128 a[136:139], v16 offset:41808
s_add_u32 s16, s16, 4096
v_fma_f32 v218, v228, s51, v230
v_mfma_f32_16x16x32_bf16 a[124:127], a[164:167], a[140:143], a[124:127]
v_fma_f32 v219, v229, s51, v231
v_fmac_f32 v228, s51, v212
v_mfma_f32_16x16x32_bf16 a[124:127], a[172:175], a[144:147], a[124:127]
buffer_load_dwordx4 v[152:155], v1, s[4:7], 0 offen offset:1408
v_mfma_f32_16x16x32_bf16 a[124:127], a[180:183], a[148:151], a[124:127]
v_fmac_f32 v229, s51, v213
s_waitcnt vmcnt(16) lgkmcnt(1)
v_mfma_f32_16x16x32_bf16 a[124:127], a[188:191], a[152:155], a[124:127]
buffer_load_dwordx4 v[156:159], v2, s[4:7], 0 offen offset:384
v_fmac_f32 v212, s51, v226
v_fmac_f32 v213, s51, v227
v_mfma_f32_16x16x32_bf16 a[120:123], a[184:187], a[152:155], a[120:123]
buffer_load_dwordx4 v[160:163], v2, s[4:7], 0 offen offset:1408
v_mfma_f32_16x16x32_bf16 a[120:123], a[176:179], a[148:151], a[120:123]
buffer_load_dwordx4 v[164:167], v2, s[4:7], 0 offen offset:2432
v_mfma_f32_16x16x32_bf16 a[120:123], a[168:171], a[144:147], a[120:123]
v_fmac_f32 v226, s51, v224
v_fmac_f32 v227, s51, v225
v_mfma_f32_16x16x32_bf16 a[120:123], a[160:163], a[140:143], a[120:123]
ds_read_b128 a[140:143], v16 offset:42304
v_fma_f32 v224, v226, s60, v228
v_fma_f32 v225, v227, s60, v229
v_fma_f32 v232, v212, s60, v218
v_mfma_f32_16x16x32_bf16 a[64:67], a[192:195], a[156:159], a[64:67]
ds_read_b128 a[144:147], v16 offset:42320
v_fma_f32 v233, v213, s60, v219
v_mfma_f32_16x16x32_bf16 a[64:67], a[200:203], a[128:131], a[64:67]
ds_read_b128 a[148:151], v16 offset:42816
v_fmac_f32 v228, s52, v226
v_mfma_f32_16x16x32_bf16 a[64:67], a[208:211], a[132:135], a[64:67]
v_fmac_f32 v229, s52, v227
s_waitcnt vmcnt(11) lgkmcnt(3)
v_mfma_f32_16x16x32_bf16 a[64:67], a[216:219], a[136:139], a[64:67]
buffer_load_dwordx4 a[160:163], v13, s[8:11], s16 offen offset:0 sc1
v_fmac_f32 v218, s52, v212
v_fmac_f32 v219, s52, v213
v_mfma_f32_16x16x32_bf16 a[68:71], a[220:223], a[136:139], a[68:71]
v_fma_f32 v226, -v224, s53, v232
v_fma_f32 v227, -v225, s53, v233
v_mfma_f32_16x16x32_bf16 a[68:71], a[212:215], a[132:135], a[68:71]
v_fmac_f32 v232, s53, v224
v_fmac_f32 v233, s53, v225
v_mfma_f32_16x16x32_bf16 a[68:71], a[204:207], a[128:131], a[68:71]
buffer_load_dwordx4 a[164:167], v14, s[8:11], s16 offen offset:0 sc1
v_mfma_f32_16x16x32_bf16 a[68:71], a[196:199], a[156:159], a[68:71]
v_fma_f32 v212, -v228, s54, v218
v_fma_f32 v213, -v229, s54, v219
v_fmac_f32 v218, s54, v228
v_fmac_f32 v219, s54, v229
v_mfma_f32_16x16x32_bf16 a[76:79], a[196:199], a[128:131], a[76:79]
v_cvt_pk_bf16_f32 v197, v226, v227
v_cvt_pk_bf16_f32 v201, v232, v233
v_mfma_f32_16x16x32_bf16 a[76:79], a[204:207], a[132:135], a[76:79]
ds_read_b128 a[152:155], v16 offset:42832
v_cvt_pk_bf16_f32 v205, v212, v213
v_mfma_f32_16x16x32_bf16 a[76:79], a[212:215], a[136:139], a[76:79]
v_cvt_pk_bf16_f32 v209, v218, v219
s_waitcnt vmcnt(12) lgkmcnt(1)
v_mfma_f32_16x16x32_bf16 a[76:79], a[220:223], a[140:143], a[76:79]
v_lshlrev_b32 v214, 16, v170
v_and_b32 v215, s50, v170
v_lshlrev_b32 v222, 16, v174
v_and_b32 v223, s50, v174
v_mfma_f32_16x16x32_bf16 a[72:75], a[216:219], a[140:143], a[72:75]
v_lshlrev_b32 v224, 16, v178
v_and_b32 v225, s50, v178
v_mfma_f32_16x16x32_bf16 a[72:75], a[208:211], a[136:139], a[72:75]
v_lshlrev_b32 v228, 16, v182
v_and_b32 v229, s50, v182
v_mfma_f32_16x16x32_bf16 a[72:75], a[200:203], a[132:135], a[72:75]
buffer_load_dwordx4 a[168:171], v13, s[8:11], s16 offen offset:1024 sc1
v_mfma_f32_16x16x32_bf16 a[72:75], a[192:195], a[128:131], a[72:75]
v_fma_f32 v226, v224, s51, v228
v_fma_f32 v227, v225, s51, v229
v_mfma_f32_16x16x32_bf16 a[80:83], a[192:195], a[132:135], a[80:83]
v_fmac_f32 v224, s51, v222
v_fmac_f32 v225, s51, v223
v_mfma_f32_16x16x32_bf16 a[80:83], a[200:203], a[136:139], a[80:83]
ds_read_b128 a[156:159], v16 offset:41312
v_fmac_f32 v222, s51, v214
v_mfma_f32_16x16x32_bf16 a[80:83], a[208:211], a[140:143], a[80:83]
v_fmac_f32 v223, s51, v215
v_fmac_f32 v214, s51, v234
v_mfma_f32_16x16x32_bf16 a[80:83], a[216:219], a[144:147], a[80:83]
v_fmac_f32 v215, s51, v235
v_fma_f32 v234, v214, s60, v224
v_mfma_f32_16x16x32_bf16 a[84:87], a[220:223], a[144:147], a[84:87]
v_fma_f32 v235, v215, s60, v225
v_fma_f32 v232, v222, s60, v226
v_mfma_f32_16x16x32_bf16 a[84:87], a[212:215], a[140:143], a[84:87]
v_fma_f32 v233, v223, s60, v227
v_fmac_f32 v224, s52, v214
v_mfma_f32_16x16x32_bf16 a[84:87], a[204:207], a[136:139], a[84:87]
buffer_load_dwordx4 a[172:175], v14, s[8:11], s16 offen offset:1024 sc1
v_mfma_f32_16x16x32_bf16 a[84:87], a[196:199], a[132:135], a[84:87]
v_fmac_f32 v225, s52, v215
v_fmac_f32 v226, s52, v222
v_mfma_f32_16x16x32_bf16 a[92:95], a[196:199], a[136:139], a[92:95]
v_fmac_f32 v227, s52, v223
v_fma_f32 v214, -v234, s53, v232
v_mfma_f32_16x16x32_bf16 a[92:95], a[204:207], a[140:143], a[92:95]
ds_read_b128 a[128:131], v16 offset:41328
v_fma_f32 v215, -v235, s53, v233
v_mfma_f32_16x16x32_bf16 a[92:95], a[212:215], a[144:147], a[92:95]
v_fmac_f32 v232, s53, v234
v_fmac_f32 v233, s53, v235
v_mfma_f32_16x16x32_bf16 a[92:95], a[220:223], a[148:151], a[92:95]
v_fma_f32 v222, -v224, s54, v226
v_fma_f32 v223, -v225, s54, v227
v_mfma_f32_16x16x32_bf16 a[88:91], a[216:219], a[148:151], a[88:91]
v_fmac_f32 v226, s54, v224
v_fmac_f32 v227, s54, v225
v_mfma_f32_16x16x32_bf16 a[88:91], a[208:211], a[144:147], a[88:91]
v_cvt_pk_bf16_f32 v198, v214, v215
v_cvt_pk_bf16_f32 v202, v232, v233
v_mfma_f32_16x16x32_bf16 a[88:91], a[200:203], a[140:143], a[88:91]
buffer_load_dwordx4 a[176:179], v13, s[8:11], s16 offen offset:2048 sc1
v_mfma_f32_16x16x32_bf16 a[88:91], a[192:195], a[136:139], a[88:91]
v_cvt_pk_bf16_f32 v206, v222, v223
v_cvt_pk_bf16_f32 v210, v226, v227
v_mfma_f32_16x16x32_bf16 a[96:99], a[192:195], a[140:143], a[96:99]
v_lshlrev_b32 v212, 16, v171
v_and_b32 v213, s50, v171
v_mfma_f32_16x16x32_bf16 a[96:99], a[200:203], a[144:147], a[96:99]
ds_read_b128 a[132:135], v16 offset:41824
v_lshlrev_b32 v218, 16, v175
v_mfma_f32_16x16x32_bf16 a[96:99], a[208:211], a[148:151], a[96:99]
v_and_b32 v219, s50, v175
s_waitcnt vmcnt(14) lgkmcnt(1)
v_mfma_f32_16x16x32_bf16 a[96:99], a[216:219], a[152:155], a[96:99]
v_lshlrev_b32 v234, 16, v179
v_and_b32 v235, s50, v179
v_mfma_f32_16x16x32_bf16 a[100:103], a[220:223], a[152:155], a[100:103]
v_lshlrev_b32 v224, 16, v183
v_and_b32 v225, s50, v183
v_mfma_f32_16x16x32_bf16 a[100:103], a[212:215], a[148:151], a[100:103]
v_fma_f32 v214, v234, s51, v224
v_fma_f32 v215, v235, s51, v225
v_mfma_f32_16x16x32_bf16 a[100:103], a[204:207], a[144:147], a[100:103]
ds_read_b128 a[136:139], v16 offset:49536
v_fmac_f32 v234, s51, v218
v_mfma_f32_16x16x32_bf16 a[100:103], a[196:199], a[140:143], a[100:103]
ds_read_b128 a[140:143], v16 offset:49552
v_fmac_f32 v235, s51, v219
v_mfma_f32_16x16x32_bf16 a[108:111], a[196:199], a[144:147], a[108:111]
buffer_load_dwordx4 a[180:183], v14, s[8:11], s16 offen offset:2048 sc1
v_mfma_f32_16x16x32_bf16 a[108:111], a[204:207], a[148:151], a[108:111]
v_fmac_f32 v218, s51, v212
v_fmac_f32 v219, s51, v213
v_mfma_f32_16x16x32_bf16 a[108:111], a[212:215], a[152:155], a[108:111]
buffer_store_dwordx4 v[240:243], v12, s[8:11], s36 offen sc1
v_mfma_f32_16x16x32_bf16 a[108:111], a[220:223], a[156:159], a[108:111]
s_add_u32 s36, s3, 163840
v_fmac_f32 v212, s51, v220
v_fmac_f32 v213, s51, v221
v_fma_f32 v220, v212, s60, v234
v_mfma_f32_16x16x32_bf16 a[104:107], a[216:219], a[156:159], a[104:107]
v_fma_f32 v221, v213, s60, v235
v_fma_f32 v232, v218, s60, v214
v_mfma_f32_16x16x32_bf16 a[104:107], a[208:211], a[152:155], a[104:107]
v_fma_f32 v233, v219, s60, v215
v_fmac_f32 v234, s52, v212
v_mfma_f32_16x16x32_bf16 a[104:107], a[200:203], a[148:151], a[104:107]
buffer_load_dwordx4 a[184:187], v13, s[8:11], s16 offen offset:3072 sc1
v_mfma_f32_16x16x32_bf16 a[104:107], a[192:195], a[144:147], a[104:107]
ds_read_b128 a[144:147], v16 offset:50048
v_fmac_f32 v235, s52, v213
v_fmac_f32 v214, s52, v218
v_fmac_f32 v215, s52, v219
v_mfma_f32_16x16x32_bf16 a[112:115], a[192:195], a[148:151], a[112:115]
v_fma_f32 v212, -v220, s53, v232
v_fma_f32 v213, -v221, s53, v233
v_mfma_f32_16x16x32_bf16 a[112:115], a[200:203], a[152:155], a[112:115]
v_fmac_f32 v232, s53, v220
v_fmac_f32 v233, s53, v221
v_mfma_f32_16x16x32_bf16 a[112:115], a[208:211], a[156:159], a[112:115]
v_fma_f32 v218, -v234, s54, v214
v_fma_f32 v219, -v235, s54, v215
v_mfma_f32_16x16x32_bf16 a[112:115], a[216:219], a[128:131], a[112:115]
v_fmac_f32 v214, s54, v234
v_fmac_f32 v215, s54, v235
v_mfma_f32_16x16x32_bf16 a[116:119], a[220:223], a[128:131], a[116:119]
v_cvt_pk_bf16_f32 v199, v212, v213
v_cvt_pk_bf16_f32 v203, v232, v233
v_mfma_f32_16x16x32_bf16 a[116:119], a[212:215], a[156:159], a[116:119]
v_cvt_pk_bf16_f32 v207, v218, v219
v_cvt_pk_bf16_f32 v211, v214, v215
v_mfma_f32_16x16x32_bf16 a[116:119], a[204:207], a[152:155], a[116:119]
buffer_load_dwordx4 a[188:191], v14, s[8:11], s16 offen offset:3072 sc1
v_mfma_f32_16x16x32_bf16 a[116:119], a[196:199], a[148:151], a[116:119]
ds_read_b128 a[148:151], v16 offset:50064
s_add_u32 s16, s16, 1052672
v_mfma_f32_16x16x32_bf16 a[124:127], a[196:199], a[152:155], a[124:127]
ds_write_b128 v7, v[196:199] offset:512
v_mfma_f32_16x16x32_bf16 a[124:127], a[204:207], a[156:159], a[124:127]
ds_write_b128 v7, v[200:203] offset:17024
v_mfma_f32_16x16x32_bf16 a[124:127], a[212:215], a[128:131], a[124:127]
s_waitcnt lgkmcnt(3)
v_mfma_f32_16x16x32_bf16 a[124:127], a[220:223], a[132:135], a[124:127]
ds_write_b128 v7, v[204:207] offset:33536
v_mfma_f32_16x16x32_bf16 a[120:123], a[216:219], a[132:135], a[120:123]
ds_write_b128 v7, v[208:211] offset:50048
v_mfma_f32_16x16x32_bf16 a[120:123], a[208:211], a[128:131], a[120:123]
v_lshlrev_b32 v222, 16, v184
v_and_b32 v223, s50, v184
v_mfma_f32_16x16x32_bf16 a[120:123], a[200:203], a[156:159], a[120:123]
v_lshlrev_b32 v226, 16, v188
v_and_b32 v227, s50, v188
v_mfma_f32_16x16x32_bf16 a[120:123], a[192:195], a[152:155], a[120:123]
ds_read_b128 a[152:155], v16 offset:50560
v_lshlrev_b32 v220, 16, v192
v_mfma_f32_16x16x32_bf16 v[84:87], a[224:227], a[136:139], v[84:87]
ds_read_b128 a[156:159], v16 offset:50576
v_and_b32 v221, s50, v192
v_mfma_f32_16x16x32_bf16 v[84:87], a[232:235], a[140:143], v[84:87]
ds_read_b128 a[128:131], v16 offset:51072
s_waitcnt vmcnt(13) lgkmcnt(6)
v_mfma_f32_16x16x32_bf16 v[84:87], a[240:243], a[144:147], v[84:87]
buffer_load_dwordx4 a[192:195], v13, s[8:11], s16 offen offset:0 sc1
v_mfma_f32_16x16x32_bf16 v[84:87], a[248:251], a[148:151], v[84:87]
v_lshlrev_b32 v234, 16, v148
v_and_b32 v235, s50, v148
v_fma_f32 v212, v220, s51, v234
v_fma_f32 v213, v221, s51, v235
v_mfma_f32_16x16x32_bf16 v[88:91], a[252:255], a[148:151], v[88:91]
s_getpc_b64 s[46:47]
v_fmac_f32 v220, s51, v226
v_mfma_f32_16x16x32_bf16 v[88:91], a[244:247], a[144:147], v[88:91]
global_load_dword v252, v255, s[46:47] offset:2048
v_mfma_f32_16x16x32_bf16 v[88:91], a[236:239], a[140:143], v[88:91]
buffer_load_dwordx4 a[196:199], v14, s[8:11], s16 offen offset:0 sc1
v_mfma_f32_16x16x32_bf16 v[88:91], a[228:231], a[136:139], v[88:91]
v_fmac_f32 v221, s51, v227
v_fmac_f32 v226, s51, v222
v_fmac_f32 v227, s51, v223
v_fmac_f32 v222, s51, v216
v_mfma_f32_16x16x32_bf16 v[96:99], a[228:231], a[140:143], v[96:99]
buffer_load_dwordx4 v[168:171], v2, s[4:7], 0 offen offset:3456
v_mfma_f32_16x16x32_bf16 v[96:99], a[236:239], a[144:147], v[96:99]
ds_read_b128 a[132:135], v16 offset:51088
v_fmac_f32 v223, s51, v217
v_mfma_f32_16x16x32_bf16 v[96:99], a[244:247], a[148:151], v[96:99]
v_fma_f32 v216, v222, s60, v220
s_waitcnt lgkmcnt(1)
v_mfma_f32_16x16x32_bf16 v[96:99], a[252:255], a[152:155], v[96:99]
buffer_load_dwordx4 v[172:175], v3, s[4:7], 0 offen offset:384
v_fma_f32 v217, v223, s60, v221
v_fma_f32 v232, v226, s60, v212
v_mfma_f32_16x16x32_bf16 v[92:95], a[248:251], a[152:155], v[92:95]
buffer_load_dwordx4 v[176:179], v3, s[4:7], 0 offen offset:1408
v_mfma_f32_16x16x32_bf16 v[92:95], a[240:243], a[148:151], v[92:95]
buffer_load_dwordx4 v[180:183], v3, s[4:7], 0 offen offset:2432
v_mfma_f32_16x16x32_bf16 v[92:95], a[232:235], a[144:147], v[92:95]
buffer_load_dwordx4 a[200:203], v13, s[8:11], s16 offen offset:1024 sc1
v_mfma_f32_16x16x32_bf16 v[92:95], a[224:227], a[140:143], v[92:95]
v_fma_f32 v233, v227, s60, v213
v_fmac_f32 v220, s52, v222
v_fmac_f32 v221, s52, v223
v_fmac_f32 v212, s52, v226
v_mfma_f32_16x16x32_bf16 v[100:103], a[224:227], a[144:147], v[100:103]
v_fmac_f32 v213, s52, v227
v_fma_f32 v222, -v216, s53, v232
v_mfma_f32_16x16x32_bf16 v[100:103], a[232:235], a[148:151], v[100:103]
ds_read_b128 a[136:139], v16 offset:49568
v_fma_f32 v223, -v217, s53, v233
v_mfma_f32_16x16x32_bf16 v[100:103], a[240:243], a[152:155], v[100:103]
v_fmac_f32 v232, s53, v216
v_fmac_f32 v233, s53, v217
v_mfma_f32_16x16x32_bf16 v[100:103], a[248:251], a[156:159], v[100:103]
v_fma_f32 v226, -v220, s54, v212
v_fma_f32 v227, -v221, s54, v213
v_fmac_f32 v212, s54, v220
v_fmac_f32 v213, s54, v221
v_mfma_f32_16x16x32_bf16 v[104:107], a[252:255], a[156:159], v[104:107]
v_cvt_pk_bf16_f32 v196, v222, v223
v_cvt_pk_bf16_f32 v200, v232, v233
v_mfma_f32_16x16x32_bf16 v[104:107], a[244:247], a[152:155], v[104:107]
v_cvt_pk_bf16_f32 v204, v226, v227
v_cvt_pk_bf16_f32 v208, v212, v213
v_mfma_f32_16x16x32_bf16 v[104:107], a[236:239], a[148:151], v[104:107]
buffer_load_dwordx4 a[204:207], v14, s[8:11], s16 offen offset:1024 sc1
v_mfma_f32_16x16x32_bf16 v[104:107], a[228:231], a[144:147], v[104:107]
v_lshlrev_b32 v218, 16, v185
v_and_b32 v219, s50, v185
v_lshlrev_b32 v214, 16, v189
v_and_b32 v215, s50, v189
v_mfma_f32_16x16x32_bf16 v[112:115], a[228:231], a[148:151], v[112:115]
v_lshlrev_b32 v216, 16, v193
v_and_b32 v217, s50, v193
v_mfma_f32_16x16x32_bf16 v[112:115], a[236:239], a[152:155], v[112:115]
ds_read_b128 a[140:143], v16 offset:49584
v_lshlrev_b32 v220, 16, v149
v_mfma_f32_16x16x32_bf16 v[112:115], a[244:247], a[156:159], v[112:115]
v_and_b32 v221, s50, v149
v_fma_f32 v222, v216, s51, v220
v_mfma_f32_16x16x32_bf16 v[112:115], a[252:255], a[128:131], v[112:115]
v_fma_f32 v223, v217, s51, v221
v_fmac_f32 v216, s51, v214
v_fmac_f32 v217, s51, v215
v_mfma_f32_16x16x32_bf16 v[108:111], a[248:251], a[128:131], v[108:111]
v_fmac_f32 v214, s51, v218
v_fmac_f32 v215, s51, v219
v_mfma_f32_16x16x32_bf16 v[108:111], a[240:243], a[156:159], v[108:111]
v_fmac_f32 v218, s51, v230
v_fmac_f32 v219, s51, v231
v_mfma_f32_16x16x32_bf16 v[108:111], a[232:235], a[152:155], v[108:111]
buffer_load_dwordx4 a[208:211], v13, s[8:11], s16 offen offset:2048 sc1
v_mfma_f32_16x16x32_bf16 v[108:111], a[224:227], a[148:151], v[108:111]
v_fma_f32 v230, v218, s60, v216
v_fma_f32 v231, v219, s60, v217
v_fma_f32 v232, v214, s60, v222
v_mfma_f32_16x16x32_bf16 v[116:119], a[224:227], a[152:155], v[116:119]
v_fma_f32 v233, v215, s60, v223
v_fmac_f32 v216, s52, v218
v_mfma_f32_16x16x32_bf16 v[116:119], a[232:235], a[156:159], v[116:119]
ds_read_b128 a[144:147], v16 offset:50080
v_fmac_f32 v217, s52, v219
v_mfma_f32_16x16x32_bf16 v[116:119], a[240:243], a[128:131], v[116:119]
v_fmac_f32 v222, s52, v214
s_waitcnt lgkmcnt(1)
v_mfma_f32_16x16x32_bf16 v[116:119], a[248:251], a[132:135], v[116:119]
v_fmac_f32 v223, s52, v215
v_fma_f32 v218, -v230, s53, v232
v_mfma_f32_16x16x32_bf16 v[120:123], a[252:255], a[132:135], v[120:123]
v_fma_f32 v219, -v231, s53, v233
v_fmac_f32 v232, s53, v230
v_mfma_f32_16x16x32_bf16 v[120:123], a[244:247], a[128:131], v[120:123]
v_fmac_f32 v233, s53, v231
v_fma_f32 v214, -v216, s54, v222
v_mfma_f32_16x16x32_bf16 v[120:123], a[236:239], a[156:159], v[120:123]
ds_read_b128 a[148:151], v16 offset:57792
v_fma_f32 v215, -v217, s54, v223
v_mfma_f32_16x16x32_bf16 v[120:123], a[228:231], a[152:155], v[120:123]
ds_read_b128 a[152:155], v16 offset:57808
v_fmac_f32 v222, s54, v216
v_mfma_f32_16x16x32_bf16 v[128:131], a[228:231], a[156:159], v[128:131]
buffer_load_dwordx4 a[212:215], v14, s[8:11], s16 offen offset:2048 sc1
v_mfma_f32_16x16x32_bf16 v[128:131], a[236:239], a[128:131], v[128:131]
v_fmac_f32 v223, s54, v217
v_cvt_pk_bf16_f32 v197, v218, v219
v_mfma_f32_16x16x32_bf16 v[128:131], a[244:247], a[132:135], v[128:131]
v_cvt_pk_bf16_f32 v201, v232, v233
v_cvt_pk_bf16_f32 v205, v214, v215
v_mfma_f32_16x16x32_bf16 v[128:131], a[252:255], a[136:139], v[128:131]
v_cvt_pk_bf16_f32 v209, v222, v223
v_lshlrev_b32 v226, 16, v186
v_mfma_f32_16x16x32_bf16 v[124:127], a[248:251], a[136:139], v[124:127]
v_and_b32 v227, s50, v186
v_lshlrev_b32 v212, 16, v190
v_mfma_f32_16x16x32_bf16 v[124:127], a[240:243], a[132:135], v[124:127]
v_and_b32 v213, s50, v190
v_lshlrev_b32 v230, 16, v194
v_mfma_f32_16x16x32_bf16 v[124:127], a[232:235], a[128:131], v[124:127]
buffer_load_dwordx4 a[216:219], v13, s[8:11], s16 offen offset:3072 sc1
v_mfma_f32_16x16x32_bf16 v[124:127], a[224:227], a[156:159], v[124:127]
ds_read_b128 a[156:159], v16 offset:58304
v_and_b32 v231, s50, v194
v_lshlrev_b32 v216, 16, v150
v_mfma_f32_16x16x32_bf16 v[132:135], a[224:227], a[128:131], v[132:135]
v_and_b32 v217, s50, v150
v_fma_f32 v218, v230, s51, v216
v_mfma_f32_16x16x32_bf16 v[132:135], a[232:235], a[132:135], v[132:135]
v_fma_f32 v219, v231, s51, v217
v_fmac_f32 v230, s51, v212
v_mfma_f32_16x16x32_bf16 v[132:135], a[240:243], a[136:139], v[132:135]
v_fmac_f32 v231, s51, v213
v_fmac_f32 v212, s51, v226
v_mfma_f32_16x16x32_bf16 v[132:135], a[248:251], a[140:143], v[132:135]
v_fmac_f32 v213, s51, v227
v_fmac_f32 v226, s51, v228
v_mfma_f32_16x16x32_bf16 v[136:139], a[252:255], a[140:143], v[136:139]
v_fmac_f32 v227, s51, v229
v_fma_f32 v228, v226, s60, v230
v_mfma_f32_16x16x32_bf16 v[136:139], a[244:247], a[136:139], v[136:139]
v_fma_f32 v229, v227, s60, v231
v_fma_f32 v232, v212, s60, v218
v_mfma_f32_16x16x32_bf16 v[136:139], a[236:239], a[132:135], v[136:139]
buffer_load_dwordx4 a[220:223], v14, s[8:11], s16 offen offset:3072 sc1
v_mfma_f32_16x16x32_bf16 v[136:139], a[228:231], a[128:131], v[136:139]
ds_read_b128 a[128:131], v16 offset:58320
s_add_u32 s16, s16, 4096
v_fma_f32 v233, v213, s60, v219
v_mfma_f32_16x16x32_bf16 v[144:147], a[228:231], a[132:135], v[144:147]
v_fmac_f32 v230, s52, v226
v_fmac_f32 v231, s52, v227
v_mfma_f32_16x16x32_bf16 v[144:147], a[236:239], a[136:139], v[144:147]
v_fmac_f32 v218, s52, v212
v_fmac_f32 v219, s52, v213
v_mfma_f32_16x16x32_bf16 v[144:147], a[244:247], a[140:143], v[144:147]
v_fma_f32 v226, -v228, s53, v232
s_waitcnt vmcnt(16) lgkmcnt(1)
v_mfma_f32_16x16x32_bf16 v[144:147], a[252:255], a[144:147], v[144:147]
buffer_store_dwordx4 v[244:247], v12, s[8:11], s36 offen sc1
v_fma_f32 v227, -v229, s53, v233
v_mfma_f32_16x16x32_bf16 v[140:143], a[248:251], a[144:147], v[140:143]
v_fmac_f32 v232, s53, v228
v_fmac_f32 v233, s53, v229
v_mfma_f32_16x16x32_bf16 v[140:143], a[240:243], a[140:143], v[140:143]
v_fma_f32 v212, -v230, s54, v218
v_fma_f32 v213, -v231, s54, v219
v_mfma_f32_16x16x32_bf16 v[140:143], a[232:235], a[136:139], v[140:143]
v_fmac_f32 v218, s54, v230
v_fmac_f32 v219, s54, v231
v_mfma_f32_16x16x32_bf16 v[140:143], a[224:227], a[132:135], v[140:143]
ds_read_b128 a[132:135], v16 offset:58816
v_cvt_pk_bf16_f32 v198, v226, v227
v_mfma_f32_16x16x32_bf16 v[84:87], a[160:163], a[148:151], v[84:87]
ds_read_b128 a[136:139], v16 offset:58832
v_cvt_pk_bf16_f32 v202, v232, v233
v_mfma_f32_16x16x32_bf16 v[84:87], a[168:171], a[152:155], v[84:87]
ds_read_b128 a[140:143], v16 offset:59328
v_cvt_pk_bf16_f32 v206, v212, v213
v_mfma_f32_16x16x32_bf16 v[84:87], a[176:179], a[156:159], v[84:87]
v_cvt_pk_bf16_f32 v210, v218, v219
s_waitcnt vmcnt(11) lgkmcnt(3)
v_mfma_f32_16x16x32_bf16 v[84:87], a[184:187], a[128:131], v[84:87]
buffer_load_dwordx4 a[224:227], v13, s[8:11], s16 offen offset:0 sc1
v_lshlrev_b32 v214, 16, v187
v_and_b32 v215, s50, v187
v_mfma_f32_16x16x32_bf16 v[88:91], a[188:191], a[128:131], v[88:91]
v_lshlrev_b32 v222, 16, v191
v_and_b32 v223, s50, v191
v_mfma_f32_16x16x32_bf16 v[88:91], a[180:183], a[156:159], v[88:91]
v_lshlrev_b32 v228, 16, v195
v_and_b32 v229, s50, v195
v_mfma_f32_16x16x32_bf16 v[88:91], a[172:175], a[152:155], v[88:91]
buffer_load_dwordx4 a[228:231], v14, s[8:11], s16 offen offset:0 sc1
v_mfma_f32_16x16x32_bf16 v[88:91], a[164:167], a[148:151], v[88:91]
v_lshlrev_b32 v230, 16, v151
v_and_b32 v231, s50, v151
v_fma_f32 v226, v228, s51, v230
v_mfma_f32_16x16x32_bf16 v[96:99], a[164:167], a[152:155], v[96:99]
v_fma_f32 v227, v229, s51, v231
v_fmac_f32 v228, s51, v222
v_mfma_f32_16x16x32_bf16 v[96:99], a[172:175], a[156:159], v[96:99]
ds_read_b128 a[144:147], v16 offset:59344
v_fmac_f32 v229, s51, v223
v_mfma_f32_16x16x32_bf16 v[96:99], a[180:183], a[128:131], v[96:99]
v_fmac_f32 v222, s51, v214
s_waitcnt lgkmcnt(1)
v_mfma_f32_16x16x32_bf16 v[96:99], a[188:191], a[132:135], v[96:99]
v_fmac_f32 v223, s51, v215
v_fmac_f32 v214, s51, v224
v_mfma_f32_16x16x32_bf16 v[92:95], a[184:187], a[132:135], v[92:95]
v_fmac_f32 v215, s51, v225
v_fma_f32 v224, v214, s60, v228
v_mfma_f32_16x16x32_bf16 v[92:95], a[176:179], a[128:131], v[92:95]
v_fma_f32 v225, v215, s60, v229
v_fma_f32 v232, v222, s60, v226
v_mfma_f32_16x16x32_bf16 v[92:95], a[168:171], a[156:159], v[92:95]
buffer_load_dwordx4 a[232:235], v13, s[8:11], s16 offen offset:1024 sc1
v_mfma_f32_16x16x32_bf16 v[92:95], a[160:163], a[152:155], v[92:95]
v_fma_f32 v233, v223, s60, v227
v_fmac_f32 v228, s52, v214
v_mfma_f32_16x16x32_bf16 v[100:103], a[160:163], a[156:159], v[100:103]
v_fmac_f32 v229, s52, v215
v_fmac_f32 v226, s52, v222
v_mfma_f32_16x16x32_bf16 v[100:103], a[168:171], a[128:131], v[100:103]
ds_read_b128 a[148:151], v16 offset:57824
v_fmac_f32 v227, s52, v223
v_mfma_f32_16x16x32_bf16 v[100:103], a[176:179], a[132:135], v[100:103]
v_fma_f32 v214, -v224, s53, v232
v_fma_f32 v215, -v225, s53, v233
v_mfma_f32_16x16x32_bf16 v[100:103], a[184:187], a[136:139], v[100:103]
v_fmac_f32 v232, s53, v224
v_fmac_f32 v233, s53, v225
v_mfma_f32_16x16x32_bf16 v[104:107], a[188:191], a[136:139], v[104:107]
v_fma_f32 v222, -v228, s54, v226
v_fma_f32 v223, -v229, s54, v227
v_mfma_f32_16x16x32_bf16 v[104:107], a[180:183], a[132:135], v[104:107]
v_fmac_f32 v226, s54, v228
v_fmac_f32 v227, s54, v229
v_mfma_f32_16x16x32_bf16 v[104:107], a[172:175], a[128:131], v[104:107]
buffer_load_dwordx4 a[236:239], v14, s[8:11], s16 offen offset:1024 sc1
v_mfma_f32_16x16x32_bf16 v[104:107], a[164:167], a[156:159], v[104:107]
v_cvt_pk_bf16_f32 v199, v214, v215
v_cvt_pk_bf16_f32 v203, v232, v233
v_mfma_f32_16x16x32_bf16 v[112:115], a[164:167], a[128:131], v[112:115]
v_cvt_pk_bf16_f32 v207, v222, v223
v_cvt_pk_bf16_f32 v211, v226, v227
v_mfma_f32_16x16x32_bf16 v[112:115], a[172:175], a[132:135], v[112:115]
ds_read_b128 a[152:155], v16 offset:57840
v_mfma_f32_16x16x32_bf16 v[112:115], a[180:183], a[136:139], v[112:115]
buffer_load_dwordx4 v[184:187], v3, s[4:7], 0 offen offset:3456
v_mfma_f32_16x16x32_bf16 v[112:115], a[188:191], a[140:143], v[112:115]
buffer_load_dwordx4 v[188:191], v9, s[4:7], 0 offen offset:1408
v_mfma_f32_16x16x32_bf16 v[108:111], a[184:187], a[140:143], v[108:111]
buffer_load_dwordx4 v[192:195], v10, s[4:7], 0 offen offset:1408
v_mfma_f32_16x16x32_bf16 v[108:111], a[176:179], a[136:139], v[108:111]
buffer_load_dwordx4 v[148:151], v10, s[4:7], 0 offen offset:3456
v_mfma_f32_16x16x32_bf16 v[108:111], a[168:171], a[132:135], v[108:111]
buffer_load_dwordx4 a[240:243], v13, s[8:11], s16 offen offset:2048 sc1
v_mfma_f32_16x16x32_bf16 v[108:111], a[160:163], a[128:131], v[108:111]
ds_write_b128 v7, v[196:199] offset:528
v_mfma_f32_16x16x32_bf16 v[116:119], a[160:163], a[132:135], v[116:119]
ds_write_b128 v7, v[200:203] offset:17040
v_mfma_f32_16x16x32_bf16 v[116:119], a[168:171], a[136:139], v[116:119]
ds_read_b128 a[156:159], v16 offset:58336
v_mfma_f32_16x16x32_bf16 v[116:119], a[176:179], a[140:143], v[116:119]
s_waitcnt lgkmcnt(3)
v_mfma_f32_16x16x32_bf16 v[116:119], a[184:187], a[144:147], v[116:119]
ds_write_b128 v7, v[204:207] offset:33552
v_mfma_f32_16x16x32_bf16 v[120:123], a[188:191], a[144:147], v[120:123]
ds_write_b128 v7, v[208:211] offset:50064
v_mfma_f32_16x16x32_bf16 v[120:123], a[180:183], a[140:143], v[120:123]
v_lshlrev_b32 v212, 16, v152
v_and_b32 v213, s50, v152
v_mfma_f32_16x16x32_bf16 v[120:123], a[172:175], a[136:139], v[120:123]
buffer_load_dwordx4 a[244:247], v14, s[8:11], s16 offen offset:2048 sc1
v_mfma_f32_16x16x32_bf16 v[120:123], a[164:167], a[132:135], v[120:123]
v_lshlrev_b32 v218, 16, v156
v_and_b32 v219, s50, v156
v_mfma_f32_16x16x32_bf16 v[128:131], a[164:167], a[136:139], v[128:131]
s_waitcnt lgkmcnt(0)
s_barrier
v_mfma_f32_16x16x32_bf16 v[128:131], a[172:175], a[140:143], v[128:131]
ds_read_b128 a[128:131], v15 offset:0
v_lshlrev_b32 v224, 16, v160
v_mfma_f32_16x16x32_bf16 v[128:131], a[180:183], a[144:147], v[128:131]
ds_read_b128 a[132:135], v15 offset:16
v_and_b32 v225, s50, v160
v_mfma_f32_16x16x32_bf16 v[128:131], a[188:191], a[148:151], v[128:131]
v_lshlrev_b32 v228, 16, v164
v_and_b32 v229, s50, v164
v_mfma_f32_16x16x32_bf16 v[124:127], a[184:187], a[148:151], v[124:127]
s_waitcnt vmcnt(20)
v_lshlrev_b32 v214, 16, v168
v_mfma_f32_16x16x32_bf16 v[124:127], a[176:179], a[144:147], v[124:127]
v_and_b32 v215, s50, v168
v_fma_f32 v232, v228, s51, v214
v_mfma_f32_16x16x32_bf16 v[124:127], a[168:171], a[140:143], v[124:127]
buffer_load_dwordx4 a[248:251], v13, s[8:11], s16 offen offset:3072 sc1
v_mfma_f32_16x16x32_bf16 v[124:127], a[160:163], a[136:139], v[124:127]
ds_read_b128 a[136:139], v15 offset:512
v_fma_f32 v233, v229, s51, v215
v_mfma_f32_16x16x32_bf16 v[132:135], a[160:163], a[140:143], v[132:135]
v_fmac_f32 v228, s51, v224
v_fmac_f32 v229, s51, v225
v_mfma_f32_16x16x32_bf16 v[132:135], a[168:171], a[144:147], v[132:135]
v_fmac_f32 v224, s51, v218
v_fmac_f32 v225, s51, v219
v_mfma_f32_16x16x32_bf16 v[132:135], a[176:179], a[148:151], v[132:135]
v_fmac_f32 v218, s51, v212
v_fmac_f32 v219, s51, v213
v_mfma_f32_16x16x32_bf16 v[132:135], a[184:187], a[152:155], v[132:135]
v_fma_f32 v212, v218, s60, v228
v_fma_f32 v213, v219, s60, v229
v_mfma_f32_16x16x32_bf16 v[136:139], a[188:191], a[152:155], v[136:139]
v_fma_f32 v222, v224, s60, v232
v_fma_f32 v223, v225, s60, v233
v_mfma_f32_16x16x32_bf16 v[136:139], a[180:183], a[148:151], v[136:139]
v_fmac_f32 v228, s52, v218
v_fmac_f32 v229, s52, v219
v_mfma_f32_16x16x32_bf16 v[136:139], a[172:175], a[144:147], v[136:139]
buffer_load_dwordx4 a[252:255], v14, s[8:11], s16 offen offset:3072 sc1
v_mfma_f32_16x16x32_bf16 v[136:139], a[164:167], a[140:143], v[136:139]
ds_read_b128 a[140:143], v15 offset:528
s_add_u32 s16, s16, 4096
v_mfma_f32_16x16x32_bf16 v[144:147], a[164:167], a[144:147], v[144:147]
v_fmac_f32 v232, s52, v224
v_fmac_f32 v233, s52, v225
v_mfma_f32_16x16x32_bf16 v[144:147], a[172:175], a[148:151], v[144:147]
v_fma_f32 v218, -v212, s53, v222
v_fma_f32 v219, -v213, s53, v223
v_mfma_f32_16x16x32_bf16 v[144:147], a[180:183], a[152:155], v[144:147]
v_fmac_f32 v222, s53, v212
v_fmac_f32 v223, s53, v213
v_mfma_f32_16x16x32_bf16 v[144:147], a[188:191], a[156:159], v[144:147]
v_fma_f32 v224, -v228, s54, v232
v_fma_f32 v225, -v229, s54, v233
v_mfma_f32_16x16x32_bf16 v[140:143], a[184:187], a[156:159], v[140:143]
v_fmac_f32 v232, s54, v228
v_fmac_f32 v233, s54, v229
v_mfma_f32_16x16x32_bf16 v[140:143], a[176:179], a[152:155], v[140:143]
v_cvt_pk_bf16_f32 v196, v218, v219
v_cvt_pk_bf16_f32 v200, v222, v223
v_mfma_f32_16x16x32_bf16 v[140:143], a[168:171], a[148:151], v[140:143]
v_cvt_pk_bf16_f32 v204, v224, v225
v_cvt_pk_bf16_f32 v208, v232, v233
v_mfma_f32_16x16x32_bf16 v[140:143], a[160:163], a[144:147], v[140:143]
ds_read_b128 a[144:147], v15 offset:1024
s_waitcnt vmcnt(13) lgkmcnt(2)
v_mfma_f32_16x16x32_bf16 a[0:3], a[192:195], a[128:131], a[0:3]
ds_read_b128 a[148:151], v15 offset:1040
v_lshlrev_b32 v226, 16, v153
v_mfma_f32_16x16x32_bf16 a[0:3], a[200:203], a[132:135], a[0:3]
ds_read_b128 a[152:155], v15 offset:1536
v_and_b32 v227, s50, v153
v_mfma_f32_16x16x32_bf16 a[0:3], a[208:211], a[136:139], a[0:3]
v_lshlrev_b32 v234, 16, v157
s_waitcnt lgkmcnt(3)
v_mfma_f32_16x16x32_bf16 a[0:3], a[216:219], a[140:143], a[0:3]
buffer_load_dwordx4 a[160:163], v13, s[8:11], s16 offen offset:0 sc1
v_mfma_f32_16x16x32_bf16 a[4:7], a[220:223], a[140:143], a[4:7]
v_and_b32 v235, s50, v157
v_lshlrev_b32 v220, 16, v161
v_mfma_f32_16x16x32_bf16 a[4:7], a[212:215], a[136:139], a[4:7]
v_and_b32 v221, s50, v161
v_lshlrev_b32 v216, 16, v165
v_mfma_f32_16x16x32_bf16 a[4:7], a[204:207], a[132:135], a[4:7]
buffer_load_dwordx4 a[164:167], v14, s[8:11], s16 offen offset:0 sc1
v_mfma_f32_16x16x32_bf16 a[4:7], a[196:199], a[128:131], a[4:7]
v_and_b32 v217, s50, v165
v_lshlrev_b32 v230, 16, v169
v_mfma_f32_16x16x32_bf16 a[12:15], a[196:199], a[132:135], a[12:15]
v_and_b32 v231, s50, v169
v_fma_f32 v212, v216, s51, v230
v_mfma_f32_16x16x32_bf16 a[12:15], a[204:207], a[136:139], a[12:15]
ds_read_b128 a[156:159], v15 offset:1552
v_fma_f32 v213, v217, s51, v231
v_mfma_f32_16x16x32_bf16 a[12:15], a[212:215], a[140:143], a[12:15]
v_fmac_f32 v216, s51, v220
s_waitcnt lgkmcnt(1)
v_mfma_f32_16x16x32_bf16 a[12:15], a[220:223], a[144:147], a[12:15]
v_fmac_f32 v217, s51, v221
v_fmac_f32 v220, s51, v234
v_mfma_f32_16x16x32_bf16 a[8:11], a[216:219], a[144:147], a[8:11]
v_fmac_f32 v221, s51, v235
v_fmac_f32 v234, s51, v226
v_mfma_f32_16x16x32_bf16 a[8:11], a[208:211], a[140:143], a[8:11]
v_fmac_f32 v235, s51, v227
v_fma_f32 v226, v234, s60, v216
v_mfma_f32_16x16x32_bf16 a[8:11], a[200:203], a[136:139], a[8:11]
buffer_load_dwordx4 a[168:171], v13, s[8:11], s16 offen offset:1024 sc1
v_mfma_f32_16x16x32_bf16 a[8:11], a[192:195], a[132:135], a[8:11]
v_fma_f32 v227, v235, s60, v217
v_fma_f32 v228, v220, s60, v212
v_mfma_f32_16x16x32_bf16 a[16:19], a[192:195], a[136:139], a[16:19]
v_fma_f32 v229, v221, s60, v213
v_fmac_f32 v216, s52, v234
v_mfma_f32_16x16x32_bf16 a[16:19], a[200:203], a[140:143], a[16:19]
ds_read_b128 a[128:131], v15 offset:32
v_fmac_f32 v217, s52, v235
v_mfma_f32_16x16x32_bf16 a[16:19], a[208:211], a[144:147], a[16:19]
v_fmac_f32 v212, s52, v220
v_fmac_f32 v213, s52, v221
v_mfma_f32_16x16x32_bf16 a[16:19], a[216:219], a[148:151], a[16:19]
v_fma_f32 v234, -v226, s53, v228
v_fma_f32 v235, -v227, s53, v229
v_mfma_f32_16x16x32_bf16 a[20:23], a[220:223], a[148:151], a[20:23]
v_fmac_f32 v228, s53, v226
v_fmac_f32 v229, s53, v227
v_mfma_f32_16x16x32_bf16 a[20:23], a[212:215], a[144:147], a[20:23]
v_fma_f32 v220, -v216, s54, v212
v_fma_f32 v221, -v217, s54, v213
v_mfma_f32_16x16x32_bf16 a[20:23], a[204:207], a[140:143], a[20:23]
buffer_load_dwordx4 a[172:175], v14, s[8:11], s16 offen offset:1024 sc1
v_mfma_f32_16x16x32_bf16 a[20:23], a[196:199], a[136:139], a[20:23]
v_fmac_f32 v212, s54, v216
v_fmac_f32 v213, s54, v217
v_mfma_f32_16x16x32_bf16 a[28:31], a[196:199], a[140:143], a[28:31]
v_cvt_pk_bf16_f32 v197, v234, v235
v_cvt_pk_bf16_f32 v201, v228, v229
v_mfma_f32_16x16x32_bf16 a[28:31], a[204:207], a[144:147], a[28:31]
ds_read_b128 a[132:135], v15 offset:48
v_cvt_pk_bf16_f32 v205, v220, v221
v_mfma_f32_16x16x32_bf16 a[28:31], a[212:215], a[148:151], a[28:31]
v_cvt_pk_bf16_f32 v209, v212, v213
v_lshlrev_b32 v218, 16, v154
v_mfma_f32_16x16x32_bf16 a[28:31], a[220:223], a[152:155], a[28:31]
v_and_b32 v219, s50, v154
v_lshlrev_b32 v222, 16, v158
v_mfma_f32_16x16x32_bf16 a[24:27], a[216:219], a[152:155], a[24:27]
v_and_b32 v223, s50, v158
v_lshlrev_b32 v224, 16, v162
v_mfma_f32_16x16x32_bf16 a[24:27], a[208:211], a[148:151], a[24:27]
v_and_b32 v225, s50, v162
v_lshlrev_b32 v232, 16, v166
v_mfma_f32_16x16x32_bf16 a[24:27], a[200:203], a[144:147], a[24:27]
buffer_load_dwordx4 a[176:179], v13, s[8:11], s16 offen offset:2048 sc1
v_mfma_f32_16x16x32_bf16 a[24:27], a[192:195], a[140:143], a[24:27]
v_and_b32 v233, s50, v166
v_lshlrev_b32 v226, 16, v170
v_mfma_f32_16x16x32_bf16 a[32:35], a[192:195], a[144:147], a[32:35]
v_and_b32 v227, s50, v170
v_fma_f32 v216, v232, s51, v226
v_mfma_f32_16x16x32_bf16 a[32:35], a[200:203], a[148:151], a[32:35]
ds_read_b128 a[136:139], v15 offset:544
v_fma_f32 v217, v233, s51, v227
v_mfma_f32_16x16x32_bf16 a[32:35], a[208:211], a[152:155], a[32:35]
v_fmac_f32 v232, s51, v224
s_waitcnt lgkmcnt(1)
v_mfma_f32_16x16x32_bf16 a[32:35], a[216:219], a[156:159], a[32:35]
v_fmac_f32 v233, s51, v225
v_fmac_f32 v224, s51, v222
v_mfma_f32_16x16x32_bf16 a[36:39], a[220:223], a[156:159], a[36:39]
v_fmac_f32 v225, s51, v223
v_fmac_f32 v222, s51, v218
v_mfma_f32_16x16x32_bf16 a[36:39], a[212:215], a[152:155], a[36:39]
v_fmac_f32 v223, s51, v219
v_fma_f32 v218, v222, s60, v232
v_mfma_f32_16x16x32_bf16 a[36:39], a[204:207], a[148:151], a[36:39]
ds_read_b128 a[140:143], v15 offset:8256
v_fma_f32 v219, v223, s60, v233
v_mfma_f32_16x16x32_bf16 a[36:39], a[196:199], a[144:147], a[36:39]
ds_read_b128 a[144:147], v15 offset:8272
v_fma_f32 v234, v224, s60, v216
v_mfma_f32_16x16x32_bf16 a[44:47], a[196:199], a[148:151], a[44:47]
buffer_load_dwordx4 a[180:183], v14, s[8:11], s16 offen offset:2048 sc1
v_mfma_f32_16x16x32_bf16 a[44:47], a[204:207], a[152:155], a[44:47]
v_fma_f32 v235, v225, s60, v217
v_fmac_f32 v232, s52, v222
v_mfma_f32_16x16x32_bf16 a[44:47], a[212:215], a[156:159], a[44:47]
v_fmac_f32 v233, s52, v223
v_fmac_f32 v216, s52, v224
v_mfma_f32_16x16x32_bf16 a[44:47], a[220:223], a[128:131], a[44:47]
v_fmac_f32 v217, s52, v225
v_fma_f32 v222, -v218, s53, v234
v_mfma_f32_16x16x32_bf16 a[40:43], a[216:219], a[128:131], a[40:43]
v_fma_f32 v223, -v219, s53, v235
v_fmac_f32 v234, s53, v218
v_mfma_f32_16x16x32_bf16 a[40:43], a[208:211], a[156:159], a[40:43]
v_fmac_f32 v235, s53, v219
v_fma_f32 v224, -v232, s54, v216
v_mfma_f32_16x16x32_bf16 a[40:43], a[200:203], a[152:155], a[40:43]
buffer_load_dwordx4 a[184:187], v13, s[8:11], s16 offen offset:3072 sc1
v_mfma_f32_16x16x32_bf16 a[40:43], a[192:195], a[148:151], a[40:43]
ds_read_b128 a[148:151], v15 offset:8768
v_fma_f32 v225, -v233, s54, v217
v_mfma_f32_16x16x32_bf16 a[48:51], a[192:195], a[152:155], a[48:51]
v_fmac_f32 v216, s54, v232
v_fmac_f32 v217, s54, v233
v_mfma_f32_16x16x32_bf16 a[48:51], a[200:203], a[156:159], a[48:51]
v_cvt_pk_bf16_f32 v198, v222, v223
v_cvt_pk_bf16_f32 v202, v234, v235
v_mfma_f32_16x16x32_bf16 a[48:51], a[208:211], a[128:131], a[48:51]
v_cvt_pk_bf16_f32 v206, v224, v225
v_cvt_pk_bf16_f32 v210, v216, v217
v_mfma_f32_16x16x32_bf16 a[48:51], a[216:219], a[132:135], a[48:51]
v_lshlrev_b32 v228, 16, v155
v_and_b32 v229, s50, v155
v_mfma_f32_16x16x32_bf16 a[52:55], a[220:223], a[132:135], a[52:55]
v_lshlrev_b32 v220, 16, v159
v_and_b32 v221, s50, v159
v_mfma_f32_16x16x32_bf16 a[52:55], a[212:215], a[128:131], a[52:55]
v_lshlrev_b32 v212, 16, v163
v_and_b32 v213, s50, v163
v_mfma_f32_16x16x32_bf16 a[52:55], a[204:207], a[156:159], a[52:55]
buffer_load_dwordx4 a[188:191], v14, s[8:11], s16 offen offset:3072 sc1
v_mfma_f32_16x16x32_bf16 a[52:55], a[196:199], a[152:155], a[52:55]
ds_read_b128 a[152:155], v15 offset:8784
s_add_u32 s16, s16, 4096
v_mfma_f32_16x16x32_bf16 a[60:63], a[196:199], a[156:159], a[60:63]
v_lshlrev_b32 v218, 16, v167
v_and_b32 v219, s50, v167
v_mfma_f32_16x16x32_bf16 a[60:63], a[204:207], a[128:131], a[60:63]
v_lshlrev_b32 v232, 16, v171
v_and_b32 v233, s50, v171
v_mfma_f32_16x16x32_bf16 a[60:63], a[212:215], a[132:135], a[60:63]
v_fma_f32 v222, v218, s51, v232
s_waitcnt vmcnt(16) lgkmcnt(1)
v_mfma_f32_16x16x32_bf16 a[60:63], a[220:223], a[136:139], a[60:63]
v_fma_f32 v223, v219, s51, v233
v_fmac_f32 v218, s51, v212
v_mfma_f32_16x16x32_bf16 a[56:59], a[216:219], a[136:139], a[56:59]
v_fmac_f32 v219, s51, v213
v_fmac_f32 v212, s51, v220
v_mfma_f32_16x16x32_bf16 a[56:59], a[208:211], a[132:135], a[56:59]
v_fmac_f32 v213, s51, v221
v_fmac_f32 v220, s51, v228
v_mfma_f32_16x16x32_bf16 a[56:59], a[200:203], a[128:131], a[56:59]
v_fmac_f32 v221, s51, v229
v_fma_f32 v228, v220, s60, v218
v_mfma_f32_16x16x32_bf16 a[56:59], a[192:195], a[156:159], a[56:59]
ds_read_b128 a[156:159], v15 offset:9280
v_fma_f32 v229, v221, s60, v219
v_mfma_f32_16x16x32_bf16 a[0:3], a[224:227], a[140:143], a[0:3]
ds_read_b128 a[128:131], v15 offset:9296
v_fma_f32 v234, v212, s60, v222
v_mfma_f32_16x16x32_bf16 a[0:3], a[232:235], a[144:147], a[0:3]
ds_read_b128 a[132:135], v15 offset:9792
s_waitcnt vmcnt(6) lgkmcnt(3)
v_mfma_f32_16x16x32_bf16 a[0:3], a[240:243], a[148:151], a[0:3]
buffer_load_dwordx4 a[192:195], v13, s[8:11], s16 offen offset:0 sc1
v_mfma_f32_16x16x32_bf16 a[0:3], a[248:251], a[152:155], a[0:3]
v_fma_f32 v235, v213, s60, v223
v_fmac_f32 v218, s52, v220
v_mfma_f32_16x16x32_bf16 a[4:7], a[252:255], a[152:155], a[4:7]
v_fmac_f32 v219, s52, v221
v_fmac_f32 v222, s52, v212
v_mfma_f32_16x16x32_bf16 a[4:7], a[244:247], a[148:151], a[4:7]
v_fmac_f32 v223, s52, v213
v_fma_f32 v220, -v228, s53, v234
v_mfma_f32_16x16x32_bf16 a[4:7], a[236:239], a[144:147], a[4:7]
buffer_load_dwordx4 a[196:199], v14, s[8:11], s16 offen offset:0 sc1
v_mfma_f32_16x16x32_bf16 a[4:7], a[228:231], a[140:143], a[4:7]
v_fma_f32 v221, -v229, s53, v235
v_fmac_f32 v234, s53, v228
v_mfma_f32_16x16x32_bf16 a[12:15], a[228:231], a[144:147], a[12:15]
v_fmac_f32 v235, s53, v229
v_fma_f32 v212, -v218, s54, v222
v_mfma_f32_16x16x32_bf16 a[12:15], a[236:239], a[148:151], a[12:15]
ds_read_b128 a[136:139], v15 offset:9808
v_fma_f32 v213, -v219, s54, v223
v_mfma_f32_16x16x32_bf16 a[12:15], a[244:247], a[152:155], a[12:15]
v_fmac_f32 v222, s54, v218
s_waitcnt vmcnt(7) lgkmcnt(1)
v_mfma_f32_16x16x32_bf16 a[12:15], a[252:255], a[156:159], a[12:15]
v_fmac_f32 v223, s54, v219
v_cvt_pk_bf16_f32 v199, v220, v221
v_mfma_f32_16x16x32_bf16 a[8:11], a[248:251], a[156:159], a[8:11]
v_cvt_pk_bf16_f32 v203, v234, v235
v_cvt_pk_bf16_f32 v207, v212, v213
v_mfma_f32_16x16x32_bf16 a[8:11], a[240:243], a[152:155], a[8:11]
v_cvt_pk_bf16_f32 v211, v222, v223
v_mfma_f32_16x16x32_bf16 a[8:11], a[232:235], a[148:151], a[8:11]
buffer_load_dwordx4 a[200:203], v13, s[8:11], s16 offen offset:1024 sc1
v_mfma_f32_16x16x32_bf16 a[8:11], a[224:227], a[144:147], a[8:11]
buffer_load_dwordx4 v[152:155], v11, s[4:7], 0 offen offset:384
v_mfma_f32_16x16x32_bf16 a[16:19], a[224:227], a[148:151], a[16:19]
buffer_load_dwordx4 v[156:159], v10, s[4:7], 0 offen offset:2432
v_mfma_f32_16x16x32_bf16 a[16:19], a[232:235], a[152:155], a[16:19]
ds_read_b128 a[140:143], v15 offset:8288
v_mfma_f32_16x16x32_bf16 a[16:19], a[240:243], a[156:159], a[16:19]
buffer_load_dwordx4 v[160:163], v10, s[4:7], 0 offen offset:384
v_mfma_f32_16x16x32_bf16 a[16:19], a[248:251], a[128:131], a[16:19]
buffer_load_dwordx4 v[164:167], v9, s[4:7], 0 offen offset:384
v_mfma_f32_16x16x32_bf16 a[20:23], a[252:255], a[128:131], a[20:23]
buffer_load_dwordx4 v[168:171], v4, s[4:7], 0 offen offset:384
v_mfma_f32_16x16x32_bf16 a[20:23], a[244:247], a[156:159], a[20:23]
ds_write_b128 v8, v[196:199] offset:0
v_mfma_f32_16x16x32_bf16 a[20:23], a[236:239], a[152:155], a[20:23]
buffer_load_dwordx4 a[204:207], v14, s[8:11], s16 offen offset:1024 sc1
v_mfma_f32_16x16x32_bf16 a[20:23], a[228:231], a[148:151], a[20:23]
ds_write_b128 v8, v[200:203] offset:16512
v_mfma_f32_16x16x32_bf16 a[28:31], a[228:231], a[152:155], a[28:31]
ds_write_b128 v8, v[204:207] offset:33024
v_mfma_f32_16x16x32_bf16 a[28:31], a[236:239], a[156:159], a[28:31]
ds_read_b128 a[144:147], v15 offset:8304
v_mfma_f32_16x16x32_bf16 a[28:31], a[244:247], a[128:131], a[28:31]
ds_write_b128 v8, v[208:211] offset:49536
v_mfma_f32_16x16x32_bf16 a[28:31], a[252:255], a[132:135], a[28:31]
v_lshlrev_b32 v224, 16, v172
v_and_b32 v225, s50, v172
v_mfma_f32_16x16x32_bf16 a[24:27], a[248:251], a[132:135], a[24:27]
v_lshlrev_b32 v216, 16, v176
v_and_b32 v217, s50, v176
v_mfma_f32_16x16x32_bf16 a[24:27], a[240:243], a[128:131], a[24:27]
v_lshlrev_b32 v228, 16, v180
v_and_b32 v229, s50, v180
v_mfma_f32_16x16x32_bf16 a[24:27], a[232:235], a[156:159], a[24:27]
buffer_load_dwordx4 a[208:211], v13, s[8:11], s16 offen offset:2048 sc1
v_mfma_f32_16x16x32_bf16 a[24:27], a[224:227], a[152:155], a[24:27]
v_lshlrev_b32 v218, 16, v184
v_and_b32 v219, s50, v184
v_mfma_f32_16x16x32_bf16 a[32:35], a[224:227], a[156:159], a[32:35]
v_fma_f32 v220, v228, s51, v218
v_fma_f32 v221, v229, s51, v219
v_mfma_f32_16x16x32_bf16 a[32:35], a[232:235], a[128:131], a[32:35]
ds_read_b128 a[148:151], v15 offset:8800
v_fmac_f32 v228, s51, v216
v_mfma_f32_16x16x32_bf16 a[32:35], a[240:243], a[132:135], a[32:35]
v_fmac_f32 v229, s51, v217
s_waitcnt vmcnt(12) lgkmcnt(2)
v_mfma_f32_16x16x32_bf16 a[32:35], a[248:251], a[136:139], a[32:35]
v_fmac_f32 v216, s51, v224
v_fmac_f32 v217, s51, v225
v_mfma_f32_16x16x32_bf16 a[36:39], a[252:255], a[136:139], a[36:39]
v_fmac_f32 v224, s51, v214
v_fmac_f32 v225, s51, v215
v_mfma_f32_16x16x32_bf16 a[36:39], a[244:247], a[132:135], a[36:39]
v_fma_f32 v214, v224, s60, v228
v_fma_f32 v215, v225, s60, v229
v_mfma_f32_16x16x32_bf16 a[36:39], a[236:239], a[128:131], a[36:39]
ds_read_b128 a[152:155], v15 offset:16512
v_fma_f32 v234, v216, s60, v220
v_mfma_f32_16x16x32_bf16 a[36:39], a[228:231], a[156:159], a[36:39]
ds_read_b128 a[156:159], v15 offset:16528
v_fma_f32 v235, v217, s60, v221
v_mfma_f32_16x16x32_bf16 a[44:47], a[228:231], a[128:131], a[44:47]
buffer_load_dwordx4 a[212:215], v14, s[8:11], s16 offen offset:2048 sc1
v_mfma_f32_16x16x32_bf16 a[44:47], a[236:239], a[132:135], a[44:47]
v_fmac_f32 v228, s52, v224
v_fmac_f32 v229, s52, v225
v_mfma_f32_16x16x32_bf16 a[44:47], a[244:247], a[136:139], a[44:47]
v_fmac_f32 v220, s52, v216
v_fmac_f32 v221, s52, v217
v_mfma_f32_16x16x32_bf16 a[44:47], a[252:255], a[140:143], a[44:47]
v_fma_f32 v224, -v214, s53, v234
v_fma_f32 v225, -v215, s53, v235
v_mfma_f32_16x16x32_bf16 a[40:43], a[248:251], a[140:143], a[40:43]
v_fmac_f32 v234, s53, v214
v_fmac_f32 v235, s53, v215
v_mfma_f32_16x16x32_bf16 a[40:43], a[240:243], a[136:139], a[40:43]
v_fma_f32 v216, -v228, s54, v220
v_fma_f32 v217, -v229, s54, v221
v_mfma_f32_16x16x32_bf16 a[40:43], a[232:235], a[132:135], a[40:43]
buffer_load_dwordx4 a[216:219], v13, s[8:11], s16 offen offset:3072 sc1
v_mfma_f32_16x16x32_bf16 a[40:43], a[224:227], a[128:131], a[40:43]
ds_read_b128 a[128:131], v15 offset:17024
v_fmac_f32 v220, s54, v228
v_mfma_f32_16x16x32_bf16 a[48:51], a[224:227], a[132:135], a[48:51]
v_fmac_f32 v221, s54, v229
v_cvt_pk_bf16_f32 v196, v224, v225
v_mfma_f32_16x16x32_bf16 a[48:51], a[232:235], a[136:139], a[48:51]
v_cvt_pk_bf16_f32 v200, v234, v235
v_cvt_pk_bf16_f32 v204, v216, v217
v_mfma_f32_16x16x32_bf16 a[48:51], a[240:243], a[140:143], a[48:51]
v_cvt_pk_bf16_f32 v208, v220, v221
v_lshlrev_b32 v212, 16, v173
v_mfma_f32_16x16x32_bf16 a[48:51], a[248:251], a[144:147], a[48:51]
v_and_b32 v213, s50, v173
v_lshlrev_b32 v222, 16, v177
v_mfma_f32_16x16x32_bf16 a[52:55], a[252:255], a[144:147], a[52:55]
v_and_b32 v223, s50, v177
v_lshlrev_b32 v214, 16, v181
v_mfma_f32_16x16x32_bf16 a[52:55], a[244:247], a[140:143], a[52:55]
v_and_b32 v215, s50, v181
v_lshlrev_b32 v228, 16, v185
v_mfma_f32_16x16x32_bf16 a[52:55], a[236:239], a[136:139], a[52:55]
buffer_load_dwordx4 a[220:223], v14, s[8:11], s16 offen offset:3072 sc1
v_mfma_f32_16x16x32_bf16 a[52:55], a[228:231], a[132:135], a[52:55]
ds_read_b128 a[132:135], v15 offset:17040
s_add_u32 s16, s16, 4096
v_mfma_f32_16x16x32_bf16 a[60:63], a[228:231], a[136:139], a[60:63]
v_and_b32 v229, s50, v185
v_fma_f32 v224, v214, s51, v228
v_mfma_f32_16x16x32_bf16 a[60:63], a[236:239], a[140:143], a[60:63]
v_fma_f32 v225, v215, s51, v229
v_fmac_f32 v214, s51, v222
v_mfma_f32_16x16x32_bf16 a[60:63], a[244:247], a[144:147], a[60:63]
v_fmac_f32 v215, s51, v223
s_waitcnt vmcnt(12) lgkmcnt(1)
v_mfma_f32_16x16x32_bf16 a[60:63], a[252:255], a[148:151], a[60:63]
v_fmac_f32 v222, s51, v212
v_fmac_f32 v223, s51, v213
v_mfma_f32_16x16x32_bf16 a[56:59], a[248:251], a[148:151], a[56:59]
v_fmac_f32 v212, s51, v230
v_fmac_f32 v213, s51, v231
v_mfma_f32_16x16x32_bf16 a[56:59], a[240:243], a[144:147], a[56:59]
v_fma_f32 v230, v212, s60, v214
v_fma_f32 v231, v213, s60, v215
v_mfma_f32_16x16x32_bf16 a[56:59], a[232:235], a[140:143], a[56:59]
s_getpc_b64 s[46:47]
v_fma_f32 v234, v222, s60, v224
v_mfma_f32_16x16x32_bf16 a[56:59], a[224:227], a[136:139], a[56:59]
ds_read_b128 a[136:139], v15 offset:17536
v_fma_f32 v235, v223, s60, v225
v_mfma_f32_16x16x32_bf16 v[20:23], a[160:163], a[152:155], v[20:23]
ds_read_b128 a[140:143], v15 offset:17552
v_fmac_f32 v214, s52, v212
v_mfma_f32_16x16x32_bf16 v[20:23], a[168:171], a[156:159], v[20:23]
ds_read_b128 a[144:147], v15 offset:18048
v_fmac_f32 v215, s52, v213
v_mfma_f32_16x16x32_bf16 v[20:23], a[176:179], a[128:131], v[20:23]
v_fmac_f32 v224, s52, v222
s_waitcnt vmcnt(11) lgkmcnt(3)
v_mfma_f32_16x16x32_bf16 v[20:23], a[184:187], a[132:135], v[20:23]
buffer_load_dwordx4 a[224:227], v13, s[8:11], s16 offen offset:0 sc1
v_mfma_f32_16x16x32_bf16 v[24:27], a[188:191], a[132:135], v[24:27]
global_load_dword v252, v255, s[46:47] offset:2048
v_mfma_f32_16x16x32_bf16 v[24:27], a[180:183], a[128:131], v[24:27]
v_fmac_f32 v225, s52, v223
v_fma_f32 v212, -v230, s53, v234
v_mfma_f32_16x16x32_bf16 v[24:27], a[172:175], a[156:159], v[24:27]
buffer_load_dwordx4 a[228:231], v14, s[8:11], s16 offen offset:0 sc1
v_mfma_f32_16x16x32_bf16 v[24:27], a[164:167], a[152:155], v[24:27]
v_fma_f32 v213, -v231, s53, v235
v_fmac_f32 v234, s53, v230
v_mfma_f32_16x16x32_bf16 v[32:35], a[164:167], a[156:159], v[32:35]
v_fmac_f32 v235, s53, v231
v_fma_f32 v222, -v214, s54, v224
v_mfma_f32_16x16x32_bf16 v[32:35], a[172:175], a[128:131], v[32:35]
ds_read_b128 a[148:151], v15 offset:18064
v_fma_f32 v223, -v215, s54, v225
v_mfma_f32_16x16x32_bf16 v[32:35], a[180:183], a[132:135], v[32:35]
v_fmac_f32 v224, s54, v214
s_waitcnt vmcnt(13) lgkmcnt(1)
v_mfma_f32_16x16x32_bf16 v[32:35], a[188:191], a[136:139], v[32:35]
v_fmac_f32 v225, s54, v215
v_cvt_pk_bf16_f32 v197, v212, v213
v_mfma_f32_16x16x32_bf16 v[28:31], a[184:187], a[136:139], v[28:31]
v_cvt_pk_bf16_f32 v201, v234, v235
v_cvt_pk_bf16_f32 v205, v222, v223
v_mfma_f32_16x16x32_bf16 v[28:31], a[176:179], a[132:135], v[28:31]
v_cvt_pk_bf16_f32 v209, v224, v225
v_lshlrev_b32 v216, 16, v174
v_mfma_f32_16x16x32_bf16 v[28:31], a[168:171], a[128:131], v[28:31]
buffer_load_dwordx4 a[232:235], v13, s[8:11], s16 offen offset:1024 sc1
v_mfma_f32_16x16x32_bf16 v[28:31], a[160:163], a[156:159], v[28:31]
v_and_b32 v217, s50, v174
v_lshlrev_b32 v220, 16, v178
v_mfma_f32_16x16x32_bf16 v[36:39], a[160:163], a[128:131], v[36:39]
v_and_b32 v221, s50, v178
v_lshlrev_b32 v230, 16, v182
v_mfma_f32_16x16x32_bf16 v[36:39], a[168:171], a[132:135], v[36:39]
ds_read_b128 a[152:155], v15 offset:16544
v_and_b32 v231, s50, v182
v_mfma_f32_16x16x32_bf16 v[36:39], a[176:179], a[136:139], v[36:39]
v_lshlrev_b32 v214, 16, v186
v_and_b32 v215, s50, v186
v_mfma_f32_16x16x32_bf16 v[36:39], a[184:187], a[140:143], v[36:39]
v_fma_f32 v212, v230, s51, v214
v_fma_f32 v213, v231, s51, v215
v_mfma_f32_16x16x32_bf16 v[40:43], a[188:191], a[140:143], v[40:43]
v_fmac_f32 v230, s51, v220
v_fmac_f32 v231, s51, v221
v_mfma_f32_16x16x32_bf16 v[40:43], a[180:183], a[136:139], v[40:43]
v_fmac_f32 v220, s51, v216
v_fmac_f32 v221, s51, v217
v_mfma_f32_16x16x32_bf16 v[40:43], a[172:175], a[132:135], v[40:43]
buffer_load_dwordx4 a[236:239], v14, s[8:11], s16 offen offset:1024 sc1
v_mfma_f32_16x16x32_bf16 v[40:43], a[164:167], a[128:131], v[40:43]
v_fmac_f32 v216, s51, v226
v_fmac_f32 v217, s51, v227
v_mfma_f32_16x16x32_bf16 v[48:51], a[164:167], a[132:135], v[48:51]
v_fma_f32 v226, v216, s60, v230
v_fma_f32 v227, v217, s60, v231
v_mfma_f32_16x16x32_bf16 v[48:51], a[172:175], a[136:139], v[48:51]
ds_read_b128 a[156:159], v15 offset:16560
v_fma_f32 v234, v220, s60, v212
v_mfma_f32_16x16x32_bf16 v[48:51], a[180:183], a[140:143], v[48:51]
v_fma_f32 v235, v221, s60, v213
v_fmac_f32 v230, s52, v216
v_mfma_f32_16x16x32_bf16 v[48:51], a[188:191], a[144:147], v[48:51]
v_fmac_f32 v231, s52, v217
v_fmac_f32 v212, s52, v220
v_mfma_f32_16x16x32_bf16 v[44:47], a[184:187], a[144:147], v[44:47]
v_fmac_f32 v213, s52, v221
v_fma_f32 v216, -v226, s53, v234
v_mfma_f32_16x16x32_bf16 v[44:47], a[176:179], a[140:143], v[44:47]
v_fma_f32 v217, -v227, s53, v235
v_fmac_f32 v234, s53, v226
v_mfma_f32_16x16x32_bf16 v[44:47], a[168:171], a[136:139], v[44:47]
buffer_load_dwordx4 a[240:243], v13, s[8:11], s16 offen offset:2048 sc1
v_mfma_f32_16x16x32_bf16 v[44:47], a[160:163], a[132:135], v[44:47]
v_fmac_f32 v235, s53, v227
v_fma_f32 v220, -v230, s54, v212
v_mfma_f32_16x16x32_bf16 v[52:55], a[160:163], a[136:139], v[52:55]
v_fma_f32 v221, -v231, s54, v213
v_fmac_f32 v212, s54, v230
v_mfma_f32_16x16x32_bf16 v[52:55], a[168:171], a[140:143], v[52:55]
ds_read_b128 a[128:131], v15 offset:17056
v_fmac_f32 v213, s54, v231
v_mfma_f32_16x16x32_bf16 v[52:55], a[176:179], a[144:147], v[52:55]
v_cvt_pk_bf16_f32 v198, v216, v217
s_waitcnt lgkmcnt(1)
v_mfma_f32_16x16x32_bf16 v[52:55], a[184:187], a[148:151], v[52:55]
v_cvt_pk_bf16_f32 v202, v234, v235
v_cvt_pk_bf16_f32 v206, v220, v221
v_mfma_f32_16x16x32_bf16 v[56:59], a[188:191], a[148:151], v[56:59]
v_cvt_pk_bf16_f32 v210, v212, v213
v_lshlrev_b32 v222, 16, v175
v_mfma_f32_16x16x32_bf16 v[56:59], a[180:183], a[144:147], v[56:59]
v_and_b32 v223, s50, v175
v_lshlrev_b32 v224, 16, v179
v_mfma_f32_16x16x32_bf16 v[56:59], a[172:175], a[140:143], v[56:59]
ds_read_b128 a[132:135], v15 offset:24768
v_and_b32 v225, s50, v179
v_mfma_f32_16x16x32_bf16 v[56:59], a[164:167], a[136:139], v[56:59]
ds_read_b128 a[136:139], v15 offset:24784
v_lshlrev_b32 v226, 16, v183
v_mfma_f32_16x16x32_bf16 v[64:67], a[164:167], a[140:143], v[64:67]
buffer_load_dwordx4 a[244:247], v14, s[8:11], s16 offen offset:2048 sc1
v_mfma_f32_16x16x32_bf16 v[64:67], a[172:175], a[144:147], v[64:67]
v_and_b32 v227, s50, v183
v_lshlrev_b32 v230, 16, v187
v_mfma_f32_16x16x32_bf16 v[64:67], a[180:183], a[148:151], v[64:67]
v_and_b32 v231, s50, v187
v_fma_f32 v216, v226, s51, v230
v_mfma_f32_16x16x32_bf16 v[64:67], a[188:191], a[152:155], v[64:67]
v_fma_f32 v217, v227, s51, v231
v_fmac_f32 v226, s51, v224
v_mfma_f32_16x16x32_bf16 v[60:63], a[184:187], a[152:155], v[60:63]
v_fmac_f32 v227, s51, v225
v_fmac_f32 v224, s51, v222
v_mfma_f32_16x16x32_bf16 v[60:63], a[176:179], a[148:151], v[60:63]
v_fmac_f32 v225, s51, v223
v_fmac_f32 v222, s51, v232
v_mfma_f32_16x16x32_bf16 v[60:63], a[168:171], a[144:147], v[60:63]
buffer_load_dwordx4 a[248:251], v13, s[8:11], s16 offen offset:3072 sc1
v_mfma_f32_16x16x32_bf16 v[60:63], a[160:163], a[140:143], v[60:63]
ds_read_b128 a[140:143], v15 offset:25280
v_fmac_f32 v223, s51, v233
v_mfma_f32_16x16x32_bf16 v[68:71], a[160:163], a[144:147], v[68:71]
v_fma_f32 v232, v222, s60, v226
v_fma_f32 v233, v223, s60, v227
v_mfma_f32_16x16x32_bf16 v[68:71], a[168:171], a[148:151], v[68:71]
v_fma_f32 v234, v224, s60, v216
v_fma_f32 v235, v225, s60, v217
v_mfma_f32_16x16x32_bf16 v[68:71], a[176:179], a[152:155], v[68:71]
v_fmac_f32 v226, s52, v222
v_fmac_f32 v227, s52, v223
v_mfma_f32_16x16x32_bf16 v[68:71], a[184:187], a[156:159], v[68:71]
v_fmac_f32 v216, s52, v224
v_fmac_f32 v217, s52, v225
v_mfma_f32_16x16x32_bf16 v[72:75], a[188:191], a[156:159], v[72:75]
v_fma_f32 v222, -v232, s53, v234
v_fma_f32 v223, -v233, s53, v235
v_mfma_f32_16x16x32_bf16 v[72:75], a[180:183], a[152:155], v[72:75]
v_fmac_f32 v234, s53, v232
v_fmac_f32 v235, s53, v233
v_mfma_f32_16x16x32_bf16 v[72:75], a[172:175], a[148:151], v[72:75]
buffer_load_dwordx4 a[252:255], v14, s[8:11], s16 offen offset:3072 sc1
v_mfma_f32_16x16x32_bf16 v[72:75], a[164:167], a[144:147], v[72:75]
ds_read_b128 a[144:147], v15 offset:25296
s_add_u32 s16, s16, 4096
v_mfma_f32_16x16x32_bf16 v[80:83], a[164:167], a[148:151], v[80:83]
v_fma_f32 v224, -v226, s54, v216
v_fma_f32 v225, -v227, s54, v217
v_mfma_f32_16x16x32_bf16 v[80:83], a[172:175], a[152:155], v[80:83]
v_fmac_f32 v216, s54, v226
v_fmac_f32 v217, s54, v227
v_mfma_f32_16x16x32_bf16 v[80:83], a[180:183], a[156:159], v[80:83]
v_cvt_pk_bf16_f32 v199, v222, v223
s_waitcnt lgkmcnt(1)
v_mfma_f32_16x16x32_bf16 v[80:83], a[188:191], a[128:131], v[80:83]
v_cvt_pk_bf16_f32 v203, v234, v235
v_cvt_pk_bf16_f32 v207, v224, v225
v_mfma_f32_16x16x32_bf16 v[76:79], a[184:187], a[128:131], v[76:79]
v_cvt_pk_bf16_f32 v211, v216, v217
v_mfma_f32_16x16x32_bf16 v[76:79], a[176:179], a[156:159], v[76:79]
buffer_load_dwordx4 v[172:175], v4, s[4:7], 0 offen offset:1408
v_mfma_f32_16x16x32_bf16 v[76:79], a[168:171], a[152:155], v[76:79]
buffer_load_dwordx4 v[176:179], v4, s[4:7], 0 offen offset:2432
v_mfma_f32_16x16x32_bf16 v[76:79], a[160:163], a[148:151], v[76:79]
ds_read_b128 a[148:151], v15 offset:25792
v_mfma_f32_16x16x32_bf16 v[20:23], a[192:195], a[132:135], v[20:23]
ds_read_b128 a[152:155], v15 offset:25808
v_mfma_f32_16x16x32_bf16 v[20:23], a[200:203], a[136:139], v[20:23]
ds_read_b128 a[156:159], v15 offset:26304
s_waitcnt vmcnt(8) lgkmcnt(3)
v_mfma_f32_16x16x32_bf16 v[20:23], a[208:211], a[140:143], v[20:23]
buffer_load_dwordx4 a[160:163], v13, s[8:11], s16 offen offset:0 sc1
v_mfma_f32_16x16x32_bf16 v[20:23], a[216:219], a[144:147], v[20:23]
buffer_load_dwordx4 v[180:183], v4, s[4:7], 0 offen offset:3456
v_mfma_f32_16x16x32_bf16 v[24:27], a[220:223], a[144:147], v[24:27]
buffer_load_dwordx4 v[184:187], v5, s[4:7], 0 offen offset:384
v_mfma_f32_16x16x32_bf16 v[24:27], a[212:215], a[140:143], v[24:27]
ds_write_b128 v8, v[196:199] offset:16
v_mfma_f32_16x16x32_bf16 v[24:27], a[204:207], a[136:139], v[24:27]
buffer_load_dwordx4 a[164:167], v14, s[8:11], s16 offen offset:0 sc1
v_mfma_f32_16x16x32_bf16 v[24:27], a[196:199], a[132:135], v[24:27]
ds_write_b128 v8, v[200:203] offset:16528
v_mfma_f32_16x16x32_bf16 v[32:35], a[196:199], a[136:139], v[32:35]
ds_write_b128 v8, v[204:207] offset:33040
v_mfma_f32_16x16x32_bf16 v[32:35], a[204:207], a[140:143], v[32:35]
ds_read_b128 a[128:131], v15 offset:26320
v_mfma_f32_16x16x32_bf16 v[32:35], a[212:215], a[144:147], v[32:35]
s_waitcnt vmcnt(11) lgkmcnt(4)
v_mfma_f32_16x16x32_bf16 v[32:35], a[220:223], a[148:151], v[32:35]
ds_write_b128 v8, v[208:211] offset:49552
v_lshlrev_b32 v220, 16, v188
v_and_b32 v221, s50, v188
v_mfma_f32_16x16x32_bf16 v[28:31], a[216:219], a[148:151], v[28:31]
v_lshlrev_b32 v212, 16, v192
v_and_b32 v213, s50, v192
v_mfma_f32_16x16x32_bf16 v[28:31], a[208:211], a[144:147], v[28:31]
v_lshlrev_b32 v232, 16, v148
v_and_b32 v233, s50, v148
v_mfma_f32_16x16x32_bf16 v[28:31], a[200:203], a[140:143], v[28:31]
buffer_load_dwordx4 a[168:171], v13, s[8:11], s16 offen offset:1024 sc1
v_mfma_f32_16x16x32_bf16 v[28:31], a[192:195], a[136:139], v[28:31]
v_fmac_f32 v232, s56, v212
v_fmac_f32 v233, s56, v213
v_fmac_f32 v232, s55, v220
v_fmac_f32 v233, s55, v221
v_mfma_f32_16x16x32_bf16 v[36:39], a[192:195], a[140:143], v[36:39]
v_lshlrev_b32 v226, 16, v189
v_and_b32 v227, s50, v189
v_mfma_f32_16x16x32_bf16 v[36:39], a[200:203], a[144:147], v[36:39]
ds_read_b128 a[132:135], v15 offset:24800
v_lshlrev_b32 v222, 16, v193
v_mfma_f32_16x16x32_bf16 v[36:39], a[208:211], a[148:151], v[36:39]
v_and_b32 v223, s50, v193
v_lshlrev_b32 v234, 16, v149
v_mfma_f32_16x16x32_bf16 v[36:39], a[216:219], a[152:155], v[36:39]
v_and_b32 v235, s50, v149
v_fmac_f32 v234, s56, v222
v_fmac_f32 v235, s56, v223
v_fmac_f32 v234, s55, v226
v_mfma_f32_16x16x32_bf16 v[40:43], a[220:223], a[152:155], v[40:43]
v_fmac_f32 v235, s55, v227
v_lshlrev_b32 v224, 16, v190
v_mfma_f32_16x16x32_bf16 v[40:43], a[212:215], a[148:151], v[40:43]
v_and_b32 v225, s50, v190
v_lshlrev_b32 v216, 16, v194
v_mfma_f32_16x16x32_bf16 v[40:43], a[204:207], a[144:147], v[40:43]
buffer_load_dwordx4 a[172:175], v14, s[8:11], s16 offen offset:1024 sc1
v_mfma_f32_16x16x32_bf16 v[40:43], a[196:199], a[140:143], v[40:43]
v_and_b32 v217, s50, v194
v_lshlrev_b32 v220, 16, v150
v_and_b32 v221, s50, v150
v_fmac_f32 v220, s56, v216
v_mfma_f32_16x16x32_bf16 v[48:51], a[196:199], a[144:147], v[48:51]
v_fmac_f32 v221, s56, v217
v_fmac_f32 v220, s55, v224
v_mfma_f32_16x16x32_bf16 v[48:51], a[204:207], a[148:151], v[48:51]
ds_read_b128 a[136:139], v15 offset:24816
v_fmac_f32 v221, s55, v225
v_mfma_f32_16x16x32_bf16 v[48:51], a[212:215], a[152:155], v[48:51]
v_lshlrev_b32 v212, 16, v191
v_and_b32 v213, s50, v191
v_mfma_f32_16x16x32_bf16 v[48:51], a[220:223], a[156:159], v[48:51]
v_lshlrev_b32 v226, 16, v195
v_and_b32 v227, s50, v195
v_mfma_f32_16x16x32_bf16 v[44:47], a[216:219], a[156:159], v[44:47]
v_lshlrev_b32 v222, 16, v151
v_and_b32 v223, s50, v151
v_mfma_f32_16x16x32_bf16 v[44:47], a[208:211], a[152:155], v[44:47]
v_fmac_f32 v222, s56, v226
v_fmac_f32 v223, s56, v227
v_mfma_f32_16x16x32_bf16 v[44:47], a[200:203], a[148:151], v[44:47]
buffer_load_dwordx4 a[176:179], v13, s[8:11], s16 offen offset:2048 sc1
v_mfma_f32_16x16x32_bf16 v[44:47], a[192:195], a[144:147], v[44:47]
v_fmac_f32 v222, s55, v212
v_fmac_f32 v223, s55, v213
v_mfma_f32_16x16x32_bf16 v[52:55], a[192:195], a[148:151], v[52:55]
buffer_load_dwordx4 v[188:191], v5, s[4:7], 0 offen offset:1408
v_mfma_f32_16x16x32_bf16 v[52:55], a[200:203], a[152:155], v[52:55]
ds_read_b128 a[140:143], v15 offset:25312
v_lshlrev_b32 v224, 16, v152
v_mfma_f32_16x16x32_bf16 v[52:55], a[208:211], a[156:159], v[52:55]
v_and_b32 v225, s50, v152
s_waitcnt vmcnt(12) lgkmcnt(1)
v_mfma_f32_16x16x32_bf16 v[52:55], a[216:219], a[128:131], v[52:55]
buffer_load_dwordx4 v[192:195], v5, s[4:7], 0 offen offset:2432
v_lshlrev_b32 v216, 16, v156
v_and_b32 v217, s50, v156
v_mfma_f32_16x16x32_bf16 v[56:59], a[220:223], a[128:131], v[56:59]
buffer_load_dwordx4 v[148:151], v5, s[4:7], 0 offen offset:3456
v_mfma_f32_16x16x32_bf16 v[56:59], a[212:215], a[156:159], v[56:59]
v_fma_f32 v224, v224, s58, v232
v_fma_f32 v225, v225, s58, v233
v_mfma_f32_16x16x32_bf16 v[56:59], a[204:207], a[152:155], v[56:59]
ds_read_b128 a[144:147], v15 offset:33024
v_fmac_f32 v224, s57, v216
v_mfma_f32_16x16x32_bf16 v[56:59], a[196:199], a[148:151], v[56:59]
ds_read_b128 a[148:151], v15 offset:33040
v_fmac_f32 v225, s57, v217
v_fmac_f32 v216, s58, v232
v_fmac_f32 v217, s58, v233
v_mfma_f32_16x16x32_bf16 v[64:67], a[196:199], a[152:155], v[64:67]
buffer_load_dwordx4 a[180:183], v14, s[8:11], s16 offen offset:2048 sc1
v_mfma_f32_16x16x32_bf16 v[64:67], a[204:207], a[156:159], v[64:67]
v_cvt_pk_bf16_f32 v236, v232, v233
v_lshlrev_b32 v212, 16, v160
v_mfma_f32_16x16x32_bf16 v[64:67], a[212:215], a[128:131], v[64:67]
v_and_b32 v213, s50, v160
v_lshlrev_b32 v226, 16, v164
v_mfma_f32_16x16x32_bf16 v[64:67], a[220:223], a[132:135], v[64:67]
v_and_b32 v227, s50, v164
v_fmac_f32 v224, s59, v212
v_fmac_f32 v225, s59, v213
v_fmac_f32 v216, s56, v212
v_mfma_f32_16x16x32_bf16 v[60:63], a[216:219], a[132:135], v[60:63]
v_fmac_f32 v217, s56, v213
v_fmac_f32 v216, s55, v226
v_mfma_f32_16x16x32_bf16 v[60:63], a[208:211], a[128:131], v[60:63]
v_fmac_f32 v217, s55, v227
v_cvt_pk_bf16_f32 v240, v216, v217
v_mfma_f32_16x16x32_bf16 v[60:63], a[200:203], a[156:159], v[60:63]
buffer_load_dwordx4 a[184:187], v13, s[8:11], s16 offen offset:3072 sc1
v_mfma_f32_16x16x32_bf16 v[60:63], a[192:195], a[152:155], v[60:63]
ds_read_b128 a[152:155], v15 offset:33536
v_cvt_pk_bf16_f32 v244, v224, v225
v_lshlrev_b32 v232, 16, v153
v_and_b32 v233, s50, v153
v_mfma_f32_16x16x32_bf16 v[68:71], a[192:195], a[156:159], v[68:71]
v_lshlrev_b32 v226, 16, v157
v_and_b32 v227, s50, v157
v_mfma_f32_16x16x32_bf16 v[68:71], a[200:203], a[128:131], v[68:71]
v_fma_f32 v232, v232, s58, v234
v_fma_f32 v233, v233, s58, v235
v_mfma_f32_16x16x32_bf16 v[68:71], a[208:211], a[132:135], v[68:71]
v_fmac_f32 v232, s57, v226
v_fmac_f32 v233, s57, v227
v_mfma_f32_16x16x32_bf16 v[68:71], a[216:219], a[136:139], v[68:71]
v_fmac_f32 v226, s58, v234
v_fmac_f32 v227, s58, v235
v_mfma_f32_16x16x32_bf16 v[72:75], a[220:223], a[136:139], v[72:75]
v_cvt_pk_bf16_f32 v237, v234, v235
v_lshlrev_b32 v212, 16, v161
v_mfma_f32_16x16x32_bf16 v[72:75], a[212:215], a[132:135], v[72:75]
v_and_b32 v213, s50, v161
v_lshlrev_b32 v216, 16, v165
v_mfma_f32_16x16x32_bf16 v[72:75], a[204:207], a[128:131], v[72:75]
buffer_load_dwordx4 a[188:191], v14, s[8:11], s16 offen offset:3072 sc1
v_mfma_f32_16x16x32_bf16 v[72:75], a[196:199], a[156:159], v[72:75]
ds_read_b128 a[156:159], v15 offset:33552
s_add_u32 s16, s16, 4096
v_mfma_f32_16x16x32_bf16 v[80:83], a[196:199], a[128:131], v[80:83]
v_and_b32 v217, s50, v165
v_fmac_f32 v232, s59, v212
v_mfma_f32_16x16x32_bf16 v[80:83], a[204:207], a[132:135], v[80:83]
v_fmac_f32 v233, s59, v213
v_fmac_f32 v226, s56, v212
v_mfma_f32_16x16x32_bf16 v[80:83], a[212:215], a[136:139], v[80:83]
v_fmac_f32 v227, s56, v213
s_waitcnt vmcnt(15) lgkmcnt(1)
v_mfma_f32_16x16x32_bf16 v[80:83], a[220:223], a[140:143], v[80:83]
v_fmac_f32 v226, s55, v216
v_fmac_f32 v227, s55, v217
v_mfma_f32_16x16x32_bf16 v[76:79], a[216:219], a[140:143], v[76:79]
v_cvt_pk_bf16_f32 v241, v226, v227
v_cvt_pk_bf16_f32 v245, v232, v233
v_mfma_f32_16x16x32_bf16 v[76:79], a[208:211], a[136:139], v[76:79]
v_lshlrev_b32 v224, 16, v154
v_and_b32 v225, s50, v154
v_mfma_f32_16x16x32_bf16 v[76:79], a[200:203], a[132:135], v[76:79]
v_lshlrev_b32 v234, 16, v158
v_and_b32 v235, s50, v158
v_mfma_f32_16x16x32_bf16 v[76:79], a[192:195], a[128:131], v[76:79]
ds_read_b128 a[128:131], v15 offset:34048
v_fma_f32 v224, v224, s58, v220
v_mfma_f32_16x16x32_bf16 a[64:67], a[224:227], a[144:147], a[64:67]
ds_read_b128 a[132:135], v15 offset:34064
v_fma_f32 v225, v225, s58, v221
v_mfma_f32_16x16x32_bf16 a[64:67], a[232:235], a[148:151], a[64:67]
ds_read_b128 a[136:139], v15 offset:34560
v_fmac_f32 v224, s57, v234
v_mfma_f32_16x16x32_bf16 a[64:67], a[240:243], a[152:155], a[64:67]
v_fmac_f32 v225, s57, v235
s_waitcnt lgkmcnt(3)
v_mfma_f32_16x16x32_bf16 a[64:67], a[248:251], a[156:159], a[64:67]
buffer_load_dwordx4 a[192:195], v13, s[8:11], s16 offen offset:0 sc1
v_fmac_f32 v234, s58, v220
v_fmac_f32 v235, s58, v221
v_mfma_f32_16x16x32_bf16 a[68:71], a[252:255], a[156:159], a[68:71]
v_cvt_pk_bf16_f32 v238, v220, v221
v_lshlrev_b32 v216, 16, v162
v_mfma_f32_16x16x32_bf16 a[68:71], a[244:247], a[152:155], a[68:71]
v_and_b32 v217, s50, v162
v_lshlrev_b32 v212, 16, v166
v_mfma_f32_16x16x32_bf16 a[68:71], a[236:239], a[148:151], a[68:71]
buffer_load_dwordx4 a[196:199], v14, s[8:11], s16 offen offset:0 sc1
v_mfma_f32_16x16x32_bf16 a[68:71], a[228:231], a[144:147], a[68:71]
v_and_b32 v213, s50, v166
v_fmac_f32 v224, s59, v216
v_mfma_f32_16x16x32_bf16 a[76:79], a[228:231], a[148:151], a[76:79]
v_fmac_f32 v225, s59, v217
v_fmac_f32 v234, s56, v216
v_mfma_f32_16x16x32_bf16 a[76:79], a[236:239], a[152:155], a[76:79]
ds_read_b128 a[140:143], v15 offset:34576
v_fmac_f32 v235, s56, v217
v_mfma_f32_16x16x32_bf16 a[76:79], a[244:247], a[156:159], a[76:79]
v_fmac_f32 v234, s55, v212
s_waitcnt lgkmcnt(1)
v_mfma_f32_16x16x32_bf16 a[76:79], a[252:255], a[128:131], a[76:79]
v_fmac_f32 v235, s55, v213
v_cvt_pk_bf16_f32 v242, v234, v235
v_mfma_f32_16x16x32_bf16 a[72:75], a[248:251], a[128:131], a[72:75]
v_cvt_pk_bf16_f32 v246, v224, v225
v_lshlrev_b32 v226, 16, v155
v_mfma_f32_16x16x32_bf16 a[72:75], a[240:243], a[156:159], a[72:75]
v_and_b32 v227, s50, v155
v_lshlrev_b32 v232, 16, v159
v_mfma_f32_16x16x32_bf16 a[72:75], a[232:235], a[152:155], a[72:75]
buffer_load_dwordx4 a[200:203], v13, s[8:11], s16 offen offset:1024 sc1
v_mfma_f32_16x16x32_bf16 a[72:75], a[224:227], a[148:151], a[72:75]
v_and_b32 v233, s50, v159
v_fma_f32 v226, v226, s58, v222
v_fma_f32 v227, v227, s58, v223
v_mfma_f32_16x16x32_bf16 a[80:83], a[224:227], a[152:155], a[80:83]
v_fmac_f32 v226, s57, v232
v_fmac_f32 v227, s57, v233
v_mfma_f32_16x16x32_bf16 a[80:83], a[232:235], a[156:159], a[80:83]
ds_read_b128 a[144:147], v15 offset:33056
v_fmac_f32 v232, s58, v222
v_mfma_f32_16x16x32_bf16 a[80:83], a[240:243], a[128:131], a[80:83]
v_fmac_f32 v233, s58, v223
v_cvt_pk_bf16_f32 v239, v222, v223
v_mfma_f32_16x16x32_bf16 a[80:83], a[248:251], a[132:135], a[80:83]
v_lshlrev_b32 v220, 16, v163
v_and_b32 v221, s50, v163
v_mfma_f32_16x16x32_bf16 a[84:87], a[252:255], a[132:135], a[84:87]
v_lshlrev_b32 v212, 16, v167
v_and_b32 v213, s50, v167
v_mfma_f32_16x16x32_bf16 a[84:87], a[244:247], a[128:131], a[84:87]
v_fmac_f32 v226, s59, v220
v_fmac_f32 v227, s59, v221
v_mfma_f32_16x16x32_bf16 a[84:87], a[236:239], a[156:159], a[84:87]
buffer_load_dwordx4 a[204:207], v14, s[8:11], s16 offen offset:1024 sc1
v_mfma_f32_16x16x32_bf16 a[84:87], a[228:231], a[152:155], a[84:87]
v_fmac_f32 v232, s56, v220
v_fmac_f32 v233, s56, v221
v_mfma_f32_16x16x32_bf16 a[92:95], a[228:231], a[156:159], a[92:95]
v_fmac_f32 v232, s55, v212
v_fmac_f32 v233, s55, v213
v_mfma_f32_16x16x32_bf16 a[92:95], a[236:239], a[128:131], a[92:95]
ds_read_b128 a[148:151], v15 offset:33072
v_cvt_pk_bf16_f32 v243, v232, v233
v_mfma_f32_16x16x32_bf16 a[92:95], a[244:247], a[132:135], a[92:95]
v_cvt_pk_bf16_f32 v247, v226, v227
s_add_u32 s36, s3, 49152
v_mfma_f32_16x16x32_bf16 a[92:95], a[252:255], a[136:139], a[92:95]
buffer_store_dwordx4 v[236:239], v12, s[8:11], s36 offen sc1
v_lshlrev_b32 v216, 16, v168
v_mfma_f32_16x16x32_bf16 a[88:91], a[248:251], a[136:139], a[88:91]
s_add_u32 s36, s3, 114688
v_and_b32 v217, s50, v168
v_mfma_f32_16x16x32_bf16 a[88:91], a[240:243], a[132:135], a[88:91]
s_waitcnt vmcnt(19) lgkmcnt(1)
v_lshlrev_b32 v234, 16, v172
v_mfma_f32_16x16x32_bf16 a[88:91], a[232:235], a[128:131], a[88:91]
buffer_load_dwordx4 a[208:211], v13, s[8:11], s16 offen offset:2048 sc1
v_mfma_f32_16x16x32_bf16 a[88:91], a[224:227], a[156:159], a[88:91]
v_and_b32 v235, s50, v172
v_mfma_f32_16x16x32_bf16 a[96:99], a[224:227], a[128:131], a[96:99]
s_waitcnt vmcnt(18)
v_lshlrev_b32 v224, 16, v176
v_mfma_f32_16x16x32_bf16 a[96:99], a[232:235], a[132:135], a[96:99]
ds_read_b128 a[152:155], v15 offset:33568
v_and_b32 v225, s50, v176
v_mfma_f32_16x16x32_bf16 a[96:99], a[240:243], a[136:139], a[96:99]
s_waitcnt vmcnt(17) lgkmcnt(1)
v_lshlrev_b32 v222, 16, v180
v_mfma_f32_16x16x32_bf16 a[96:99], a[248:251], a[140:143], a[96:99]
v_and_b32 v223, s50, v180
v_fma_f32 v212, v224, s51, v222
v_fma_f32 v213, v225, s51, v223
v_fmac_f32 v224, s51, v234
v_mfma_f32_16x16x32_bf16 a[100:103], a[252:255], a[140:143], a[100:103]
v_fmac_f32 v225, s51, v235
v_fmac_f32 v234, s51, v216
v_mfma_f32_16x16x32_bf16 a[100:103], a[244:247], a[136:139], a[100:103]
v_fmac_f32 v235, s51, v217
v_fmac_f32 v216, s51, v218
v_mfma_f32_16x16x32_bf16 a[100:103], a[236:239], a[132:135], a[100:103]
ds_read_b128 a[156:159], v15 offset:41280
v_fmac_f32 v217, s51, v219
v_mfma_f32_16x16x32_bf16 a[100:103], a[228:231], a[128:131], a[100:103]
ds_read_b128 a[128:131], v15 offset:41296
v_fma_f32 v218, v216, s60, v224
v_fma_f32 v219, v217, s60, v225
v_fma_f32 v220, v234, s60, v212
v_mfma_f32_16x16x32_bf16 a[108:111], a[228:231], a[132:135], a[108:111]
buffer_load_dwordx4 a[212:215], v14, s[8:11], s16 offen offset:2048 sc1
v_mfma_f32_16x16x32_bf16 a[108:111], a[236:239], a[136:139], a[108:111]
v_fma_f32 v221, v235, s60, v213
v_fmac_f32 v224, s52, v216
v_mfma_f32_16x16x32_bf16 a[108:111], a[244:247], a[140:143], a[108:111]
v_fmac_f32 v225, s52, v217
v_fmac_f32 v212, s52, v234
v_mfma_f32_16x16x32_bf16 a[108:111], a[252:255], a[144:147], a[108:111]
v_fmac_f32 v213, s52, v235
v_fma_f32 v216, -v218, s53, v220
v_fma_f32 v217, -v219, s53, v221
v_mfma_f32_16x16x32_bf16 a[104:107], a[248:251], a[144:147], a[104:107]
v_fmac_f32 v220, s53, v218
v_fmac_f32 v221, s53, v219
v_mfma_f32_16x16x32_bf16 a[104:107], a[240:243], a[140:143], a[104:107]
v_fma_f32 v234, -v224, s54, v212
v_fma_f32 v235, -v225, s54, v213
v_mfma_f32_16x16x32_bf16 a[104:107], a[232:235], a[136:139], a[104:107]
buffer_load_dwordx4 a[216:219], v13, s[8:11], s16 offen offset:3072 sc1
v_mfma_f32_16x16x32_bf16 a[104:107], a[224:227], a[132:135], a[104:107]
ds_read_b128 a[132:135], v15 offset:41792
v_fmac_f32 v212, s54, v224
v_fmac_f32 v213, s54, v225
v_mfma_f32_16x16x32_bf16 a[112:115], a[224:227], a[136:139], a[112:115]
v_cvt_pk_bf16_f32 v196, v216, v217
v_cvt_pk_bf16_f32 v200, v220, v221
v_mfma_f32_16x16x32_bf16 a[112:115], a[232:235], a[140:143], a[112:115]
v_cvt_pk_bf16_f32 v204, v234, v235
v_cvt_pk_bf16_f32 v208, v212, v213
v_mfma_f32_16x16x32_bf16 a[112:115], a[240:243], a[144:147], a[112:115]
v_lshlrev_b32 v232, 16, v169
v_and_b32 v233, s50, v169
v_mfma_f32_16x16x32_bf16 a[112:115], a[248:251], a[148:151], a[112:115]
v_lshlrev_b32 v226, 16, v173
v_and_b32 v227, s50, v173
v_mfma_f32_16x16x32_bf16 a[116:119], a[252:255], a[148:151], a[116:119]
v_lshlrev_b32 v218, 16, v177
v_and_b32 v219, s50, v177
v_mfma_f32_16x16x32_bf16 a[116:119], a[244:247], a[144:147], a[116:119]
v_lshlrev_b32 v224, 16, v181
v_and_b32 v225, s50, v181
v_mfma_f32_16x16x32_bf16 a[116:119], a[236:239], a[140:143], a[116:119]
buffer_load_dwordx4 a[220:223], v14, s[8:11], s16 offen offset:3072 sc1
v_mfma_f32_16x16x32_bf16 a[116:119], a[228:231], a[136:139], a[116:119]
ds_read_b128 a[136:139], v15 offset:41808
s_add_u32 s16, s16, 4096
v_fma_f32 v216, v218, s51, v224
v_mfma_f32_16x16x32_bf16 a[124:127], a[228:231], a[140:143], a[124:127]
v_fma_f32 v217, v219, s51, v225
v_fmac_f32 v218, s51, v226
v_mfma_f32_16x16x32_bf16 a[124:127], a[236:239], a[144:147], a[124:127]
v_fmac_f32 v219, s51, v227
v_fmac_f32 v226, s51, v232
v_mfma_f32_16x16x32_bf16 a[124:127], a[244:247], a[148:151], a[124:127]
v_fmac_f32 v227, s51, v233
s_waitcnt vmcnt(15) lgkmcnt(1)
v_mfma_f32_16x16x32_bf16 a[124:127], a[252:255], a[152:155], a[124:127]
v_fmac_f32 v232, s51, v228
v_fmac_f32 v233, s51, v229
v_mfma_f32_16x16x32_bf16 a[120:123], a[248:251], a[152:155], a[120:123]
v_fma_f32 v228, v232, s60, v218
v_fma_f32 v229, v233, s60, v219
v_mfma_f32_16x16x32_bf16 a[120:123], a[240:243], a[148:151], a[120:123]
v_fma_f32 v220, v226, s60, v216
v_fma_f32 v221, v227, s60, v217
v_mfma_f32_16x16x32_bf16 a[120:123], a[232:235], a[144:147], a[120:123]
v_fmac_f32 v218, s52, v232
v_fmac_f32 v219, s52, v233
v_mfma_f32_16x16x32_bf16 a[120:123], a[224:227], a[140:143], a[120:123]
ds_read_b128 a[140:143], v15 offset:42304
v_fmac_f32 v216, s52, v226
v_mfma_f32_16x16x32_bf16 a[64:67], a[160:163], a[156:159], a[64:67]
ds_read_b128 a[144:147], v15 offset:42320
v_fmac_f32 v217, s52, v227
v_mfma_f32_16x16x32_bf16 a[64:67], a[168:171], a[128:131], a[64:67]
ds_read_b128 a[148:151], v15 offset:42816
v_fma_f32 v232, -v228, s53, v220
v_mfma_f32_16x16x32_bf16 a[64:67], a[176:179], a[132:135], a[64:67]
v_fma_f32 v233, -v229, s53, v221
s_waitcnt vmcnt(7) lgkmcnt(3)
v_mfma_f32_16x16x32_bf16 a[64:67], a[184:187], a[136:139], a[64:67]
buffer_load_dwordx4 a[224:227], v13, s[8:11], s16 offen offset:0 sc1
v_fmac_f32 v220, s53, v228
v_mfma_f32_16x16x32_bf16 a[68:71], a[188:191], a[136:139], a[68:71]
v_fmac_f32 v221, s53, v229
v_fma_f32 v226, -v218, s54, v216
v_mfma_f32_16x16x32_bf16 a[68:71], a[180:183], a[132:135], a[68:71]
v_fma_f32 v227, -v219, s54, v217
v_fmac_f32 v216, s54, v218
v_mfma_f32_16x16x32_bf16 a[68:71], a[172:175], a[128:131], a[68:71]
buffer_load_dwordx4 a[228:231], v14, s[8:11], s16 offen offset:0 sc1
v_mfma_f32_16x16x32_bf16 a[68:71], a[164:167], a[156:159], a[68:71]
v_fmac_f32 v217, s54, v219
v_cvt_pk_bf16_f32 v197, v232, v233
v_cvt_pk_bf16_f32 v201, v220, v221
v_mfma_f32_16x16x32_bf16 a[76:79], a[164:167], a[128:131], a[76:79]
v_cvt_pk_bf16_f32 v205, v226, v227
v_cvt_pk_bf16_f32 v209, v216, v217
v_mfma_f32_16x16x32_bf16 a[76:79], a[172:175], a[132:135], a[76:79]
ds_read_b128 a[152:155], v15 offset:42832
v_lshlrev_b32 v234, 16, v170
v_mfma_f32_16x16x32_bf16 a[76:79], a[180:183], a[136:139], a[76:79]
v_and_b32 v235, s50, v170
s_waitcnt vmcnt(8) lgkmcnt(1)
v_mfma_f32_16x16x32_bf16 a[76:79], a[188:191], a[140:143], a[76:79]
v_lshlrev_b32 v212, 16, v174
v_and_b32 v213, s50, v174
v_mfma_f32_16x16x32_bf16 a[72:75], a[184:187], a[140:143], a[72:75]
v_lshlrev_b32 v228, 16, v178
v_and_b32 v229, s50, v178
v_mfma_f32_16x16x32_bf16 a[72:75], a[176:179], a[136:139], a[72:75]
v_lshlrev_b32 v218, 16, v182
v_and_b32 v219, s50, v182
v_mfma_f32_16x16x32_bf16 a[72:75], a[168:171], a[132:135], a[72:75]
buffer_load_dwordx4 a[232:235], v13, s[8:11], s16 offen offset:1024 sc1
v_mfma_f32_16x16x32_bf16 a[72:75], a[160:163], a[128:131], a[72:75]
v_fma_f32 v232, v228, s51, v218
v_fma_f32 v233, v229, s51, v219
v_mfma_f32_16x16x32_bf16 a[80:83], a[160:163], a[132:135], a[80:83]
v_fmac_f32 v228, s51, v212
v_fmac_f32 v229, s51, v213
v_mfma_f32_16x16x32_bf16 a[80:83], a[168:171], a[136:139], a[80:83]
ds_read_b128 a[156:159], v15 offset:41312
v_fmac_f32 v212, s51, v234
v_mfma_f32_16x16x32_bf16 a[80:83], a[176:179], a[140:143], a[80:83]
v_fmac_f32 v213, s51, v235
v_fmac_f32 v234, s51, v214
v_mfma_f32_16x16x32_bf16 a[80:83], a[184:187], a[144:147], a[80:83]
v_fmac_f32 v235, s51, v215
v_fma_f32 v214, v234, s60, v228
v_mfma_f32_16x16x32_bf16 a[84:87], a[188:191], a[144:147], a[84:87]
v_fma_f32 v215, v235, s60, v229
v_fma_f32 v220, v212, s60, v232
v_mfma_f32_16x16x32_bf16 a[84:87], a[180:183], a[140:143], a[84:87]
v_fma_f32 v221, v213, s60, v233
v_fmac_f32 v228, s52, v234
v_mfma_f32_16x16x32_bf16 a[84:87], a[172:175], a[136:139], a[84:87]
buffer_load_dwordx4 a[236:239], v14, s[8:11], s16 offen offset:1024 sc1
v_mfma_f32_16x16x32_bf16 a[84:87], a[164:167], a[132:135], a[84:87]
buffer_store_dwordx4 v[240:243], v12, s[8:11], s36 offen sc1
v_fmac_f32 v229, s52, v235
v_fmac_f32 v232, s52, v212
v_mfma_f32_16x16x32_bf16 a[92:95], a[164:167], a[136:139], a[92:95]
s_add_u32 s36, s3, 180224
v_fmac_f32 v233, s52, v213
v_mfma_f32_16x16x32_bf16 a[92:95], a[172:175], a[140:143], a[92:95]
ds_read_b128 a[128:131], v15 offset:41328
v_fma_f32 v234, -v214, s53, v220
v_mfma_f32_16x16x32_bf16 a[92:95], a[180:183], a[144:147], a[92:95]
v_fma_f32 v235, -v215, s53, v221
v_fmac_f32 v220, s53, v214
v_mfma_f32_16x16x32_bf16 a[92:95], a[188:191], a[148:151], a[92:95]
v_fmac_f32 v221, s53, v215
v_fma_f32 v212, -v228, s54, v232
v_mfma_f32_16x16x32_bf16 a[88:91], a[184:187], a[148:151], a[88:91]
v_fma_f32 v213, -v229, s54, v233
v_fmac_f32 v232, s54, v228
v_mfma_f32_16x16x32_bf16 a[88:91], a[176:179], a[144:147], a[88:91]
v_fmac_f32 v233, s54, v229
v_cvt_pk_bf16_f32 v198, v234, v235
v_mfma_f32_16x16x32_bf16 a[88:91], a[168:171], a[140:143], a[88:91]
buffer_load_dwordx4 a[240:243], v13, s[8:11], s16 offen offset:2048 sc1
v_mfma_f32_16x16x32_bf16 a[88:91], a[160:163], a[136:139], a[88:91]
v_cvt_pk_bf16_f32 v202, v220, v221
v_cvt_pk_bf16_f32 v206, v212, v213
v_mfma_f32_16x16x32_bf16 a[96:99], a[160:163], a[140:143], a[96:99]
v_cvt_pk_bf16_f32 v210, v232, v233
v_lshlrev_b32 v226, 16, v171
v_mfma_f32_16x16x32_bf16 a[96:99], a[168:171], a[144:147], a[96:99]
ds_read_b128 a[132:135], v15 offset:41824
v_and_b32 v227, s50, v171
v_mfma_f32_16x16x32_bf16 a[96:99], a[176:179], a[148:151], a[96:99]
v_lshlrev_b32 v216, 16, v175
s_waitcnt vmcnt(11) lgkmcnt(1)
v_mfma_f32_16x16x32_bf16 a[96:99], a[184:187], a[152:155], a[96:99]
v_and_b32 v217, s50, v175
v_lshlrev_b32 v214, 16, v179
v_mfma_f32_16x16x32_bf16 a[100:103], a[188:191], a[152:155], a[100:103]
v_and_b32 v215, s50, v179
v_lshlrev_b32 v228, 16, v183
v_mfma_f32_16x16x32_bf16 a[100:103], a[180:183], a[148:151], a[100:103]
v_and_b32 v229, s50, v183
v_fma_f32 v234, v214, s51, v228
v_mfma_f32_16x16x32_bf16 a[100:103], a[172:175], a[144:147], a[100:103]
ds_read_b128 a[136:139], v15 offset:49536
v_fma_f32 v235, v215, s51, v229
v_mfma_f32_16x16x32_bf16 a[100:103], a[164:167], a[140:143], a[100:103]
ds_read_b128 a[140:143], v15 offset:49552
v_fmac_f32 v214, s51, v216
v_mfma_f32_16x16x32_bf16 a[108:111], a[164:167], a[144:147], a[108:111]
buffer_load_dwordx4 a[244:247], v14, s[8:11], s16 offen offset:2048 sc1
v_mfma_f32_16x16x32_bf16 a[108:111], a[172:175], a[148:151], a[108:111]
v_fmac_f32 v215, s51, v217
v_fmac_f32 v216, s51, v226
v_mfma_f32_16x16x32_bf16 a[108:111], a[180:183], a[152:155], a[108:111]
v_fmac_f32 v217, s51, v227
v_fmac_f32 v226, s51, v230
v_mfma_f32_16x16x32_bf16 a[108:111], a[188:191], a[156:159], a[108:111]
v_fmac_f32 v227, s51, v231
v_fma_f32 v230, v226, s60, v214
v_fma_f32 v231, v227, s60, v215
v_mfma_f32_16x16x32_bf16 a[104:107], a[184:187], a[156:159], a[104:107]
v_fma_f32 v220, v216, s60, v234
v_fma_f32 v221, v217, s60, v235
v_mfma_f32_16x16x32_bf16 a[104:107], a[176:179], a[152:155], a[104:107]
v_fmac_f32 v214, s52, v226
v_fmac_f32 v215, s52, v227
v_mfma_f32_16x16x32_bf16 a[104:107], a[168:171], a[148:151], a[104:107]
buffer_load_dwordx4 a[248:251], v13, s[8:11], s16 offen offset:3072 sc1
v_mfma_f32_16x16x32_bf16 a[104:107], a[160:163], a[144:147], a[104:107]
ds_read_b128 a[144:147], v15 offset:50048
v_fmac_f32 v234, s52, v216
v_fmac_f32 v235, s52, v217
v_mfma_f32_16x16x32_bf16 a[112:115], a[160:163], a[148:151], a[112:115]
v_fma_f32 v226, -v230, s53, v220
v_fma_f32 v227, -v231, s53, v221
v_mfma_f32_16x16x32_bf16 a[112:115], a[168:171], a[152:155], a[112:115]
v_fmac_f32 v220, s53, v230
v_fmac_f32 v221, s53, v231
v_mfma_f32_16x16x32_bf16 a[112:115], a[176:179], a[156:159], a[112:115]
v_fma_f32 v216, -v214, s54, v234
v_fma_f32 v217, -v215, s54, v235
v_mfma_f32_16x16x32_bf16 a[112:115], a[184:187], a[128:131], a[112:115]
v_fmac_f32 v234, s54, v214
v_fmac_f32 v235, s54, v215
v_mfma_f32_16x16x32_bf16 a[116:119], a[188:191], a[128:131], a[116:119]
v_cvt_pk_bf16_f32 v199, v226, v227
v_cvt_pk_bf16_f32 v203, v220, v221
v_mfma_f32_16x16x32_bf16 a[116:119], a[180:183], a[156:159], a[116:119]
v_cvt_pk_bf16_f32 v207, v216, v217
v_cvt_pk_bf16_f32 v211, v234, v235
v_mfma_f32_16x16x32_bf16 a[116:119], a[172:175], a[152:155], a[116:119]
buffer_load_dwordx4 a[252:255], v14, s[8:11], s16 offen offset:3072 sc1
v_mfma_f32_16x16x32_bf16 a[116:119], a[164:167], a[148:151], a[116:119]
ds_read_b128 a[148:151], v15 offset:50064
s_add_u32 s16, s16, 1052672
v_mfma_f32_16x16x32_bf16 a[124:127], a[164:167], a[152:155], a[124:127]
s_getpc_b64 s[46:47]
v_mfma_f32_16x16x32_bf16 a[124:127], a[172:175], a[156:159], a[124:127]
global_load_dword v252, v255, s[46:47] offset:2048
v_mfma_f32_16x16x32_bf16 a[124:127], a[180:183], a[128:131], a[124:127]
s_waitcnt lgkmcnt(1)
v_mfma_f32_16x16x32_bf16 a[124:127], a[188:191], a[132:135], a[124:127]
ds_write_b128 v8, v[196:199] offset:512
v_mfma_f32_16x16x32_bf16 a[120:123], a[184:187], a[132:135], a[120:123]
ds_write_b128 v8, v[200:203] offset:17024
v_mfma_f32_16x16x32_bf16 a[120:123], a[176:179], a[128:131], a[120:123]
ds_write_b128 v8, v[204:207] offset:33536
v_mfma_f32_16x16x32_bf16 a[120:123], a[168:171], a[156:159], a[120:123]
ds_write_b128 v8, v[208:211] offset:50048
v_mfma_f32_16x16x32_bf16 a[120:123], a[160:163], a[152:155], a[120:123]
ds_read_b128 a[152:155], v15 offset:50560
v_lshlrev_b32 v212, 16, v184
v_and_b32 v213, s50, v184
v_lshlrev_b32 v232, 16, v188
v_mfma_f32_16x16x32_bf16 v[84:87], a[192:195], a[136:139], v[84:87]
ds_read_b128 a[156:159], v15 offset:50576
v_and_b32 v233, s50, v188
v_mfma_f32_16x16x32_bf16 v[84:87], a[200:203], a[140:143], v[84:87]
ds_read_b128 a[128:131], v15 offset:51072
s_waitcnt vmcnt(8) lgkmcnt(7)
v_mfma_f32_16x16x32_bf16 v[84:87], a[208:211], a[144:147], v[84:87]
buffer_load_dwordx4 a[160:163], v13, s[8:11], s16 offen offset:0 sc1
v_mfma_f32_16x16x32_bf16 v[84:87], a[216:219], a[148:151], v[84:87]
v_lshlrev_b32 v230, 16, v192
v_and_b32 v231, s50, v192
v_lshlrev_b32 v214, 16, v148
v_and_b32 v215, s50, v148
v_mfma_f32_16x16x32_bf16 v[88:91], a[220:223], a[148:151], v[88:91]
v_fma_f32 v226, v230, s51, v214
v_fma_f32 v227, v231, s51, v215
v_mfma_f32_16x16x32_bf16 v[88:91], a[212:215], a[144:147], v[88:91]
v_fmac_f32 v230, s51, v232
v_fmac_f32 v231, s51, v233
v_mfma_f32_16x16x32_bf16 v[88:91], a[204:207], a[140:143], v[88:91]
buffer_load_dwordx4 a[164:167], v14, s[8:11], s16 offen offset:0 sc1
v_mfma_f32_16x16x32_bf16 v[88:91], a[196:199], a[136:139], v[88:91]
v_fmac_f32 v232, s51, v212
v_fmac_f32 v233, s51, v213
v_fmac_f32 v212, s51, v222
v_fmac_f32 v213, s51, v223
v_mfma_f32_16x16x32_bf16 v[96:99], a[196:199], a[140:143], v[96:99]
v_fma_f32 v222, v212, s60, v230
v_fma_f32 v223, v213, s60, v231
v_mfma_f32_16x16x32_bf16 v[96:99], a[204:207], a[144:147], v[96:99]
ds_read_b128 a[132:135], v15 offset:51088
v_fma_f32 v220, v232, s60, v226
v_mfma_f32_16x16x32_bf16 v[96:99], a[212:215], a[148:151], v[96:99]
v_fma_f32 v221, v233, s60, v227
s_waitcnt vmcnt(9) lgkmcnt(1)
v_mfma_f32_16x16x32_bf16 v[96:99], a[220:223], a[152:155], v[96:99]
v_fmac_f32 v230, s52, v212
v_fmac_f32 v231, s52, v213
v_fmac_f32 v226, s52, v232
v_mfma_f32_16x16x32_bf16 v[92:95], a[216:219], a[152:155], v[92:95]
v_fmac_f32 v227, s52, v233
v_fma_f32 v212, -v222, s53, v220
v_mfma_f32_16x16x32_bf16 v[92:95], a[208:211], a[148:151], v[92:95]
v_fma_f32 v213, -v223, s53, v221
v_fmac_f32 v220, s53, v222
v_mfma_f32_16x16x32_bf16 v[92:95], a[200:203], a[144:147], v[92:95]
buffer_load_dwordx4 a[168:171], v13, s[8:11], s16 offen offset:1024 sc1
v_mfma_f32_16x16x32_bf16 v[92:95], a[192:195], a[140:143], v[92:95]
v_fmac_f32 v221, s53, v223
v_fma_f32 v232, -v230, s54, v226
v_fma_f32 v233, -v231, s54, v227
v_mfma_f32_16x16x32_bf16 v[100:103], a[192:195], a[144:147], v[100:103]
v_fmac_f32 v226, s54, v230
v_fmac_f32 v227, s54, v231
v_mfma_f32_16x16x32_bf16 v[100:103], a[200:203], a[148:151], v[100:103]
ds_read_b128 a[136:139], v15 offset:49568
v_cvt_pk_bf16_f32 v196, v212, v213
v_mfma_f32_16x16x32_bf16 v[100:103], a[208:211], a[152:155], v[100:103]
v_cvt_pk_bf16_f32 v200, v220, v221
v_cvt_pk_bf16_f32 v204, v232, v233
v_mfma_f32_16x16x32_bf16 v[100:103], a[216:219], a[156:159], v[100:103]
buffer_store_dwordx4 v[244:247], v12, s[8:11], s36 offen sc1
v_cvt_pk_bf16_f32 v208, v226, v227
v_mfma_f32_16x16x32_bf16 v[104:107], a[220:223], a[156:159], v[104:107]
v_lshlrev_b32 v216, 16, v185
v_and_b32 v217, s50, v185
v_mfma_f32_16x16x32_bf16 v[104:107], a[212:215], a[152:155], v[104:107]
v_lshlrev_b32 v234, 16, v189
v_and_b32 v235, s50, v189
v_mfma_f32_16x16x32_bf16 v[104:107], a[204:207], a[148:151], v[104:107]
buffer_load_dwordx4 a[172:175], v14, s[8:11], s16 offen offset:1024 sc1
v_mfma_f32_16x16x32_bf16 v[104:107], a[196:199], a[144:147], v[104:107]
v_lshlrev_b32 v222, 16, v193
v_and_b32 v223, s50, v193
v_mfma_f32_16x16x32_bf16 v[112:115], a[196:199], a[148:151], v[112:115]
v_lshlrev_b32 v230, 16, v149
v_and_b32 v231, s50, v149
v_mfma_f32_16x16x32_bf16 v[112:115], a[204:207], a[152:155], v[112:115]
ds_read_b128 a[140:143], v15 offset:49584
v_fma_f32 v212, v222, s51, v230
v_mfma_f32_16x16x32_bf16 v[112:115], a[212:215], a[156:159], v[112:115]
v_fma_f32 v213, v223, s51, v231
v_fmac_f32 v222, s51, v234
v_mfma_f32_16x16x32_bf16 v[112:115], a[220:223], a[128:131], v[112:115]
v_fmac_f32 v223, s51, v235
v_fmac_f32 v234, s51, v216
v_mfma_f32_16x16x32_bf16 v[108:111], a[216:219], a[128:131], v[108:111]
v_fmac_f32 v235, s51, v217
v_fmac_f32 v216, s51, v224
v_mfma_f32_16x16x32_bf16 v[108:111], a[208:211], a[156:159], v[108:111]
v_fmac_f32 v217, s51, v225
v_fma_f32 v224, v216, s60, v222
v_mfma_f32_16x16x32_bf16 v[108:111], a[200:203], a[152:155], v[108:111]
buffer_load_dwordx4 a[176:179], v13, s[8:11], s16 offen offset:2048 sc1
v_mfma_f32_16x16x32_bf16 v[108:111], a[192:195], a[148:151], v[108:111]
v_fma_f32 v225, v217, s60, v223
v_fma_f32 v220, v234, s60, v212
v_mfma_f32_16x16x32_bf16 v[116:119], a[192:195], a[152:155], v[116:119]
v_fma_f32 v221, v235, s60, v213
v_fmac_f32 v222, s52, v216
v_mfma_f32_16x16x32_bf16 v[116:119], a[200:203], a[156:159], v[116:119]
ds_read_b128 a[144:147], v15 offset:50080
v_fmac_f32 v223, s52, v217
v_mfma_f32_16x16x32_bf16 v[116:119], a[208:211], a[128:131], v[116:119]
v_fmac_f32 v212, s52, v234
s_waitcnt vmcnt(12) lgkmcnt(1)
v_mfma_f32_16x16x32_bf16 v[116:119], a[216:219], a[132:135], v[116:119]
v_fmac_f32 v213, s52, v235
v_fma_f32 v216, -v224, s53, v220
v_mfma_f32_16x16x32_bf16 v[120:123], a[220:223], a[132:135], v[120:123]
v_fma_f32 v217, -v225, s53, v221
v_fmac_f32 v220, s53, v224
v_mfma_f32_16x16x32_bf16 v[120:123], a[212:215], a[128:131], v[120:123]
v_fmac_f32 v221, s53, v225
v_fma_f32 v234, -v222, s54, v212
v_mfma_f32_16x16x32_bf16 v[120:123], a[204:207], a[156:159], v[120:123]
ds_read_b128 a[148:151], v15 offset:57792
v_fma_f32 v235, -v223, s54, v213
v_mfma_f32_16x16x32_bf16 v[120:123], a[196:199], a[152:155], v[120:123]
ds_read_b128 a[152:155], v15 offset:57808
v_fmac_f32 v212, s54, v222
v_mfma_f32_16x16x32_bf16 v[128:131], a[196:199], a[156:159], v[128:131]
buffer_load_dwordx4 a[180:183], v14, s[8:11], s16 offen offset:2048 sc1
v_mfma_f32_16x16x32_bf16 v[128:131], a[204:207], a[128:131], v[128:131]
v_fmac_f32 v213, s54, v223
v_cvt_pk_bf16_f32 v197, v216, v217
v_mfma_f32_16x16x32_bf16 v[128:131], a[212:215], a[132:135], v[128:131]
v_cvt_pk_bf16_f32 v201, v220, v221
v_cvt_pk_bf16_f32 v205, v234, v235
v_mfma_f32_16x16x32_bf16 v[128:131], a[220:223], a[136:139], v[128:131]
v_cvt_pk_bf16_f32 v209, v212, v213
v_lshlrev_b32 v232, 16, v186
v_mfma_f32_16x16x32_bf16 v[124:127], a[216:219], a[136:139], v[124:127]
v_and_b32 v233, s50, v186
v_lshlrev_b32 v226, 16, v190
v_mfma_f32_16x16x32_bf16 v[124:127], a[208:211], a[132:135], v[124:127]
v_and_b32 v227, s50, v190
v_lshlrev_b32 v224, 16, v194
v_mfma_f32_16x16x32_bf16 v[124:127], a[200:203], a[128:131], v[124:127]
buffer_load_dwordx4 a[184:187], v13, s[8:11], s16 offen offset:3072 sc1
v_mfma_f32_16x16x32_bf16 v[124:127], a[192:195], a[156:159], v[124:127]
ds_read_b128 a[156:159], v15 offset:58304
v_and_b32 v225, s50, v194
v_lshlrev_b32 v222, 16, v150
v_mfma_f32_16x16x32_bf16 v[132:135], a[192:195], a[128:131], v[132:135]
v_and_b32 v223, s50, v150
v_fma_f32 v216, v224, s51, v222
v_mfma_f32_16x16x32_bf16 v[132:135], a[200:203], a[132:135], v[132:135]
v_fma_f32 v217, v225, s51, v223
v_fmac_f32 v224, s51, v226
v_mfma_f32_16x16x32_bf16 v[132:135], a[208:211], a[136:139], v[132:135]
v_fmac_f32 v225, s51, v227
v_fmac_f32 v226, s51, v232
v_mfma_f32_16x16x32_bf16 v[132:135], a[216:219], a[140:143], v[132:135]
v_fmac_f32 v227, s51, v233
v_fmac_f32 v232, s51, v218
v_mfma_f32_16x16x32_bf16 v[136:139], a[220:223], a[140:143], v[136:139]
v_fmac_f32 v233, s51, v219
v_fma_f32 v218, v232, s60, v224
v_mfma_f32_16x16x32_bf16 v[136:139], a[212:215], a[136:139], v[136:139]
v_fma_f32 v219, v233, s60, v225
v_fma_f32 v220, v226, s60, v216
v_mfma_f32_16x16x32_bf16 v[136:139], a[204:207], a[132:135], v[136:139]
buffer_load_dwordx4 a[188:191], v14, s[8:11], s16 offen offset:3072 sc1
v_mfma_f32_16x16x32_bf16 v[136:139], a[196:199], a[128:131], v[136:139]
ds_read_b128 a[128:131], v15 offset:58320
s_add_u32 s16, s16, 4096
v_fma_f32 v221, v227, s60, v217
v_mfma_f32_16x16x32_bf16 v[144:147], a[196:199], a[132:135], v[144:147]
v_fmac_f32 v224, s52, v232
v_fmac_f32 v225, s52, v233
v_mfma_f32_16x16x32_bf16 v[144:147], a[204:207], a[136:139], v[144:147]
v_fmac_f32 v216, s52, v226
v_fmac_f32 v217, s52, v227
v_mfma_f32_16x16x32_bf16 v[144:147], a[212:215], a[140:143], v[144:147]
v_fma_f32 v232, -v218, s53, v220
s_waitcnt lgkmcnt(1)
v_mfma_f32_16x16x32_bf16 v[144:147], a[220:223], a[144:147], v[144:147]
v_fma_f32 v233, -v219, s53, v221
v_fmac_f32 v220, s53, v218
v_mfma_f32_16x16x32_bf16 v[140:143], a[216:219], a[144:147], v[140:143]
v_fmac_f32 v221, s53, v219
v_fma_f32 v226, -v224, s54, v216
v_mfma_f32_16x16x32_bf16 v[140:143], a[208:211], a[140:143], v[140:143]
v_fma_f32 v227, -v225, s54, v217
v_fmac_f32 v216, s54, v224
v_mfma_f32_16x16x32_bf16 v[140:143], a[200:203], a[136:139], v[140:143]
v_fmac_f32 v217, s54, v225
v_cvt_pk_bf16_f32 v198, v232, v233
v_mfma_f32_16x16x32_bf16 v[140:143], a[192:195], a[132:135], v[140:143]
ds_read_b128 a[132:135], v15 offset:58816
v_cvt_pk_bf16_f32 v202, v220, v221
v_mfma_f32_16x16x32_bf16 v[84:87], a[224:227], a[148:151], v[84:87]
ds_read_b128 a[136:139], v15 offset:58832
v_cvt_pk_bf16_f32 v206, v226, v227
v_mfma_f32_16x16x32_bf16 v[84:87], a[232:235], a[152:155], v[84:87]
ds_read_b128 a[140:143], v15 offset:59328
s_waitcnt vmcnt(7) lgkmcnt(3)
v_mfma_f32_16x16x32_bf16 v[84:87], a[240:243], a[156:159], v[84:87]
buffer_load_dwordx4 a[192:195], v13, s[8:11], s16 offen offset:0 sc1
v_mfma_f32_16x16x32_bf16 v[84:87], a[248:251], a[128:131], v[84:87]
v_cvt_pk_bf16_f32 v210, v216, v217
v_lshlrev_b32 v234, 16, v187
v_and_b32 v235, s50, v187
v_lshlrev_b32 v212, 16, v191
v_mfma_f32_16x16x32_bf16 v[88:91], a[252:255], a[128:131], v[88:91]
v_and_b32 v213, s50, v191
v_lshlrev_b32 v218, 16, v195
v_mfma_f32_16x16x32_bf16 v[88:91], a[244:247], a[156:159], v[88:91]
v_and_b32 v219, s50, v195
v_lshlrev_b32 v224, 16, v151
v_mfma_f32_16x16x32_bf16 v[88:91], a[236:239], a[152:155], v[88:91]
buffer_load_dwordx4 a[196:199], v14, s[8:11], s16 offen offset:0 sc1
v_mfma_f32_16x16x32_bf16 v[88:91], a[228:231], a[148:151], v[88:91]
v_and_b32 v225, s50, v151
v_fma_f32 v232, v218, s51, v224
v_mfma_f32_16x16x32_bf16 v[96:99], a[228:231], a[152:155], v[96:99]
v_fma_f32 v233, v219, s51, v225
v_fmac_f32 v218, s51, v212
v_mfma_f32_16x16x32_bf16 v[96:99], a[236:239], a[156:159], v[96:99]
ds_read_b128 a[144:147], v15 offset:59344
v_fmac_f32 v219, s51, v213
v_mfma_f32_16x16x32_bf16 v[96:99], a[244:247], a[128:131], v[96:99]
v_fmac_f32 v212, s51, v234
s_waitcnt vmcnt(8) lgkmcnt(1)
v_mfma_f32_16x16x32_bf16 v[96:99], a[252:255], a[132:135], v[96:99]
v_fmac_f32 v213, s51, v235
v_fmac_f32 v234, s51, v228
v_mfma_f32_16x16x32_bf16 v[92:95], a[248:251], a[132:135], v[92:95]
v_fmac_f32 v235, s51, v229
v_fma_f32 v228, v234, s60, v218
v_mfma_f32_16x16x32_bf16 v[92:95], a[240:243], a[128:131], v[92:95]
v_fma_f32 v229, v235, s60, v219
v_fma_f32 v220, v212, s60, v232
v_mfma_f32_16x16x32_bf16 v[92:95], a[232:235], a[156:159], v[92:95]
buffer_load_dwordx4 a[200:203], v13, s[8:11], s16 offen offset:1024 sc1
v_mfma_f32_16x16x32_bf16 v[92:95], a[224:227], a[152:155], v[92:95]
v_fma_f32 v221, v213, s60, v233
v_fmac_f32 v218, s52, v234
v_mfma_f32_16x16x32_bf16 v[100:103], a[224:227], a[156:159], v[100:103]
v_fmac_f32 v219, s52, v235
v_fmac_f32 v232, s52, v212
v_mfma_f32_16x16x32_bf16 v[100:103], a[232:235], a[128:131], v[100:103]
ds_read_b128 a[148:151], v15 offset:57824
v_fmac_f32 v233, s52, v213
v_mfma_f32_16x16x32_bf16 v[100:103], a[240:243], a[132:135], v[100:103]
v_fma_f32 v234, -v228, s53, v220
v_fma_f32 v235, -v229, s53, v221
v_mfma_f32_16x16x32_bf16 v[100:103], a[248:251], a[136:139], v[100:103]
v_fmac_f32 v220, s53, v228
v_fmac_f32 v221, s53, v229
v_mfma_f32_16x16x32_bf16 v[104:107], a[252:255], a[136:139], v[104:107]
v_fma_f32 v212, -v218, s54, v232
v_fma_f32 v213, -v219, s54, v233
v_mfma_f32_16x16x32_bf16 v[104:107], a[244:247], a[132:135], v[104:107]
v_fmac_f32 v232, s54, v218
v_fmac_f32 v233, s54, v219
v_mfma_f32_16x16x32_bf16 v[104:107], a[236:239], a[128:131], v[104:107]
buffer_load_dwordx4 a[204:207], v14, s[8:11], s16 offen offset:1024 sc1
v_mfma_f32_16x16x32_bf16 v[104:107], a[228:231], a[156:159], v[104:107]
v_cvt_pk_bf16_f32 v199, v234, v235
v_cvt_pk_bf16_f32 v203, v220, v221
v_mfma_f32_16x16x32_bf16 v[112:115], a[228:231], a[128:131], v[112:115]
v_cvt_pk_bf16_f32 v207, v212, v213
v_cvt_pk_bf16_f32 v211, v232, v233
v_mfma_f32_16x16x32_bf16 v[112:115], a[236:239], a[132:135], v[112:115]
ds_read_b128 a[152:155], v15 offset:57840
v_mfma_f32_16x16x32_bf16 v[112:115], a[244:247], a[136:139], v[112:115]
ds_write_b128 v8, v[196:199] offset:528
v_mfma_f32_16x16x32_bf16 v[112:115], a[252:255], a[140:143], v[112:115]
ds_write_b128 v8, v[200:203] offset:17040
v_mfma_f32_16x16x32_bf16 v[108:111], a[248:251], a[140:143], v[108:111]
ds_write_b128 v8, v[204:207] offset:33552
v_mfma_f32_16x16x32_bf16 v[108:111], a[240:243], a[136:139], v[108:111]
ds_write_b128 v8, v[208:211] offset:50064
v_mfma_f32_16x16x32_bf16 v[108:111], a[232:235], a[132:135], v[108:111]
buffer_load_dwordx4 a[208:211], v13, s[8:11], s16 offen offset:2048 sc1
v_mfma_f32_16x16x32_bf16 v[108:111], a[224:227], a[128:131], v[108:111]
v_mfma_f32_16x16x32_bf16 v[116:119], a[224:227], a[132:135], v[116:119]
v_mfma_f32_16x16x32_bf16 v[116:119], a[232:235], a[136:139], v[116:119]
ds_read_b128 a[156:159], v15 offset:58336
v_mfma_f32_16x16x32_bf16 v[116:119], a[240:243], a[140:143], v[116:119]
s_waitcnt lgkmcnt(5)
v_mfma_f32_16x16x32_bf16 v[116:119], a[248:251], a[144:147], v[116:119]
v_mfma_f32_16x16x32_bf16 v[120:123], a[252:255], a[144:147], v[120:123]
v_mfma_f32_16x16x32_bf16 v[120:123], a[244:247], a[140:143], v[120:123]
v_mfma_f32_16x16x32_bf16 v[120:123], a[236:239], a[136:139], v[120:123]
buffer_load_dwordx4 a[212:215], v14, s[8:11], s16 offen offset:2048 sc1
v_mfma_f32_16x16x32_bf16 v[120:123], a[228:231], a[132:135], v[120:123]
v_mfma_f32_16x16x32_bf16 v[128:131], a[228:231], a[136:139], v[128:131]
s_waitcnt vmcnt(7) lgkmcnt(0)
s_barrier
v_mfma_f32_16x16x32_bf16 v[128:131], a[236:239], a[140:143], v[128:131]
ds_read_b128 a[128:131], v16 offset:0
v_mfma_f32_16x16x32_bf16 v[128:131], a[244:247], a[144:147], v[128:131]
ds_read_b128 a[132:135], v16 offset:16
v_mfma_f32_16x16x32_bf16 v[128:131], a[252:255], a[148:151], v[128:131]
s_or_b32 s36, s17, s19
s_cmp_eq_u32 s36, 0
s_cbranch_scc1 Lv_pub
Lv_pubr:
v_mfma_f32_16x16x32_bf16 v[124:127], a[248:251], a[148:151], v[124:127]
v_and_b32 v212, 15, v0
v_bfe_u32 v213, v0, 4, 2
v_mfma_f32_16x16x32_bf16 v[124:127], a[240:243], a[144:147], v[124:127]
v_lshrrev_b32 v214, 1, v212
v_xor_b32 v214, v214, v213
v_mfma_f32_16x16x32_bf16 v[124:127], a[232:235], a[140:143], v[124:127]
buffer_load_dwordx4 a[216:219], v13, s[8:11], s16 offen offset:3072 sc1
v_mfma_f32_16x16x32_bf16 v[124:127], a[224:227], a[136:139], v[124:127]
ds_read_b128 a[136:139], v16 offset:512
v_lshlrev_b32 v214, 4, v214
v_mfma_f32_16x16x32_bf16 v[132:135], a[224:227], a[140:143], v[132:135]
v_add_u32 v215, 1, v212
v_bfe_u32 v216, v215, 1, 3
v_mfma_f32_16x16x32_bf16 v[132:135], a[232:235], a[144:147], v[132:135]
v_xor_b32 v216, v216, v213
v_lshlrev_b32 v216, 4, v216
v_mfma_f32_16x16x32_bf16 v[132:135], a[240:243], a[148:151], v[132:135]
v_lshl_add_u32 v1, v212, 7, v214
v_xor_b32 v2, 64, v1
v_mfma_f32_16x16x32_bf16 v[132:135], a[248:251], a[152:155], v[132:135]
v_lshl_add_u32 v3, v215, 7, v216
v_xor_b32 v4, 64, v3
v_mfma_f32_16x16x32_bf16 v[136:139], a[252:255], a[152:155], v[136:139]
v_add_u32 v5, 0x10000, v1
v_add_u32 v6, 0x10000, v2
v_mfma_f32_16x16x32_bf16 v[136:139], a[244:247], a[148:151], v[136:139]
v_add_u32 v7, 0x10000, v3
v_add_u32 v8, 0x10000, v4
v_mfma_f32_16x16x32_bf16 v[136:139], a[236:239], a[144:147], v[136:139]
buffer_load_dwordx4 a[220:223], v14, s[8:11], s16 offen offset:3072 sc1
v_mfma_f32_16x16x32_bf16 v[136:139], a[228:231], a[140:143], v[136:139]
ds_read_b128 a[140:143], v16 offset:528
s_add_u32 s16, s16, 4096
v_mfma_f32_16x16x32_bf16 v[144:147], a[228:231], a[144:147], v[144:147]
v_mfma_f32_16x16x32_bf16 v[144:147], a[236:239], a[148:151], v[144:147]
v_mfma_f32_16x16x32_bf16 v[144:147], a[244:247], a[152:155], v[144:147]
v_mfma_f32_16x16x32_bf16 v[144:147], a[252:255], a[156:159], v[144:147]
v_mfma_f32_16x16x32_bf16 v[140:143], a[248:251], a[156:159], v[140:143]
v_mfma_f32_16x16x32_bf16 v[140:143], a[240:243], a[152:155], v[140:143]
v_mfma_f32_16x16x32_bf16 v[140:143], a[232:235], a[148:151], v[140:143]
v_mfma_f32_16x16x32_bf16 v[140:143], a[224:227], a[144:147], v[140:143]
ds_read_b128 a[144:147], v16 offset:1024
s_waitcnt vmcnt(6) lgkmcnt(2)
v_mfma_f32_16x16x32_bf16 a[0:3], a[160:163], a[128:131], a[0:3]
ds_read_b128 a[148:151], v16 offset:1040
v_mfma_f32_16x16x32_bf16 a[0:3], a[168:171], a[132:135], a[0:3]
ds_read_b128 a[152:155], v16 offset:1536
v_mfma_f32_16x16x32_bf16 a[0:3], a[176:179], a[136:139], a[0:3]
s_waitcnt lgkmcnt(3)
v_mfma_f32_16x16x32_bf16 a[0:3], a[184:187], a[140:143], a[0:3]
buffer_load_dwordx4 a[224:227], v13, s[8:11], s16 offen offset:0 sc1
v_mfma_f32_16x16x32_bf16 a[4:7], a[188:191], a[140:143], a[4:7]
v_mfma_f32_16x16x32_bf16 a[4:7], a[180:183], a[136:139], a[4:7]
v_mfma_f32_16x16x32_bf16 a[4:7], a[172:175], a[132:135], a[4:7]
buffer_load_dwordx4 a[228:231], v14, s[8:11], s16 offen offset:0 sc1
v_mfma_f32_16x16x32_bf16 a[4:7], a[164:167], a[128:131], a[4:7]
v_mfma_f32_16x16x32_bf16 a[12:15], a[164:167], a[132:135], a[12:15]
v_mfma_f32_16x16x32_bf16 a[12:15], a[172:175], a[136:139], a[12:15]
ds_read_b128 a[156:159], v16 offset:1552
v_mfma_f32_16x16x32_bf16 a[12:15], a[180:183], a[140:143], a[12:15]
s_waitcnt vmcnt(7) lgkmcnt(1)
v_mfma_f32_16x16x32_bf16 a[12:15], a[188:191], a[144:147], a[12:15]
v_mfma_f32_16x16x32_bf16 a[8:11], a[184:187], a[144:147], a[8:11]
v_mfma_f32_16x16x32_bf16 a[8:11], a[176:179], a[140:143], a[8:11]
v_mfma_f32_16x16x32_bf16 a[8:11], a[168:171], a[136:139], a[8:11]
buffer_load_dwordx4 a[232:235], v13, s[8:11], s16 offen offset:1024 sc1
v_mfma_f32_16x16x32_bf16 a[8:11], a[160:163], a[132:135], a[8:11]
v_mfma_f32_16x16x32_bf16 a[16:19], a[160:163], a[136:139], a[16:19]
v_mfma_f32_16x16x32_bf16 a[16:19], a[168:171], a[140:143], a[16:19]
ds_read_b128 a[128:131], v16 offset:32
v_mfma_f32_16x16x32_bf16 a[16:19], a[176:179], a[144:147], a[16:19]
v_mfma_f32_16x16x32_bf16 a[16:19], a[184:187], a[148:151], a[16:19]
v_mfma_f32_16x16x32_bf16 a[20:23], a[188:191], a[148:151], a[20:23]
v_mfma_f32_16x16x32_bf16 a[20:23], a[180:183], a[144:147], a[20:23]
v_mfma_f32_16x16x32_bf16 a[20:23], a[172:175], a[140:143], a[20:23]
buffer_load_dwordx4 a[236:239], v14, s[8:11], s16 offen offset:1024 sc1
v_mfma_f32_16x16x32_bf16 a[20:23], a[164:167], a[136:139], a[20:23]
v_mfma_f32_16x16x32_bf16 a[28:31], a[164:167], a[140:143], a[28:31]
v_mfma_f32_16x16x32_bf16 a[28:31], a[172:175], a[144:147], a[28:31]
ds_read_b128 a[132:135], v16 offset:48
v_mfma_f32_16x16x32_bf16 a[28:31], a[180:183], a[148:151], a[28:31]
v_mfma_f32_16x16x32_bf16 a[28:31], a[188:191], a[152:155], a[28:31]
v_mfma_f32_16x16x32_bf16 a[24:27], a[184:187], a[152:155], a[24:27]
v_mfma_f32_16x16x32_bf16 a[24:27], a[176:179], a[148:151], a[24:27]
v_mfma_f32_16x16x32_bf16 a[24:27], a[168:171], a[144:147], a[24:27]
buffer_load_dwordx4 a[240:243], v13, s[8:11], s16 offen offset:2048 sc1
v_mfma_f32_16x16x32_bf16 a[24:27], a[160:163], a[140:143], a[24:27]
v_mfma_f32_16x16x32_bf16 a[32:35], a[160:163], a[144:147], a[32:35]
v_mfma_f32_16x16x32_bf16 a[32:35], a[168:171], a[148:151], a[32:35]
ds_read_b128 a[136:139], v16 offset:544
v_mfma_f32_16x16x32_bf16 a[32:35], a[176:179], a[152:155], a[32:35]
s_waitcnt vmcnt(7) lgkmcnt(1)
v_mfma_f32_16x16x32_bf16 a[32:35], a[184:187], a[156:159], a[32:35]
v_mfma_f32_16x16x32_bf16 a[36:39], a[188:191], a[156:159], a[36:39]
v_mfma_f32_16x16x32_bf16 a[36:39], a[180:183], a[152:155], a[36:39]
v_mfma_f32_16x16x32_bf16 a[36:39], a[172:175], a[148:151], a[36:39]
ds_read_b128 a[140:143], v16 offset:8256
v_mfma_f32_16x16x32_bf16 a[36:39], a[164:167], a[144:147], a[36:39]
ds_read_b128 a[144:147], v16 offset:8272
v_mfma_f32_16x16x32_bf16 a[44:47], a[164:167], a[148:151], a[44:47]
buffer_load_dwordx4 a[244:247], v14, s[8:11], s16 offen offset:2048 sc1
v_mfma_f32_16x16x32_bf16 a[44:47], a[172:175], a[152:155], a[44:47]
v_mfma_f32_16x16x32_bf16 a[44:47], a[180:183], a[156:159], a[44:47]
v_mfma_f32_16x16x32_bf16 a[44:47], a[188:191], a[128:131], a[44:47]
v_mfma_f32_16x16x32_bf16 a[40:43], a[184:187], a[128:131], a[40:43]
v_mfma_f32_16x16x32_bf16 a[40:43], a[176:179], a[156:159], a[40:43]
v_mfma_f32_16x16x32_bf16 a[40:43], a[168:171], a[152:155], a[40:43]
buffer_load_dwordx4 a[248:251], v13, s[8:11], s16 offen offset:3072 sc1
v_mfma_f32_16x16x32_bf16 a[40:43], a[160:163], a[148:151], a[40:43]
ds_read_b128 a[148:151], v16 offset:8768
v_mfma_f32_16x16x32_bf16 a[48:51], a[160:163], a[152:155], a[48:51]
v_mfma_f32_16x16x32_bf16 a[48:51], a[168:171], a[156:159], a[48:51]
v_mfma_f32_16x16x32_bf16 a[48:51], a[176:179], a[128:131], a[48:51]
v_mfma_f32_16x16x32_bf16 a[48:51], a[184:187], a[132:135], a[48:51]
v_mfma_f32_16x16x32_bf16 a[52:55], a[188:191], a[132:135], a[52:55]
v_mfma_f32_16x16x32_bf16 a[52:55], a[180:183], a[128:131], a[52:55]
v_mfma_f32_16x16x32_bf16 a[52:55], a[172:175], a[156:159], a[52:55]
buffer_load_dwordx4 a[252:255], v14, s[8:11], s16 offen offset:3072 sc1
v_mfma_f32_16x16x32_bf16 a[52:55], a[164:167], a[152:155], a[52:55]
ds_read_b128 a[152:155], v16 offset:8784
s_add_u32 s16, s16, 4096
v_mfma_f32_16x16x32_bf16 a[60:63], a[164:167], a[156:159], a[60:63]
v_mfma_f32_16x16x32_bf16 a[60:63], a[172:175], a[128:131], a[60:63]
v_mfma_f32_16x16x32_bf16 a[60:63], a[180:183], a[132:135], a[60:63]
s_waitcnt vmcnt(8) lgkmcnt(1)
v_mfma_f32_16x16x32_bf16 a[60:63], a[188:191], a[136:139], a[60:63]
v_mfma_f32_16x16x32_bf16 a[56:59], a[184:187], a[136:139], a[56:59]
v_mfma_f32_16x16x32_bf16 a[56:59], a[176:179], a[132:135], a[56:59]
v_mfma_f32_16x16x32_bf16 a[56:59], a[168:171], a[128:131], a[56:59]
v_mfma_f32_16x16x32_bf16 a[56:59], a[160:163], a[156:159], a[56:59]
ds_read_b128 a[156:159], v16 offset:9280
v_mfma_f32_16x16x32_bf16 a[0:3], a[192:195], a[140:143], a[0:3]
ds_read_b128 a[128:131], v16 offset:9296
v_mfma_f32_16x16x32_bf16 a[0:3], a[200:203], a[144:147], a[0:3]
ds_read_b128 a[132:135], v16 offset:9792
v_mfma_f32_16x16x32_bf16 a[0:3], a[208:211], a[148:151], a[0:3]
s_waitcnt vmcnt(6) lgkmcnt(3)
v_mfma_f32_16x16x32_bf16 a[0:3], a[216:219], a[152:155], a[0:3]
buffer_load_dwordx4 a[160:163], v13, s[8:11], s16 offen offset:0 sc1
v_mfma_f32_16x16x32_bf16 a[4:7], a[220:223], a[152:155], a[4:7]
v_mfma_f32_16x16x32_bf16 a[4:7], a[212:215], a[148:151], a[4:7]
v_mfma_f32_16x16x32_bf16 a[4:7], a[204:207], a[144:147], a[4:7]
buffer_load_dwordx4 a[164:167], v14, s[8:11], s16 offen offset:0 sc1
v_mfma_f32_16x16x32_bf16 a[4:7], a[196:199], a[140:143], a[4:7]
v_mfma_f32_16x16x32_bf16 a[12:15], a[196:199], a[144:147], a[12:15]
v_mfma_f32_16x16x32_bf16 a[12:15], a[204:207], a[148:151], a[12:15]
ds_read_b128 a[136:139], v16 offset:9808
v_mfma_f32_16x16x32_bf16 a[12:15], a[212:215], a[152:155], a[12:15]
s_waitcnt vmcnt(7) lgkmcnt(1)
v_mfma_f32_16x16x32_bf16 a[12:15], a[220:223], a[156:159], a[12:15]
v_mfma_f32_16x16x32_bf16 a[8:11], a[216:219], a[156:159], a[8:11]
v_mfma_f32_16x16x32_bf16 a[8:11], a[208:211], a[152:155], a[8:11]
v_mfma_f32_16x16x32_bf16 a[8:11], a[200:203], a[148:151], a[8:11]
buffer_load_dwordx4 a[168:171], v13, s[8:11], s16 offen offset:1024 sc1
v_mfma_f32_16x16x32_bf16 a[8:11], a[192:195], a[144:147], a[8:11]
v_mfma_f32_16x16x32_bf16 a[16:19], a[192:195], a[148:151], a[16:19]
v_mfma_f32_16x16x32_bf16 a[16:19], a[200:203], a[152:155], a[16:19]
ds_read_b128 a[140:143], v16 offset:8288
v_mfma_f32_16x16x32_bf16 a[16:19], a[208:211], a[156:159], a[16:19]
v_mfma_f32_16x16x32_bf16 a[16:19], a[216:219], a[128:131], a[16:19]
v_mfma_f32_16x16x32_bf16 a[20:23], a[220:223], a[128:131], a[20:23]
v_mfma_f32_16x16x32_bf16 a[20:23], a[212:215], a[156:159], a[20:23]
v_mfma_f32_16x16x32_bf16 a[20:23], a[204:207], a[152:155], a[20:23]
buffer_load_dwordx4 a[172:175], v14, s[8:11], s16 offen offset:1024 sc1
v_mfma_f32_16x16x32_bf16 a[20:23], a[196:199], a[148:151], a[20:23]
v_mfma_f32_16x16x32_bf16 a[28:31], a[196:199], a[152:155], a[28:31]
v_mfma_f32_16x16x32_bf16 a[28:31], a[204:207], a[156:159], a[28:31]
ds_read_b128 a[144:147], v16 offset:8304
v_mfma_f32_16x16x32_bf16 a[28:31], a[212:215], a[128:131], a[28:31]
v_mfma_f32_16x16x32_bf16 a[28:31], a[220:223], a[132:135], a[28:31]
v_mfma_f32_16x16x32_bf16 a[24:27], a[216:219], a[132:135], a[24:27]
v_mfma_f32_16x16x32_bf16 a[24:27], a[208:211], a[128:131], a[24:27]
v_mfma_f32_16x16x32_bf16 a[24:27], a[200:203], a[156:159], a[24:27]
buffer_load_dwordx4 a[176:179], v13, s[8:11], s16 offen offset:2048 sc1
v_mfma_f32_16x16x32_bf16 a[24:27], a[192:195], a[152:155], a[24:27]
v_mfma_f32_16x16x32_bf16 a[32:35], a[192:195], a[156:159], a[32:35]
v_mfma_f32_16x16x32_bf16 a[32:35], a[200:203], a[128:131], a[32:35]
ds_read_b128 a[148:151], v16 offset:8800
v_mfma_f32_16x16x32_bf16 a[32:35], a[208:211], a[132:135], a[32:35]
s_waitcnt vmcnt(7) lgkmcnt(1)
v_mfma_f32_16x16x32_bf16 a[32:35], a[216:219], a[136:139], a[32:35]
v_mfma_f32_16x16x32_bf16 a[36:39], a[220:223], a[136:139], a[36:39]
v_mfma_f32_16x16x32_bf16 a[36:39], a[212:215], a[132:135], a[36:39]
v_mfma_f32_16x16x32_bf16 a[36:39], a[204:207], a[128:131], a[36:39]
ds_read_b128 a[152:155], v16 offset:16512
v_mfma_f32_16x16x32_bf16 a[36:39], a[196:199], a[156:159], a[36:39]
ds_read_b128 a[156:159], v16 offset:16528
v_mfma_f32_16x16x32_bf16 a[44:47], a[196:199], a[128:131], a[44:47]
buffer_load_dwordx4 a[180:183], v14, s[8:11], s16 offen offset:2048 sc1
v_mfma_f32_16x16x32_bf16 a[44:47], a[204:207], a[132:135], a[44:47]
v_mfma_f32_16x16x32_bf16 a[44:47], a[212:215], a[136:139], a[44:47]
v_mfma_f32_16x16x32_bf16 a[44:47], a[220:223], a[140:143], a[44:47]
v_mfma_f32_16x16x32_bf16 a[40:43], a[216:219], a[140:143], a[40:43]
v_mfma_f32_16x16x32_bf16 a[40:43], a[208:211], a[136:139], a[40:43]
v_mfma_f32_16x16x32_bf16 a[40:43], a[200:203], a[132:135], a[40:43]
buffer_load_dwordx4 a[184:187], v13, s[8:11], s16 offen offset:3072 sc1
v_mfma_f32_16x16x32_bf16 a[40:43], a[192:195], a[128:131], a[40:43]
ds_read_b128 a[128:131], v16 offset:17024
v_mfma_f32_16x16x32_bf16 a[48:51], a[192:195], a[132:135], a[48:51]
v_mfma_f32_16x16x32_bf16 a[48:51], a[200:203], a[136:139], a[48:51]
v_mfma_f32_16x16x32_bf16 a[48:51], a[208:211], a[140:143], a[48:51]
s_getpc_b64 s[46:47]
v_mfma_f32_16x16x32_bf16 a[48:51], a[216:219], a[144:147], a[48:51]
global_load_dword v252, v255, s[46:47] offset:2048
v_mfma_f32_16x16x32_bf16 a[52:55], a[220:223], a[144:147], a[52:55]
v_mfma_f32_16x16x32_bf16 a[52:55], a[212:215], a[140:143], a[52:55]
v_mfma_f32_16x16x32_bf16 a[52:55], a[204:207], a[136:139], a[52:55]
buffer_load_dwordx4 a[188:191], v14, s[8:11], s16 offen offset:3072 sc1
v_mfma_f32_16x16x32_bf16 a[52:55], a[196:199], a[132:135], a[52:55]
ds_read_b128 a[132:135], v16 offset:17040
s_add_u32 s16, s16, 4096
v_mfma_f32_16x16x32_bf16 a[60:63], a[196:199], a[136:139], a[60:63]
v_mfma_f32_16x16x32_bf16 a[60:63], a[204:207], a[140:143], a[60:63]
v_mfma_f32_16x16x32_bf16 a[60:63], a[212:215], a[144:147], a[60:63]
s_waitcnt vmcnt(9) lgkmcnt(1)
v_mfma_f32_16x16x32_bf16 a[60:63], a[220:223], a[148:151], a[60:63]
v_mfma_f32_16x16x32_bf16 a[56:59], a[216:219], a[148:151], a[56:59]
v_mfma_f32_16x16x32_bf16 a[56:59], a[208:211], a[144:147], a[56:59]
v_mfma_f32_16x16x32_bf16 a[56:59], a[200:203], a[140:143], a[56:59]
buffer_load_dwordx2 v[218:219], v19, s[8:11], 0 offen sc1
v_mfma_f32_16x16x32_bf16 a[56:59], a[192:195], a[136:139], a[56:59]
ds_read_b128 a[136:139], v16 offset:17536
v_mfma_f32_16x16x32_bf16 v[20:23], a[224:227], a[152:155], v[20:23]
ds_read_b128 a[140:143], v16 offset:17552
v_mfma_f32_16x16x32_bf16 v[20:23], a[232:235], a[156:159], v[20:23]
ds_read_b128 a[144:147], v16 offset:18048
v_mfma_f32_16x16x32_bf16 v[20:23], a[240:243], a[128:131], v[20:23]
s_waitcnt vmcnt(8) lgkmcnt(3)
v_mfma_f32_16x16x32_bf16 v[20:23], a[248:251], a[132:135], v[20:23]
buffer_load_dwordx4 a[192:195], v13, s[8:11], s16 offen offset:0 sc1
v_mfma_f32_16x16x32_bf16 v[24:27], a[252:255], a[132:135], v[24:27]
v_mfma_f32_16x16x32_bf16 v[24:27], a[244:247], a[128:131], v[24:27]
v_mfma_f32_16x16x32_bf16 v[24:27], a[236:239], a[156:159], v[24:27]
buffer_load_dwordx4 a[196:199], v14, s[8:11], s16 offen offset:0 sc1
v_mfma_f32_16x16x32_bf16 v[24:27], a[228:231], a[152:155], v[24:27]
v_mfma_f32_16x16x32_bf16 v[32:35], a[228:231], a[156:159], v[32:35]
v_mfma_f32_16x16x32_bf16 v[32:35], a[236:239], a[128:131], v[32:35]
ds_read_b128 a[148:151], v16 offset:18064
v_mfma_f32_16x16x32_bf16 v[32:35], a[244:247], a[132:135], v[32:35]
s_waitcnt vmcnt(9) lgkmcnt(1)
v_mfma_f32_16x16x32_bf16 v[32:35], a[252:255], a[136:139], v[32:35]
v_mfma_f32_16x16x32_bf16 v[28:31], a[248:251], a[136:139], v[28:31]
v_mfma_f32_16x16x32_bf16 v[28:31], a[240:243], a[132:135], v[28:31]
v_mfma_f32_16x16x32_bf16 v[28:31], a[232:235], a[128:131], v[28:31]
buffer_load_dwordx4 a[200:203], v13, s[8:11], s16 offen offset:1024 sc1
v_mfma_f32_16x16x32_bf16 v[28:31], a[224:227], a[156:159], v[28:31]
v_mfma_f32_16x16x32_bf16 v[36:39], a[224:227], a[128:131], v[36:39]
v_mfma_f32_16x16x32_bf16 v[36:39], a[232:235], a[132:135], v[36:39]
ds_read_b128 a[152:155], v16 offset:16544
v_mfma_f32_16x16x32_bf16 v[36:39], a[240:243], a[136:139], v[36:39]
v_mfma_f32_16x16x32_bf16 v[36:39], a[248:251], a[140:143], v[36:39]
v_mfma_f32_16x16x32_bf16 v[40:43], a[252:255], a[140:143], v[40:43]
v_mfma_f32_16x16x32_bf16 v[40:43], a[244:247], a[136:139], v[40:43]
v_mfma_f32_16x16x32_bf16 v[40:43], a[236:239], a[132:135], v[40:43]
buffer_load_dwordx4 a[204:207], v14, s[8:11], s16 offen offset:1024 sc1
v_mfma_f32_16x16x32_bf16 v[40:43], a[228:231], a[128:131], v[40:43]
v_mfma_f32_16x16x32_bf16 v[48:51], a[228:231], a[132:135], v[48:51]
v_mfma_f32_16x16x32_bf16 v[48:51], a[236:239], a[136:139], v[48:51]
ds_read_b128 a[156:159], v16 offset:16560
v_mfma_f32_16x16x32_bf16 v[48:51], a[244:247], a[140:143], v[48:51]
v_mfma_f32_16x16x32_bf16 v[48:51], a[252:255], a[144:147], v[48:51]
v_mfma_f32_16x16x32_bf16 v[44:47], a[248:251], a[144:147], v[44:47]
v_mfma_f32_16x16x32_bf16 v[44:47], a[240:243], a[140:143], v[44:47]
v_mfma_f32_16x16x32_bf16 v[44:47], a[232:235], a[136:139], v[44:47]
buffer_load_dwordx4 a[208:211], v13, s[8:11], s16 offen offset:2048 sc1
v_mfma_f32_16x16x32_bf16 v[44:47], a[224:227], a[132:135], v[44:47]
v_mfma_f32_16x16x32_bf16 v[52:55], a[224:227], a[136:139], v[52:55]
v_mfma_f32_16x16x32_bf16 v[52:55], a[232:235], a[140:143], v[52:55]
ds_read_b128 a[128:131], v16 offset:17056
v_mfma_f32_16x16x32_bf16 v[52:55], a[240:243], a[144:147], v[52:55]
s_waitcnt vmcnt(9) lgkmcnt(1)
v_mfma_f32_16x16x32_bf16 v[52:55], a[248:251], a[148:151], v[52:55]
v_mfma_f32_16x16x32_bf16 v[56:59], a[252:255], a[148:151], v[56:59]
v_mfma_f32_16x16x32_bf16 v[56:59], a[244:247], a[144:147], v[56:59]
v_mfma_f32_16x16x32_bf16 v[56:59], a[236:239], a[140:143], v[56:59]
ds_read_b128 a[132:135], v16 offset:24768
v_mfma_f32_16x16x32_bf16 v[56:59], a[228:231], a[136:139], v[56:59]
ds_read_b128 a[136:139], v16 offset:24784
v_mfma_f32_16x16x32_bf16 v[64:67], a[228:231], a[140:143], v[64:67]
buffer_load_dwordx4 a[212:215], v14, s[8:11], s16 offen offset:2048 sc1
v_mfma_f32_16x16x32_bf16 v[64:67], a[236:239], a[144:147], v[64:67]
v_mfma_f32_16x16x32_bf16 v[64:67], a[244:247], a[148:151], v[64:67]
v_mfma_f32_16x16x32_bf16 v[64:67], a[252:255], a[152:155], v[64:67]
v_mfma_f32_16x16x32_bf16 v[60:63], a[248:251], a[152:155], v[60:63]
v_mfma_f32_16x16x32_bf16 v[60:63], a[240:243], a[148:151], v[60:63]
v_mfma_f32_16x16x32_bf16 v[60:63], a[232:235], a[144:147], v[60:63]
buffer_load_dwordx4 a[216:219], v13, s[8:11], s16 offen offset:3072 sc1
v_mfma_f32_16x16x32_bf16 v[60:63], a[224:227], a[140:143], v[60:63]
ds_read_b128 a[140:143], v16 offset:25280
v_mfma_f32_16x16x32_bf16 v[68:71], a[224:227], a[144:147], v[68:71]
v_mfma_f32_16x16x32_bf16 v[68:71], a[232:235], a[148:151], v[68:71]
v_mfma_f32_16x16x32_bf16 v[68:71], a[240:243], a[152:155], v[68:71]
v_mfma_f32_16x16x32_bf16 v[68:71], a[248:251], a[156:159], v[68:71]
v_mfma_f32_16x16x32_bf16 v[72:75], a[252:255], a[156:159], v[72:75]
v_mfma_f32_16x16x32_bf16 v[72:75], a[244:247], a[152:155], v[72:75]
v_mfma_f32_16x16x32_bf16 v[72:75], a[236:239], a[148:151], v[72:75]
buffer_load_dwordx4 a[220:223], v14, s[8:11], s16 offen offset:3072 sc1
v_mfma_f32_16x16x32_bf16 v[72:75], a[228:231], a[144:147], v[72:75]
ds_read_b128 a[144:147], v16 offset:25296
s_add_u32 s16, s16, 4096
v_mfma_f32_16x16x32_bf16 v[80:83], a[228:231], a[148:151], v[80:83]
s_waitcnt vmcnt(8) lgkmcnt(1)
v_cmp_ne_u64 vcc, s[32:33], v[218:219]
v_mfma_f32_16x16x32_bf16 v[80:83], a[236:239], a[152:155], v[80:83]
v_mov_b32 v220, 132160
v_mfma_f32_16x16x32_bf16 v[80:83], a[244:247], a[156:159], v[80:83]
s_cmp_lg_u64 vcc, 0
s_cbranch_scc1 Lv_spin
Lv_spinr:
v_mfma_f32_16x16x32_bf16 v[80:83], a[252:255], a[128:131], v[80:83]
s_barrier
v_mfma_f32_16x16x32_bf16 v[76:79], a[248:251], a[128:131], v[76:79]
ds_read_b32 v218, v220
v_mfma_f32_16x16x32_bf16 v[76:79], a[240:243], a[156:159], v[76:79]
v_mfma_f32_16x16x32_bf16 v[76:79], a[232:235], a[152:155], v[76:79]
v_mfma_f32_16x16x32_bf16 v[76:79], a[224:227], a[148:151], v[76:79]
ds_read_b128 a[148:151], v16 offset:25792
v_mfma_f32_16x16x32_bf16 v[20:23], a[160:163], a[132:135], v[20:23]
ds_read_b128 a[152:155], v16 offset:25808
v_mfma_f32_16x16x32_bf16 v[20:23], a[168:171], a[136:139], v[20:23]
ds_read_b128 a[156:159], v16 offset:26304
v_mfma_f32_16x16x32_bf16 v[20:23], a[176:179], a[140:143], v[20:23]
s_waitcnt vmcnt(6) lgkmcnt(4)
v_mfma_f32_16x16x32_bf16 v[20:23], a[184:187], a[144:147], v[20:23]
buffer_load_dwordx4 a[224:227], v13, s[8:11], s16 offen offset:0 sc1
v_mfma_f32_16x16x32_bf16 v[24:27], a[188:191], a[144:147], v[24:27]
v_mfma_f32_16x16x32_bf16 v[24:27], a[180:183], a[140:143], v[24:27]
s_waitcnt lgkmcnt(3)
v_readfirstlane_b32 s36, v218
v_mfma_f32_16x16x32_bf16 v[24:27], a[172:175], a[136:139], v[24:27]
buffer_load_dwordx4 a[228:231], v14, s[8:11], s16 offen offset:0 sc1
v_mfma_f32_16x16x32_bf16 v[24:27], a[164:167], a[132:135], v[24:27]
s_cmp_lg_u32 s36, 0
s_cbranch_scc1 Lv_fall
Lv_fallr:
v_mfma_f32_16x16x32_bf16 v[32:35], a[164:167], a[136:139], v[32:35]
v_lshrrev_b32 v212, 5, v0
v_and_b32 v213, 7, v0
v_mfma_f32_16x16x32_bf16 v[32:35], a[172:175], a[140:143], v[32:35]
ds_read_b128 a[128:131], v16 offset:26320
v_xor_b32 v212, v212, v213
v_mfma_f32_16x16x32_bf16 v[32:35], a[180:183], a[144:147], v[32:35]
v_lshlrev_b32 v212, 4, v212
s_waitcnt vmcnt(7) lgkmcnt(1)
v_mfma_f32_16x16x32_bf16 v[32:35], a[188:191], a[148:151], v[32:35]
v_and_b32 v213, 15, v0
v_lshl_add_u32 v212, v213, 7, v212
v_mfma_f32_16x16x32_bf16 v[28:31], a[184:187], a[148:151], v[28:31]
v_bfe_u32 v213, v0, 4, 1
v_lshl_add_u32 v212, v213, 3, v212
v_mfma_f32_16x16x32_bf16 v[28:31], a[176:179], a[144:147], v[28:31]
v_add_u32 v9, 131072, v212
v_lshlrev_b32 v10, 4, v0
v_mfma_f32_16x16x32_bf16 v[28:31], a[168:171], a[140:143], v[28:31]
buffer_load_dwordx4 a[232:235], v13, s[8:11], s16 offen offset:1024 sc1
v_mfma_f32_16x16x32_bf16 v[28:31], a[160:163], a[136:139], v[28:31]
v_add_u32 v10, 131072, v10
v_accvgpr_read_b32 v236, a0
v_mfma_f32_16x16x32_bf16 v[36:39], a[160:163], a[140:143], v[36:39]
v_accvgpr_read_b32 v237, a1
v_add_f32 v238, v236, v20
v_mfma_f32_16x16x32_bf16 v[36:39], a[168:171], a[144:147], v[36:39]
ds_read_b128 a[132:135], v16 offset:24800
v_add_f32 v239, v237, v21
v_mfma_f32_16x16x32_bf16 v[36:39], a[176:179], a[148:151], v[36:39]
v_sub_f32 v20, v236, v20
v_sub_f32 v21, v237, v21
v_mfma_f32_16x16x32_bf16 v[36:39], a[184:187], a[152:155], v[36:39]
v_accvgpr_write_b32 a0, v238
v_accvgpr_write_b32 a1, v239
v_mfma_f32_16x16x32_bf16 v[40:43], a[188:191], a[152:155], v[40:43]
v_accvgpr_read_b32 v240, a2
v_accvgpr_read_b32 v241, a3
v_mfma_f32_16x16x32_bf16 v[40:43], a[180:183], a[148:151], v[40:43]
v_add_f32 v242, v240, v22
v_add_f32 v243, v241, v23
v_mfma_f32_16x16x32_bf16 v[40:43], a[172:175], a[144:147], v[40:43]
buffer_load_dwordx4 a[236:239], v14, s[8:11], s16 offen offset:1024 sc1
v_mfma_f32_16x16x32_bf16 v[40:43], a[164:167], a[140:143], v[40:43]
v_sub_f32 v22, v240, v22
v_sub_f32 v23, v241, v23
v_mfma_f32_16x16x32_bf16 v[48:51], a[164:167], a[144:147], v[48:51]
v_accvgpr_write_b32 a2, v242
v_accvgpr_write_b32 a3, v243
v_mfma_f32_16x16x32_bf16 v[48:51], a[172:175], a[148:151], v[48:51]
ds_read_b128 a[136:139], v16 offset:24816
v_accvgpr_read_b32 v244, a4
v_mfma_f32_16x16x32_bf16 v[48:51], a[180:183], a[152:155], v[48:51]
v_accvgpr_read_b32 v245, a5
v_add_f32 v246, v244, v24
v_mfma_f32_16x16x32_bf16 v[48:51], a[188:191], a[156:159], v[48:51]
v_add_f32 v247, v245, v25
v_sub_f32 v24, v244, v24
v_mfma_f32_16x16x32_bf16 v[44:47], a[184:187], a[156:159], v[44:47]
v_sub_f32 v25, v245, v25
v_accvgpr_write_b32 a4, v246
v_mfma_f32_16x16x32_bf16 v[44:47], a[176:179], a[152:155], v[44:47]
v_accvgpr_write_b32 a5, v247
v_accvgpr_read_b32 v236, a6
v_mfma_f32_16x16x32_bf16 v[44:47], a[168:171], a[148:151], v[44:47]
buffer_load_dwordx4 a[240:243], v13, s[8:11], s16 offen offset:2048 sc1
v_mfma_f32_16x16x32_bf16 v[44:47], a[160:163], a[144:147], v[44:47]
v_accvgpr_read_b32 v237, a7
v_add_f32 v238, v236, v26
v_mfma_f32_16x16x32_bf16 v[52:55], a[160:163], a[148:151], v[52:55]
v_add_f32 v239, v237, v27
v_sub_f32 v26, v236, v26
v_mfma_f32_16x16x32_bf16 v[52:55], a[168:171], a[152:155], v[52:55]
ds_read_b128 a[140:143], v16 offset:25312
v_sub_f32 v27, v237, v27
v_mfma_f32_16x16x32_bf16 v[52:55], a[176:179], a[156:159], v[52:55]
s_add_u32 m0, s49, 0
s_waitcnt vmcnt(7) lgkmcnt(1)
v_mfma_f32_16x16x32_bf16 v[52:55], a[184:187], a[128:131], v[52:55]
v_accvgpr_write_b32 a6, v238
v_accvgpr_write_b32 a7, v239
v_mfma_f32_16x16x32_bf16 v[56:59], a[188:191], a[128:131], v[56:59]
v_accvgpr_read_b32 v240, a8
v_accvgpr_read_b32 v241, a9
v_mfma_f32_16x16x32_bf16 v[56:59], a[180:183], a[156:159], v[56:59]
v_add_f32 v242, v240, v28
v_add_f32 v243, v241, v29
v_mfma_f32_16x16x32_bf16 v[56:59], a[172:175], a[152:155], v[56:59]
ds_read_b128 a[144:147], v16 offset:33024
v_sub_f32 v28, v240, v28
v_mfma_f32_16x16x32_bf16 v[56:59], a[164:167], a[148:151], v[56:59]
ds_read_b128 a[148:151], v16 offset:33040
v_sub_f32 v29, v241, v29
v_mfma_f32_16x16x32_bf16 v[64:67], a[164:167], a[152:155], v[64:67]
buffer_load_dwordx4 a[244:247], v14, s[8:11], s16 offen offset:2048 sc1
v_mfma_f32_16x16x32_bf16 v[64:67], a[172:175], a[156:159], v[64:67]
s_add_u32 s48, s3, 0
v_accvgpr_write_b32 a8, v242
v_mfma_f32_16x16x32_bf16 v[64:67], a[180:183], a[128:131], v[64:67]
v_accvgpr_write_b32 a9, v243
v_accvgpr_read_b32 v244, a10
v_mfma_f32_16x16x32_bf16 v[64:67], a[188:191], a[132:135], v[64:67]
v_accvgpr_read_b32 v245, a11
v_add_f32 v246, v244, v30
v_mfma_f32_16x16x32_bf16 v[60:63], a[184:187], a[132:135], v[60:63]
v_add_f32 v247, v245, v31
v_sub_f32 v30, v244, v30
v_mfma_f32_16x16x32_bf16 v[60:63], a[176:179], a[128:131], v[60:63]
v_sub_f32 v31, v245, v31
v_accvgpr_write_b32 a10, v246
v_mfma_f32_16x16x32_bf16 v[60:63], a[168:171], a[156:159], v[60:63]
buffer_load_dwordx4 a[248:251], v13, s[8:11], s16 offen offset:3072 sc1
v_mfma_f32_16x16x32_bf16 v[60:63], a[160:163], a[152:155], v[60:63]
ds_read_b128 a[152:155], v16 offset:33536
v_accvgpr_write_b32 a11, v247
v_mfma_f32_16x16x32_bf16 v[68:71], a[160:163], a[156:159], v[68:71]
v_accvgpr_read_b32 v236, a12
v_accvgpr_read_b32 v237, a13
v_mfma_f32_16x16x32_bf16 v[68:71], a[168:171], a[128:131], v[68:71]
buffer_load_dwordx4 v18, s[8:11], s48 offen offset:0 sc1 lds
v_mfma_f32_16x16x32_bf16 v[68:71], a[176:179], a[132:135], v[68:71]
v_add_f32 v238, v236, v32
v_add_f32 v239, v237, v33
v_mfma_f32_16x16x32_bf16 v[68:71], a[184:187], a[136:139], v[68:71]
v_sub_f32 v32, v236, v32
v_sub_f32 v33, v237, v33
v_mfma_f32_16x16x32_bf16 v[72:75], a[188:191], a[136:139], v[72:75]
v_accvgpr_write_b32 a12, v238
v_accvgpr_write_b32 a13, v239
v_mfma_f32_16x16x32_bf16 v[72:75], a[180:183], a[132:135], v[72:75]
v_accvgpr_read_b32 v240, a14
v_accvgpr_read_b32 v241, a15
v_mfma_f32_16x16x32_bf16 v[72:75], a[172:175], a[128:131], v[72:75]
buffer_load_dwordx4 a[252:255], v14, s[8:11], s16 offen offset:3072 sc1
v_mfma_f32_16x16x32_bf16 v[72:75], a[164:167], a[156:159], v[72:75]
ds_read_b128 a[156:159], v16 offset:33552
s_add_u32 s16, s16, 4096
v_mfma_f32_16x16x32_bf16 v[80:83], a[164:167], a[128:131], v[80:83]
v_add_f32 v242, v240, v34
v_add_f32 v243, v241, v35
v_mfma_f32_16x16x32_bf16 v[80:83], a[172:175], a[132:135], v[80:83]
buffer_load_dwordx4 v18, s[8:11], s48 offen offset:1024 sc1 lds
v_mfma_f32_16x16x32_bf16 v[80:83], a[180:183], a[136:139], v[80:83]
v_sub_f32 v34, v240, v34
s_waitcnt vmcnt(10) lgkmcnt(1)
v_mfma_f32_16x16x32_bf16 v[80:83], a[188:191], a[140:143], v[80:83]
v_sub_f32 v35, v241, v35
v_accvgpr_write_b32 a14, v242
v_mfma_f32_16x16x32_bf16 v[76:79], a[184:187], a[140:143], v[76:79]
v_accvgpr_write_b32 a15, v243
v_accvgpr_read_b32 v244, a16
v_mfma_f32_16x16x32_bf16 v[76:79], a[176:179], a[136:139], v[76:79]
v_accvgpr_read_b32 v245, a17
v_add_f32 v246, v244, v36
v_mfma_f32_16x16x32_bf16 v[76:79], a[168:171], a[132:135], v[76:79]
v_add_f32 v247, v245, v37
v_sub_f32 v36, v244, v36
v_mfma_f32_16x16x32_bf16 v[76:79], a[160:163], a[128:131], v[76:79]
ds_read_b128 a[128:131], v16 offset:34048
v_sub_f32 v37, v245, v37
v_mfma_f32_16x16x32_bf16 a[64:67], a[192:195], a[144:147], a[64:67]
ds_read_b128 a[132:135], v16 offset:34064
v_accvgpr_write_b32 a16, v246
v_mfma_f32_16x16x32_bf16 a[64:67], a[200:203], a[148:151], a[64:67]
ds_read_b128 a[136:139], v16 offset:34560
v_accvgpr_write_b32 a17, v247
v_mfma_f32_16x16x32_bf16 a[64:67], a[208:211], a[152:155], a[64:67]
v_accvgpr_read_b32 v236, a18
s_waitcnt vmcnt(8) lgkmcnt(3)
v_mfma_f32_16x16x32_bf16 a[64:67], a[216:219], a[156:159], a[64:67]
buffer_load_dwordx4 a[160:163], v13, s[8:11], s16 offen offset:0 sc1
v_mfma_f32_16x16x32_bf16 a[68:71], a[220:223], a[156:159], a[68:71]
buffer_load_dwordx4 v18, s[8:11], s48 offen offset:2048 sc1 lds
v_mfma_f32_16x16x32_bf16 a[68:71], a[212:215], a[152:155], a[68:71]
v_accvgpr_read_b32 v237, a19
v_add_f32 v238, v236, v38
v_mfma_f32_16x16x32_bf16 a[68:71], a[204:207], a[148:151], a[68:71]
buffer_load_dwordx4 a[164:167], v14, s[8:11], s16 offen offset:0 sc1
v_mfma_f32_16x16x32_bf16 a[68:71], a[196:199], a[144:147], a[68:71]
v_add_f32 v239, v237, v39
v_sub_f32 v38, v236, v38
v_mfma_f32_16x16x32_bf16 a[76:79], a[196:199], a[148:151], a[76:79]
buffer_load_dwordx4 v18, s[8:11], s48 offen offset:3072 sc1 lds
v_mfma_f32_16x16x32_bf16 a[76:79], a[204:207], a[152:155], a[76:79]
ds_read_b128 a[140:143], v16 offset:34576
v_sub_f32 v39, v237, v39
v_mfma_f32_16x16x32_bf16 a[76:79], a[212:215], a[156:159], a[76:79]
v_accvgpr_write_b32 a18, v238
s_waitcnt vmcnt(11) lgkmcnt(1)
v_mfma_f32_16x16x32_bf16 a[76:79], a[220:223], a[128:131], a[76:79]
v_accvgpr_write_b32 a19, v239
v_accvgpr_read_b32 v240, a20
v_mfma_f32_16x16x32_bf16 a[72:75], a[216:219], a[128:131], a[72:75]
v_accvgpr_read_b32 v241, a21
v_add_f32 v242, v240, v40
v_mfma_f32_16x16x32_bf16 a[72:75], a[208:211], a[156:159], a[72:75]
v_add_f32 v243, v241, v41
v_sub_f32 v40, v240, v40
v_mfma_f32_16x16x32_bf16 a[72:75], a[200:203], a[152:155], a[72:75]
buffer_load_dwordx4 a[168:171], v13, s[8:11], s16 offen offset:1024 sc1
v_mfma_f32_16x16x32_bf16 a[72:75], a[192:195], a[148:151], a[72:75]
v_sub_f32 v41, v241, v41
v_accvgpr_write_b32 a20, v242
v_mfma_f32_16x16x32_bf16 a[80:83], a[192:195], a[152:155], a[80:83]
s_add_u32 m0, s49, 16384
v_accvgpr_write_b32 a21, v243
v_mfma_f32_16x16x32_bf16 a[80:83], a[200:203], a[156:159], a[80:83]
ds_read_b128 a[144:147], v16 offset:33056
v_accvgpr_read_b32 v244, a22
v_mfma_f32_16x16x32_bf16 a[80:83], a[208:211], a[128:131], a[80:83]
v_accvgpr_read_b32 v245, a23
v_add_f32 v246, v244, v42
v_mfma_f32_16x16x32_bf16 a[80:83], a[216:219], a[132:135], a[80:83]
v_add_f32 v247, v245, v43
v_sub_f32 v42, v244, v42
v_mfma_f32_16x16x32_bf16 a[84:87], a[220:223], a[132:135], a[84:87]
v_sub_f32 v43, v245, v43
v_accvgpr_write_b32 a22, v246
v_mfma_f32_16x16x32_bf16 a[84:87], a[212:215], a[128:131], a[84:87]
v_accvgpr_write_b32 a23, v247
v_accvgpr_read_b32 v236, a24
v_mfma_f32_16x16x32_bf16 a[84:87], a[204:207], a[156:159], a[84:87]
buffer_load_dwordx4 a[172:175], v14, s[8:11], s16 offen offset:1024 sc1
v_mfma_f32_16x16x32_bf16 a[84:87], a[196:199], a[152:155], a[84:87]
v_accvgpr_read_b32 v237, a25
v_add_f32 v238, v236, v44
v_mfma_f32_16x16x32_bf16 a[92:95], a[196:199], a[156:159], a[92:95]
s_add_u32 s48, s3, 16384
v_add_f32 v239, v237, v45
v_mfma_f32_16x16x32_bf16 a[92:95], a[204:207], a[128:131], a[92:95]
ds_read_b128 a[148:151], v16 offset:33072
v_sub_f32 v44, v236, v44
v_mfma_f32_16x16x32_bf16 a[92:95], a[212:215], a[132:135], a[92:95]
v_sub_f32 v45, v237, v45
v_accvgpr_write_b32 a24, v238
v_mfma_f32_16x16x32_bf16 a[92:95], a[220:223], a[136:139], a[92:95]
v_accvgpr_write_b32 a25, v239
v_accvgpr_read_b32 v240, a26
v_mfma_f32_16x16x32_bf16 a[88:91], a[216:219], a[136:139], a[88:91]
v_accvgpr_read_b32 v241, a27
v_add_f32 v242, v240, v46
v_mfma_f32_16x16x32_bf16 a[88:91], a[208:211], a[132:135], a[88:91]
v_add_f32 v243, v241, v47
v_sub_f32 v46, v240, v46
v_mfma_f32_16x16x32_bf16 a[88:91], a[200:203], a[128:131], a[88:91]
buffer_load_dwordx4 a[176:179], v13, s[8:11], s16 offen offset:2048 sc1
v_mfma_f32_16x16x32_bf16 a[88:91], a[192:195], a[156:159], a[88:91]
v_sub_f32 v47, v241, v47
v_accvgpr_write_b32 a26, v242
v_mfma_f32_16x16x32_bf16 a[96:99], a[192:195], a[128:131], a[96:99]
buffer_load_dwordx4 v18, s[8:11], s48 offen offset:0 sc1 lds
v_mfma_f32_16x16x32_bf16 a[96:99], a[200:203], a[132:135], a[96:99]
ds_read_b128 a[152:155], v16 offset:33568
v_accvgpr_write_b32 a27, v243
v_mfma_f32_16x16x32_bf16 a[96:99], a[208:211], a[136:139], a[96:99]
v_accvgpr_read_b32 v244, a28
s_waitcnt vmcnt(12) lgkmcnt(1)
v_mfma_f32_16x16x32_bf16 a[96:99], a[216:219], a[140:143], a[96:99]
v_accvgpr_read_b32 v245, a29
v_add_f32 v246, v244, v48
v_mfma_f32_16x16x32_bf16 a[100:103], a[220:223], a[140:143], a[100:103]
v_add_f32 v247, v245, v49
v_sub_f32 v48, v244, v48
v_mfma_f32_16x16x32_bf16 a[100:103], a[212:215], a[136:139], a[100:103]
v_sub_f32 v49, v245, v49
v_accvgpr_write_b32 a28, v246
v_mfma_f32_16x16x32_bf16 a[100:103], a[204:207], a[132:135], a[100:103]
ds_read_b128 a[156:159], v16 offset:41280
v_accvgpr_write_b32 a29, v247
v_mfma_f32_16x16x32_bf16 a[100:103], a[196:199], a[128:131], a[100:103]
ds_read_b128 a[128:131], v16 offset:41296
v_accvgpr_read_b32 v236, a30
v_mfma_f32_16x16x32_bf16 a[108:111], a[196:199], a[132:135], a[108:111]
buffer_load_dwordx4 a[180:183], v14, s[8:11], s16 offen offset:2048 sc1
v_mfma_f32_16x16x32_bf16 a[108:111], a[204:207], a[136:139], a[108:111]
buffer_load_dwordx4 v18, s[8:11], s48 offen offset:1024 sc1 lds
v_mfma_f32_16x16x32_bf16 a[108:111], a[212:215], a[140:143], a[108:111]
v_accvgpr_read_b32 v237, a31
v_add_f32 v238, v236, v50
v_mfma_f32_16x16x32_bf16 a[108:111], a[220:223], a[144:147], a[108:111]
v_add_f32 v239, v237, v51
v_sub_f32 v50, v236, v50
v_mfma_f32_16x16x32_bf16 a[104:107], a[216:219], a[144:147], a[104:107]
v_sub_f32 v51, v237, v51
v_accvgpr_write_b32 a30, v238
v_mfma_f32_16x16x32_bf16 a[104:107], a[208:211], a[140:143], a[104:107]
v_accvgpr_write_b32 a31, v239
v_accvgpr_read_b32 v240, a32
v_mfma_f32_16x16x32_bf16 a[104:107], a[200:203], a[136:139], a[104:107]
buffer_load_dwordx4 a[184:187], v13, s[8:11], s16 offen offset:3072 sc1
v_mfma_f32_16x16x32_bf16 a[104:107], a[192:195], a[132:135], a[104:107]
ds_read_b128 a[132:135], v16 offset:41792
v_accvgpr_read_b32 v241, a33
v_mfma_f32_16x16x32_bf16 a[112:115], a[192:195], a[136:139], a[112:115]
buffer_load_dwordx4 v18, s[8:11], s48 offen offset:2048 sc1 lds
v_mfma_f32_16x16x32_bf16 a[112:115], a[200:203], a[140:143], a[112:115]
v_add_f32 v242, v240, v52
v_add_f32 v243, v241, v53
v_mfma_f32_16x16x32_bf16 a[112:115], a[208:211], a[144:147], a[112:115]
v_sub_f32 v52, v240, v52
v_sub_f32 v53, v241, v53
v_mfma_f32_16x16x32_bf16 a[112:115], a[216:219], a[148:151], a[112:115]
v_accvgpr_write_b32 a32, v242
v_accvgpr_write_b32 a33, v243
v_mfma_f32_16x16x32_bf16 a[116:119], a[220:223], a[148:151], a[116:119]
v_accvgpr_read_b32 v244, a34
v_accvgpr_read_b32 v245, a35
v_mfma_f32_16x16x32_bf16 a[116:119], a[212:215], a[144:147], a[116:119]
v_add_f32 v246, v244, v54
v_add_f32 v247, v245, v55
v_mfma_f32_16x16x32_bf16 a[116:119], a[204:207], a[140:143], a[116:119]
buffer_load_dwordx4 a[188:191], v14, s[8:11], s16 offen offset:3072 sc1
v_mfma_f32_16x16x32_bf16 a[116:119], a[196:199], a[136:139], a[116:119]
ds_read_b128 a[136:139], v16 offset:41808
s_add_u32 s16, s16, 4096
v_mfma_f32_16x16x32_bf16 a[124:127], a[196:199], a[140:143], a[124:127]
buffer_load_dwordx4 v18, s[8:11], s48 offen offset:3072 sc1 lds
v_mfma_f32_16x16x32_bf16 a[124:127], a[204:207], a[144:147], a[124:127]
v_sub_f32 v54, v244, v54
v_sub_f32 v55, v245, v55
v_mfma_f32_16x16x32_bf16 a[124:127], a[212:215], a[148:151], a[124:127]
v_accvgpr_write_b32 a34, v246
s_waitcnt vmcnt(14) lgkmcnt(1)
v_mfma_f32_16x16x32_bf16 a[124:127], a[220:223], a[152:155], a[124:127]
v_accvgpr_write_b32 a35, v247
v_accvgpr_read_b32 v236, a36
v_mfma_f32_16x16x32_bf16 a[120:123], a[216:219], a[152:155], a[120:123]
v_accvgpr_read_b32 v237, a37
v_add_f32 v238, v236, v56
v_mfma_f32_16x16x32_bf16 a[120:123], a[208:211], a[148:151], a[120:123]
v_add_f32 v239, v237, v57
v_sub_f32 v56, v236, v56
v_mfma_f32_16x16x32_bf16 a[120:123], a[200:203], a[144:147], a[120:123]
v_sub_f32 v57, v237, v57
v_accvgpr_write_b32 a36, v238
v_mfma_f32_16x16x32_bf16 a[120:123], a[192:195], a[140:143], a[120:123]
ds_read_b128 a[140:143], v16 offset:42304
s_add_u32 m0, s49, 32768
v_mfma_f32_16x16x32_bf16 a[64:67], a[224:227], a[156:159], a[64:67]
ds_read_b128 a[144:147], v16 offset:42320
v_accvgpr_write_b32 a37, v239
v_mfma_f32_16x16x32_bf16 a[64:67], a[232:235], a[128:131], a[64:67]
ds_read_b128 a[148:151], v16 offset:42816
v_accvgpr_read_b32 v240, a38
v_mfma_f32_16x16x32_bf16 a[64:67], a[240:243], a[132:135], a[64:67]
v_accvgpr_read_b32 v241, a39
s_waitcnt vmcnt(10) lgkmcnt(3)
v_mfma_f32_16x16x32_bf16 a[64:67], a[248:251], a[136:139], a[64:67]
buffer_load_dwordx4 a[192:195], v13, s[8:11], s16 offen offset:0 sc1
v_mfma_f32_16x16x32_bf16 a[68:71], a[252:255], a[136:139], a[68:71]
v_add_f32 v242, v240, v58
v_add_f32 v243, v241, v59
v_mfma_f32_16x16x32_bf16 a[68:71], a[244:247], a[132:135], a[68:71]
v_sub_f32 v58, v240, v58
v_sub_f32 v59, v241, v59
v_mfma_f32_16x16x32_bf16 a[68:71], a[236:239], a[128:131], a[68:71]
buffer_load_dwordx4 a[196:199], v14, s[8:11], s16 offen offset:0 sc1
v_mfma_f32_16x16x32_bf16 a[68:71], a[228:231], a[156:159], a[68:71]
s_add_u32 s48, s3, 32768
v_accvgpr_write_b32 a38, v242
v_mfma_f32_16x16x32_bf16 a[76:79], a[228:231], a[128:131], a[76:79]
v_accvgpr_write_b32 a39, v243
v_accvgpr_read_b32 v244, a40
v_mfma_f32_16x16x32_bf16 a[76:79], a[236:239], a[132:135], a[76:79]
ds_read_b128 a[152:155], v16 offset:42832
v_accvgpr_read_b32 v245, a41
v_mfma_f32_16x16x32_bf16 a[76:79], a[244:247], a[136:139], a[76:79]
v_add_f32 v246, v244, v60
s_waitcnt vmcnt(11) lgkmcnt(1)
v_mfma_f32_16x16x32_bf16 a[76:79], a[252:255], a[140:143], a[76:79]
v_add_f32 v247, v245, v61
v_sub_f32 v60, v244, v60
v_mfma_f32_16x16x32_bf16 a[72:75], a[248:251], a[140:143], a[72:75]
v_sub_f32 v61, v245, v61
v_accvgpr_write_b32 a40, v246
v_mfma_f32_16x16x32_bf16 a[72:75], a[240:243], a[136:139], a[72:75]
v_accvgpr_write_b32 a41, v247
v_accvgpr_read_b32 v236, a42
v_mfma_f32_16x16x32_bf16 a[72:75], a[232:235], a[132:135], a[72:75]
buffer_load_dwordx4 a[200:203], v13, s[8:11], s16 offen offset:1024 sc1
v_mfma_f32_16x16x32_bf16 a[72:75], a[224:227], a[128:131], a[72:75]
buffer_load_dwordx4 v18, s[8:11], s48 offen offset:0 sc1 lds
v_mfma_f32_16x16x32_bf16 a[80:83], a[224:227], a[132:135], a[80:83]
v_accvgpr_read_b32 v237, a43
v_add_f32 v238, v236, v62
v_mfma_f32_16x16x32_bf16 a[80:83], a[232:235], a[136:139], a[80:83]
ds_read_b128 a[156:159], v16 offset:41312
v_add_f32 v239, v237, v63
v_mfma_f32_16x16x32_bf16 a[80:83], a[240:243], a[140:143], a[80:83]
v_sub_f32 v62, v236, v62
v_sub_f32 v63, v237, v63
v_mfma_f32_16x16x32_bf16 a[80:83], a[248:251], a[144:147], a[80:83]
v_accvgpr_write_b32 a42, v238
v_accvgpr_write_b32 a43, v239
v_mfma_f32_16x16x32_bf16 a[84:87], a[252:255], a[144:147], a[84:87]
v_accvgpr_read_b32 v240, a44
v_accvgpr_read_b32 v241, a45
v_mfma_f32_16x16x32_bf16 a[84:87], a[244:247], a[140:143], a[84:87]
v_add_f32 v242, v240, v64
v_add_f32 v243, v241, v65
v_mfma_f32_16x16x32_bf16 a[84:87], a[236:239], a[136:139], a[84:87]
buffer_load_dwordx4 a[204:207], v14, s[8:11], s16 offen offset:1024 sc1
v_mfma_f32_16x16x32_bf16 a[84:87], a[228:231], a[132:135], a[84:87]
buffer_load_dwordx4 v18, s[8:11], s48 offen offset:1024 sc1 lds
v_mfma_f32_16x16x32_bf16 a[92:95], a[228:231], a[136:139], a[92:95]
v_sub_f32 v64, v240, v64
v_sub_f32 v65, v241, v65
v_mfma_f32_16x16x32_bf16 a[92:95], a[236:239], a[140:143], a[92:95]
ds_read_b128 a[128:131], v16 offset:41328
v_accvgpr_write_b32 a44, v242
v_mfma_f32_16x16x32_bf16 a[92:95], a[244:247], a[144:147], a[92:95]
v_accvgpr_write_b32 a45, v243
v_accvgpr_read_b32 v244, a46
v_mfma_f32_16x16x32_bf16 a[92:95], a[252:255], a[148:151], a[92:95]
v_accvgpr_read_b32 v245, a47
v_add_f32 v246, v244, v66
v_mfma_f32_16x16x32_bf16 a[88:91], a[248:251], a[148:151], a[88:91]
v_add_f32 v247, v245, v67
v_sub_f32 v66, v244, v66
v_mfma_f32_16x16x32_bf16 a[88:91], a[240:243], a[144:147], a[88:91]
v_sub_f32 v67, v245, v67
v_accvgpr_write_b32 a46, v246
v_mfma_f32_16x16x32_bf16 a[88:91], a[232:235], a[140:143], a[88:91]
buffer_load_dwordx4 a[208:211], v13, s[8:11], s16 offen offset:2048 sc1
v_mfma_f32_16x16x32_bf16 a[88:91], a[224:227], a[136:139], a[88:91]
buffer_load_dwordx4 v18, s[8:11], s48 offen offset:2048 sc1 lds
v_mfma_f32_16x16x32_bf16 a[96:99], a[224:227], a[140:143], a[96:99]
v_accvgpr_write_b32 a47, v247
v_accvgpr_read_b32 v236, a48
v_mfma_f32_16x16x32_bf16 a[96:99], a[232:235], a[144:147], a[96:99]
ds_read_b128 a[132:135], v16 offset:41824
v_accvgpr_read_b32 v237, a49
v_mfma_f32_16x16x32_bf16 a[96:99], a[240:243], a[148:151], a[96:99]
v_add_f32 v238, v236, v68
s_waitcnt vmcnt(12) lgkmcnt(1)
v_mfma_f32_16x16x32_bf16 a[96:99], a[248:251], a[152:155], a[96:99]
v_add_f32 v239, v237, v69
v_sub_f32 v68, v236, v68
v_mfma_f32_16x16x32_bf16 a[100:103], a[252:255], a[152:155], a[100:103]
v_sub_f32 v69, v237, v69
v_accvgpr_write_b32 a48, v238
v_mfma_f32_16x16x32_bf16 a[100:103], a[244:247], a[148:151], a[100:103]
buffer_load_dwordx4 v18, s[8:11], s48 offen offset:3072 sc1 lds
v_mfma_f32_16x16x32_bf16 a[100:103], a[236:239], a[144:147], a[100:103]
ds_read_b128 a[136:139], v16 offset:49536
v_accvgpr_write_b32 a49, v239
v_mfma_f32_16x16x32_bf16 a[100:103], a[228:231], a[140:143], a[100:103]
ds_read_b128 a[140:143], v16 offset:49552
v_accvgpr_read_b32 v240, a50
v_mfma_f32_16x16x32_bf16 a[108:111], a[228:231], a[144:147], a[108:111]
buffer_load_dwordx4 a[212:215], v14, s[8:11], s16 offen offset:2048 sc1
v_mfma_f32_16x16x32_bf16 a[108:111], a[236:239], a[148:151], a[108:111]
v_accvgpr_read_b32 v241, a51
v_add_f32 v242, v240, v70
v_mfma_f32_16x16x32_bf16 a[108:111], a[244:247], a[152:155], a[108:111]
v_add_f32 v243, v241, v71
v_sub_f32 v70, v240, v70
v_mfma_f32_16x16x32_bf16 a[108:111], a[252:255], a[156:159], a[108:111]
v_sub_f32 v71, v241, v71
v_accvgpr_write_b32 a50, v242
v_mfma_f32_16x16x32_bf16 a[104:107], a[248:251], a[156:159], a[104:107]
s_getpc_b64 s[46:47]
v_accvgpr_write_b32 a51, v243
v_mfma_f32_16x16x32_bf16 a[104:107], a[240:243], a[152:155], a[104:107]
s_add_u32 m0, s49, 49152
v_accvgpr_read_b32 v244, a52
v_mfma_f32_16x16x32_bf16 a[104:107], a[232:235], a[148:151], a[104:107]
buffer_load_dwordx4 a[216:219], v13, s[8:11], s16 offen offset:3072 sc1
v_mfma_f32_16x16x32_bf16 a[104:107], a[224:227], a[144:147], a[104:107]
ds_read_b128 a[144:147], v16 offset:50048
v_accvgpr_read_b32 v245, a53
v_mfma_f32_16x16x32_bf16 a[112:115], a[224:227], a[148:151], a[112:115]
global_load_dword v252, v255, s[46:47] offset:2048
v_mfma_f32_16x16x32_bf16 a[112:115], a[232:235], a[152:155], a[112:115]
v_add_f32 v246, v244, v72
v_add_f32 v247, v245, v73
v_mfma_f32_16x16x32_bf16 a[112:115], a[240:243], a[156:159], a[112:115]
v_sub_f32 v72, v244, v72
v_sub_f32 v73, v245, v73
v_mfma_f32_16x16x32_bf16 a[112:115], a[248:251], a[128:131], a[112:115]
v_accvgpr_write_b32 a52, v246
v_accvgpr_write_b32 a53, v247
v_mfma_f32_16x16x32_bf16 a[116:119], a[252:255], a[128:131], a[116:119]
v_accvgpr_read_b32 v236, a54
v_accvgpr_read_b32 v237, a55
v_mfma_f32_16x16x32_bf16 a[116:119], a[244:247], a[156:159], a[116:119]
s_add_u32 s48, s3, 49152
v_add_f32 v238, v236, v74
v_mfma_f32_16x16x32_bf16 a[116:119], a[236:239], a[152:155], a[116:119]
buffer_load_dwordx4 a[220:223], v14, s[8:11], s16 offen offset:3072 sc1
v_mfma_f32_16x16x32_bf16 a[116:119], a[228:231], a[148:151], a[116:119]
ds_read_b128 a[148:151], v16 offset:50064
s_add_u32 s16, s16, 1052672
v_mfma_f32_16x16x32_bf16 a[124:127], a[228:231], a[152:155], a[124:127]
v_add_f32 v239, v237, v75
v_sub_f32 v74, v236, v74
v_mfma_f32_16x16x32_bf16 a[124:127], a[236:239], a[156:159], a[124:127]
v_sub_f32 v75, v237, v75
v_accvgpr_write_b32 a54, v238
v_mfma_f32_16x16x32_bf16 a[124:127], a[244:247], a[128:131], a[124:127]
v_accvgpr_write_b32 a55, v239
s_waitcnt vmcnt(13) lgkmcnt(1)
v_mfma_f32_16x16x32_bf16 a[124:127], a[252:255], a[132:135], a[124:127]
v_accvgpr_read_b32 v240, a56
v_accvgpr_read_b32 v241, a57
v_mfma_f32_16x16x32_bf16 a[120:123], a[248:251], a[132:135], a[120:123]
v_add_f32 v242, v240, v76
v_add_f32 v243, v241, v77
v_mfma_f32_16x16x32_bf16 a[120:123], a[240:243], a[128:131], a[120:123]
buffer_load_dwordx4 v18, s[8:11], s48 offen offset:0 sc1 lds
v_mfma_f32_16x16x32_bf16 a[120:123], a[232:235], a[156:159], a[120:123]
v_sub_f32 v76, v240, v76
v_sub_f32 v77, v241, v77
v_mfma_f32_16x16x32_bf16 a[120:123], a[224:227], a[152:155], a[120:123]
ds_read_b128 a[152:155], v16 offset:50560
v_accvgpr_write_b32 a56, v242
v_mfma_f32_16x16x32_bf16 v[84:87], a[160:163], a[136:139], v[84:87]
ds_read_b128 a[156:159], v16 offset:50576
v_accvgpr_write_b32 a57, v243
v_mfma_f32_16x16x32_bf16 v[84:87], a[168:171], a[140:143], v[84:87]
ds_read_b128 a[128:131], v16 offset:51072
v_accvgpr_read_b32 v244, a58
v_mfma_f32_16x16x32_bf16 v[84:87], a[176:179], a[144:147], v[84:87]
v_accvgpr_read_b32 v245, a59
s_waitcnt vmcnt(12) lgkmcnt(3)
v_mfma_f32_16x16x32_bf16 v[84:87], a[184:187], a[148:151], v[84:87]
buffer_load_dwordx4 a[224:227], v13, s[8:11], s16 offen offset:0 sc1
v_mfma_f32_16x16x32_bf16 v[88:91], a[188:191], a[148:151], v[88:91]
buffer_load_dwordx4 v18, s[8:11], s48 offen offset:1024 sc1 lds
v_mfma_f32_16x16x32_bf16 v[88:91], a[180:183], a[144:147], v[88:91]
v_add_f32 v246, v244, v78
v_add_f32 v247, v245, v79
v_mfma_f32_16x16x32_bf16 v[88:91], a[172:175], a[140:143], v[88:91]
buffer_load_dwordx4 a[228:231], v14, s[8:11], s16 offen offset:0 sc1
v_mfma_f32_16x16x32_bf16 v[88:91], a[164:167], a[136:139], v[88:91]
v_sub_f32 v78, v244, v78
v_sub_f32 v79, v245, v79
v_mfma_f32_16x16x32_bf16 v[96:99], a[164:167], a[140:143], v[96:99]
v_accvgpr_write_b32 a58, v246
v_accvgpr_write_b32 a59, v247
v_mfma_f32_16x16x32_bf16 v[96:99], a[172:175], a[144:147], v[96:99]
ds_read_b128 a[132:135], v16 offset:51088
v_accvgpr_read_b32 v236, a60
v_mfma_f32_16x16x32_bf16 v[96:99], a[180:183], a[148:151], v[96:99]
v_accvgpr_read_b32 v237, a61
s_waitcnt vmcnt(13) lgkmcnt(1)
v_mfma_f32_16x16x32_bf16 v[96:99], a[188:191], a[152:155], v[96:99]
v_add_f32 v238, v236, v80
v_add_f32 v239, v237, v81
v_mfma_f32_16x16x32_bf16 v[92:95], a[184:187], a[152:155], v[92:95]
buffer_load_dwordx4 v18, s[8:11], s48 offen offset:2048 sc1 lds
v_mfma_f32_16x16x32_bf16 v[92:95], a[176:179], a[148:151], v[92:95]
v_sub_f32 v80, v236, v80
v_sub_f32 v81, v237, v81
v_mfma_f32_16x16x32_bf16 v[92:95], a[168:171], a[144:147], v[92:95]
buffer_load_dwordx4 a[232:235], v13, s[8:11], s16 offen offset:1024 sc1
v_mfma_f32_16x16x32_bf16 v[92:95], a[160:163], a[140:143], v[92:95]
v_accvgpr_write_b32 a60, v238
v_accvgpr_write_b32 a61, v239
v_mfma_f32_16x16x32_bf16 v[100:103], a[160:163], a[144:147], v[100:103]
v_accvgpr_read_b32 v240, a62
v_accvgpr_read_b32 v241, a63
v_mfma_f32_16x16x32_bf16 v[100:103], a[168:171], a[148:151], v[100:103]
ds_read_b128 a[136:139], v16 offset:49568
v_add_f32 v242, v240, v82
v_mfma_f32_16x16x32_bf16 v[100:103], a[176:179], a[152:155], v[100:103]
v_add_f32 v243, v241, v83
v_sub_f32 v82, v240, v82
v_mfma_f32_16x16x32_bf16 v[100:103], a[184:187], a[156:159], v[100:103]
v_sub_f32 v83, v241, v83
v_accvgpr_write_b32 a62, v242
v_mfma_f32_16x16x32_bf16 v[104:107], a[188:191], a[156:159], v[104:107]
buffer_load_dwordx4 v18, s[8:11], s48 offen offset:3072 sc1 lds
v_mfma_f32_16x16x32_bf16 v[104:107], a[180:183], a[152:155], v[104:107]
v_accvgpr_write_b32 a63, v243
v_mfma_f32_16x16x32_bf16 v[104:107], a[172:175], a[148:151], v[104:107]
buffer_load_dwordx4 a[236:239], v14, s[8:11], s16 offen offset:1024 sc1
v_mfma_f32_16x16x32_bf16 v[104:107], a[164:167], a[144:147], v[104:107]
v_mfma_f32_16x16x32_bf16 v[112:115], a[164:167], a[148:151], v[112:115]
v_mfma_f32_16x16x32_bf16 v[112:115], a[172:175], a[152:155], v[112:115]
ds_read_b128 a[140:143], v16 offset:49584
v_mfma_f32_16x16x32_bf16 v[112:115], a[180:183], a[156:159], v[112:115]
v_mfma_f32_16x16x32_bf16 v[112:115], a[188:191], a[128:131], v[112:115]
v_mfma_f32_16x16x32_bf16 v[108:111], a[184:187], a[128:131], v[108:111]
v_mfma_f32_16x16x32_bf16 v[108:111], a[176:179], a[156:159], v[108:111]
v_mfma_f32_16x16x32_bf16 v[108:111], a[168:171], a[152:155], v[108:111]
buffer_load_dwordx4 a[240:243], v13, s[8:11], s16 offen offset:2048 sc1
v_mfma_f32_16x16x32_bf16 v[108:111], a[160:163], a[148:151], v[108:111]
v_mfma_f32_16x16x32_bf16 v[116:119], a[160:163], a[152:155], v[116:119]
v_mfma_f32_16x16x32_bf16 v[116:119], a[168:171], a[156:159], v[116:119]
ds_read_b128 a[144:147], v16 offset:50080
v_mfma_f32_16x16x32_bf16 v[116:119], a[176:179], a[128:131], v[116:119]
s_waitcnt vmcnt(12) lgkmcnt(1)
v_mfma_f32_16x16x32_bf16 v[116:119], a[184:187], a[132:135], v[116:119]
v_mfma_f32_16x16x32_bf16 v[120:123], a[188:191], a[132:135], v[120:123]
v_mfma_f32_16x16x32_bf16 v[120:123], a[180:183], a[128:131], v[120:123]
v_mfma_f32_16x16x32_bf16 v[120:123], a[172:175], a[156:159], v[120:123]
ds_read_b128 a[148:151], v16 offset:57792
v_mfma_f32_16x16x32_bf16 v[120:123], a[164:167], a[152:155], v[120:123]
ds_read_b128 a[152:155], v16 offset:57808
v_mfma_f32_16x16x32_bf16 v[128:131], a[164:167], a[156:159], v[128:131]
buffer_load_dwordx4 a[244:247], v14, s[8:11], s16 offen offset:2048 sc1
v_mfma_f32_16x16x32_bf16 v[128:131], a[172:175], a[128:131], v[128:131]
v_mfma_f32_16x16x32_bf16 v[128:131], a[180:183], a[132:135], v[128:131]
v_mfma_f32_16x16x32_bf16 v[128:131], a[188:191], a[136:139], v[128:131]
v_mfma_f32_16x16x32_bf16 v[124:127], a[184:187], a[136:139], v[124:127]
v_mfma_f32_16x16x32_bf16 v[124:127], a[176:179], a[132:135], v[124:127]
v_mfma_f32_16x16x32_bf16 v[124:127], a[168:171], a[128:131], v[124:127]
buffer_load_dwordx4 a[248:251], v13, s[8:11], s16 offen offset:3072 sc1
v_mfma_f32_16x16x32_bf16 v[124:127], a[160:163], a[156:159], v[124:127]
ds_read_b128 a[156:159], v16 offset:58304
v_mfma_f32_16x16x32_bf16 v[132:135], a[160:163], a[128:131], v[132:135]
v_mfma_f32_16x16x32_bf16 v[132:135], a[168:171], a[132:135], v[132:135]
v_mfma_f32_16x16x32_bf16 v[132:135], a[176:179], a[136:139], v[132:135]
v_mfma_f32_16x16x32_bf16 v[132:135], a[184:187], a[140:143], v[132:135]
v_mfma_f32_16x16x32_bf16 v[136:139], a[188:191], a[140:143], v[136:139]
v_mfma_f32_16x16x32_bf16 v[136:139], a[180:183], a[136:139], v[136:139]
v_mfma_f32_16x16x32_bf16 v[136:139], a[172:175], a[132:135], v[136:139]
buffer_load_dwordx4 a[252:255], v14, s[8:11], s16 offen offset:3072 sc1
v_mfma_f32_16x16x32_bf16 v[136:139], a[164:167], a[128:131], v[136:139]
ds_read_b128 a[128:131], v16 offset:58320
s_add_u32 s16, s16, 4096
v_mfma_f32_16x16x32_bf16 v[144:147], a[164:167], a[132:135], v[144:147]
v_mfma_f32_16x16x32_bf16 v[144:147], a[172:175], a[136:139], v[144:147]
v_mfma_f32_16x16x32_bf16 v[144:147], a[180:183], a[140:143], v[144:147]
s_waitcnt vmcnt(11) lgkmcnt(1)
v_mfma_f32_16x16x32_bf16 v[144:147], a[188:191], a[144:147], v[144:147]
v_mfma_f32_16x16x32_bf16 v[140:143], a[184:187], a[144:147], v[140:143]
v_mfma_f32_16x16x32_bf16 v[140:143], a[176:179], a[140:143], v[140:143]
v_mfma_f32_16x16x32_bf16 v[140:143], a[168:171], a[136:139], v[140:143]
v_mfma_f32_16x16x32_bf16 v[140:143], a[160:163], a[132:135], v[140:143]
ds_read_b128 a[132:135], v16 offset:58816
v_mfma_f32_16x16x32_bf16 v[84:87], a[192:195], a[148:151], v[84:87]
ds_read_b128 a[136:139], v16 offset:58832
v_mfma_f32_16x16x32_bf16 v[84:87], a[200:203], a[152:155], v[84:87]
ds_read_b128 a[140:143], v16 offset:59328
v_mfma_f32_16x16x32_bf16 v[84:87], a[208:211], a[156:159], v[84:87]
s_waitcnt vmcnt(8) lgkmcnt(3)
v_mfma_f32_16x16x32_bf16 v[84:87], a[216:219], a[128:131], v[84:87]
buffer_load_dwordx4 a[160:163], v13, s[8:11], s16 offen offset:0 sc1
v_mfma_f32_16x16x32_bf16 v[88:91], a[220:223], a[128:131], v[88:91]
v_mfma_f32_16x16x32_bf16 v[88:91], a[212:215], a[156:159], v[88:91]
v_mfma_f32_16x16x32_bf16 v[88:91], a[204:207], a[152:155], v[88:91]
buffer_load_dwordx4 a[164:167], v14, s[8:11], s16 offen offset:0 sc1
v_mfma_f32_16x16x32_bf16 v[88:91], a[196:199], a[148:151], v[88:91]
v_mfma_f32_16x16x32_bf16 v[96:99], a[196:199], a[152:155], v[96:99]
v_mfma_f32_16x16x32_bf16 v[96:99], a[204:207], a[156:159], v[96:99]
ds_read_b128 a[144:147], v16 offset:59344
v_mfma_f32_16x16x32_bf16 v[96:99], a[212:215], a[128:131], v[96:99]
s_waitcnt vmcnt(8) lgkmcnt(1)
v_mfma_f32_16x16x32_bf16 v[96:99], a[220:223], a[132:135], v[96:99]
v_mfma_f32_16x16x32_bf16 v[92:95], a[216:219], a[132:135], v[92:95]
v_accvgpr_read_b32 v246, a64
v_accvgpr_read_b32 v247, a65
v_mfma_f32_16x16x32_bf16 v[92:95], a[208:211], a[128:131], v[92:95]
v_accvgpr_read_b32 v244, a0
v_accvgpr_read_b32 v245, a1
v_mfma_f32_16x16x32_bf16 v[92:95], a[200:203], a[156:159], v[92:95]
buffer_load_dwordx4 a[168:171], v13, s[8:11], s16 offen offset:1024 sc1
v_mfma_f32_16x16x32_bf16 v[92:95], a[192:195], a[152:155], v[92:95]
v_add_f32 v236, v246, v84
v_add_f32 v237, v247, v85
v_mfma_f32_16x16x32_bf16 v[100:103], a[192:195], a[156:159], v[100:103]
v_sub_f32 v246, v246, v84
v_sub_f32 v247, v247, v85
v_mfma_f32_16x16x32_bf16 v[100:103], a[200:203], a[128:131], v[100:103]
ds_read_b128 a[148:151], v16 offset:57824
v_mul_f32 v84, s61, v20
v_mfma_f32_16x16x32_bf16 v[100:103], a[208:211], a[132:135], v[100:103]
v_mul_f32 v85, s61, v21
v_fmac_f32 v20, s62, v246
v_mfma_f32_16x16x32_bf16 v[100:103], a[216:219], a[136:139], v[100:103]
v_fmac_f32 v21, s62, v247
v_fmac_f32 v84, s63, v246
v_mfma_f32_16x16x32_bf16 v[104:107], a[220:223], a[136:139], v[104:107]
v_fmac_f32 v85, s63, v247
v_mul_f32 v246, s64, v244
v_mfma_f32_16x16x32_bf16 v[104:107], a[212:215], a[132:135], v[104:107]
v_mul_f32 v247, s64, v245
v_fmac_f32 v246, s65, v236
v_mfma_f32_16x16x32_bf16 v[104:107], a[204:207], a[128:131], v[104:107]
buffer_load_dwordx4 a[172:175], v14, s[8:11], s16 offen offset:1024 sc1
v_mfma_f32_16x16x32_bf16 v[104:107], a[196:199], a[156:159], v[104:107]
v_fmac_f32 v247, s65, v237
v_fmac_f32 v236, s66, v244
v_mfma_f32_16x16x32_bf16 v[112:115], a[196:199], a[128:131], v[112:115]
v_fmac_f32 v237, s66, v245
v_accvgpr_write_b32 a64, v246
v_mfma_f32_16x16x32_bf16 v[112:115], a[204:207], a[132:135], v[112:115]
ds_read_b128 a[152:155], v16 offset:57840
v_accvgpr_write_b32 a65, v247
v_mfma_f32_16x16x32_bf16 v[112:115], a[212:215], a[136:139], v[112:115]
v_accvgpr_write_b32 a0, v236
v_accvgpr_write_b32 a1, v237
v_mfma_f32_16x16x32_bf16 v[112:115], a[220:223], a[140:143], v[112:115]
v_accvgpr_read_b32 v240, a66
v_accvgpr_read_b32 v241, a67
v_mfma_f32_16x16x32_bf16 v[108:111], a[216:219], a[140:143], v[108:111]
v_accvgpr_read_b32 v238, a2
v_accvgpr_read_b32 v239, a3
v_mfma_f32_16x16x32_bf16 v[108:111], a[208:211], a[136:139], v[108:111]
v_add_f32 v242, v240, v86
v_add_f32 v243, v241, v87
v_mfma_f32_16x16x32_bf16 v[108:111], a[200:203], a[132:135], v[108:111]
buffer_load_dwordx4 a[176:179], v13, s[8:11], s16 offen offset:2048 sc1
v_mfma_f32_16x16x32_bf16 v[108:111], a[192:195], a[128:131], v[108:111]
v_sub_f32 v240, v240, v86
v_sub_f32 v241, v241, v87
v_mfma_f32_16x16x32_bf16 v[116:119], a[192:195], a[132:135], v[116:119]
v_mul_f32 v86, s61, v22
v_mul_f32 v87, s61, v23
v_mfma_f32_16x16x32_bf16 v[116:119], a[200:203], a[136:139], v[116:119]
ds_read_b128 a[156:159], v16 offset:58336
v_fmac_f32 v22, s62, v240
v_mfma_f32_16x16x32_bf16 v[116:119], a[208:211], a[140:143], v[116:119]
v_fmac_f32 v23, s62, v241
s_waitcnt vmcnt(7) lgkmcnt(1)
v_mfma_f32_16x16x32_bf16 v[116:119], a[216:219], a[144:147], v[116:119]
v_fmac_f32 v86, s63, v240
v_fmac_f32 v87, s63, v241
v_mfma_f32_16x16x32_bf16 v[120:123], a[220:223], a[144:147], v[120:123]
v_mul_f32 v240, s64, v238
v_mul_f32 v241, s64, v239
v_mfma_f32_16x16x32_bf16 v[120:123], a[212:215], a[140:143], v[120:123]
v_fmac_f32 v240, s65, v242
v_fmac_f32 v241, s65, v243
v_mfma_f32_16x16x32_bf16 v[120:123], a[204:207], a[136:139], v[120:123]
buffer_load_dwordx4 a[180:183], v14, s[8:11], s16 offen offset:2048 sc1
v_mfma_f32_16x16x32_bf16 v[120:123], a[196:199], a[132:135], v[120:123]
v_fmac_f32 v242, s66, v238
v_fmac_f32 v243, s66, v239
v_mfma_f32_16x16x32_bf16 v[128:131], a[196:199], a[136:139], v[128:131]
s_waitcnt lgkmcnt(0)
s_barrier
v_mfma_f32_16x16x32_bf16 v[128:131], a[204:207], a[140:143], v[128:131]
ds_read_b128 a[128:131], v1 offset:0
v_accvgpr_write_b32 a66, v240
v_mfma_f32_16x16x32_bf16 v[128:131], a[212:215], a[144:147], v[128:131]
ds_read_b128 a[132:135], v1 offset:2048
v_accvgpr_write_b32 a67, v241
v_mfma_f32_16x16x32_bf16 v[128:131], a[220:223], a[148:151], v[128:131]
v_accvgpr_write_b32 a2, v242
v_accvgpr_write_b32 a3, v243
v_mfma_f32_16x16x32_bf16 v[124:127], a[216:219], a[148:151], v[124:127]
s_add_u32 m0, s49, 65536
v_accvgpr_read_b32 v246, a68
v_mfma_f32_16x16x32_bf16 v[124:127], a[208:211], a[144:147], v[124:127]
v_accvgpr_read_b32 v247, a69
v_accvgpr_read_b32 v244, a4
v_mfma_f32_16x16x32_bf16 v[124:127], a[200:203], a[140:143], v[124:127]
buffer_load_dwordx4 a[184:187], v13, s[8:11], s16 offen offset:3072 sc1
v_mfma_f32_16x16x32_bf16 v[124:127], a[192:195], a[136:139], v[124:127]
ds_read_b128 a[136:139], v1 offset:4096
v_accvgpr_read_b32 v245, a5
v_mfma_f32_16x16x32_bf16 v[132:135], a[192:195], a[140:143], v[132:135]
v_add_f32 v236, v246, v88
v_add_f32 v237, v247, v89
v_mfma_f32_16x16x32_bf16 v[132:135], a[200:203], a[144:147], v[132:135]
v_sub_f32 v246, v246, v88
v_sub_f32 v247, v247, v89
v_mfma_f32_16x16x32_bf16 v[132:135], a[208:211], a[148:151], v[132:135]
v_mul_f32 v88, s61, v24
v_mul_f32 v89, s61, v25
v_mfma_f32_16x16x32_bf16 v[132:135], a[216:219], a[152:155], v[132:135]
v_fmac_f32 v24, s62, v246
v_fmac_f32 v25, s62, v247
v_mfma_f32_16x16x32_bf16 v[136:139], a[220:223], a[152:155], v[136:139]
v_fmac_f32 v88, s63, v246
v_fmac_f32 v89, s63, v247
v_mfma_f32_16x16x32_bf16 v[136:139], a[212:215], a[148:151], v[136:139]
v_mul_f32 v246, s64, v244
v_mul_f32 v247, s64, v245
v_mfma_f32_16x16x32_bf16 v[136:139], a[204:207], a[144:147], v[136:139]
buffer_load_dwordx4 a[188:191], v14, s[8:11], s16 offen offset:3072 sc1
v_mfma_f32_16x16x32_bf16 v[136:139], a[196:199], a[140:143], v[136:139]
ds_read_b128 a[140:143], v1 offset:6144
s_add_u32 s16, s16, 4096
v_mfma_f32_16x16x32_bf16 v[144:147], a[196:199], a[144:147], v[144:147]
s_add_u32 s48, s3, 65536
v_fmac_f32 v246, s65, v236
v_mfma_f32_16x16x32_bf16 v[144:147], a[204:207], a[148:151], v[144:147]
v_fmac_f32 v247, s65, v237
v_fmac_f32 v236, s66, v244
v_mfma_f32_16x16x32_bf16 v[144:147], a[212:215], a[152:155], v[144:147]
v_fmac_f32 v237, s66, v245
v_accvgpr_write_b32 a68, v246
v_mfma_f32_16x16x32_bf16 v[144:147], a[220:223], a[156:159], v[144:147]
v_accvgpr_write_b32 a69, v247
v_accvgpr_write_b32 a4, v236
v_mfma_f32_16x16x32_bf16 v[140:143], a[216:219], a[156:159], v[140:143]
v_accvgpr_write_b32 a5, v237
v_accvgpr_read_b32 v240, a70
v_mfma_f32_16x16x32_bf16 v[140:143], a[208:211], a[152:155], v[140:143]
v_accvgpr_read_b32 v241, a71
v_accvgpr_read_b32 v238, a6
v_mfma_f32_16x16x32_bf16 v[140:143], a[200:203], a[148:151], v[140:143]
v_accvgpr_read_b32 v239, a7
v_add_f32 v242, v240, v90
v_mfma_f32_16x16x32_bf16 v[140:143], a[192:195], a[144:147], v[140:143]
ds_read_b128 a[144:147], v1 offset:8192
s_waitcnt vmcnt(6) lgkmcnt(2)
v_mfma_f32_16x16x32_bf16 v[148:151], a[224:227], a[128:131], 0
ds_read_b128 a[148:151], v1 offset:10240
v_add_f32 v243, v241, v91
v_mfma_f32_16x16x32_bf16 v[148:151], a[232:235], a[132:135], v[148:151]
ds_read_b128 a[152:155], v1 offset:12288
v_sub_f32 v240, v240, v90
v_mfma_f32_16x16x32_bf16 v[148:151], a[240:243], a[136:139], v[148:151]
v_sub_f32 v241, v241, v91
s_waitcnt lgkmcnt(3)
v_mfma_f32_16x16x32_bf16 v[148:151], a[248:251], a[140:143], v[148:151]
buffer_load_dwordx4 a[192:195], v13, s[8:11], s16 offen offset:0 sc1
v_mfma_f32_16x16x32_bf16 v[152:155], a[252:255], a[140:143], 0
v_mul_f32 v90, s61, v26
v_mul_f32 v91, s61, v27
v_mfma_f32_16x16x32_bf16 v[152:155], a[244:247], a[136:139], v[152:155]
buffer_load_dwordx4 v18, s[8:11], s48 offen offset:0 sc1 lds
v_mfma_f32_16x16x32_bf16 v[152:155], a[236:239], a[132:135], v[152:155]
buffer_load_dwordx4 a[196:199], v14, s[8:11], s16 offen offset:0 sc1
v_mfma_f32_16x16x32_bf16 v[152:155], a[228:231], a[128:131], v[152:155]
v_fmac_f32 v26, s62, v240
v_fmac_f32 v27, s62, v241
v_mfma_f32_16x16x32_bf16 v[160:163], a[228:231], a[132:135], 0
v_fmac_f32 v90, s63, v240
v_fmac_f32 v91, s63, v241
v_mfma_f32_16x16x32_bf16 v[160:163], a[236:239], a[136:139], v[160:163]
ds_read_b128 a[156:159], v1 offset:14336
v_mul_f32 v240, s64, v238
v_mfma_f32_16x16x32_bf16 v[160:163], a[244:247], a[140:143], v[160:163]
v_mul_f32 v241, s64, v239
s_waitcnt vmcnt(8) lgkmcnt(1)
v_mfma_f32_16x16x32_bf16 v[160:163], a[252:255], a[144:147], v[160:163]
v_fmac_f32 v240, s65, v242
v_fmac_f32 v241, s65, v243
v_mfma_f32_16x16x32_bf16 v[156:159], a[248:251], a[144:147], 0
v_fmac_f32 v242, s66, v238
v_fmac_f32 v243, s66, v239
v_mfma_f32_16x16x32_bf16 v[156:159], a[240:243], a[140:143], v[156:159]
v_accvgpr_write_b32 a70, v240
v_accvgpr_write_b32 a71, v241
v_mfma_f32_16x16x32_bf16 v[156:159], a[232:235], a[136:139], v[156:159]
buffer_load_dwordx4 a[200:203], v13, s[8:11], s16 offen offset:1024 sc1
v_mfma_f32_16x16x32_bf16 v[156:159], a[224:227], a[132:135], v[156:159]
v_accvgpr_write_b32 a6, v242
v_accvgpr_write_b32 a7, v243
v_mfma_f32_16x16x32_bf16 v[164:167], a[224:227], a[136:139], 0
v_accvgpr_read_b32 v246, a72
v_accvgpr_read_b32 v247, a73
v_mfma_f32_16x16x32_bf16 v[164:167], a[232:235], a[140:143], v[164:167]
ds_read_b128 a[128:131], v3 offset:0
v_accvgpr_read_b32 v244, a8
v_mfma_f32_16x16x32_bf16 v[164:167], a[240:243], a[144:147], v[164:167]
buffer_load_dwordx4 v18, s[8:11], s48 offen offset:1024 sc1 lds
v_mfma_f32_16x16x32_bf16 v[164:167], a[248:251], a[148:151], v[164:167]
v_accvgpr_read_b32 v245, a9
v_add_f32 v236, v246, v92
v_mfma_f32_16x16x32_bf16 v[168:171], a[252:255], a[148:151], 0
v_add_f32 v237, v247, v93
v_sub_f32 v246, v246, v92
v_mfma_f32_16x16x32_bf16 v[168:171], a[244:247], a[144:147], v[168:171]
v_sub_f32 v247, v247, v93
v_mul_f32 v92, s61, v28
v_mfma_f32_16x16x32_bf16 v[168:171], a[236:239], a[140:143], v[168:171]
buffer_load_dwordx4 a[204:207], v14, s[8:11], s16 offen offset:1024 sc1
v_mfma_f32_16x16x32_bf16 v[168:171], a[228:231], a[136:139], v[168:171]
v_mul_f32 v93, s61, v29
v_fmac_f32 v28, s62, v246
v_mfma_f32_16x16x32_bf16 v[176:179], a[228:231], a[140:143], 0
v_fmac_f32 v29, s62, v247
v_fmac_f32 v92, s63, v246
v_mfma_f32_16x16x32_bf16 v[176:179], a[236:239], a[144:147], v[176:179]
ds_read_b128 a[132:135], v3 offset:2048
v_fmac_f32 v93, s63, v247
v_mfma_f32_16x16x32_bf16 v[176:179], a[244:247], a[148:151], v[176:179]
v_mul_f32 v246, s64, v244
v_mul_f32 v247, s64, v245
v_mfma_f32_16x16x32_bf16 v[176:179], a[252:255], a[152:155], v[176:179]
v_fmac_f32 v246, s65, v236
v_fmac_f32 v247, s65, v237
v_mfma_f32_16x16x32_bf16 v[172:175], a[248:251], a[152:155], 0
v_fmac_f32 v236, s66, v244
v_fmac_f32 v237, s66, v245
v_mfma_f32_16x16x32_bf16 v[172:175], a[240:243], a[148:151], v[172:175]
v_accvgpr_write_b32 a72, v246
v_accvgpr_write_b32 a73, v247
v_mfma_f32_16x16x32_bf16 v[172:175], a[232:235], a[144:147], v[172:175]
buffer_load_dwordx4 a[208:211], v13, s[8:11], s16 offen offset:2048 sc1
v_mfma_f32_16x16x32_bf16 v[172:175], a[224:227], a[140:143], v[172:175]
buffer_load_dwordx4 v18, s[8:11], s48 offen offset:2048 sc1 lds
v_mfma_f32_16x16x32_bf16 v[180:183], a[224:227], a[144:147], 0
v_accvgpr_write_b32 a8, v236
v_accvgpr_write_b32 a9, v237
v_mfma_f32_16x16x32_bf16 v[180:183], a[232:235], a[148:151], v[180:183]
ds_read_b128 a[136:139], v3 offset:4096
v_accvgpr_read_b32 v240, a74
v_mfma_f32_16x16x32_bf16 v[180:183], a[240:243], a[152:155], v[180:183]
v_accvgpr_read_b32 v241, a75
s_waitcnt vmcnt(10) lgkmcnt(1)
v_mfma_f32_16x16x32_bf16 v[180:183], a[248:251], a[156:159], v[180:183]
v_accvgpr_read_b32 v238, a10
v_accvgpr_read_b32 v239, a11
v_mfma_f32_16x16x32_bf16 v[184:187], a[252:255], a[156:159], 0
v_add_f32 v242, v240, v94
v_add_f32 v243, v241, v95
v_mfma_f32_16x16x32_bf16 v[184:187], a[244:247], a[152:155], v[184:187]
v_sub_f32 v240, v240, v94
v_sub_f32 v241, v241, v95
v_mfma_f32_16x16x32_bf16 v[184:187], a[236:239], a[148:151], v[184:187]
ds_read_b128 a[140:143], v2 offset:0
v_mul_f32 v94, s61, v30
v_mfma_f32_16x16x32_bf16 v[184:187], a[228:231], a[144:147], v[184:187]
ds_read_b128 a[144:147], v2 offset:2048
v_mul_f32 v95, s61, v31
v_mfma_f32_16x16x32_bf16 v[192:195], a[228:231], a[148:151], 0
buffer_load_dwordx4 a[212:215], v14, s[8:11], s16 offen offset:2048 sc1
v_mfma_f32_16x16x32_bf16 v[192:195], a[236:239], a[152:155], v[192:195]
v_fmac_f32 v30, s62, v240
v_fmac_f32 v31, s62, v241
v_mfma_f32_16x16x32_bf16 v[192:195], a[244:247], a[156:159], v[192:195]
buffer_load_dwordx4 v18, s[8:11], s48 offen offset:3072 sc1 lds
v_mfma_f32_16x16x32_bf16 v[192:195], a[252:255], a[128:131], v[192:195]
v_fmac_f32 v94, s63, v240
v_fmac_f32 v95, s63, v241
v_mfma_f32_16x16x32_bf16 v[188:191], a[248:251], a[128:131], 0
v_mul_f32 v240, s64, v238
v_mul_f32 v241, s64, v239
v_mfma_f32_16x16x32_bf16 v[188:191], a[240:243], a[156:159], v[188:191]
v_fmac_f32 v240, s65, v242
v_fmac_f32 v241, s65, v243
v_mfma_f32_16x16x32_bf16 v[188:191], a[232:235], a[152:155], v[188:191]
buffer_load_dwordx4 a[216:219], v13, s[8:11], s16 offen offset:3072 sc1
v_mfma_f32_16x16x32_bf16 v[188:191], a[224:227], a[148:151], v[188:191]
ds_read_b128 a[148:151], v2 offset:4096
v_fmac_f32 v242, s66, v238
v_mfma_f32_16x16x32_bf16 v[196:199], a[224:227], a[152:155], 0
v_fmac_f32 v243, s66, v239
v_accvgpr_write_b32 a74, v240
v_mfma_f32_16x16x32_bf16 v[196:199], a[232:235], a[156:159], v[196:199]
v_accvgpr_write_b32 a75, v241
v_accvgpr_write_b32 a10, v242
v_mfma_f32_16x16x32_bf16 v[196:199], a[240:243], a[128:131], v[196:199]
v_accvgpr_write_b32 a11, v243
v_accvgpr_read_b32 v246, a76
v_mfma_f32_16x16x32_bf16 v[196:199], a[248:251], a[132:135], v[196:199]
v_accvgpr_read_b32 v247, a77
v_accvgpr_read_b32 v244, a12
v_mfma_f32_16x16x32_bf16 v[200:203], a[252:255], a[132:135], 0
v_accvgpr_read_b32 v245, a13
v_add_f32 v236, v246, v96
v_mfma_f32_16x16x32_bf16 v[200:203], a[244:247], a[128:131], v[200:203]
v_add_f32 v237, v247, v97
v_sub_f32 v246, v246, v96
v_mfma_f32_16x16x32_bf16 v[200:203], a[236:239], a[156:159], v[200:203]
buffer_load_dwordx4 a[220:223], v14, s[8:11], s16 offen offset:3072 sc1
v_mfma_f32_16x16x32_bf16 v[200:203], a[228:231], a[152:155], v[200:203]
ds_read_b128 a[152:155], v2 offset:6144
s_add_u32 s16, s16, 4096
v_mfma_f32_16x16x32_bf16 v[208:211], a[228:231], a[156:159], 0
s_add_u32 m0, s49, 81920
v_sub_f32 v247, v247, v97
v_mfma_f32_16x16x32_bf16 v[208:211], a[236:239], a[128:131], v[208:211]
v_mul_f32 v96, s61, v32
v_mul_f32 v97, s61, v33
v_mfma_f32_16x16x32_bf16 v[208:211], a[244:247], a[132:135], v[208:211]
v_fmac_f32 v32, s62, v246
s_waitcnt vmcnt(12) lgkmcnt(1)
v_mfma_f32_16x16x32_bf16 v[208:211], a[252:255], a[136:139], v[208:211]
v_fmac_f32 v33, s62, v247
v_fmac_f32 v96, s63, v246
v_mfma_f32_16x16x32_bf16 v[204:207], a[248:251], a[136:139], 0
v_fmac_f32 v97, s63, v247
v_mul_f32 v246, s64, v244
v_mfma_f32_16x16x32_bf16 v[204:207], a[240:243], a[132:135], v[204:207]
v_mul_f32 v247, s64, v245
v_fmac_f32 v246, s65, v236
v_mfma_f32_16x16x32_bf16 v[204:207], a[232:235], a[128:131], v[204:207]
v_fmac_f32 v247, s65, v237
v_fmac_f32 v236, s66, v244
v_mfma_f32_16x16x32_bf16 v[204:207], a[224:227], a[156:159], v[204:207]
ds_read_b128 a[156:159], v2 offset:8192
v_fmac_f32 v237, s66, v245
v_mfma_f32_16x16x32_bf16 v[148:151], a[160:163], a[140:143], v[148:151]
ds_read_b128 a[128:131], v2 offset:10240
v_accvgpr_write_b32 a76, v246
v_mfma_f32_16x16x32_bf16 v[148:151], a[168:171], a[144:147], v[148:151]
ds_read_b128 a[132:135], v2 offset:12288
v_accvgpr_write_b32 a77, v247
v_mfma_f32_16x16x32_bf16 v[148:151], a[176:179], a[148:151], v[148:151]
v_accvgpr_write_b32 a12, v236
s_waitcnt vmcnt(9) lgkmcnt(3)
v_mfma_f32_16x16x32_bf16 v[148:151], a[184:187], a[152:155], v[148:151]
buffer_load_dwordx4 a[224:227], v13, s[8:11], s16 offen offset:0 sc1
v_mfma_f32_16x16x32_bf16 v[152:155], a[188:191], a[152:155], v[152:155]
s_add_u32 s48, s3, 81920
v_accvgpr_write_b32 a13, v237
v_mfma_f32_16x16x32_bf16 v[152:155], a[180:183], a[148:151], v[152:155]
v_accvgpr_read_b32 v240, a78
v_accvgpr_read_b32 v241, a79
v_mfma_f32_16x16x32_bf16 v[152:155], a[172:175], a[144:147], v[152:155]
buffer_load_dwordx4 a[228:231], v14, s[8:11], s16 offen offset:0 sc1
v_mfma_f32_16x16x32_bf16 v[152:155], a[164:167], a[140:143], v[152:155]
v_accvgpr_read_b32 v238, a14
v_accvgpr_read_b32 v239, a15
v_mfma_f32_16x16x32_bf16 v[160:163], a[164:167], a[144:147], v[160:163]
v_add_f32 v242, v240, v98
v_add_f32 v243, v241, v99
v_mfma_f32_16x16x32_bf16 v[160:163], a[172:175], a[148:151], v[160:163]
ds_read_b128 a[136:139], v2 offset:14336
v_sub_f32 v240, v240, v98
v_mfma_f32_16x16x32_bf16 v[160:163], a[180:183], a[152:155], v[160:163]
v_sub_f32 v241, v241, v99
s_waitcnt vmcnt(9) lgkmcnt(1)
v_mfma_f32_16x16x32_bf16 v[160:163], a[188:191], a[156:159], v[160:163]
v_mul_f32 v98, s61, v34
v_mul_f32 v99, s61, v35
v_mfma_f32_16x16x32_bf16 v[156:159], a[184:187], a[156:159], v[156:159]
v_fmac_f32 v34, s62, v240
v_fmac_f32 v35, s62, v241
v_mfma_f32_16x16x32_bf16 v[156:159], a[176:179], a[152:155], v[156:159]
v_fmac_f32 v98, s63, v240
v_fmac_f32 v99, s63, v241
v_mfma_f32_16x16x32_bf16 v[156:159], a[168:171], a[148:151], v[156:159]
buffer_load_dwordx4 a[232:235], v13, s[8:11], s16 offen offset:1024 sc1
v_mfma_f32_16x16x32_bf16 v[156:159], a[160:163], a[144:147], v[156:159]
v_mul_f32 v240, s64, v238
v_mul_f32 v241, s64, v239
v_mfma_f32_16x16x32_bf16 v[164:167], a[160:163], a[148:151], v[164:167]
buffer_load_dwordx4 v18, s[8:11], s48 offen offset:0 sc1 lds
v_mfma_f32_16x16x32_bf16 v[164:167], a[168:171], a[152:155], v[164:167]
ds_read_b128 a[140:143], v4 offset:0
v_fmac_f32 v240, s65, v242
v_mfma_f32_16x16x32_bf16 v[164:167], a[176:179], a[156:159], v[164:167]
v_fmac_f32 v241, s65, v243
v_fmac_f32 v242, s66, v238
v_mfma_f32_16x16x32_bf16 v[164:167], a[184:187], a[128:131], v[164:167]
v_fmac_f32 v243, s66, v239
v_accvgpr_write_b32 a78, v240
v_mfma_f32_16x16x32_bf16 v[168:171], a[188:191], a[128:131], v[168:171]
v_accvgpr_write_b32 a79, v241
v_accvgpr_write_b32 a14, v242
v_mfma_f32_16x16x32_bf16 v[168:171], a[180:183], a[156:159], v[168:171]
v_accvgpr_write_b32 a15, v243
v_accvgpr_read_b32 v246, a80
v_mfma_f32_16x16x32_bf16 v[168:171], a[172:175], a[152:155], v[168:171]
buffer_load_dwordx4 a[236:239], v14, s[8:11], s16 offen offset:1024 sc1
v_mfma_f32_16x16x32_bf16 v[168:171], a[164:167], a[148:151], v[168:171]
v_accvgpr_read_b32 v247, a81
v_accvgpr_read_b32 v244, a16
v_mfma_f32_16x16x32_bf16 v[176:179], a[164:167], a[152:155], v[176:179]
v_accvgpr_read_b32 v245, a17
v_add_f32 v236, v246, v100
v_mfma_f32_16x16x32_bf16 v[176:179], a[172:175], a[156:159], v[176:179]
ds_read_b128 a[144:147], v4 offset:2048
v_add_f32 v237, v247, v101
v_mfma_f32_16x16x32_bf16 v[176:179], a[180:183], a[128:131], v[176:179]
v_sub_f32 v246, v246, v100
v_sub_f32 v247, v247, v101
v_mfma_f32_16x16x32_bf16 v[176:179], a[188:191], a[132:135], v[176:179]
v_mul_f32 v100, s61, v36
v_mul_f32 v101, s61, v37
v_mfma_f32_16x16x32_bf16 v[172:175], a[184:187], a[132:135], v[172:175]
buffer_load_dwordx4 v18, s[8:11], s48 offen offset:1024 sc1 lds
v_mfma_f32_16x16x32_bf16 v[172:175], a[176:179], a[128:131], v[172:175]
v_fmac_f32 v36, s62, v246
v_fmac_f32 v37, s62, v247
v_mfma_f32_16x16x32_bf16 v[172:175], a[168:171], a[156:159], v[172:175]
buffer_load_dwordx4 a[240:243], v13, s[8:11], s16 offen offset:2048 sc1
v_mfma_f32_16x16x32_bf16 v[172:175], a[160:163], a[152:155], v[172:175]
v_fmac_f32 v100, s63, v246
v_fmac_f32 v101, s63, v247
v_mfma_f32_16x16x32_bf16 v[180:183], a[160:163], a[156:159], v[180:183]
v_mul_f32 v246, s64, v244
v_mul_f32 v247, s64, v245
v_mfma_f32_16x16x32_bf16 v[180:183], a[168:171], a[128:131], v[180:183]
ds_read_b128 a[148:151], v4 offset:4096
v_fmac_f32 v246, s65, v236
v_mfma_f32_16x16x32_bf16 v[180:183], a[176:179], a[132:135], v[180:183]
v_fmac_f32 v247, s65, v237
s_waitcnt vmcnt(9) lgkmcnt(1)
v_mfma_f32_16x16x32_bf16 v[180:183], a[184:187], a[136:139], v[180:183]
v_fmac_f32 v236, s66, v244
v_fmac_f32 v237, s66, v245
v_mfma_f32_16x16x32_bf16 v[184:187], a[188:191], a[136:139], v[184:187]
v_accvgpr_write_b32 a80, v246
v_accvgpr_write_b32 a81, v247
v_mfma_f32_16x16x32_bf16 v[184:187], a[180:183], a[132:135], v[184:187]
v_accvgpr_write_b32 a16, v236
v_accvgpr_write_b32 a17, v237
v_mfma_f32_16x16x32_bf16 v[184:187], a[172:175], a[128:131], v[184:187]
ds_read_b128 a[152:155], v1 offset:16384
s_getpc_b64 s[46:47]
v_mfma_f32_16x16x32_bf16 v[184:187], a[164:167], a[156:159], v[184:187]
ds_read_b128 a[156:159], v1 offset:18432
v_accvgpr_read_b32 v240, a82
v_mfma_f32_16x16x32_bf16 v[192:195], a[164:167], a[128:131], v[192:195]
buffer_load_dwordx4 a[244:247], v14, s[8:11], s16 offen offset:2048 sc1
v_mfma_f32_16x16x32_bf16 v[192:195], a[172:175], a[132:135], v[192:195]
buffer_load_dwordx4 v18, s[8:11], s48 offen offset:2048 sc1 lds
v_mfma_f32_16x16x32_bf16 v[192:195], a[180:183], a[136:139], v[192:195]
global_load_dword v252, v255, s[46:47] offset:2048
v_mfma_f32_16x16x32_bf16 v[192:195], a[188:191], a[140:143], v[192:195]
v_accvgpr_read_b32 v241, a83
v_accvgpr_read_b32 v238, a18
v_mfma_f32_16x16x32_bf16 v[188:191], a[184:187], a[140:143], v[188:191]
v_accvgpr_read_b32 v239, a19
v_add_f32 v242, v240, v102
v_mfma_f32_16x16x32_bf16 v[188:191], a[176:179], a[136:139], v[188:191]
v_add_f32 v243, v241, v103
v_sub_f32 v240, v240, v102
v_mfma_f32_16x16x32_bf16 v[188:191], a[168:171], a[132:135], v[188:191]
buffer_load_dwordx4 a[248:251], v13, s[8:11], s16 offen offset:3072 sc1
v_mfma_f32_16x16x32_bf16 v[188:191], a[160:163], a[128:131], v[188:191]
ds_read_b128 a[128:131], v1 offset:20480
v_sub_f32 v241, v241, v103
v_mfma_f32_16x16x32_bf16 v[196:199], a[160:163], a[132:135], v[196:199]
v_mul_f32 v102, s61, v38
v_mul_f32 v103, s61, v39
v_mfma_f32_16x16x32_bf16 v[196:199], a[168:171], a[136:139], v[196:199]
v_fmac_f32 v38, s62, v240
v_fmac_f32 v39, s62, v241
v_mfma_f32_16x16x32_bf16 v[196:199], a[176:179], a[140:143], v[196:199]
v_fmac_f32 v102, s63, v240
v_fmac_f32 v103, s63, v241
v_mfma_f32_16x16x32_bf16 v[196:199], a[184:187], a[144:147], v[196:199]
v_mul_f32 v240, s64, v238
v_mul_f32 v241, s64, v239
v_mfma_f32_16x16x32_bf16 v[200:203], a[188:191], a[144:147], v[200:203]
v_fmac_f32 v240, s65, v242
v_fmac_f32 v241, s65, v243
v_mfma_f32_16x16x32_bf16 v[200:203], a[180:183], a[140:143], v[200:203]
buffer_load_dwordx4 v18, s[8:11], s48 offen offset:3072 sc1 lds
v_mfma_f32_16x16x32_bf16 v[200:203], a[172:175], a[136:139], v[200:203]
buffer_load_dwordx4 a[252:255], v14, s[8:11], s16 offen offset:3072 sc1
v_mfma_f32_16x16x32_bf16 v[200:203], a[164:167], a[132:135], v[200:203]
ds_read_b128 a[132:135], v1 offset:22528
s_add_u32 s16, s16, 4096
v_mfma_f32_16x16x32_bf16 v[208:211], a[164:167], a[136:139], v[208:211]
v_fmac_f32 v242, s66, v238
v_fmac_f32 v243, s66, v239
v_mfma_f32_16x16x32_bf16 v[208:211], a[172:175], a[140:143], v[208:211]
v_accvgpr_write_b32 a82, v240
v_accvgpr_write_b32 a83, v241
v_mfma_f32_16x16x32_bf16 v[208:211], a[180:183], a[144:147], v[208:211]
v_accvgpr_write_b32 a18, v242
s_waitcnt vmcnt(13) lgkmcnt(1)
v_mfma_f32_16x16x32_bf16 v[208:211], a[188:191], a[148:151], v[208:211]
v_accvgpr_write_b32 a19, v243
v_accvgpr_read_b32 v246, a84
v_mfma_f32_16x16x32_bf16 v[204:207], a[184:187], a[148:151], v[204:207]
v_accvgpr_read_b32 v247, a85
v_accvgpr_read_b32 v244, a20
v_mfma_f32_16x16x32_bf16 v[204:207], a[176:179], a[144:147], v[204:207]
v_accvgpr_read_b32 v245, a21
v_add_f32 v236, v246, v104
v_mfma_f32_16x16x32_bf16 v[204:207], a[168:171], a[140:143], v[204:207]
v_add_f32 v237, v247, v105
v_sub_f32 v246, v246, v104
v_mfma_f32_16x16x32_bf16 v[204:207], a[160:163], a[136:139], v[204:207]
ds_read_b128 a[136:139], v1 offset:24576
v_sub_f32 v247, v247, v105
v_mfma_f32_16x16x32_bf16 v[148:151], a[192:195], a[152:155], v[148:151]
ds_read_b128 a[140:143], v1 offset:26624
v_mul_f32 v104, s61, v40
v_mfma_f32_16x16x32_bf16 v[148:151], a[200:203], a[156:159], v[148:151]
ds_read_b128 a[144:147], v1 offset:28672
v_mul_f32 v105, s61, v41
v_mfma_f32_16x16x32_bf16 v[148:151], a[208:211], a[128:131], v[148:151]
s_add_u32 m0, s49, 98304
s_waitcnt vmcnt(11) lgkmcnt(3)
v_mfma_f32_16x16x32_bf16 v[148:151], a[216:219], a[132:135], v[148:151]
buffer_load_dwordx4 a[160:163], v13, s[8:11], s16 offen offset:0 sc1
v_mfma_f32_16x16x32_bf16 v[152:155], a[220:223], a[132:135], v[152:155]
v_fmac_f32 v40, s62, v246
v_fmac_f32 v41, s62, v247
v_mfma_f32_16x16x32_bf16 v[152:155], a[212:215], a[128:131], v[152:155]
v_fmac_f32 v104, s63, v246
v_fmac_f32 v105, s63, v247
v_mfma_f32_16x16x32_bf16 v[152:155], a[204:207], a[156:159], v[152:155]
buffer_load_dwordx4 a[164:167], v14, s[8:11], s16 offen offset:0 sc1
v_mfma_f32_16x16x32_bf16 v[152:155], a[196:199], a[152:155], v[152:155]
v_mul_f32 v246, s64, v244
v_mul_f32 v247, s64, v245
v_mfma_f32_16x16x32_bf16 v[160:163], a[196:199], a[156:159], v[160:163]
v_fmac_f32 v246, s65, v236
v_fmac_f32 v247, s65, v237
v_mfma_f32_16x16x32_bf16 v[160:163], a[204:207], a[128:131], v[160:163]
ds_read_b128 a[148:151], v1 offset:30720
v_fmac_f32 v236, s66, v244
v_mfma_f32_16x16x32_bf16 v[160:163], a[212:215], a[132:135], v[160:163]
v_fmac_f32 v237, s66, v245
s_waitcnt vmcnt(11) lgkmcnt(1)
v_mfma_f32_16x16x32_bf16 v[160:163], a[220:223], a[136:139], v[160:163]
v_accvgpr_write_b32 a84, v246
v_accvgpr_write_b32 a85, v247
v_mfma_f32_16x16x32_bf16 v[156:159], a[216:219], a[136:139], v[156:159]
v_accvgpr_write_b32 a20, v236
v_accvgpr_write_b32 a21, v237
v_mfma_f32_16x16x32_bf16 v[156:159], a[208:211], a[132:135], v[156:159]
v_accvgpr_read_b32 v240, a86
v_accvgpr_read_b32 v241, a87
v_mfma_f32_16x16x32_bf16 v[156:159], a[200:203], a[128:131], v[156:159]
buffer_load_dwordx4 a[168:171], v13, s[8:11], s16 offen offset:1024 sc1
v_mfma_f32_16x16x32_bf16 v[156:159], a[192:195], a[156:159], v[156:159]
s_add_u32 s48, s3, 98304
v_accvgpr_read_b32 v238, a22
v_mfma_f32_16x16x32_bf16 v[164:167], a[192:195], a[128:131], v[164:167]
v_accvgpr_read_b32 v239, a23
v_add_f32 v242, v240, v106
v_mfma_f32_16x16x32_bf16 v[164:167], a[200:203], a[132:135], v[164:167]
ds_read_b128 a[152:155], v3 offset:16384
v_add_f32 v243, v241, v107
v_mfma_f32_16x16x32_bf16 v[164:167], a[208:211], a[136:139], v[164:167]
v_sub_f32 v240, v240, v106
v_sub_f32 v241, v241, v107
v_mfma_f32_16x16x32_bf16 v[164:167], a[216:219], a[140:143], v[164:167]
v_mul_f32 v106, s61, v42
v_mul_f32 v107, s61, v43
v_mfma_f32_16x16x32_bf16 v[168:171], a[220:223], a[140:143], v[168:171]
v_fmac_f32 v42, s62, v240
v_fmac_f32 v43, s62, v241
v_mfma_f32_16x16x32_bf16 v[168:171], a[212:215], a[136:139], v[168:171]
v_fmac_f32 v106, s63, v240
v_fmac_f32 v107, s63, v241
v_mfma_f32_16x16x32_bf16 v[168:171], a[204:207], a[132:135], v[168:171]
buffer_load_dwordx4 a[172:175], v14, s[8:11], s16 offen offset:1024 sc1
v_mfma_f32_16x16x32_bf16 v[168:171], a[196:199], a[128:131], v[168:171]
v_mul_f32 v240, s64, v238
v_mul_f32 v241, s64, v239
v_mfma_f32_16x16x32_bf16 v[176:179], a[196:199], a[132:135], v[176:179]
v_fmac_f32 v240, s65, v242
v_fmac_f32 v241, s65, v243
v_mfma_f32_16x16x32_bf16 v[176:179], a[204:207], a[136:139], v[176:179]
ds_read_b128 a[156:159], v3 offset:18432
v_fmac_f32 v242, s66, v238
v_mfma_f32_16x16x32_bf16 v[176:179], a[212:215], a[140:143], v[176:179]
v_fmac_f32 v243, s66, v239
v_accvgpr_write_b32 a86, v240
v_mfma_f32_16x16x32_bf16 v[176:179], a[220:223], a[144:147], v[176:179]
buffer_load_dwordx4 v18, s[8:11], s48 offen offset:0 sc1 lds
v_mfma_f32_16x16x32_bf16 v[172:175], a[216:219], a[144:147], v[172:175]
v_accvgpr_write_b32 a87, v241
v_accvgpr_write_b32 a22, v242
v_mfma_f32_16x16x32_bf16 v[172:175], a[208:211], a[140:143], v[172:175]
v_accvgpr_write_b32 a23, v243
v_accvgpr_read_b32 v246, a88
v_mfma_f32_16x16x32_bf16 v[172:175], a[200:203], a[136:139], v[172:175]
buffer_load_dwordx4 a[176:179], v13, s[8:11], s16 offen offset:2048 sc1
v_mfma_f32_16x16x32_bf16 v[172:175], a[192:195], a[132:135], v[172:175]
v_accvgpr_read_b32 v247, a89
v_accvgpr_read_b32 v244, a24
v_mfma_f32_16x16x32_bf16 v[180:183], a[192:195], a[136:139], v[180:183]
v_accvgpr_read_b32 v245, a25
v_add_f32 v236, v246, v108
v_mfma_f32_16x16x32_bf16 v[180:183], a[200:203], a[140:143], v[180:183]
ds_read_b128 a[128:131], v3 offset:20480
v_add_f32 v237, v247, v109
v_mfma_f32_16x16x32_bf16 v[180:183], a[208:211], a[144:147], v[180:183]
v_sub_f32 v246, v246, v108
s_waitcnt vmcnt(9) lgkmcnt(1)
v_mfma_f32_16x16x32_bf16 v[180:183], a[216:219], a[148:151], v[180:183]
v_sub_f32 v247, v247, v109
v_mul_f32 v108, s61, v44
v_mfma_f32_16x16x32_bf16 v[184:187], a[220:223], a[148:151], v[184:187]
v_mul_f32 v109, s61, v45
v_fmac_f32 v44, s62, v246
v_mfma_f32_16x16x32_bf16 v[184:187], a[212:215], a[144:147], v[184:187]
v_fmac_f32 v45, s62, v247
v_fmac_f32 v108, s63, v246
v_mfma_f32_16x16x32_bf16 v[184:187], a[204:207], a[140:143], v[184:187]
ds_read_b128 a[132:135], v2 offset:16384
v_fmac_f32 v109, s63, v247
v_mfma_f32_16x16x32_bf16 v[184:187], a[196:199], a[136:139], v[184:187]
ds_read_b128 a[136:139], v2 offset:18432
v_mul_f32 v246, s64, v244
v_mfma_f32_16x16x32_bf16 v[192:195], a[196:199], a[140:143], v[192:195]
buffer_load_dwordx4 a[180:183], v14, s[8:11], s16 offen offset:2048 sc1
v_mfma_f32_16x16x32_bf16 v[192:195], a[204:207], a[144:147], v[192:195]
buffer_load_dwordx4 v18, s[8:11], s48 offen offset:1024 sc1 lds
v_mfma_f32_16x16x32_bf16 v[192:195], a[212:215], a[148:151], v[192:195]
v_mul_f32 v247, s64, v245
v_fmac_f32 v246, s65, v236
v_mfma_f32_16x16x32_bf16 v[192:195], a[220:223], a[152:155], v[192:195]
v_fmac_f32 v247, s65, v237
v_fmac_f32 v236, s66, v244
v_mfma_f32_16x16x32_bf16 v[188:191], a[216:219], a[152:155], v[188:191]
v_fmac_f32 v237, s66, v245
v_accvgpr_write_b32 a88, v246
v_mfma_f32_16x16x32_bf16 v[188:191], a[208:211], a[148:151], v[188:191]
v_accvgpr_write_b32 a89, v247
v_accvgpr_write_b32 a24, v236
v_mfma_f32_16x16x32_bf16 v[188:191], a[200:203], a[144:147], v[188:191]
buffer_load_dwordx4 a[184:187], v13, s[8:11], s16 offen offset:3072 sc1
v_mfma_f32_16x16x32_bf16 v[188:191], a[192:195], a[140:143], v[188:191]
ds_read_b128 a[140:143], v2 offset:20480
v_accvgpr_write_b32 a25, v237
v_mfma_f32_16x16x32_bf16 v[196:199], a[192:195], a[144:147], v[196:199]
v_accvgpr_read_b32 v240, a90
v_accvgpr_read_b32 v241, a91
v_mfma_f32_16x16x32_bf16 v[196:199], a[200:203], a[148:151], v[196:199]
v_accvgpr_read_b32 v238, a26
v_accvgpr_read_b32 v239, a27
v_mfma_f32_16x16x32_bf16 v[196:199], a[208:211], a[152:155], v[196:199]
v_add_f32 v242, v240, v110
v_add_f32 v243, v241, v111
v_mfma_f32_16x16x32_bf16 v[196:199], a[216:219], a[156:159], v[196:199]
v_sub_f32 v240, v240, v110
v_sub_f32 v241, v241, v111
v_mfma_f32_16x16x32_bf16 v[200:203], a[220:223], a[156:159], v[200:203]
buffer_load_dwordx4 v18, s[8:11], s48 offen offset:2048 sc1 lds
v_mfma_f32_16x16x32_bf16 v[200:203], a[212:215], a[152:155], v[200:203]
v_mul_f32 v110, s61, v46
v_mul_f32 v111, s61, v47
v_mfma_f32_16x16x32_bf16 v[200:203], a[204:207], a[148:151], v[200:203]
buffer_load_dwordx4 a[188:191], v14, s[8:11], s16 offen offset:3072 sc1
v_mfma_f32_16x16x32_bf16 v[200:203], a[196:199], a[144:147], v[200:203]
ds_read_b128 a[144:147], v2 offset:22528
s_add_u32 s16, s16, 4096
v_mfma_f32_16x16x32_bf16 v[208:211], a[196:199], a[148:151], v[208:211]
v_fmac_f32 v46, s62, v240
v_fmac_f32 v47, s62, v241
v_mfma_f32_16x16x32_bf16 v[208:211], a[204:207], a[152:155], v[208:211]
v_fmac_f32 v110, s63, v240
v_fmac_f32 v111, s63, v241
v_mfma_f32_16x16x32_bf16 v[208:211], a[212:215], a[156:159], v[208:211]
v_mul_f32 v240, s64, v238
s_waitcnt vmcnt(11) lgkmcnt(1)
v_mfma_f32_16x16x32_bf16 v[208:211], a[220:223], a[128:131], v[208:211]
v_mul_f32 v241, s64, v239
v_fmac_f32 v240, s65, v242
v_mfma_f32_16x16x32_bf16 v[204:207], a[216:219], a[128:131], v[204:207]
v_fmac_f32 v241, s65, v243
v_fmac_f32 v242, s66, v238
v_mfma_f32_16x16x32_bf16 v[204:207], a[208:211], a[156:159], v[204:207]
v_fmac_f32 v243, s66, v239
v_accvgpr_write_b32 a90, v240
v_mfma_f32_16x16x32_bf16 v[204:207], a[200:203], a[152:155], v[204:207]
v_accvgpr_write_b32 a91, v241
v_accvgpr_write_b32 a26, v242
v_mfma_f32_16x16x32_bf16 v[204:207], a[192:195], a[148:151], v[204:207]
ds_read_b128 a[148:151], v2 offset:24576
v_accvgpr_write_b32 a27, v243
v_mfma_f32_16x16x32_bf16 v[148:151], a[224:227], a[132:135], v[148:151]
ds_read_b128 a[152:155], v2 offset:26624
v_accvgpr_read_b32 v246, a92
v_mfma_f32_16x16x32_bf16 v[148:151], a[232:235], a[136:139], v[148:151]
ds_read_b128 a[156:159], v2 offset:28672
v_accvgpr_read_b32 v247, a93
v_mfma_f32_16x16x32_bf16 v[148:151], a[240:243], a[140:143], v[148:151]
v_accvgpr_read_b32 v244, a28
s_waitcnt vmcnt(9) lgkmcnt(3)
v_mfma_f32_16x16x32_bf16 v[148:151], a[248:251], a[144:147], v[148:151]
buffer_load_dwordx4 a[192:195], v13, s[8:11], s16 offen offset:0 sc1
v_mfma_f32_16x16x32_bf16 v[152:155], a[252:255], a[144:147], v[152:155]
buffer_load_dwordx4 v18, s[8:11], s48 offen offset:3072 sc1 lds
v_mfma_f32_16x16x32_bf16 v[152:155], a[244:247], a[140:143], v[152:155]
v_accvgpr_read_b32 v245, a29
v_add_f32 v236, v246, v112
v_mfma_f32_16x16x32_bf16 v[152:155], a[236:239], a[136:139], v[152:155]
buffer_load_dwordx4 a[196:199], v14, s[8:11], s16 offen offset:0 sc1
v_mfma_f32_16x16x32_bf16 v[152:155], a[228:231], a[132:135], v[152:155]
v_add_f32 v237, v247, v113
v_sub_f32 v246, v246, v112
v_mfma_f32_16x16x32_bf16 v[160:163], a[228:231], a[136:139], v[160:163]
v_sub_f32 v247, v247, v113
v_mul_f32 v112, s61, v48
v_mfma_f32_16x16x32_bf16 v[160:163], a[236:239], a[140:143], v[160:163]
ds_read_b128 a[128:131], v2 offset:30720
v_mul_f32 v113, s61, v49
v_mfma_f32_16x16x32_bf16 v[160:163], a[244:247], a[144:147], v[160:163]
v_fmac_f32 v48, s62, v246
s_waitcnt vmcnt(11) lgkmcnt(1)
v_mfma_f32_16x16x32_bf16 v[160:163], a[252:255], a[148:151], v[160:163]
v_fmac_f32 v49, s62, v247
v_fmac_f32 v112, s63, v246
v_mfma_f32_16x16x32_bf16 v[156:159], a[248:251], a[148:151], v[156:159]
v_fmac_f32 v113, s63, v247
v_mul_f32 v246, s64, v244
v_mfma_f32_16x16x32_bf16 v[156:159], a[240:243], a[144:147], v[156:159]
s_add_u32 m0, s49, 114688
v_mul_f32 v247, s64, v245
v_mfma_f32_16x16x32_bf16 v[156:159], a[232:235], a[140:143], v[156:159]
buffer_load_dwordx4 a[200:203], v13, s[8:11], s16 offen offset:1024 sc1
v_mfma_f32_16x16x32_bf16 v[156:159], a[224:227], a[136:139], v[156:159]
v_fmac_f32 v246, s65, v236
v_fmac_f32 v247, s65, v237
v_mfma_f32_16x16x32_bf16 v[164:167], a[224:227], a[140:143], v[164:167]
v_fmac_f32 v236, s66, v244
v_fmac_f32 v237, s66, v245
v_mfma_f32_16x16x32_bf16 v[164:167], a[232:235], a[144:147], v[164:167]
ds_read_b128 a[132:135], v4 offset:16384
v_accvgpr_write_b32 a92, v246
v_mfma_f32_16x16x32_bf16 v[164:167], a[240:243], a[148:151], v[164:167]
v_accvgpr_write_b32 a93, v247
v_accvgpr_write_b32 a28, v236
v_mfma_f32_16x16x32_bf16 v[164:167], a[248:251], a[152:155], v[164:167]
v_accvgpr_write_b32 a29, v237
v_accvgpr_read_b32 v240, a94
v_mfma_f32_16x16x32_bf16 v[168:171], a[252:255], a[152:155], v[168:171]
v_accvgpr_read_b32 v241, a95
v_accvgpr_read_b32 v238, a30
v_mfma_f32_16x16x32_bf16 v[168:171], a[244:247], a[148:151], v[168:171]
v_accvgpr_read_b32 v239, a31
v_add_f32 v242, v240, v114
v_mfma_f32_16x16x32_bf16 v[168:171], a[236:239], a[144:147], v[168:171]
buffer_load_dwordx4 a[204:207], v14, s[8:11], s16 offen offset:1024 sc1
v_mfma_f32_16x16x32_bf16 v[168:171], a[228:231], a[140:143], v[168:171]
v_add_f32 v243, v241, v115
v_sub_f32 v240, v240, v114
v_mfma_f32_16x16x32_bf16 v[176:179], a[228:231], a[144:147], v[176:179]
v_sub_f32 v241, v241, v115
v_mul_f32 v114, s61, v50
v_mfma_f32_16x16x32_bf16 v[176:179], a[236:239], a[148:151], v[176:179]
ds_read_b128 a[136:139], v4 offset:18432
s_add_u32 s48, s3, 114688
v_mfma_f32_16x16x32_bf16 v[176:179], a[244:247], a[152:155], v[176:179]
v_mul_f32 v115, s61, v51
v_fmac_f32 v50, s62, v240
v_mfma_f32_16x16x32_bf16 v[176:179], a[252:255], a[156:159], v[176:179]
v_fmac_f32 v51, s62, v241
v_fmac_f32 v114, s63, v240
v_mfma_f32_16x16x32_bf16 v[172:175], a[248:251], a[156:159], v[172:175]
v_fmac_f32 v115, s63, v241
v_mul_f32 v240, s64, v238
v_mfma_f32_16x16x32_bf16 v[172:175], a[240:243], a[152:155], v[172:175]
v_mul_f32 v241, s64, v239
v_fmac_f32 v240, s65, v242
v_mfma_f32_16x16x32_bf16 v[172:175], a[232:235], a[148:151], v[172:175]
buffer_load_dwordx4 a[208:211], v13, s[8:11], s16 offen offset:2048 sc1
v_mfma_f32_16x16x32_bf16 v[172:175], a[224:227], a[144:147], v[172:175]
v_fmac_f32 v241, s65, v243
v_fmac_f32 v242, s66, v238
v_mfma_f32_16x16x32_bf16 v[180:183], a[224:227], a[148:151], v[180:183]
v_fmac_f32 v243, s66, v239
v_accvgpr_write_b32 a94, v240
v_mfma_f32_16x16x32_bf16 v[180:183], a[232:235], a[152:155], v[180:183]
ds_read_b128 a[140:143], v4 offset:20480
v_accvgpr_write_b32 a95, v241
v_mfma_f32_16x16x32_bf16 v[180:183], a[240:243], a[156:159], v[180:183]
v_accvgpr_write_b32 a30, v242
s_waitcnt vmcnt(9) lgkmcnt(1)
v_mfma_f32_16x16x32_bf16 v[180:183], a[248:251], a[128:131], v[180:183]
v_accvgpr_write_b32 a31, v243
v_accvgpr_read_b32 v246, a96
v_mfma_f32_16x16x32_bf16 v[184:187], a[252:255], a[128:131], v[184:187]
v_accvgpr_read_b32 v247, a97
v_accvgpr_read_b32 v244, a32
v_mfma_f32_16x16x32_bf16 v[184:187], a[244:247], a[156:159], v[184:187]
v_accvgpr_read_b32 v245, a33
v_add_f32 v236, v246, v116
v_mfma_f32_16x16x32_bf16 v[184:187], a[236:239], a[152:155], v[184:187]
ds_read_b128 a[144:147], v1 offset:32768
v_add_f32 v237, v247, v117
v_mfma_f32_16x16x32_bf16 v[184:187], a[228:231], a[148:151], v[184:187]
ds_read_b128 a[148:151], v1 offset:34816
v_sub_f32 v246, v246, v116
v_mfma_f32_16x16x32_bf16 v[192:195], a[228:231], a[152:155], v[192:195]
buffer_load_dwordx4 a[212:215], v14, s[8:11], s16 offen offset:2048 sc1
v_mfma_f32_16x16x32_bf16 v[192:195], a[236:239], a[156:159], v[192:195]
buffer_load_dwordx4 v18, s[8:11], s48 offen offset:0 sc1 lds
v_mfma_f32_16x16x32_bf16 v[192:195], a[244:247], a[128:131], v[192:195]
v_sub_f32 v247, v247, v117
v_mul_f32 v116, s61, v52
v_mfma_f32_16x16x32_bf16 v[192:195], a[252:255], a[132:135], v[192:195]
v_mul_f32 v117, s61, v53
v_fmac_f32 v52, s62, v246
v_mfma_f32_16x16x32_bf16 v[188:191], a[248:251], a[132:135], v[188:191]
v_fmac_f32 v53, s62, v247
v_fmac_f32 v116, s63, v246
v_mfma_f32_16x16x32_bf16 v[188:191], a[240:243], a[128:131], v[188:191]
v_fmac_f32 v117, s63, v247
v_mul_f32 v246, s64, v244
v_mfma_f32_16x16x32_bf16 v[188:191], a[232:235], a[156:159], v[188:191]
buffer_load_dwordx4 a[216:219], v13, s[8:11], s16 offen offset:3072 sc1
v_mfma_f32_16x16x32_bf16 v[188:191], a[224:227], a[152:155], v[188:191]
ds_read_b128 a[152:155], v1 offset:36864
v_mul_f32 v247, s64, v245
v_mfma_f32_16x16x32_bf16 v[196:199], a[224:227], a[156:159], v[196:199]
v_fmac_f32 v246, s65, v236
v_fmac_f32 v247, s65, v237
v_mfma_f32_16x16x32_bf16 v[196:199], a[232:235], a[128:131], v[196:199]
v_fmac_f32 v236, s66, v244
v_fmac_f32 v237, s66, v245
v_mfma_f32_16x16x32_bf16 v[196:199], a[240:243], a[132:135], v[196:199]
buffer_load_dwordx4 v18, s[8:11], s48 offen offset:1024 sc1 lds
v_mfma_f32_16x16x32_bf16 v[196:199], a[248:251], a[136:139], v[196:199]
v_accvgpr_write_b32 a96, v246
v_accvgpr_write_b32 a97, v247
v_mfma_f32_16x16x32_bf16 v[200:203], a[252:255], a[136:139], v[200:203]
v_accvgpr_write_b32 a32, v236
v_accvgpr_write_b32 a33, v237
v_mfma_f32_16x16x32_bf16 v[200:203], a[244:247], a[132:135], v[200:203]
v_accvgpr_read_b32 v240, a98
v_accvgpr_read_b32 v241, a99
v_mfma_f32_16x16x32_bf16 v[200:203], a[236:239], a[128:131], v[200:203]
buffer_load_dwordx4 a[220:223], v14, s[8:11], s16 offen offset:3072 sc1
v_mfma_f32_16x16x32_bf16 v[200:203], a[228:231], a[156:159], v[200:203]
ds_read_b128 a[156:159], v1 offset:38912
s_add_u32 s16, s16, 4096
v_mfma_f32_16x16x32_bf16 v[208:211], a[228:231], a[128:131], v[208:211]
v_accvgpr_read_b32 v238, a34
v_accvgpr_read_b32 v239, a35
v_mfma_f32_16x16x32_bf16 v[208:211], a[236:239], a[132:135], v[208:211]
v_add_f32 v242, v240, v118
v_add_f32 v243, v241, v119
v_mfma_f32_16x16x32_bf16 v[208:211], a[244:247], a[136:139], v[208:211]
v_sub_f32 v240, v240, v118
s_waitcnt vmcnt(11) lgkmcnt(1)
v_mfma_f32_16x16x32_bf16 v[208:211], a[252:255], a[140:143], v[208:211]
v_sub_f32 v241, v241, v119
v_mul_f32 v118, s61, v54
v_mfma_f32_16x16x32_bf16 v[204:207], a[248:251], a[140:143], v[204:207]
v_mul_f32 v119, s61, v55
v_fmac_f32 v54, s62, v240
v_mfma_f32_16x16x32_bf16 v[204:207], a[240:243], a[136:139], v[204:207]
v_fmac_f32 v55, s62, v241
v_fmac_f32 v118, s63, v240
v_mfma_f32_16x16x32_bf16 v[204:207], a[232:235], a[132:135], v[204:207]
v_fmac_f32 v119, s63, v241
v_mul_f32 v240, s64, v238
v_mfma_f32_16x16x32_bf16 v[204:207], a[224:227], a[128:131], v[204:207]
ds_read_b128 a[128:131], v1 offset:40960
v_mul_f32 v241, s64, v239
v_mfma_f32_16x16x32_bf16 v[148:151], a[160:163], a[144:147], v[148:151]
ds_read_b128 a[132:135], v1 offset:43008
v_fmac_f32 v240, s65, v242
v_mfma_f32_16x16x32_bf16 v[148:151], a[168:171], a[148:151], v[148:151]
ds_read_b128 a[136:139], v1 offset:45056
v_fmac_f32 v241, s65, v243
v_mfma_f32_16x16x32_bf16 v[148:151], a[176:179], a[152:155], v[148:151]
v_fmac_f32 v242, s66, v238
s_waitcnt vmcnt(8) lgkmcnt(3)
v_mfma_f32_16x16x32_bf16 v[148:151], a[184:187], a[156:159], v[148:151]
buffer_load_dwordx4 a[224:227], v13, s[8:11], s16 offen offset:0 sc1
v_mfma_f32_16x16x32_bf16 v[152:155], a[188:191], a[156:159], v[152:155]
buffer_load_dwordx4 v18, s[8:11], s48 offen offset:2048 sc1 lds
v_mfma_f32_16x16x32_bf16 v[152:155], a[180:183], a[152:155], v[152:155]
v_fmac_f32 v243, s66, v239
v_accvgpr_write_b32 a98, v240
v_mfma_f32_16x16x32_bf16 v[152:155], a[172:175], a[148:151], v[152:155]
buffer_load_dwordx4 a[228:231], v14, s[8:11], s16 offen offset:0 sc1
v_mfma_f32_16x16x32_bf16 v[152:155], a[164:167], a[144:147], v[152:155]
v_accvgpr_write_b32 a99, v241
v_accvgpr_write_b32 a34, v242
v_mfma_f32_16x16x32_bf16 v[160:163], a[164:167], a[148:151], v[160:163]
v_accvgpr_write_b32 a35, v243
v_accvgpr_read_b32 v246, a100
v_mfma_f32_16x16x32_bf16 v[160:163], a[172:175], a[152:155], v[160:163]
ds_read_b128 a[140:143], v1 offset:47104
v_accvgpr_read_b32 v247, a101
v_mfma_f32_16x16x32_bf16 v[160:163], a[180:183], a[156:159], v[160:163]
v_accvgpr_read_b32 v244, a36
s_waitcnt vmcnt(10) lgkmcnt(1)
v_mfma_f32_16x16x32_bf16 v[160:163], a[188:191], a[128:131], v[160:163]
buffer_load_dwordx4 v18, s[8:11], s48 offen offset:3072 sc1 lds
v_mfma_f32_16x16x32_bf16 v[156:159], a[184:187], a[128:131], v[156:159]
v_accvgpr_read_b32 v245, a37
v_add_f32 v236, v246, v120
v_mfma_f32_16x16x32_bf16 v[156:159], a[176:179], a[156:159], v[156:159]
v_add_f32 v237, v247, v121
v_sub_f32 v246, v246, v120
v_mfma_f32_16x16x32_bf16 v[156:159], a[168:171], a[152:155], v[156:159]
buffer_load_dwordx4 a[232:235], v13, s[8:11], s16 offen offset:1024 sc1
v_mfma_f32_16x16x32_bf16 v[156:159], a[160:163], a[148:151], v[156:159]
v_sub_f32 v247, v247, v121
v_mul_f32 v120, s61, v56
v_mfma_f32_16x16x32_bf16 v[164:167], a[160:163], a[152:155], v[164:167]
v_mul_f32 v121, s61, v57
v_fmac_f32 v56, s62, v246
v_mfma_f32_16x16x32_bf16 v[164:167], a[168:171], a[156:159], v[164:167]
ds_read_b128 a[144:147], v3 offset:32768
v_fmac_f32 v57, s62, v247
v_mfma_f32_16x16x32_bf16 v[164:167], a[176:179], a[128:131], v[164:167]
v_fmac_f32 v120, s63, v246
v_fmac_f32 v121, s63, v247
v_mfma_f32_16x16x32_bf16 v[164:167], a[184:187], a[132:135], v[164:167]
v_mul_f32 v246, s64, v244
v_mul_f32 v247, s64, v245
v_mfma_f32_16x16x32_bf16 v[168:171], a[188:191], a[132:135], v[168:171]
v_fmac_f32 v246, s65, v236
v_fmac_f32 v247, s65, v237
v_mfma_f32_16x16x32_bf16 v[168:171], a[180:183], a[128:131], v[168:171]
v_fmac_f32 v236, s66, v244
v_fmac_f32 v237, s66, v245
v_mfma_f32_16x16x32_bf16 v[168:171], a[172:175], a[156:159], v[168:171]
buffer_load_dwordx4 a[236:239], v14, s[8:11], s16 offen offset:1024 sc1
v_mfma_f32_16x16x32_bf16 v[168:171], a[164:167], a[152:155], v[168:171]
v_accvgpr_write_b32 a100, v246
v_accvgpr_write_b32 a101, v247
v_mfma_f32_16x16x32_bf16 v[176:179], a[164:167], a[156:159], v[176:179]
v_accvgpr_write_b32 a36, v236
v_accvgpr_write_b32 a37, v237
v_mfma_f32_16x16x32_bf16 v[176:179], a[172:175], a[128:131], v[176:179]
ds_read_b128 a[148:151], v3 offset:34816
v_accvgpr_read_b32 v240, a102
v_mfma_f32_16x16x32_bf16 v[176:179], a[180:183], a[132:135], v[176:179]
v_accvgpr_read_b32 v241, a103
v_accvgpr_read_b32 v238, a38
v_mfma_f32_16x16x32_bf16 v[176:179], a[188:191], a[136:139], v[176:179]
v_accvgpr_read_b32 v239, a39
v_add_f32 v242, v240, v122
v_mfma_f32_16x16x32_bf16 v[172:175], a[184:187], a[136:139], v[172:175]
v_add_f32 v243, v241, v123
v_sub_f32 v240, v240, v122
v_mfma_f32_16x16x32_bf16 v[172:175], a[176:179], a[132:135], v[172:175]
v_sub_f32 v241, v241, v123
v_mul_f32 v122, s61, v58
v_mfma_f32_16x16x32_bf16 v[172:175], a[168:171], a[128:131], v[172:175]
buffer_load_dwordx4 a[240:243], v13, s[8:11], s16 offen offset:2048 sc1
v_mfma_f32_16x16x32_bf16 v[172:175], a[160:163], a[156:159], v[172:175]
v_mul_f32 v123, s61, v59
v_fmac_f32 v58, s62, v240
v_mfma_f32_16x16x32_bf16 v[180:183], a[160:163], a[128:131], v[180:183]
v_fmac_f32 v59, s62, v241
v_fmac_f32 v122, s63, v240
v_mfma_f32_16x16x32_bf16 v[180:183], a[168:171], a[132:135], v[180:183]
ds_read_b128 a[152:155], v3 offset:36864
v_fmac_f32 v123, s63, v241
v_mfma_f32_16x16x32_bf16 v[180:183], a[176:179], a[136:139], v[180:183]
v_mul_f32 v240, s64, v238
s_waitcnt vmcnt(10) lgkmcnt(1)
v_mfma_f32_16x16x32_bf16 v[180:183], a[184:187], a[140:143], v[180:183]
v_mul_f32 v241, s64, v239
v_fmac_f32 v240, s65, v242
v_mfma_f32_16x16x32_bf16 v[184:187], a[188:191], a[140:143], v[184:187]
v_fmac_f32 v241, s65, v243
v_fmac_f32 v242, s66, v238
v_mfma_f32_16x16x32_bf16 v[184:187], a[180:183], a[136:139], v[184:187]
v_fmac_f32 v243, s66, v239
v_accvgpr_write_b32 a102, v240
v_mfma_f32_16x16x32_bf16 v[184:187], a[172:175], a[132:135], v[184:187]
ds_read_b128 a[156:159], v2 offset:32768
v_accvgpr_write_b32 a103, v241
v_mfma_f32_16x16x32_bf16 v[184:187], a[164:167], a[128:131], v[184:187]
ds_read_b128 a[128:131], v2 offset:34816
v_accvgpr_write_b32 a38, v242
v_mfma_f32_16x16x32_bf16 v[192:195], a[164:167], a[132:135], v[192:195]
buffer_load_dwordx4 a[244:247], v14, s[8:11], s16 offen offset:2048 sc1
v_mfma_f32_16x16x32_bf16 v[192:195], a[172:175], a[136:139], v[192:195]
v_accvgpr_write_b32 a39, v243
v_accvgpr_read_b32 v246, a104
v_mfma_f32_16x16x32_bf16 v[192:195], a[180:183], a[140:143], v[192:195]
v_accvgpr_read_b32 v247, a105
v_accvgpr_read_b32 v244, a40
v_mfma_f32_16x16x32_bf16 v[192:195], a[188:191], a[144:147], v[192:195]
v_accvgpr_read_b32 v245, a41
v_add_f32 v236, v246, v124
v_mfma_f32_16x16x32_bf16 v[188:191], a[184:187], a[144:147], v[188:191]
v_add_f32 v237, v247, v125
v_sub_f32 v246, v246, v124
v_mfma_f32_16x16x32_bf16 v[188:191], a[176:179], a[140:143], v[188:191]
v_sub_f32 v247, v247, v125
v_mul_f32 v124, s61, v60
v_mfma_f32_16x16x32_bf16 v[188:191], a[168:171], a[136:139], v[188:191]
buffer_load_dwordx4 a[248:251], v13, s[8:11], s16 offen offset:3072 sc1
v_mfma_f32_16x16x32_bf16 v[188:191], a[160:163], a[132:135], v[188:191]
ds_read_b128 a[132:135], v2 offset:36864
v_mul_f32 v125, s61, v61
v_mfma_f32_16x16x32_bf16 v[196:199], a[160:163], a[136:139], v[196:199]
v_fmac_f32 v60, s62, v246
v_fmac_f32 v61, s62, v247
v_mfma_f32_16x16x32_bf16 v[196:199], a[168:171], a[140:143], v[196:199]
v_fmac_f32 v124, s63, v246
v_fmac_f32 v125, s63, v247
v_mfma_f32_16x16x32_bf16 v[196:199], a[176:179], a[144:147], v[196:199]
v_mul_f32 v246, s64, v244
v_mul_f32 v247, s64, v245
v_mfma_f32_16x16x32_bf16 v[196:199], a[184:187], a[148:151], v[196:199]
v_fmac_f32 v246, s65, v236
v_fmac_f32 v247, s65, v237
v_mfma_f32_16x16x32_bf16 v[200:203], a[188:191], a[148:151], v[200:203]
v_fmac_f32 v236, s66, v244
v_fmac_f32 v237, s66, v245
v_mfma_f32_16x16x32_bf16 v[200:203], a[180:183], a[144:147], v[200:203]
v_accvgpr_write_b32 a104, v246
v_accvgpr_write_b32 a105, v247
v_mfma_f32_16x16x32_bf16 v[200:203], a[172:175], a[140:143], v[200:203]
buffer_load_dwordx4 a[252:255], v14, s[8:11], s16 offen offset:3072 sc1
v_mfma_f32_16x16x32_bf16 v[200:203], a[164:167], a[136:139], v[200:203]
ds_read_b128 a[136:139], v2 offset:38912
s_add_u32 s16, s16, 4096
v_mfma_f32_16x16x32_bf16 v[208:211], a[164:167], a[140:143], v[208:211]
v_accvgpr_write_b32 a40, v236
v_accvgpr_write_b32 a41, v237
v_mfma_f32_16x16x32_bf16 v[208:211], a[172:175], a[144:147], v[208:211]
v_accvgpr_read_b32 v240, a106
v_accvgpr_read_b32 v241, a107
v_mfma_f32_16x16x32_bf16 v[208:211], a[180:183], a[148:151], v[208:211]
v_accvgpr_read_b32 v238, a42
s_waitcnt vmcnt(10) lgkmcnt(1)
v_mfma_f32_16x16x32_bf16 v[208:211], a[188:191], a[152:155], v[208:211]
v_accvgpr_read_b32 v239, a43
v_add_f32 v242, v240, v126
v_mfma_f32_16x16x32_bf16 v[204:207], a[184:187], a[152:155], v[204:207]
v_add_f32 v243, v241, v127
v_sub_f32 v240, v240, v126
v_mfma_f32_16x16x32_bf16 v[204:207], a[176:179], a[148:151], v[204:207]
v_sub_f32 v241, v241, v127
v_mul_f32 v126, s61, v62
v_mfma_f32_16x16x32_bf16 v[204:207], a[168:171], a[144:147], v[204:207]
v_mul_f32 v127, s61, v63
v_fmac_f32 v62, s62, v240
v_mfma_f32_16x16x32_bf16 v[204:207], a[160:163], a[140:143], v[204:207]
ds_read_b128 a[140:143], v2 offset:40960
v_fmac_f32 v63, s62, v241
v_mfma_f32_16x16x32_bf16 v[148:151], a[192:195], a[156:159], v[148:151]
ds_read_b128 a[144:147], v2 offset:43008
v_fmac_f32 v126, s63, v240
v_mfma_f32_16x16x32_bf16 v[148:151], a[200:203], a[128:131], v[148:151]
ds_read_b128 a[148:151], v2 offset:45056
v_fmac_f32 v127, s63, v241
v_mfma_f32_16x16x32_bf16 v[148:151], a[208:211], a[132:135], v[148:151]
v_mul_f32 v240, s64, v238
s_waitcnt vmcnt(7) lgkmcnt(3)
v_mfma_f32_16x16x32_bf16 v[148:151], a[216:219], a[136:139], v[148:151]
buffer_load_dwordx4 a[160:163], v13, s[8:11], s16 offen offset:0 sc1
v_mfma_f32_16x16x32_bf16 v[152:155], a[220:223], a[136:139], v[152:155]
v_mul_f32 v241, s64, v239
v_fmac_f32 v240, s65, v242
v_mfma_f32_16x16x32_bf16 v[152:155], a[212:215], a[132:135], v[152:155]
v_fmac_f32 v241, s65, v243
v_fmac_f32 v242, s66, v238
v_mfma_f32_16x16x32_bf16 v[152:155], a[204:207], a[128:131], v[152:155]
buffer_load_dwordx4 a[164:167], v14, s[8:11], s16 offen offset:0 sc1
v_mfma_f32_16x16x32_bf16 v[152:155], a[196:199], a[156:159], v[152:155]
v_fmac_f32 v243, s66, v239
v_accvgpr_write_b32 a106, v240
v_mfma_f32_16x16x32_bf16 v[160:163], a[196:199], a[128:131], v[160:163]
v_accvgpr_write_b32 a107, v241
v_accvgpr_write_b32 a42, v242
v_mfma_f32_16x16x32_bf16 v[160:163], a[204:207], a[132:135], v[160:163]
ds_read_b128 a[152:155], v2 offset:47104
v_accvgpr_write_b32 a43, v243
v_mfma_f32_16x16x32_bf16 v[160:163], a[212:215], a[136:139], v[160:163]
v_accvgpr_read_b32 v246, a108
s_waitcnt vmcnt(7) lgkmcnt(1)
v_mfma_f32_16x16x32_bf16 v[160:163], a[220:223], a[140:143], v[160:163]
v_accvgpr_read_b32 v247, a109
v_accvgpr_read_b32 v244, a44
v_mfma_f32_16x16x32_bf16 v[156:159], a[216:219], a[140:143], v[156:159]
v_accvgpr_read_b32 v245, a45
v_add_f32 v236, v246, v128
v_mfma_f32_16x16x32_bf16 v[156:159], a[208:211], a[136:139], v[156:159]
v_add_f32 v237, v247, v129
v_sub_f32 v246, v246, v128
v_mfma_f32_16x16x32_bf16 v[156:159], a[200:203], a[132:135], v[156:159]
buffer_load_dwordx4 a[168:171], v13, s[8:11], s16 offen offset:1024 sc1
v_mfma_f32_16x16x32_bf16 v[156:159], a[192:195], a[128:131], v[156:159]
v_sub_f32 v247, v247, v129
v_mul_f32 v128, s61, v64
v_mfma_f32_16x16x32_bf16 v[164:167], a[192:195], a[132:135], v[164:167]
v_mul_f32 v129, s61, v65
v_fmac_f32 v64, s62, v246
v_mfma_f32_16x16x32_bf16 v[164:167], a[200:203], a[136:139], v[164:167]
ds_read_b128 a[156:159], v4 offset:32768
v_fmac_f32 v65, s62, v247
v_mfma_f32_16x16x32_bf16 v[164:167], a[208:211], a[140:143], v[164:167]
v_fmac_f32 v128, s63, v246
v_fmac_f32 v129, s63, v247
v_mfma_f32_16x16x32_bf16 v[164:167], a[216:219], a[144:147], v[164:167]
v_mul_f32 v246, s64, v244
v_mul_f32 v247, s64, v245
v_mfma_f32_16x16x32_bf16 v[168:171], a[220:223], a[144:147], v[168:171]
v_fmac_f32 v246, s65, v236
v_fmac_f32 v247, s65, v237
v_mfma_f32_16x16x32_bf16 v[168:171], a[212:215], a[140:143], v[168:171]
v_fmac_f32 v236, s66, v244
v_fmac_f32 v237, s66, v245
v_mfma_f32_16x16x32_bf16 v[168:171], a[204:207], a[136:139], v[168:171]
buffer_load_dwordx4 a[172:175], v14, s[8:11], s16 offen offset:1024 sc1
v_mfma_f32_16x16x32_bf16 v[168:171], a[196:199], a[132:135], v[168:171]
v_accvgpr_write_b32 a108, v246
v_accvgpr_write_b32 a109, v247
v_mfma_f32_16x16x32_bf16 v[176:179], a[196:199], a[136:139], v[176:179]
v_accvgpr_write_b32 a44, v236
v_accvgpr_write_b32 a45, v237
v_mfma_f32_16x16x32_bf16 v[176:179], a[204:207], a[140:143], v[176:179]
ds_read_b128 a[128:131], v4 offset:34816
v_accvgpr_read_b32 v240, a110
v_mfma_f32_16x16x32_bf16 v[176:179], a[212:215], a[144:147], v[176:179]
v_accvgpr_read_b32 v241, a111
v_accvgpr_read_b32 v238, a46
v_mfma_f32_16x16x32_bf16 v[176:179], a[220:223], a[148:151], v[176:179]
v_accvgpr_read_b32 v239, a47
v_add_f32 v242, v240, v130
v_mfma_f32_16x16x32_bf16 v[172:175], a[216:219], a[148:151], v[172:175]
v_add_f32 v243, v241, v131
v_sub_f32 v240, v240, v130
v_mfma_f32_16x16x32_bf16 v[172:175], a[208:211], a[144:147], v[172:175]
v_sub_f32 v241, v241, v131
v_mul_f32 v130, s61, v66
v_mfma_f32_16x16x32_bf16 v[172:175], a[200:203], a[140:143], v[172:175]
buffer_load_dwordx4 a[176:179], v13, s[8:11], s16 offen offset:2048 sc1
v_mfma_f32_16x16x32_bf16 v[172:175], a[192:195], a[136:139], v[172:175]
v_mul_f32 v131, s61, v67
v_fmac_f32 v66, s62, v240
v_mfma_f32_16x16x32_bf16 v[180:183], a[192:195], a[140:143], v[180:183]
s_getpc_b64 s[46:47]
v_fmac_f32 v67, s62, v241
v_mfma_f32_16x16x32_bf16 v[180:183], a[200:203], a[144:147], v[180:183]
ds_read_b128 a[132:135], v4 offset:36864
v_fmac_f32 v130, s63, v240
v_mfma_f32_16x16x32_bf16 v[180:183], a[208:211], a[148:151], v[180:183]
v_fmac_f32 v131, s63, v241
s_waitcnt vmcnt(7) lgkmcnt(1)
v_mfma_f32_16x16x32_bf16 v[180:183], a[216:219], a[152:155], v[180:183]
global_load_dword v252, v255, s[46:47] offset:2048
v_mfma_f32_16x16x32_bf16 v[184:187], a[220:223], a[152:155], v[184:187]
v_mul_f32 v240, s64, v238
v_mul_f32 v241, s64, v239
v_mfma_f32_16x16x32_bf16 v[184:187], a[212:215], a[148:151], v[184:187]
v_fmac_f32 v240, s65, v242
v_fmac_f32 v241, s65, v243
v_mfma_f32_16x16x32_bf16 v[184:187], a[204:207], a[144:147], v[184:187]
ds_read_b128 a[136:139], v1 offset:49152
v_fmac_f32 v242, s66, v238
v_mfma_f32_16x16x32_bf16 v[184:187], a[196:199], a[140:143], v[184:187]
ds_read_b128 a[140:143], v1 offset:51200
v_fmac_f32 v243, s66, v239
v_mfma_f32_16x16x32_bf16 v[192:195], a[196:199], a[144:147], v[192:195]
buffer_load_dwordx4 a[180:183], v14, s[8:11], s16 offen offset:2048 sc1
v_mfma_f32_16x16x32_bf16 v[192:195], a[204:207], a[148:151], v[192:195]
v_accvgpr_write_b32 a110, v240
v_accvgpr_write_b32 a111, v241
v_mfma_f32_16x16x32_bf16 v[192:195], a[212:215], a[152:155], v[192:195]
v_accvgpr_write_b32 a46, v242
v_accvgpr_write_b32 a47, v243
v_mfma_f32_16x16x32_bf16 v[192:195], a[220:223], a[156:159], v[192:195]
v_accvgpr_read_b32 v246, a112
v_accvgpr_read_b32 v247, a113
v_mfma_f32_16x16x32_bf16 v[188:191], a[216:219], a[156:159], v[188:191]
v_accvgpr_read_b32 v244, a48
v_accvgpr_read_b32 v245, a49
v_mfma_f32_16x16x32_bf16 v[188:191], a[208:211], a[152:155], v[188:191]
v_add_f32 v236, v246, v132
v_add_f32 v237, v247, v133
v_mfma_f32_16x16x32_bf16 v[188:191], a[200:203], a[148:151], v[188:191]
buffer_load_dwordx4 a[184:187], v13, s[8:11], s16 offen offset:3072 sc1
v_mfma_f32_16x16x32_bf16 v[188:191], a[192:195], a[144:147], v[188:191]
ds_read_b128 a[144:147], v1 offset:53248
v_sub_f32 v246, v246, v132
v_mfma_f32_16x16x32_bf16 v[196:199], a[192:195], a[148:151], v[196:199]
v_sub_f32 v247, v247, v133
v_mul_f32 v132, s61, v68
v_mfma_f32_16x16x32_bf16 v[196:199], a[200:203], a[152:155], v[196:199]
v_mul_f32 v133, s61, v69
v_fmac_f32 v68, s62, v246
v_mfma_f32_16x16x32_bf16 v[196:199], a[208:211], a[156:159], v[196:199]
v_fmac_f32 v69, s62, v247
v_fmac_f32 v132, s63, v246
v_mfma_f32_16x16x32_bf16 v[196:199], a[216:219], a[128:131], v[196:199]
v_fmac_f32 v133, s63, v247
v_mul_f32 v246, s64, v244
v_mfma_f32_16x16x32_bf16 v[200:203], a[220:223], a[128:131], v[200:203]
v_mul_f32 v247, s64, v245
v_fmac_f32 v246, s65, v236
v_mfma_f32_16x16x32_bf16 v[200:203], a[212:215], a[156:159], v[200:203]
v_fmac_f32 v247, s65, v237
v_fmac_f32 v236, s66, v244
v_mfma_f32_16x16x32_bf16 v[200:203], a[204:207], a[152:155], v[200:203]
buffer_load_dwordx4 a[188:191], v14, s[8:11], s16 offen offset:3072 sc1
v_mfma_f32_16x16x32_bf16 v[200:203], a[196:199], a[148:151], v[200:203]
ds_read_b128 a[148:151], v1 offset:55296
s_add_u32 s16, s16, 1052672
v_mfma_f32_16x16x32_bf16 v[208:211], a[196:199], a[152:155], v[208:211]
v_fmac_f32 v237, s66, v245
v_accvgpr_write_b32 a112, v246
v_mfma_f32_16x16x32_bf16 v[208:211], a[204:207], a[156:159], v[208:211]
v_accvgpr_write_b32 a113, v247
v_accvgpr_write_b32 a48, v236
v_mfma_f32_16x16x32_bf16 v[208:211], a[212:215], a[128:131], v[208:211]
v_accvgpr_write_b32 a49, v237
s_waitcnt vmcnt(9) lgkmcnt(1)
v_mfma_f32_16x16x32_bf16 v[208:211], a[220:223], a[132:135], v[208:211]
v_accvgpr_read_b32 v240, a114
v_accvgpr_read_b32 v241, a115
v_mfma_f32_16x16x32_bf16 v[204:207], a[216:219], a[132:135], v[204:207]
v_accvgpr_read_b32 v238, a50
v_accvgpr_read_b32 v239, a51
v_mfma_f32_16x16x32_bf16 v[204:207], a[208:211], a[128:131], v[204:207]
v_add_f32 v242, v240, v134
v_add_f32 v243, v241, v135
v_mfma_f32_16x16x32_bf16 v[204:207], a[200:203], a[156:159], v[204:207]
v_sub_f32 v240, v240, v134
v_sub_f32 v241, v241, v135
v_mfma_f32_16x16x32_bf16 v[204:207], a[192:195], a[152:155], v[204:207]
ds_read_b128 a[152:155], v1 offset:57344
v_mul_f32 v134, s61, v70
v_mfma_f32_16x16x32_bf16 v[148:151], a[224:227], a[136:139], v[148:151]
ds_read_b128 a[156:159], v1 offset:59392
v_mul_f32 v135, s61, v71
v_mfma_f32_16x16x32_bf16 v[148:151], a[232:235], a[140:143], v[148:151]
ds_read_b128 a[128:131], v1 offset:61440
v_fmac_f32 v70, s62, v240
v_mfma_f32_16x16x32_bf16 v[148:151], a[240:243], a[144:147], v[148:151]
v_fmac_f32 v71, s62, v241
s_waitcnt vmcnt(7) lgkmcnt(3)
v_mfma_f32_16x16x32_bf16 v[148:151], a[248:251], a[148:151], v[148:151]
buffer_load_dwordx4 a[192:195], v13, s[8:11], s16 offen offset:0 sc1
v_mfma_f32_16x16x32_bf16 v[152:155], a[252:255], a[148:151], v[152:155]
v_fmac_f32 v134, s63, v240
v_fmac_f32 v135, s63, v241
v_mfma_f32_16x16x32_bf16 v[152:155], a[244:247], a[144:147], v[152:155]
v_mul_f32 v240, s64, v238
v_mul_f32 v241, s64, v239
v_mfma_f32_16x16x32_bf16 v[152:155], a[236:239], a[140:143], v[152:155]
buffer_load_dwordx4 a[196:199], v14, s[8:11], s16 offen offset:0 sc1
v_mfma_f32_16x16x32_bf16 v[152:155], a[228:231], a[136:139], v[152:155]
v_fmac_f32 v240, s65, v242
v_fmac_f32 v241, s65, v243
v_mfma_f32_16x16x32_bf16 v[160:163], a[228:231], a[140:143], v[160:163]
v_fmac_f32 v242, s66, v238
v_fmac_f32 v243, s66, v239
v_mfma_f32_16x16x32_bf16 v[160:163], a[236:239], a[144:147], v[160:163]
ds_read_b128 a[132:135], v1 offset:63488
v_accvgpr_write_b32 a114, v240
v_mfma_f32_16x16x32_bf16 v[160:163], a[244:247], a[148:151], v[160:163]
v_accvgpr_write_b32 a115, v241
s_waitcnt vmcnt(8) lgkmcnt(1)
v_mfma_f32_16x16x32_bf16 v[160:163], a[252:255], a[152:155], v[160:163]
v_accvgpr_write_b32 a50, v242
v_accvgpr_write_b32 a51, v243
v_mfma_f32_16x16x32_bf16 v[156:159], a[248:251], a[152:155], v[156:159]
v_accvgpr_read_b32 v246, a116
v_accvgpr_read_b32 v247, a117
v_mfma_f32_16x16x32_bf16 v[156:159], a[240:243], a[148:151], v[156:159]
v_accvgpr_read_b32 v244, a52
v_accvgpr_read_b32 v245, a53
v_mfma_f32_16x16x32_bf16 v[156:159], a[232:235], a[144:147], v[156:159]
buffer_load_dwordx4 a[200:203], v13, s[8:11], s16 offen offset:1024 sc1
v_mfma_f32_16x16x32_bf16 v[156:159], a[224:227], a[140:143], v[156:159]
v_add_f32 v236, v246, v136
v_add_f32 v237, v247, v137
v_mfma_f32_16x16x32_bf16 v[164:167], a[224:227], a[144:147], v[164:167]
v_sub_f32 v246, v246, v136
v_sub_f32 v247, v247, v137
v_mfma_f32_16x16x32_bf16 v[164:167], a[232:235], a[148:151], v[164:167]
ds_read_b128 a[136:139], v3 offset:49152
v_mul_f32 v136, s61, v72
v_mfma_f32_16x16x32_bf16 v[164:167], a[240:243], a[152:155], v[164:167]
v_mul_f32 v137, s61, v73
v_fmac_f32 v72, s62, v246
v_mfma_f32_16x16x32_bf16 v[164:167], a[248:251], a[156:159], v[164:167]
v_fmac_f32 v73, s62, v247
v_fmac_f32 v136, s63, v246
v_mfma_f32_16x16x32_bf16 v[168:171], a[252:255], a[156:159], v[168:171]
v_fmac_f32 v137, s63, v247
v_mul_f32 v246, s64, v244
v_mfma_f32_16x16x32_bf16 v[168:171], a[244:247], a[152:155], v[168:171]
v_mul_f32 v247, s64, v245
v_fmac_f32 v246, s65, v236
v_mfma_f32_16x16x32_bf16 v[168:171], a[236:239], a[148:151], v[168:171]
buffer_load_dwordx4 a[204:207], v14, s[8:11], s16 offen offset:1024 sc1
v_mfma_f32_16x16x32_bf16 v[168:171], a[228:231], a[144:147], v[168:171]
v_fmac_f32 v247, s65, v237
v_fmac_f32 v236, s66, v244
v_mfma_f32_16x16x32_bf16 v[176:179], a[228:231], a[148:151], v[176:179]
v_fmac_f32 v237, s66, v245
v_accvgpr_write_b32 a116, v246
v_mfma_f32_16x16x32_bf16 v[176:179], a[236:239], a[152:155], v[176:179]
ds_read_b128 a[140:143], v3 offset:51200
v_accvgpr_write_b32 a117, v247
v_mfma_f32_16x16x32_bf16 v[176:179], a[244:247], a[156:159], v[176:179]
v_accvgpr_write_b32 a52, v236
v_accvgpr_write_b32 a53, v237
v_mfma_f32_16x16x32_bf16 v[176:179], a[252:255], a[128:131], v[176:179]
v_accvgpr_read_b32 v240, a118
v_accvgpr_read_b32 v241, a119
v_mfma_f32_16x16x32_bf16 v[172:175], a[248:251], a[128:131], v[172:175]
v_accvgpr_read_b32 v238, a54
v_accvgpr_read_b32 v239, a55
v_mfma_f32_16x16x32_bf16 v[172:175], a[240:243], a[156:159], v[172:175]
v_add_f32 v242, v240, v138
v_add_f32 v243, v241, v139
v_mfma_f32_16x16x32_bf16 v[172:175], a[232:235], a[152:155], v[172:175]
buffer_load_dwordx4 a[208:211], v13, s[8:11], s16 offen offset:2048 sc1
v_mfma_f32_16x16x32_bf16 v[172:175], a[224:227], a[148:151], v[172:175]
v_sub_f32 v240, v240, v138
v_sub_f32 v241, v241, v139
v_mfma_f32_16x16x32_bf16 v[180:183], a[224:227], a[152:155], v[180:183]
v_mul_f32 v138, s61, v74
v_mul_f32 v139, s61, v75
v_mfma_f32_16x16x32_bf16 v[180:183], a[232:235], a[156:159], v[180:183]
ds_read_b128 a[144:147], v3 offset:53248
v_fmac_f32 v74, s62, v240
v_mfma_f32_16x16x32_bf16 v[180:183], a[240:243], a[128:131], v[180:183]
v_fmac_f32 v75, s62, v241
s_waitcnt vmcnt(7) lgkmcnt(1)
v_mfma_f32_16x16x32_bf16 v[180:183], a[248:251], a[132:135], v[180:183]
v_fmac_f32 v138, s63, v240
v_fmac_f32 v139, s63, v241
v_mfma_f32_16x16x32_bf16 v[184:187], a[252:255], a[132:135], v[184:187]
v_mul_f32 v240, s64, v238
v_mul_f32 v241, s64, v239
v_mfma_f32_16x16x32_bf16 v[184:187], a[244:247], a[128:131], v[184:187]
v_fmac_f32 v240, s65, v242
v_fmac_f32 v241, s65, v243
v_mfma_f32_16x16x32_bf16 v[184:187], a[236:239], a[156:159], v[184:187]
ds_read_b128 a[148:151], v2 offset:49152
v_fmac_f32 v242, s66, v238
v_mfma_f32_16x16x32_bf16 v[184:187], a[228:231], a[152:155], v[184:187]
ds_read_b128 a[152:155], v2 offset:51200
v_fmac_f32 v243, s66, v239
v_mfma_f32_16x16x32_bf16 v[192:195], a[228:231], a[156:159], v[192:195]
buffer_load_dwordx4 a[212:215], v14, s[8:11], s16 offen offset:2048 sc1
v_mfma_f32_16x16x32_bf16 v[192:195], a[236:239], a[128:131], v[192:195]
v_accvgpr_write_b32 a118, v240
v_accvgpr_write_b32 a119, v241
v_mfma_f32_16x16x32_bf16 v[192:195], a[244:247], a[132:135], v[192:195]
v_accvgpr_write_b32 a54, v242
v_accvgpr_write_b32 a55, v243
v_mfma_f32_16x16x32_bf16 v[192:195], a[252:255], a[136:139], v[192:195]
v_accvgpr_read_b32 v246, a120
v_accvgpr_read_b32 v247, a121
v_mfma_f32_16x16x32_bf16 v[188:191], a[248:251], a[136:139], v[188:191]
v_accvgpr_read_b32 v244, a56
v_accvgpr_read_b32 v245, a57
v_mfma_f32_16x16x32_bf16 v[188:191], a[240:243], a[132:135], v[188:191]
v_add_f32 v236, v246, v140
v_add_f32 v237, v247, v141
v_mfma_f32_16x16x32_bf16 v[188:191], a[232:235], a[128:131], v[188:191]
buffer_load_dwordx4 a[216:219], v13, s[8:11], s16 offen offset:3072 sc1
v_mfma_f32_16x16x32_bf16 v[188:191], a[224:227], a[156:159], v[188:191]
ds_read_b128 a[156:159], v2 offset:53248
v_sub_f32 v246, v246, v140
v_mfma_f32_16x16x32_bf16 v[196:199], a[224:227], a[128:131], v[196:199]
v_sub_f32 v247, v247, v141
v_mul_f32 v140, s61, v76
v_mfma_f32_16x16x32_bf16 v[196:199], a[232:235], a[132:135], v[196:199]
v_mul_f32 v141, s61, v77
v_fmac_f32 v76, s62, v246
v_mfma_f32_16x16x32_bf16 v[196:199], a[240:243], a[136:139], v[196:199]
v_fmac_f32 v77, s62, v247
v_fmac_f32 v140, s63, v246
v_mfma_f32_16x16x32_bf16 v[196:199], a[248:251], a[140:143], v[196:199]
v_fmac_f32 v141, s63, v247
v_mul_f32 v246, s64, v244
v_mfma_f32_16x16x32_bf16 v[200:203], a[252:255], a[140:143], v[200:203]
v_mul_f32 v247, s64, v245
v_fmac_f32 v246, s65, v236
v_mfma_f32_16x16x32_bf16 v[200:203], a[244:247], a[136:139], v[200:203]
v_fmac_f32 v247, s65, v237
v_fmac_f32 v236, s66, v244
v_mfma_f32_16x16x32_bf16 v[200:203], a[236:239], a[132:135], v[200:203]
buffer_load_dwordx4 a[220:223], v14, s[8:11], s16 offen offset:3072 sc1
v_mfma_f32_16x16x32_bf16 v[200:203], a[228:231], a[128:131], v[200:203]
ds_read_b128 a[128:131], v2 offset:55296
s_add_u32 s16, s16, 4096
v_mfma_f32_16x16x32_bf16 v[208:211], a[228:231], a[132:135], v[208:211]
v_fmac_f32 v237, s66, v245
v_accvgpr_write_b32 a120, v246
v_mfma_f32_16x16x32_bf16 v[208:211], a[236:239], a[136:139], v[208:211]
v_accvgpr_write_b32 a121, v247
v_accvgpr_write_b32 a56, v236
v_mfma_f32_16x16x32_bf16 v[208:211], a[244:247], a[140:143], v[208:211]
v_accvgpr_write_b32 a57, v237
s_waitcnt vmcnt(8) lgkmcnt(1)
v_mfma_f32_16x16x32_bf16 v[208:211], a[252:255], a[144:147], v[208:211]
v_accvgpr_read_b32 v240, a122
v_accvgpr_read_b32 v241, a123
v_mfma_f32_16x16x32_bf16 v[204:207], a[248:251], a[144:147], v[204:207]
v_accvgpr_read_b32 v238, a58
v_accvgpr_read_b32 v239, a59
v_mfma_f32_16x16x32_bf16 v[204:207], a[240:243], a[140:143], v[204:207]
v_add_f32 v242, v240, v142
v_add_f32 v243, v241, v143
v_mfma_f32_16x16x32_bf16 v[204:207], a[232:235], a[136:139], v[204:207]
v_sub_f32 v240, v240, v142
v_sub_f32 v241, v241, v143
v_mfma_f32_16x16x32_bf16 v[204:207], a[224:227], a[132:135], v[204:207]
ds_read_b128 a[132:135], v2 offset:57344
v_mul_f32 v142, s61, v78
v_mfma_f32_16x16x32_bf16 v[148:151], a[160:163], a[148:151], v[148:151]
ds_read_b128 a[136:139], v2 offset:59392
v_mul_f32 v143, s61, v79
v_mfma_f32_16x16x32_bf16 v[148:151], a[168:171], a[152:155], v[148:151]
ds_read_b128 a[140:143], v2 offset:61440
v_fmac_f32 v78, s62, v240
v_mfma_f32_16x16x32_bf16 v[148:151], a[176:179], a[156:159], v[148:151]
v_fmac_f32 v79, s62, v241
s_waitcnt vmcnt(6) lgkmcnt(3)
v_mfma_f32_16x16x32_bf16 v[148:151], a[184:187], a[128:131], v[148:151]
buffer_load_dwordx4 a[224:227], v13, s[8:11], s16 offen offset:0 sc1
v_mfma_f32_16x16x32_bf16 v[152:155], a[188:191], a[128:131], v[152:155]
v_fmac_f32 v142, s63, v240
v_fmac_f32 v143, s63, v241
v_mfma_f32_16x16x32_bf16 v[152:155], a[180:183], a[156:159], v[152:155]
v_mul_f32 v240, s64, v238
v_mul_f32 v241, s64, v239
v_mfma_f32_16x16x32_bf16 v[152:155], a[172:175], a[152:155], v[152:155]
buffer_load_dwordx4 a[228:231], v14, s[8:11], s16 offen offset:0 sc1
v_mfma_f32_16x16x32_bf16 v[152:155], a[164:167], a[148:151], v[152:155]
v_fmac_f32 v240, s65, v242
v_fmac_f32 v241, s65, v243
v_mfma_f32_16x16x32_bf16 v[160:163], a[164:167], a[152:155], v[160:163]
v_fmac_f32 v242, s66, v238
v_fmac_f32 v243, s66, v239
v_mfma_f32_16x16x32_bf16 v[160:163], a[172:175], a[156:159], v[160:163]
ds_read_b128 a[144:147], v2 offset:63488
v_accvgpr_write_b32 a122, v240
v_mfma_f32_16x16x32_bf16 v[160:163], a[180:183], a[128:131], v[160:163]
v_accvgpr_write_b32 a123, v241
s_waitcnt vmcnt(7) lgkmcnt(1)
v_mfma_f32_16x16x32_bf16 v[160:163], a[188:191], a[132:135], v[160:163]
v_accvgpr_write_b32 a58, v242
v_accvgpr_write_b32 a59, v243
v_mfma_f32_16x16x32_bf16 v[156:159], a[184:187], a[132:135], v[156:159]
v_accvgpr_read_b32 v246, a124
v_accvgpr_read_b32 v247, a125
v_mfma_f32_16x16x32_bf16 v[156:159], a[176:179], a[128:131], v[156:159]
v_accvgpr_read_b32 v244, a60
v_accvgpr_read_b32 v245, a61
v_mfma_f32_16x16x32_bf16 v[156:159], a[168:171], a[156:159], v[156:159]
buffer_load_dwordx4 a[232:235], v13, s[8:11], s16 offen offset:1024 sc1
v_mfma_f32_16x16x32_bf16 v[156:159], a[160:163], a[152:155], v[156:159]
v_add_f32 v236, v246, v144
v_add_f32 v237, v247, v145
v_mfma_f32_16x16x32_bf16 v[164:167], a[160:163], a[156:159], v[164:167]
v_sub_f32 v246, v246, v144
v_sub_f32 v247, v247, v145
v_mfma_f32_16x16x32_bf16 v[164:167], a[168:171], a[128:131], v[164:167]
ds_read_b128 a[148:151], v4 offset:49152
v_mul_f32 v144, s61, v80
v_mfma_f32_16x16x32_bf16 v[164:167], a[176:179], a[132:135], v[164:167]
v_mul_f32 v145, s61, v81
v_fmac_f32 v80, s62, v246
v_mfma_f32_16x16x32_bf16 v[164:167], a[184:187], a[136:139], v[164:167]
v_fmac_f32 v81, s62, v247
v_fmac_f32 v144, s63, v246
v_mfma_f32_16x16x32_bf16 v[168:171], a[188:191], a[136:139], v[168:171]
v_fmac_f32 v145, s63, v247
v_mul_f32 v246, s64, v244
v_mfma_f32_16x16x32_bf16 v[168:171], a[180:183], a[132:135], v[168:171]
v_mul_f32 v247, s64, v245
v_fmac_f32 v246, s65, v236
v_mfma_f32_16x16x32_bf16 v[168:171], a[172:175], a[128:131], v[168:171]
buffer_load_dwordx4 a[236:239], v14, s[8:11], s16 offen offset:1024 sc1
v_mfma_f32_16x16x32_bf16 v[168:171], a[164:167], a[156:159], v[168:171]
v_fmac_f32 v247, s65, v237
v_fmac_f32 v236, s66, v244
v_mfma_f32_16x16x32_bf16 v[176:179], a[164:167], a[128:131], v[176:179]
v_fmac_f32 v237, s66, v245
v_accvgpr_write_b32 a124, v246
v_mfma_f32_16x16x32_bf16 v[176:179], a[172:175], a[132:135], v[176:179]
ds_read_b128 a[152:155], v4 offset:51200
v_accvgpr_write_b32 a125, v247
v_mfma_f32_16x16x32_bf16 v[176:179], a[180:183], a[136:139], v[176:179]
v_accvgpr_write_b32 a60, v236
v_accvgpr_write_b32 a61, v237
v_mfma_f32_16x16x32_bf16 v[176:179], a[188:191], a[140:143], v[176:179]
v_accvgpr_read_b32 v240, a126
v_accvgpr_read_b32 v241, a127
v_mfma_f32_16x16x32_bf16 v[172:175], a[184:187], a[140:143], v[172:175]
v_accvgpr_read_b32 v238, a62
v_accvgpr_read_b32 v239, a63
v_mfma_f32_16x16x32_bf16 v[172:175], a[176:179], a[136:139], v[172:175]
v_add_f32 v242, v240, v146
v_add_f32 v243, v241, v147
v_mfma_f32_16x16x32_bf16 v[172:175], a[168:171], a[132:135], v[172:175]
buffer_load_dwordx4 a[240:243], v13, s[8:11], s16 offen offset:2048 sc1
v_mfma_f32_16x16x32_bf16 v[172:175], a[160:163], a[128:131], v[172:175]
v_sub_f32 v240, v240, v146
v_sub_f32 v241, v241, v147
v_mfma_f32_16x16x32_bf16 v[180:183], a[160:163], a[132:135], v[180:183]
v_mul_f32 v146, s61, v82
v_mul_f32 v147, s61, v83
v_mfma_f32_16x16x32_bf16 v[180:183], a[168:171], a[136:139], v[180:183]
ds_read_b128 a[156:159], v4 offset:53248
v_fmac_f32 v82, s62, v240
v_mfma_f32_16x16x32_bf16 v[180:183], a[176:179], a[140:143], v[180:183]
v_fmac_f32 v83, s62, v241
s_waitcnt vmcnt(7) lgkmcnt(1)
v_mfma_f32_16x16x32_bf16 v[180:183], a[184:187], a[144:147], v[180:183]
v_fmac_f32 v146, s63, v240
v_fmac_f32 v147, s63, v241
v_mfma_f32_16x16x32_bf16 v[184:187], a[188:191], a[144:147], v[184:187]
v_mul_f32 v240, s64, v238
v_mul_f32 v241, s64, v239
v_mfma_f32_16x16x32_bf16 v[184:187], a[180:183], a[140:143], v[184:187]
v_fmac_f32 v240, s65, v242
v_fmac_f32 v241, s65, v243
v_mfma_f32_16x16x32_bf16 v[184:187], a[172:175], a[136:139], v[184:187]
buffer_load_dwordx4 a[244:247], v14, s[8:11], s16 offen offset:2048 sc1
v_mfma_f32_16x16x32_bf16 v[184:187], a[164:167], a[132:135], v[184:187]
v_fmac_f32 v242, s66, v238
v_fmac_f32 v243, s66, v239
v_mfma_f32_16x16x32_bf16 v[192:195], a[164:167], a[136:139], v[192:195]
s_waitcnt lgkmcnt(0)
s_barrier
v_mfma_f32_16x16x32_bf16 v[192:195], a[172:175], a[140:143], v[192:195]
ds_read_b128 a[128:131], v5 offset:0
v_accvgpr_write_b32 a126, v240
v_mfma_f32_16x16x32_bf16 v[192:195], a[180:183], a[144:147], v[192:195]
ds_read_b128 a[132:135], v5 offset:2048
v_accvgpr_write_b32 a127, v241
v_mfma_f32_16x16x32_bf16 v[192:195], a[188:191], a[148:151], v[192:195]
v_accvgpr_write_b32 a62, v242
v_accvgpr_write_b32 a63, v243
v_mfma_f32_16x16x32_bf16 v[188:191], a[184:187], a[148:151], v[188:191]
s_add_u32 m0, s49, 0
v_add_f32 v20, v20, v148
v_mfma_f32_16x16x32_bf16 v[188:191], a[176:179], a[144:147], v[188:191]
v_add_f32 v21, v21, v149
v_add_f32 v22, v22, v150
v_mfma_f32_16x16x32_bf16 v[188:191], a[168:171], a[140:143], v[188:191]
buffer_load_dwordx4 a[248:251], v13, s[8:11], s16 offen offset:3072 sc1
v_mfma_f32_16x16x32_bf16 v[188:191], a[160:163], a[136:139], v[188:191]
ds_read_b128 a[136:139], v5 offset:4096
v_add_f32 v23, v23, v151
v_mfma_f32_16x16x32_bf16 v[196:199], a[160:163], a[140:143], v[196:199]
v_add_f32 v24, v24, v152
v_add_f32 v25, v25, v153
v_mfma_f32_16x16x32_bf16 v[196:199], a[168:171], a[144:147], v[196:199]
v_add_f32 v26, v26, v154
v_add_f32 v27, v27, v155
v_mfma_f32_16x16x32_bf16 v[196:199], a[176:179], a[148:151], v[196:199]
v_min_f32 v20, s67, v20
v_min_f32 v21, s67, v21
v_mfma_f32_16x16x32_bf16 v[196:199], a[184:187], a[152:155], v[196:199]
v_min_f32 v22, s67, v22
v_min_f32 v23, s67, v23
v_mfma_f32_16x16x32_bf16 v[200:203], a[188:191], a[152:155], v[200:203]
v_exp_f32 v24, v24
v_mfma_f32_16x16x32_bf16 v[200:203], a[180:183], a[148:151], v[200:203]
v_exp_f32 v25, v25
v_mfma_f32_16x16x32_bf16 v[200:203], a[172:175], a[144:147], v[200:203]
buffer_load_dwordx4 a[252:255], v14, s[8:11], s16 offen offset:3072 sc1
v_mfma_f32_16x16x32_bf16 v[200:203], a[164:167], a[140:143], v[200:203]
ds_read_b128 a[140:143], v5 offset:6144
s_add_u32 s16, s16, 4096
v_mfma_f32_16x16x32_bf16 v[208:211], a[164:167], a[144:147], v[208:211]
s_add_u32 s48, s3, 131072
v_add_f32 v28, v28, v156
v_mfma_f32_16x16x32_bf16 v[208:211], a[172:175], a[148:151], v[208:211]
v_exp_f32 v26, v26
v_mfma_f32_16x16x32_bf16 v[208:211], a[180:183], a[152:155], v[208:211]
v_exp_f32 v27, v27
v_mfma_f32_16x16x32_bf16 v[208:211], a[188:191], a[156:159], v[208:211]
v_exp_f32 v20, v20
v_mfma_f32_16x16x32_bf16 v[204:207], a[184:187], a[156:159], v[204:207]
v_exp_f32 v21, v21
v_mfma_f32_16x16x32_bf16 v[204:207], a[176:179], a[152:155], v[204:207]
v_exp_f32 v22, v22
v_mfma_f32_16x16x32_bf16 v[204:207], a[168:171], a[148:151], v[204:207]
v_exp_f32 v23, v23
v_mfma_f32_16x16x32_bf16 v[204:207], a[160:163], a[144:147], v[204:207]
ds_read_b128 a[144:147], v5 offset:8192
s_waitcnt vmcnt(6) lgkmcnt(2)
v_mfma_f32_16x16x32_bf16 a[0:3], a[192:195], a[128:131], a[0:3]
ds_read_b128 a[148:151], v5 offset:10240
v_add_f32 v244, 1.0, v20
v_mfma_f32_16x16x32_bf16 a[0:3], a[200:203], a[132:135], a[0:3]
ds_read_b128 a[152:155], v5 offset:12288
v_add_f32 v245, 1.0, v21
v_mfma_f32_16x16x32_bf16 a[0:3], a[208:211], a[136:139], a[0:3]
v_add_f32 v246, 1.0, v22
s_waitcnt lgkmcnt(3)
v_mfma_f32_16x16x32_bf16 a[0:3], a[216:219], a[140:143], a[0:3]
buffer_load_dwordx4 a[160:163], v13, s[8:11], s16 offen offset:0 sc1
v_mfma_f32_16x16x32_bf16 a[4:7], a[220:223], a[140:143], a[4:7]
v_add_f32 v247, 1.0, v23
v_fmac_f32 v244, v244, v24
v_mfma_f32_16x16x32_bf16 a[4:7], a[212:215], a[136:139], a[4:7]
buffer_load_dwordx4 v18, s[8:11], s48 offen offset:0 sc1 lds
v_mfma_f32_16x16x32_bf16 a[4:7], a[204:207], a[132:135], a[4:7]
buffer_load_dwordx4 a[164:167], v14, s[8:11], s16 offen offset:0 sc1
v_mfma_f32_16x16x32_bf16 a[4:7], a[196:199], a[128:131], a[4:7]
v_fmac_f32 v245, v245, v25
v_fmac_f32 v246, v246, v26
v_mfma_f32_16x16x32_bf16 a[12:15], a[196:199], a[132:135], a[12:15]
v_fmac_f32 v247, v247, v27
v_add_f32 v29, v29, v157
v_mfma_f32_16x16x32_bf16 a[12:15], a[204:207], a[136:139], a[12:15]
ds_read_b128 a[156:159], v5 offset:14336
v_add_f32 v30, v30, v158
v_mfma_f32_16x16x32_bf16 a[12:15], a[212:215], a[140:143], a[12:15]
v_add_f32 v31, v31, v159
s_waitcnt vmcnt(8) lgkmcnt(1)
v_mfma_f32_16x16x32_bf16 a[12:15], a[220:223], a[144:147], a[12:15]
v_rcp_f32 v244, v244
v_mfma_f32_16x16x32_bf16 a[8:11], a[216:219], a[144:147], a[8:11]
v_rcp_f32 v245, v245
v_mfma_f32_16x16x32_bf16 a[8:11], a[208:211], a[140:143], a[8:11]
v_rcp_f32 v246, v246
v_mfma_f32_16x16x32_bf16 a[8:11], a[200:203], a[136:139], a[8:11]
buffer_load_dwordx4 a[168:171], v13, s[8:11], s16 offen offset:1024 sc1
v_mfma_f32_16x16x32_bf16 a[8:11], a[192:195], a[132:135], a[8:11]
v_rcp_f32 v247, v247
v_mfma_f32_16x16x32_bf16 a[16:19], a[192:195], a[136:139], a[16:19]
v_fma_f32 v244, -v20, v244, v244
v_fma_f32 v245, -v21, v245, v245
v_mfma_f32_16x16x32_bf16 a[16:19], a[200:203], a[140:143], a[16:19]
ds_read_b128 a[128:131], v7 offset:0
v_fma_f32 v246, -v22, v246, v246
v_mfma_f32_16x16x32_bf16 a[16:19], a[208:211], a[144:147], a[16:19]
buffer_load_dwordx4 v18, s[8:11], s48 offen offset:1024 sc1 lds
v_mfma_f32_16x16x32_bf16 a[16:19], a[216:219], a[148:151], a[16:19]
v_fma_f32 v247, -v23, v247, v247
v_cvt_pk_bf16_f32 v248, v244, v245
v_mfma_f32_16x16x32_bf16 a[20:23], a[220:223], a[148:151], a[20:23]
v_cvt_pk_bf16_f32 v249, v246, v247
v_add_f32 v32, v32, v160
v_mfma_f32_16x16x32_bf16 a[20:23], a[212:215], a[144:147], a[20:23]
ds_write_b64 v9, v[248:249] offset:0
v_mfma_f32_16x16x32_bf16 a[20:23], a[204:207], a[140:143], a[20:23]
buffer_load_dwordx4 a[172:175], v14, s[8:11], s16 offen offset:1024 sc1
v_mfma_f32_16x16x32_bf16 a[20:23], a[196:199], a[136:139], a[20:23]
v_add_f32 v33, v33, v161
v_add_f32 v34, v34, v162
v_mfma_f32_16x16x32_bf16 a[28:31], a[196:199], a[140:143], a[28:31]
v_add_f32 v35, v35, v163
v_min_f32 v28, s67, v28
v_mfma_f32_16x16x32_bf16 a[28:31], a[204:207], a[144:147], a[28:31]
ds_read_b128 a[132:135], v7 offset:2048
v_min_f32 v29, s67, v29
v_mfma_f32_16x16x32_bf16 a[28:31], a[212:215], a[148:151], a[28:31]
v_min_f32 v30, s67, v30
v_min_f32 v31, s67, v31
v_mfma_f32_16x16x32_bf16 a[28:31], a[220:223], a[152:155], a[28:31]
v_exp_f32 v32, v32
v_mfma_f32_16x16x32_bf16 a[24:27], a[216:219], a[152:155], a[24:27]
v_exp_f32 v33, v33
v_mfma_f32_16x16x32_bf16 a[24:27], a[208:211], a[148:151], a[24:27]
v_exp_f32 v34, v34
v_mfma_f32_16x16x32_bf16 a[24:27], a[200:203], a[144:147], a[24:27]
buffer_load_dwordx4 a[176:179], v13, s[8:11], s16 offen offset:2048 sc1
v_mfma_f32_16x16x32_bf16 a[24:27], a[192:195], a[140:143], a[24:27]
buffer_load_dwordx4 v18, s[8:11], s48 offen offset:2048 sc1 lds
v_mfma_f32_16x16x32_bf16 a[32:35], a[192:195], a[144:147], a[32:35]
v_exp_f32 v35, v35
v_mfma_f32_16x16x32_bf16 a[32:35], a[200:203], a[148:151], a[32:35]
ds_read_b128 a[136:139], v7 offset:4096
v_add_f32 v36, v36, v164
v_mfma_f32_16x16x32_bf16 a[32:35], a[208:211], a[152:155], a[32:35]
v_add_f32 v37, v37, v165
s_waitcnt vmcnt(10) lgkmcnt(1)
v_mfma_f32_16x16x32_bf16 a[32:35], a[216:219], a[156:159], a[32:35]
v_exp_f32 v28, v28
v_mfma_f32_16x16x32_bf16 a[36:39], a[220:223], a[156:159], a[36:39]
v_exp_f32 v29, v29
v_mfma_f32_16x16x32_bf16 a[36:39], a[212:215], a[152:155], a[36:39]
v_exp_f32 v30, v30
v_mfma_f32_16x16x32_bf16 a[36:39], a[204:207], a[148:151], a[36:39]
ds_read_b128 a[140:143], v6 offset:0
v_add_f32 v38, v38, v166
v_mfma_f32_16x16x32_bf16 a[36:39], a[196:199], a[144:147], a[36:39]
ds_read_b128 a[144:147], v6 offset:2048
v_add_f32 v39, v39, v167
v_mfma_f32_16x16x32_bf16 a[44:47], a[196:199], a[148:151], a[44:47]
buffer_load_dwordx4 a[180:183], v14, s[8:11], s16 offen offset:2048 sc1
v_mfma_f32_16x16x32_bf16 a[44:47], a[204:207], a[152:155], a[44:47]
v_exp_f32 v31, v31
v_mfma_f32_16x16x32_bf16 a[44:47], a[212:215], a[156:159], a[44:47]
buffer_load_dwordx4 v18, s[8:11], s48 offen offset:3072 sc1 lds
v_mfma_f32_16x16x32_bf16 a[44:47], a[220:223], a[128:131], a[44:47]
v_add_f32 v212, 1.0, v28
v_add_f32 v213, 1.0, v29
v_mfma_f32_16x16x32_bf16 a[40:43], a[216:219], a[128:131], a[40:43]
v_add_f32 v214, 1.0, v30
v_add_f32 v215, 1.0, v31
v_mfma_f32_16x16x32_bf16 a[40:43], a[208:211], a[156:159], a[40:43]
v_fmac_f32 v212, v212, v32
v_fmac_f32 v213, v213, v33
v_mfma_f32_16x16x32_bf16 a[40:43], a[200:203], a[152:155], a[40:43]
buffer_load_dwordx4 a[184:187], v13, s[8:11], s16 offen offset:3072 sc1
v_mfma_f32_16x16x32_bf16 a[40:43], a[192:195], a[148:151], a[40:43]
ds_read_b128 a[148:151], v6 offset:4096
v_fmac_f32 v214, v214, v34
v_mfma_f32_16x16x32_bf16 a[48:51], a[192:195], a[152:155], a[48:51]
v_fmac_f32 v215, v215, v35
v_add_f32 v40, v40, v168
v_mfma_f32_16x16x32_bf16 a[48:51], a[200:203], a[156:159], a[48:51]
v_rcp_f32 v212, v212
v_mfma_f32_16x16x32_bf16 a[48:51], a[208:211], a[128:131], a[48:51]
v_rcp_f32 v213, v213
v_mfma_f32_16x16x32_bf16 a[48:51], a[216:219], a[132:135], a[48:51]
v_rcp_f32 v214, v214
v_mfma_f32_16x16x32_bf16 a[52:55], a[220:223], a[132:135], a[52:55]
v_rcp_f32 v215, v215
v_mfma_f32_16x16x32_bf16 a[52:55], a[212:215], a[128:131], a[52:55]
v_fma_f32 v212, -v28, v212, v212
v_fma_f32 v213, -v29, v213, v213
v_mfma_f32_16x16x32_bf16 a[52:55], a[204:207], a[156:159], a[52:55]
buffer_load_dwordx4 a[188:191], v14, s[8:11], s16 offen offset:3072 sc1
v_mfma_f32_16x16x32_bf16 a[52:55], a[196:199], a[152:155], a[52:55]
ds_read_b128 a[152:155], v6 offset:6144
s_add_u32 s16, s16, 4096
v_mfma_f32_16x16x32_bf16 a[60:63], a[196:199], a[156:159], a[60:63]
s_add_u32 m0, s49, 16384
v_fma_f32 v214, -v30, v214, v214
v_mfma_f32_16x16x32_bf16 a[60:63], a[204:207], a[128:131], a[60:63]
v_fma_f32 v215, -v31, v215, v215
v_cvt_pk_bf16_f32 v224, v212, v213
v_mfma_f32_16x16x32_bf16 a[60:63], a[212:215], a[132:135], a[60:63]
v_cvt_pk_bf16_f32 v225, v214, v215
s_waitcnt vmcnt(12) lgkmcnt(1)
v_mfma_f32_16x16x32_bf16 a[60:63], a[220:223], a[136:139], a[60:63]
ds_write_b64 v9, v[224:225] offset:2048
v_mfma_f32_16x16x32_bf16 a[56:59], a[216:219], a[136:139], a[56:59]
v_add_f32 v41, v41, v169
v_add_f32 v42, v42, v170
v_mfma_f32_16x16x32_bf16 a[56:59], a[208:211], a[132:135], a[56:59]
v_add_f32 v43, v43, v171
v_min_f32 v36, s67, v36
v_mfma_f32_16x16x32_bf16 a[56:59], a[200:203], a[128:131], a[56:59]
v_min_f32 v37, s67, v37
v_min_f32 v38, s67, v38
v_mfma_f32_16x16x32_bf16 a[56:59], a[192:195], a[156:159], a[56:59]
ds_read_b128 a[156:159], v6 offset:8192
v_min_f32 v39, s67, v39
v_mfma_f32_16x16x32_bf16 a[0:3], a[224:227], a[140:143], a[0:3]
ds_read_b128 a[128:131], v6 offset:10240
v_add_f32 v44, v44, v172
v_mfma_f32_16x16x32_bf16 a[0:3], a[232:235], a[144:147], a[0:3]
ds_read_b128 a[132:135], v6 offset:12288
v_add_f32 v45, v45, v173
v_mfma_f32_16x16x32_bf16 a[0:3], a[240:243], a[148:151], a[0:3]
v_add_f32 v46, v46, v174
s_waitcnt vmcnt(9) lgkmcnt(4)
v_mfma_f32_16x16x32_bf16 a[0:3], a[248:251], a[152:155], a[0:3]
buffer_load_dwordx4 a[192:195], v13, s[8:11], s16 offen offset:0 sc1
v_mfma_f32_16x16x32_bf16 a[4:7], a[252:255], a[152:155], a[4:7]
s_add_u32 s48, s3, 147456
v_add_f32 v47, v47, v175
v_mfma_f32_16x16x32_bf16 a[4:7], a[244:247], a[148:151], a[4:7]
v_exp_f32 v40, v40
v_mfma_f32_16x16x32_bf16 a[4:7], a[236:239], a[144:147], a[4:7]
buffer_load_dwordx4 a[196:199], v14, s[8:11], s16 offen offset:0 sc1
v_mfma_f32_16x16x32_bf16 a[4:7], a[228:231], a[140:143], a[4:7]
v_exp_f32 v41, v41
v_mfma_f32_16x16x32_bf16 a[12:15], a[228:231], a[144:147], a[12:15]
v_exp_f32 v42, v42
v_mfma_f32_16x16x32_bf16 a[12:15], a[236:239], a[148:151], a[12:15]
ds_read_b128 a[136:139], v6 offset:14336
v_add_f32 v48, v48, v176
v_mfma_f32_16x16x32_bf16 a[12:15], a[244:247], a[152:155], a[12:15]
v_add_f32 v49, v49, v177
s_waitcnt vmcnt(9) lgkmcnt(1)
v_mfma_f32_16x16x32_bf16 a[12:15], a[252:255], a[156:159], a[12:15]
v_exp_f32 v43, v43
v_mfma_f32_16x16x32_bf16 a[8:11], a[248:251], a[156:159], a[8:11]
v_exp_f32 v36, v36
v_mfma_f32_16x16x32_bf16 a[8:11], a[240:243], a[152:155], a[8:11]
v_exp_f32 v37, v37
v_mfma_f32_16x16x32_bf16 a[8:11], a[232:235], a[148:151], a[8:11]
buffer_load_dwordx4 a[200:203], v13, s[8:11], s16 offen offset:1024 sc1
v_mfma_f32_16x16x32_bf16 a[8:11], a[224:227], a[144:147], a[8:11]
v_exp_f32 v38, v38
v_mfma_f32_16x16x32_bf16 a[16:19], a[224:227], a[148:151], a[16:19]
buffer_load_dwordx4 v18, s[8:11], s48 offen offset:0 sc1 lds
v_mfma_f32_16x16x32_bf16 a[16:19], a[232:235], a[152:155], a[16:19]
ds_read_b128 a[140:143], v8 offset:0
v_add_f32 v50, v50, v178
v_mfma_f32_16x16x32_bf16 a[16:19], a[240:243], a[156:159], a[16:19]
v_exp_f32 v39, v39
v_mfma_f32_16x16x32_bf16 a[16:19], a[248:251], a[128:131], a[16:19]
v_add_f32 v236, 1.0, v36
v_add_f32 v237, 1.0, v37
v_mfma_f32_16x16x32_bf16 a[20:23], a[252:255], a[128:131], a[20:23]
v_add_f32 v238, 1.0, v38
v_add_f32 v239, 1.0, v39
v_mfma_f32_16x16x32_bf16 a[20:23], a[244:247], a[156:159], a[20:23]
v_fmac_f32 v236, v236, v40
v_fmac_f32 v237, v237, v41
v_mfma_f32_16x16x32_bf16 a[20:23], a[236:239], a[152:155], a[20:23]
buffer_load_dwordx4 a[204:207], v14, s[8:11], s16 offen offset:1024 sc1
v_mfma_f32_16x16x32_bf16 a[20:23], a[228:231], a[148:151], a[20:23]
v_fmac_f32 v238, v238, v42
v_fmac_f32 v239, v239, v43
v_mfma_f32_16x16x32_bf16 a[28:31], a[228:231], a[152:155], a[28:31]
v_rcp_f32 v236, v236
v_mfma_f32_16x16x32_bf16 a[28:31], a[236:239], a[156:159], a[28:31]
ds_read_b128 a[144:147], v8 offset:2048
v_add_f32 v51, v51, v179
v_mfma_f32_16x16x32_bf16 a[28:31], a[244:247], a[128:131], a[28:31]
s_getpc_b64 s[46:47]
v_min_f32 v44, s67, v44
v_mfma_f32_16x16x32_bf16 a[28:31], a[252:255], a[132:135], a[28:31]
global_load_dword v252, v255, s[46:47] offset:2048
v_mfma_f32_16x16x32_bf16 a[24:27], a[248:251], a[132:135], a[24:27]
buffer_load_dwordx4 v18, s[8:11], s48 offen offset:1024 sc1 lds
v_mfma_f32_16x16x32_bf16 a[24:27], a[240:243], a[128:131], a[24:27]
v_rcp_f32 v237, v237
v_mfma_f32_16x16x32_bf16 a[24:27], a[232:235], a[156:159], a[24:27]
buffer_load_dwordx4 a[208:211], v13, s[8:11], s16 offen offset:2048 sc1
v_mfma_f32_16x16x32_bf16 a[24:27], a[224:227], a[152:155], a[24:27]
v_rcp_f32 v238, v238
v_mfma_f32_16x16x32_bf16 a[32:35], a[224:227], a[156:159], a[32:35]
v_rcp_f32 v239, v239
v_mfma_f32_16x16x32_bf16 a[32:35], a[232:235], a[128:131], a[32:35]
ds_read_b128 a[148:151], v8 offset:4096
v_fma_f32 v236, -v36, v236, v236
v_mfma_f32_16x16x32_bf16 a[32:35], a[240:243], a[132:135], a[32:35]
v_fma_f32 v237, -v37, v237, v237
s_waitcnt vmcnt(10) lgkmcnt(1)
v_mfma_f32_16x16x32_bf16 a[32:35], a[248:251], a[136:139], a[32:35]
v_fma_f32 v238, -v38, v238, v238
v_fma_f32 v239, -v39, v239, v239
v_mfma_f32_16x16x32_bf16 a[36:39], a[252:255], a[136:139], a[36:39]
v_cvt_pk_bf16_f32 v250, v236, v237
v_cvt_pk_bf16_f32 v251, v238, v239
v_mfma_f32_16x16x32_bf16 a[36:39], a[244:247], a[132:135], a[36:39]
ds_write_b64 v9, v[250:251] offset:4096
v_mfma_f32_16x16x32_bf16 a[36:39], a[236:239], a[128:131], a[36:39]
ds_read_b128 a[152:155], v5 offset:16384
v_min_f32 v45, s67, v45
v_mfma_f32_16x16x32_bf16 a[36:39], a[228:231], a[156:159], a[36:39]
ds_read_b128 a[156:159], v5 offset:18432
v_min_f32 v46, s67, v46
v_mfma_f32_16x16x32_bf16 a[44:47], a[228:231], a[128:131], a[44:47]
buffer_load_dwordx4 a[212:215], v14, s[8:11], s16 offen offset:2048 sc1
v_mfma_f32_16x16x32_bf16 a[44:47], a[236:239], a[132:135], a[44:47]
buffer_load_dwordx4 v18, s[8:11], s48 offen offset:2048 sc1 lds
v_mfma_f32_16x16x32_bf16 a[44:47], a[244:247], a[136:139], a[44:47]
v_min_f32 v47, s67, v47
v_add_f32 v52, v52, v180
v_mfma_f32_16x16x32_bf16 a[44:47], a[252:255], a[140:143], a[44:47]
v_exp_f32 v48, v48
v_mfma_f32_16x16x32_bf16 a[40:43], a[248:251], a[140:143], a[40:43]
v_exp_f32 v49, v49
v_mfma_f32_16x16x32_bf16 a[40:43], a[240:243], a[136:139], a[40:43]
v_exp_f32 v50, v50
v_mfma_f32_16x16x32_bf16 a[40:43], a[232:235], a[132:135], a[40:43]
buffer_load_dwordx4 a[216:219], v13, s[8:11], s16 offen offset:3072 sc1
v_mfma_f32_16x16x32_bf16 a[40:43], a[224:227], a[128:131], a[40:43]
ds_read_b128 a[128:131], v5 offset:20480
v_add_f32 v53, v53, v181
v_mfma_f32_16x16x32_bf16 a[48:51], a[224:227], a[132:135], a[48:51]
v_exp_f32 v51, v51
v_mfma_f32_16x16x32_bf16 a[48:51], a[232:235], a[136:139], a[48:51]
v_exp_f32 v44, v44
v_mfma_f32_16x16x32_bf16 a[48:51], a[240:243], a[140:143], a[48:51]
v_exp_f32 v45, v45
v_mfma_f32_16x16x32_bf16 a[48:51], a[248:251], a[144:147], a[48:51]
v_exp_f32 v46, v46
v_mfma_f32_16x16x32_bf16 a[52:55], a[252:255], a[144:147], a[52:55]
v_exp_f32 v47, v47
v_mfma_f32_16x16x32_bf16 a[52:55], a[244:247], a[140:143], a[52:55]
buffer_load_dwordx4 v18, s[8:11], s48 offen offset:3072 sc1 lds
v_mfma_f32_16x16x32_bf16 a[52:55], a[236:239], a[136:139], a[52:55]
buffer_load_dwordx4 a[220:223], v14, s[8:11], s16 offen offset:3072 sc1
v_mfma_f32_16x16x32_bf16 a[52:55], a[228:231], a[132:135], a[52:55]
ds_read_b128 a[132:135], v5 offset:22528
s_add_u32 s16, s16, 4096
v_mfma_f32_16x16x32_bf16 a[60:63], a[228:231], a[136:139], a[60:63]
v_add_f32 v216, 1.0, v44
v_add_f32 v217, 1.0, v45
v_mfma_f32_16x16x32_bf16 a[60:63], a[236:239], a[140:143], a[60:63]
v_add_f32 v218, 1.0, v46
v_add_f32 v219, 1.0, v47
v_mfma_f32_16x16x32_bf16 a[60:63], a[244:247], a[144:147], a[60:63]
v_fmac_f32 v216, v216, v48
s_waitcnt vmcnt(13) lgkmcnt(1)
v_mfma_f32_16x16x32_bf16 a[60:63], a[252:255], a[148:151], a[60:63]
v_fmac_f32 v217, v217, v49
v_fmac_f32 v218, v218, v50
v_mfma_f32_16x16x32_bf16 a[56:59], a[248:251], a[148:151], a[56:59]
v_fmac_f32 v219, v219, v51
v_add_f32 v54, v54, v182
v_mfma_f32_16x16x32_bf16 a[56:59], a[240:243], a[144:147], a[56:59]
v_rcp_f32 v216, v216
v_mfma_f32_16x16x32_bf16 a[56:59], a[232:235], a[140:143], a[56:59]
v_rcp_f32 v217, v217
v_mfma_f32_16x16x32_bf16 a[56:59], a[224:227], a[136:139], a[56:59]
ds_read_b128 a[136:139], v5 offset:24576
v_add_f32 v55, v55, v183
v_mfma_f32_16x16x32_bf16 a[0:3], a[160:163], a[152:155], a[0:3]
ds_read_b128 a[140:143], v5 offset:26624
v_add_f32 v56, v56, v184
v_mfma_f32_16x16x32_bf16 a[0:3], a[168:171], a[156:159], a[0:3]
ds_read_b128 a[144:147], v5 offset:28672
v_add_f32 v57, v57, v185
v_mfma_f32_16x16x32_bf16 a[0:3], a[176:179], a[128:131], a[0:3]
s_add_u32 m0, s49, 32768
s_waitcnt vmcnt(11) lgkmcnt(3)
v_mfma_f32_16x16x32_bf16 a[0:3], a[184:187], a[132:135], a[0:3]
buffer_load_dwordx4 a[224:227], v13, s[8:11], s16 offen offset:0 sc1
v_mfma_f32_16x16x32_bf16 a[4:7], a[188:191], a[132:135], a[4:7]
v_rcp_f32 v218, v218
v_mfma_f32_16x16x32_bf16 a[4:7], a[180:183], a[128:131], a[4:7]
v_rcp_f32 v219, v219
v_mfma_f32_16x16x32_bf16 a[4:7], a[172:175], a[156:159], a[4:7]
buffer_load_dwordx4 a[228:231], v14, s[8:11], s16 offen offset:0 sc1
v_mfma_f32_16x16x32_bf16 a[4:7], a[164:167], a[152:155], a[4:7]
v_fma_f32 v216, -v44, v216, v216
v_fma_f32 v217, -v45, v217, v217
v_mfma_f32_16x16x32_bf16 a[12:15], a[164:167], a[156:159], a[12:15]
v_fma_f32 v218, -v46, v218, v218
v_fma_f32 v219, -v47, v219, v219
v_mfma_f32_16x16x32_bf16 a[12:15], a[172:175], a[128:131], a[12:15]
ds_read_b128 a[148:151], v5 offset:30720
v_cvt_pk_bf16_f32 v226, v216, v217
v_mfma_f32_16x16x32_bf16 a[12:15], a[180:183], a[132:135], a[12:15]
v_cvt_pk_bf16_f32 v227, v218, v219
s_waitcnt vmcnt(11) lgkmcnt(1)
v_mfma_f32_16x16x32_bf16 a[12:15], a[188:191], a[136:139], a[12:15]
ds_write_b64 v9, v[226:227] offset:6144
v_mfma_f32_16x16x32_bf16 a[8:11], a[184:187], a[136:139], a[8:11]
v_add_f32 v58, v58, v186
v_add_f32 v59, v59, v187
v_mfma_f32_16x16x32_bf16 a[8:11], a[176:179], a[132:135], a[8:11]
v_min_f32 v52, s67, v52
v_min_f32 v53, s67, v53
v_mfma_f32_16x16x32_bf16 a[8:11], a[168:171], a[128:131], a[8:11]
buffer_load_dwordx4 a[232:235], v13, s[8:11], s16 offen offset:1024 sc1
v_mfma_f32_16x16x32_bf16 a[8:11], a[160:163], a[156:159], a[8:11]
s_add_u32 s48, s3, 163840
v_min_f32 v54, s67, v54
v_mfma_f32_16x16x32_bf16 a[16:19], a[160:163], a[128:131], a[16:19]
v_min_f32 v55, s67, v55
v_add_f32 v60, v60, v188
v_mfma_f32_16x16x32_bf16 a[16:19], a[168:171], a[132:135], a[16:19]
ds_read_b128 a[152:155], v7 offset:16384
v_add_f32 v61, v61, v189
v_mfma_f32_16x16x32_bf16 a[16:19], a[176:179], a[136:139], a[16:19]
v_exp_f32 v56, v56
v_mfma_f32_16x16x32_bf16 a[16:19], a[184:187], a[140:143], a[16:19]
v_exp_f32 v57, v57
v_mfma_f32_16x16x32_bf16 a[20:23], a[188:191], a[140:143], a[20:23]
s_waitcnt vmcnt(9) lgkmcnt(1)
s_barrier
v_mfma_f32_16x16x32_bf16 a[20:23], a[180:183], a[136:139], a[20:23]
ds_read_b128 v[228:231], v10 offset:0
v_add_f32 v62, v62, v190
v_mfma_f32_16x16x32_bf16 a[20:23], a[172:175], a[132:135], a[20:23]
buffer_load_dwordx4 a[236:239], v14, s[8:11], s16 offen offset:1024 sc1
v_mfma_f32_16x16x32_bf16 a[20:23], a[164:167], a[128:131], a[20:23]
ds_read_b128 v[232:235], v10 offset:4096
v_add_f32 v63, v63, v191
v_mfma_f32_16x16x32_bf16 a[28:31], a[164:167], a[132:135], a[28:31]
v_exp_f32 v58, v58
v_mfma_f32_16x16x32_bf16 a[28:31], a[172:175], a[136:139], a[28:31]
ds_read_b128 a[156:159], v7 offset:18432
v_add_f32 v64, v64, v192
v_mfma_f32_16x16x32_bf16 a[28:31], a[180:183], a[140:143], a[28:31]
v_exp_f32 v59, v59
v_mfma_f32_16x16x32_bf16 a[28:31], a[188:191], a[144:147], a[28:31]
buffer_load_dwordx4 v18, s[8:11], s48 offen offset:0 sc1 lds
v_mfma_f32_16x16x32_bf16 a[24:27], a[184:187], a[144:147], a[24:27]
v_exp_f32 v52, v52
v_mfma_f32_16x16x32_bf16 a[24:27], a[176:179], a[140:143], a[24:27]
v_exp_f32 v53, v53
v_mfma_f32_16x16x32_bf16 a[24:27], a[168:171], a[136:139], a[24:27]
buffer_load_dwordx4 a[240:243], v13, s[8:11], s16 offen offset:2048 sc1
v_mfma_f32_16x16x32_bf16 a[24:27], a[160:163], a[132:135], a[24:27]
s_waitcnt vmcnt(11) lgkmcnt(2)
buffer_store_dwordx4 v[228:231], v17, s[12:15], s24 offen offset:1024 sc1
v_mfma_f32_16x16x32_bf16 a[32:35], a[160:163], a[136:139], a[32:35]
s_waitcnt vmcnt(11) lgkmcnt(1)
buffer_store_dwordx4 v[232:235], v17, s[12:15], s26 offen offset:1024 sc1
v_mfma_f32_16x16x32_bf16 a[32:35], a[168:171], a[140:143], a[32:35]
ds_read_b128 a[128:131], v7 offset:20480
v_add_f32 v65, v65, v193
v_mfma_f32_16x16x32_bf16 a[32:35], a[176:179], a[144:147], a[32:35]
v_exp_f32 v54, v54
v_mfma_f32_16x16x32_bf16 a[32:35], a[184:187], a[148:151], a[32:35]
v_exp_f32 v55, v55
v_mfma_f32_16x16x32_bf16 a[36:39], a[188:191], a[148:151], a[36:39]
v_add_f32 v240, 1.0, v52
v_add_f32 v241, 1.0, v53
v_mfma_f32_16x16x32_bf16 a[36:39], a[180:183], a[144:147], a[36:39]
v_add_f32 v242, 1.0, v54
v_add_f32 v243, 1.0, v55
v_mfma_f32_16x16x32_bf16 a[36:39], a[172:175], a[140:143], a[36:39]
ds_read_b128 a[132:135], v6 offset:16384
v_fmac_f32 v240, v240, v56
v_mfma_f32_16x16x32_bf16 a[36:39], a[164:167], a[136:139], a[36:39]
ds_read_b128 a[136:139], v6 offset:18432
v_fmac_f32 v241, v241, v57
v_mfma_f32_16x16x32_bf16 a[44:47], a[164:167], a[140:143], a[44:47]
buffer_load_dwordx4 a[244:247], v14, s[8:11], s16 offen offset:2048 sc1
v_mfma_f32_16x16x32_bf16 a[44:47], a[172:175], a[144:147], a[44:47]
buffer_load_dwordx4 v18, s[8:11], s48 offen offset:1024 sc1 lds
v_mfma_f32_16x16x32_bf16 a[44:47], a[180:183], a[148:151], a[44:47]
v_fmac_f32 v242, v242, v58
v_fmac_f32 v243, v243, v59
v_mfma_f32_16x16x32_bf16 a[44:47], a[188:191], a[152:155], a[44:47]
v_rcp_f32 v240, v240
v_mfma_f32_16x16x32_bf16 a[40:43], a[184:187], a[152:155], a[40:43]
v_rcp_f32 v241, v241
v_mfma_f32_16x16x32_bf16 a[40:43], a[176:179], a[148:151], a[40:43]
v_rcp_f32 v242, v242
v_mfma_f32_16x16x32_bf16 a[40:43], a[168:171], a[144:147], a[40:43]
buffer_load_dwordx4 a[248:251], v13, s[8:11], s16 offen offset:3072 sc1
v_mfma_f32_16x16x32_bf16 a[40:43], a[160:163], a[140:143], a[40:43]
ds_read_b128 a[140:143], v6 offset:20480
v_add_f32 v66, v66, v194
v_mfma_f32_16x16x32_bf16 a[48:51], a[160:163], a[144:147], a[48:51]
v_rcp_f32 v243, v243
v_mfma_f32_16x16x32_bf16 a[48:51], a[168:171], a[148:151], a[48:51]
v_fma_f32 v240, -v52, v240, v240
v_fma_f32 v241, -v53, v241, v241
v_mfma_f32_16x16x32_bf16 a[48:51], a[176:179], a[152:155], a[48:51]
v_fma_f32 v242, -v54, v242, v242
s_waitcnt vmcnt(11) lgkmcnt(1)
v_mfma_f32_16x16x32_bf16 a[48:51], a[184:187], a[156:159], a[48:51]
v_fma_f32 v243, -v55, v243, v243
v_cvt_pk_bf16_f32 v248, v240, v241
v_mfma_f32_16x16x32_bf16 a[52:55], a[188:191], a[156:159], a[52:55]
buffer_load_dwordx4 v18, s[8:11], s48 offen offset:2048 sc1 lds
v_mfma_f32_16x16x32_bf16 a[52:55], a[180:183], a[152:155], a[52:55]
v_cvt_pk_bf16_f32 v249, v242, v243
v_add_f32 v67, v67, v195
v_mfma_f32_16x16x32_bf16 a[52:55], a[172:175], a[148:151], a[52:55]
buffer_load_dwordx4 a[252:255], v14, s[8:11], s16 offen offset:3072 sc1
v_mfma_f32_16x16x32_bf16 a[52:55], a[164:167], a[144:147], a[52:55]
ds_read_b128 a[144:147], v6 offset:22528
s_add_u32 s16, s16, 4096
v_mfma_f32_16x16x32_bf16 a[60:63], a[164:167], a[148:151], a[60:63]
ds_write_b64 v9, v[248:249] offset:8192
v_mfma_f32_16x16x32_bf16 a[60:63], a[172:175], a[152:155], a[60:63]
v_min_f32 v60, s67, v60
v_min_f32 v61, s67, v61
v_mfma_f32_16x16x32_bf16 a[60:63], a[180:183], a[156:159], a[60:63]
v_min_f32 v62, s67, v62
v_min_f32 v63, s67, v63
v_mfma_f32_16x16x32_bf16 a[60:63], a[188:191], a[128:131], a[60:63]
v_exp_f32 v64, v64
v_mfma_f32_16x16x32_bf16 a[56:59], a[184:187], a[128:131], a[56:59]
v_exp_f32 v65, v65
v_mfma_f32_16x16x32_bf16 a[56:59], a[176:179], a[156:159], a[56:59]
v_exp_f32 v66, v66
v_mfma_f32_16x16x32_bf16 a[56:59], a[168:171], a[152:155], a[56:59]
v_exp_f32 v67, v67
v_mfma_f32_16x16x32_bf16 a[56:59], a[160:163], a[148:151], a[56:59]
ds_read_b128 a[148:151], v6 offset:24576
v_add_f32 v68, v68, v196
v_mfma_f32_16x16x32_bf16 a[0:3], a[192:195], a[132:135], a[0:3]
ds_read_b128 a[152:155], v6 offset:26624
v_add_f32 v69, v69, v197
v_mfma_f32_16x16x32_bf16 a[0:3], a[200:203], a[136:139], a[0:3]
ds_read_b128 a[156:159], v6 offset:28672
s_waitcnt vmcnt(11) lgkmcnt(3)
v_mfma_f32_16x16x32_bf16 a[0:3], a[208:211], a[140:143], a[0:3]
buffer_load_dwordx4 a[160:163], v13, s[8:11], s16 offen offset:0 sc1
v_mfma_f32_16x16x32_bf16 a[0:3], a[216:219], a[144:147], a[0:3]
buffer_load_dwordx4 v18, s[8:11], s48 offen offset:3072 sc1 lds
v_mfma_f32_16x16x32_bf16 a[4:7], a[220:223], a[144:147], a[4:7]
v_exp_f32 v60, v60
v_mfma_f32_16x16x32_bf16 a[4:7], a[212:215], a[140:143], a[4:7]
v_exp_f32 v61, v61
v_mfma_f32_16x16x32_bf16 a[4:7], a[204:207], a[136:139], a[4:7]
buffer_load_dwordx4 a[164:167], v14, s[8:11], s16 offen offset:0 sc1
v_mfma_f32_16x16x32_bf16 a[4:7], a[196:199], a[132:135], a[4:7]
v_exp_f32 v62, v62
v_mfma_f32_16x16x32_bf16 a[12:15], a[196:199], a[136:139], a[12:15]
v_exp_f32 v63, v63
v_mfma_f32_16x16x32_bf16 a[12:15], a[204:207], a[140:143], a[12:15]
ds_read_b128 a[128:131], v6 offset:30720
v_add_f32 v220, 1.0, v60
v_mfma_f32_16x16x32_bf16 a[12:15], a[212:215], a[144:147], a[12:15]
v_add_f32 v221, 1.0, v61
s_waitcnt vmcnt(13) lgkmcnt(1)
v_mfma_f32_16x16x32_bf16 a[12:15], a[220:223], a[148:151], a[12:15]
v_add_f32 v222, 1.0, v62
v_add_f32 v223, 1.0, v63
v_mfma_f32_16x16x32_bf16 a[8:11], a[216:219], a[148:151], a[8:11]
v_fmac_f32 v220, v220, v64
v_fmac_f32 v221, v221, v65
v_mfma_f32_16x16x32_bf16 a[8:11], a[208:211], a[144:147], a[8:11]
s_add_u32 m0, s49, 49152
v_fmac_f32 v222, v222, v66
v_mfma_f32_16x16x32_bf16 a[8:11], a[200:203], a[140:143], a[8:11]
buffer_load_dwordx4 a[168:171], v13, s[8:11], s16 offen offset:1024 sc1
v_mfma_f32_16x16x32_bf16 a[8:11], a[192:195], a[136:139], a[8:11]
v_fmac_f32 v223, v223, v67
v_add_f32 v70, v70, v198
v_mfma_f32_16x16x32_bf16 a[16:19], a[192:195], a[140:143], a[16:19]
v_rcp_f32 v220, v220
v_mfma_f32_16x16x32_bf16 a[16:19], a[200:203], a[144:147], a[16:19]
ds_read_b128 a[132:135], v8 offset:16384
v_add_f32 v71, v71, v199
v_mfma_f32_16x16x32_bf16 a[16:19], a[208:211], a[148:151], a[16:19]
v_rcp_f32 v221, v221
v_mfma_f32_16x16x32_bf16 a[16:19], a[216:219], a[152:155], a[16:19]
v_rcp_f32 v222, v222
v_mfma_f32_16x16x32_bf16 a[20:23], a[220:223], a[152:155], a[20:23]
v_rcp_f32 v223, v223
v_mfma_f32_16x16x32_bf16 a[20:23], a[212:215], a[148:151], a[20:23]
v_fma_f32 v220, -v60, v220, v220
v_fma_f32 v221, -v61, v221, v221
v_mfma_f32_16x16x32_bf16 a[20:23], a[204:207], a[144:147], a[20:23]
buffer_load_dwordx4 a[172:175], v14, s[8:11], s16 offen offset:1024 sc1
v_mfma_f32_16x16x32_bf16 a[20:23], a[196:199], a[140:143], a[20:23]
v_fma_f32 v222, -v62, v222, v222
v_fma_f32 v223, -v63, v223, v223
v_mfma_f32_16x16x32_bf16 a[28:31], a[196:199], a[144:147], a[28:31]
v_cvt_pk_bf16_f32 v224, v220, v221
v_cvt_pk_bf16_f32 v225, v222, v223
v_mfma_f32_16x16x32_bf16 a[28:31], a[204:207], a[148:151], a[28:31]
ds_read_b128 a[136:139], v8 offset:18432
s_add_u32 s48, s3, 180224
v_mfma_f32_16x16x32_bf16 a[28:31], a[212:215], a[152:155], a[28:31]
ds_write_b64 v9, v[224:225] offset:10240
v_mfma_f32_16x16x32_bf16 a[28:31], a[220:223], a[156:159], a[28:31]
v_add_f32 v72, v72, v200
v_add_f32 v73, v73, v201
v_mfma_f32_16x16x32_bf16 a[24:27], a[216:219], a[156:159], a[24:27]
v_add_f32 v74, v74, v202
v_add_f32 v75, v75, v203
v_mfma_f32_16x16x32_bf16 a[24:27], a[208:211], a[152:155], a[24:27]
v_min_f32 v68, s67, v68
v_min_f32 v69, s67, v69
v_mfma_f32_16x16x32_bf16 a[24:27], a[200:203], a[148:151], a[24:27]
buffer_load_dwordx4 a[176:179], v13, s[8:11], s16 offen offset:2048 sc1
v_mfma_f32_16x16x32_bf16 a[24:27], a[192:195], a[144:147], a[24:27]
v_min_f32 v70, s67, v70
v_min_f32 v71, s67, v71
v_mfma_f32_16x16x32_bf16 a[32:35], a[192:195], a[148:151], a[32:35]
v_exp_f32 v72, v72
v_mfma_f32_16x16x32_bf16 a[32:35], a[200:203], a[152:155], a[32:35]
ds_read_b128 a[140:143], v8 offset:20480
v_add_f32 v76, v76, v204
v_mfma_f32_16x16x32_bf16 a[32:35], a[208:211], a[156:159], a[32:35]
v_add_f32 v77, v77, v205
s_waitcnt vmcnt(13) lgkmcnt(2)
v_mfma_f32_16x16x32_bf16 a[32:35], a[216:219], a[128:131], a[32:35]
v_exp_f32 v73, v73
v_mfma_f32_16x16x32_bf16 a[36:39], a[220:223], a[128:131], a[36:39]
v_exp_f32 v74, v74
v_mfma_f32_16x16x32_bf16 a[36:39], a[212:215], a[156:159], a[36:39]
v_exp_f32 v75, v75
v_mfma_f32_16x16x32_bf16 a[36:39], a[204:207], a[152:155], a[36:39]
ds_read_b128 a[144:147], v5 offset:32768
v_add_f32 v78, v78, v206
v_mfma_f32_16x16x32_bf16 a[36:39], a[196:199], a[148:151], a[36:39]
ds_read_b128 a[148:151], v5 offset:34816
v_add_f32 v79, v79, v207
v_mfma_f32_16x16x32_bf16 a[44:47], a[196:199], a[152:155], a[44:47]
buffer_load_dwordx4 a[180:183], v14, s[8:11], s16 offen offset:2048 sc1
v_mfma_f32_16x16x32_bf16 a[44:47], a[204:207], a[156:159], a[44:47]
buffer_load_dwordx4 v18, s[8:11], s48 offen offset:0 sc1 lds
v_mfma_f32_16x16x32_bf16 a[44:47], a[212:215], a[128:131], a[44:47]
v_exp_f32 v68, v68
v_mfma_f32_16x16x32_bf16 a[44:47], a[220:223], a[132:135], a[44:47]
v_exp_f32 v69, v69
v_mfma_f32_16x16x32_bf16 a[40:43], a[216:219], a[132:135], a[40:43]
v_exp_f32 v70, v70
v_mfma_f32_16x16x32_bf16 a[40:43], a[208:211], a[128:131], a[40:43]
v_exp_f32 v71, v71
v_mfma_f32_16x16x32_bf16 a[40:43], a[200:203], a[156:159], a[40:43]
buffer_load_dwordx4 a[184:187], v13, s[8:11], s16 offen offset:3072 sc1
v_mfma_f32_16x16x32_bf16 a[40:43], a[192:195], a[152:155], a[40:43]
ds_read_b128 a[152:155], v5 offset:36864
v_add_f32 v244, 1.0, v68
v_mfma_f32_16x16x32_bf16 a[48:51], a[192:195], a[156:159], a[48:51]
v_add_f32 v245, 1.0, v69
v_add_f32 v246, 1.0, v70
v_mfma_f32_16x16x32_bf16 a[48:51], a[200:203], a[128:131], a[48:51]
v_add_f32 v247, 1.0, v71
v_fmac_f32 v244, v244, v72
v_mfma_f32_16x16x32_bf16 a[48:51], a[208:211], a[132:135], a[48:51]
buffer_load_dwordx4 v18, s[8:11], s48 offen offset:1024 sc1 lds
v_mfma_f32_16x16x32_bf16 a[48:51], a[216:219], a[136:139], a[48:51]
v_fmac_f32 v245, v245, v73
v_fmac_f32 v246, v246, v74
v_mfma_f32_16x16x32_bf16 a[52:55], a[220:223], a[136:139], a[52:55]
v_fmac_f32 v247, v247, v75
v_add_f32 v80, v80, v208
v_mfma_f32_16x16x32_bf16 a[52:55], a[212:215], a[132:135], a[52:55]
v_rcp_f32 v244, v244
v_mfma_f32_16x16x32_bf16 a[52:55], a[204:207], a[128:131], a[52:55]
buffer_load_dwordx4 a[188:191], v14, s[8:11], s16 offen offset:3072 sc1
v_mfma_f32_16x16x32_bf16 a[52:55], a[196:199], a[156:159], a[52:55]
ds_read_b128 a[156:159], v5 offset:38912
s_add_u32 s16, s16, 4096
v_mfma_f32_16x16x32_bf16 a[60:63], a[196:199], a[128:131], a[60:63]
v_rcp_f32 v245, v245
v_mfma_f32_16x16x32_bf16 a[60:63], a[204:207], a[132:135], a[60:63]
v_rcp_f32 v246, v246
v_mfma_f32_16x16x32_bf16 a[60:63], a[212:215], a[136:139], a[60:63]
v_add_f32 v81, v81, v209
s_waitcnt lgkmcnt(1)
v_mfma_f32_16x16x32_bf16 a[60:63], a[220:223], a[140:143], a[60:63]
v_rcp_f32 v247, v247
v_mfma_f32_16x16x32_bf16 a[56:59], a[216:219], a[140:143], a[56:59]
v_fma_f32 v244, -v68, v244, v244
v_fma_f32 v245, -v69, v245, v245
v_mfma_f32_16x16x32_bf16 a[56:59], a[208:211], a[136:139], a[56:59]
v_fma_f32 v246, -v70, v246, v246
v_fma_f32 v247, -v71, v247, v247
v_mfma_f32_16x16x32_bf16 a[56:59], a[200:203], a[132:135], a[56:59]
v_cvt_pk_bf16_f32 v250, v244, v245
v_cvt_pk_bf16_f32 v251, v246, v247
v_mfma_f32_16x16x32_bf16 a[56:59], a[192:195], a[128:131], a[56:59]
ds_read_b128 a[128:131], v5 offset:40960
v_add_f32 v82, v82, v210
v_mfma_f32_16x16x32_bf16 a[0:3], a[224:227], a[144:147], a[0:3]
ds_read_b128 a[132:135], v5 offset:43008
v_add_f32 v83, v83, v211
v_mfma_f32_16x16x32_bf16 a[0:3], a[232:235], a[148:151], a[0:3]
ds_read_b128 a[136:139], v5 offset:45056
v_min_f32 v76, s67, v76
v_mfma_f32_16x16x32_bf16 a[0:3], a[240:243], a[152:155], a[0:3]
v_min_f32 v77, s67, v77
s_waitcnt vmcnt(8) lgkmcnt(3)
v_mfma_f32_16x16x32_bf16 a[0:3], a[248:251], a[156:159], a[0:3]
buffer_load_dwordx4 a[192:195], v13, s[8:11], s16 offen offset:0 sc1
v_mfma_f32_16x16x32_bf16 a[4:7], a[252:255], a[156:159], a[4:7]
buffer_load_dwordx4 v18, s[8:11], s48 offen offset:2048 sc1 lds
v_mfma_f32_16x16x32_bf16 a[4:7], a[244:247], a[152:155], a[4:7]
ds_write_b64 v9, v[250:251] offset:12288
v_mfma_f32_16x16x32_bf16 a[4:7], a[236:239], a[148:151], a[4:7]
buffer_load_dwordx4 a[196:199], v14, s[8:11], s16 offen offset:0 sc1
v_mfma_f32_16x16x32_bf16 a[4:7], a[228:231], a[144:147], a[4:7]
v_min_f32 v78, s67, v78
v_min_f32 v79, s67, v79
v_mfma_f32_16x16x32_bf16 a[12:15], a[228:231], a[148:151], a[12:15]
v_exp_f32 v80, v80
v_mfma_f32_16x16x32_bf16 a[12:15], a[236:239], a[152:155], a[12:15]
ds_read_b128 a[140:143], v5 offset:47104
v_accvgpr_read_b32 v236, a64
v_mfma_f32_16x16x32_bf16 a[12:15], a[244:247], a[156:159], a[12:15]
v_accvgpr_read_b32 v237, a65
s_waitcnt vmcnt(10) lgkmcnt(2)
v_mfma_f32_16x16x32_bf16 a[12:15], a[252:255], a[128:131], a[12:15]
buffer_load_dwordx4 v18, s[8:11], s48 offen offset:3072 sc1 lds
v_mfma_f32_16x16x32_bf16 a[8:11], a[248:251], a[128:131], a[8:11]
v_exp_f32 v81, v81
v_mfma_f32_16x16x32_bf16 a[8:11], a[240:243], a[156:159], a[8:11]
v_exp_f32 v82, v82
v_mfma_f32_16x16x32_bf16 a[8:11], a[232:235], a[152:155], a[8:11]
buffer_load_dwordx4 a[200:203], v13, s[8:11], s16 offen offset:1024 sc1
v_mfma_f32_16x16x32_bf16 a[8:11], a[224:227], a[148:151], a[8:11]
v_exp_f32 v83, v83
v_mfma_f32_16x16x32_bf16 a[16:19], a[224:227], a[152:155], a[16:19]
v_exp_f32 v76, v76
v_mfma_f32_16x16x32_bf16 a[16:19], a[232:235], a[156:159], a[16:19]
ds_read_b128 a[144:147], v7 offset:32768
v_accvgpr_read_b32 v238, a66
v_mfma_f32_16x16x32_bf16 a[16:19], a[240:243], a[128:131], a[16:19]
v_exp_f32 v77, v77
v_mfma_f32_16x16x32_bf16 a[16:19], a[248:251], a[132:135], a[16:19]
v_exp_f32 v78, v78
v_mfma_f32_16x16x32_bf16 a[20:23], a[252:255], a[132:135], a[20:23]
v_exp_f32 v79, v79
v_mfma_f32_16x16x32_bf16 a[20:23], a[244:247], a[128:131], a[20:23]
v_add_f32 v212, 1.0, v76
v_add_f32 v213, 1.0, v77
v_mfma_f32_16x16x32_bf16 a[20:23], a[236:239], a[156:159], a[20:23]
buffer_load_dwordx4 a[204:207], v14, s[8:11], s16 offen offset:1024 sc1
v_mfma_f32_16x16x32_bf16 a[20:23], a[228:231], a[152:155], a[20:23]
v_add_f32 v214, 1.0, v78
v_add_f32 v215, 1.0, v79
v_mfma_f32_16x16x32_bf16 a[28:31], a[228:231], a[156:159], a[28:31]
v_fmac_f32 v212, v212, v80
v_fmac_f32 v213, v213, v81
v_mfma_f32_16x16x32_bf16 a[28:31], a[236:239], a[128:131], a[28:31]
ds_read_b128 a[148:151], v7 offset:34816
v_fmac_f32 v214, v214, v82
v_mfma_f32_16x16x32_bf16 a[28:31], a[244:247], a[132:135], a[28:31]
v_fmac_f32 v215, v215, v83
v_accvgpr_read_b32 v239, a67
v_mfma_f32_16x16x32_bf16 a[28:31], a[252:255], a[136:139], a[28:31]
v_rcp_f32 v212, v212
v_mfma_f32_16x16x32_bf16 a[24:27], a[248:251], a[136:139], a[24:27]
v_rcp_f32 v213, v213
v_mfma_f32_16x16x32_bf16 a[24:27], a[240:243], a[132:135], a[24:27]
v_rcp_f32 v214, v214
v_mfma_f32_16x16x32_bf16 a[24:27], a[232:235], a[128:131], a[24:27]
buffer_load_dwordx4 a[208:211], v13, s[8:11], s16 offen offset:2048 sc1
v_mfma_f32_16x16x32_bf16 a[24:27], a[224:227], a[156:159], a[24:27]
v_rcp_f32 v215, v215
v_mfma_f32_16x16x32_bf16 a[32:35], a[224:227], a[128:131], a[32:35]
v_fma_f32 v212, -v76, v212, v212
v_fma_f32 v213, -v77, v213, v213
v_mfma_f32_16x16x32_bf16 a[32:35], a[232:235], a[132:135], a[32:35]
ds_read_b128 a[152:155], v7 offset:36864
v_fma_f32 v214, -v78, v214, v214
v_mfma_f32_16x16x32_bf16 a[32:35], a[240:243], a[136:139], a[32:35]
v_fma_f32 v215, -v79, v215, v215
s_waitcnt vmcnt(10) lgkmcnt(1)
v_mfma_f32_16x16x32_bf16 a[32:35], a[248:251], a[140:143], a[32:35]
v_cvt_pk_bf16_f32 v226, v212, v213
v_cvt_pk_bf16_f32 v227, v214, v215
v_mfma_f32_16x16x32_bf16 a[36:39], a[252:255], a[140:143], a[36:39]
ds_write_b64 v9, v[226:227] offset:14336
v_mfma_f32_16x16x32_bf16 a[36:39], a[244:247], a[136:139], a[36:39]
v_accvgpr_read_b32 v240, a68
v_accvgpr_read_b32 v241, a69
v_mfma_f32_16x16x32_bf16 a[36:39], a[236:239], a[132:135], a[36:39]
ds_read_b128 a[156:159], v6 offset:32768
v_accvgpr_read_b32 v242, a70
v_mfma_f32_16x16x32_bf16 a[36:39], a[228:231], a[128:131], a[36:39]
ds_read_b128 a[128:131], v6 offset:34816
v_accvgpr_read_b32 v243, a71
v_mfma_f32_16x16x32_bf16 a[44:47], a[228:231], a[132:135], a[44:47]
buffer_load_dwordx4 a[212:215], v14, s[8:11], s16 offen offset:2048 sc1
v_mfma_f32_16x16x32_bf16 a[44:47], a[236:239], a[136:139], a[44:47]
v_fmac_f32 v236, s68, v148
v_fmac_f32 v237, s68, v149
v_mfma_f32_16x16x32_bf16 a[44:47], a[244:247], a[140:143], a[44:47]
v_fmac_f32 v238, s68, v150
v_fmac_f32 v239, s68, v151
v_mfma_f32_16x16x32_bf16 a[44:47], a[252:255], a[144:147], a[44:47]
v_fmac_f32 v240, s68, v152
v_fmac_f32 v241, s68, v153
v_mfma_f32_16x16x32_bf16 a[40:43], a[248:251], a[144:147], a[40:43]
v_fmac_f32 v242, s68, v154
v_fmac_f32 v243, s68, v155
v_mfma_f32_16x16x32_bf16 a[40:43], a[240:243], a[140:143], a[40:43]
s_waitcnt vmcnt(9) lgkmcnt(2)
s_barrier
v_mfma_f32_16x16x32_bf16 a[40:43], a[232:235], a[136:139], a[40:43]
buffer_load_dwordx4 a[216:219], v13, s[8:11], s16 offen offset:3072 sc1
v_mfma_f32_16x16x32_bf16 a[40:43], a[224:227], a[132:135], a[40:43]
ds_read_b128 a[132:135], v6 offset:36864
v_min_f32 v236, s67, v236
v_mfma_f32_16x16x32_bf16 a[48:51], a[224:227], a[136:139], a[48:51]
ds_read_b128 v[228:231], v10 offset:8192
v_min_f32 v237, s67, v237
v_mfma_f32_16x16x32_bf16 a[48:51], a[232:235], a[140:143], a[48:51]
ds_read_b128 v[232:235], v10 offset:12288
v_min_f32 v238, s67, v238
v_mfma_f32_16x16x32_bf16 a[48:51], a[240:243], a[144:147], a[48:51]
v_min_f32 v239, s67, v239
v_accvgpr_read_b32 v216, a72
v_mfma_f32_16x16x32_bf16 a[48:51], a[248:251], a[148:151], a[48:51]
v_exp_f32 v240, v240
v_mfma_f32_16x16x32_bf16 a[52:55], a[252:255], a[148:151], a[52:55]
v_exp_f32 v241, v241
v_mfma_f32_16x16x32_bf16 a[52:55], a[244:247], a[144:147], a[52:55]
v_exp_f32 v242, v242
v_mfma_f32_16x16x32_bf16 a[52:55], a[236:239], a[140:143], a[52:55]
buffer_load_dwordx4 a[220:223], v14, s[8:11], s16 offen offset:3072 sc1
v_mfma_f32_16x16x32_bf16 a[52:55], a[228:231], a[136:139], a[52:55]
ds_read_b128 a[136:139], v6 offset:38912
s_add_u32 s16, s16, 4096
v_mfma_f32_16x16x32_bf16 a[60:63], a[228:231], a[140:143], a[60:63]
v_exp_f32 v243, v243
v_mfma_f32_16x16x32_bf16 a[60:63], a[236:239], a[144:147], a[60:63]
s_waitcnt vmcnt(10) lgkmcnt(2)
buffer_store_dwordx4 v[228:231], v17, s[12:15], s28 offen offset:1024 sc1
v_mfma_f32_16x16x32_bf16 a[60:63], a[244:247], a[148:151], a[60:63]
s_waitcnt lgkmcnt(1)
buffer_store_dwordx4 v[232:235], v17, s[12:15], s30 offen offset:1024 sc1
v_mfma_f32_16x16x32_bf16 a[60:63], a[252:255], a[152:155], a[60:63]
v_exp_f32 v236, v236
v_mfma_f32_16x16x32_bf16 a[56:59], a[248:251], a[152:155], a[56:59]
v_exp_f32 v237, v237
v_mfma_f32_16x16x32_bf16 a[56:59], a[240:243], a[148:151], a[56:59]
v_exp_f32 v238, v238
v_mfma_f32_16x16x32_bf16 a[56:59], a[232:235], a[144:147], a[56:59]
v_exp_f32 v239, v239
v_mfma_f32_16x16x32_bf16 a[56:59], a[224:227], a[140:143], a[56:59]
ds_read_b128 a[140:143], v6 offset:40960
v_add_f32 v244, 1.0, v236
v_mfma_f32_16x16x32_bf16 a[0:3], a[160:163], a[156:159], a[0:3]
ds_read_b128 a[144:147], v6 offset:43008
v_add_f32 v245, 1.0, v237
v_mfma_f32_16x16x32_bf16 a[0:3], a[168:171], a[128:131], a[0:3]
ds_read_b128 a[148:151], v6 offset:45056
v_add_f32 v246, 1.0, v238
v_mfma_f32_16x16x32_bf16 a[0:3], a[176:179], a[132:135], a[0:3]
v_add_f32 v247, 1.0, v239
s_waitcnt vmcnt(9) lgkmcnt(3)
v_mfma_f32_16x16x32_bf16 a[0:3], a[184:187], a[136:139], a[0:3]
buffer_load_dwordx4 a[224:227], v13, s[8:11], s16 offen offset:0 sc1
v_mfma_f32_16x16x32_bf16 a[4:7], a[188:191], a[136:139], a[4:7]
v_fmac_f32 v244, v244, v240
v_fmac_f32 v245, v245, v241
v_mfma_f32_16x16x32_bf16 a[4:7], a[180:183], a[132:135], a[4:7]
v_fmac_f32 v246, v246, v242
v_fmac_f32 v247, v247, v243
v_mfma_f32_16x16x32_bf16 a[4:7], a[172:175], a[128:131], a[4:7]
buffer_load_dwordx4 a[228:231], v14, s[8:11], s16 offen offset:0 sc1
v_mfma_f32_16x16x32_bf16 a[4:7], a[164:167], a[156:159], a[4:7]
v_rcp_f32 v244, v244
v_mfma_f32_16x16x32_bf16 a[12:15], a[164:167], a[128:131], a[12:15]
v_rcp_f32 v245, v245
v_mfma_f32_16x16x32_bf16 a[12:15], a[172:175], a[132:135], a[12:15]
ds_read_b128 a[152:155], v6 offset:47104
v_accvgpr_read_b32 v217, a73
v_mfma_f32_16x16x32_bf16 a[12:15], a[180:183], a[136:139], a[12:15]
v_accvgpr_read_b32 v218, a74
s_waitcnt vmcnt(9) lgkmcnt(1)
v_mfma_f32_16x16x32_bf16 a[12:15], a[188:191], a[140:143], a[12:15]
v_rcp_f32 v246, v246
v_mfma_f32_16x16x32_bf16 a[8:11], a[184:187], a[140:143], a[8:11]
v_rcp_f32 v247, v247
v_mfma_f32_16x16x32_bf16 a[8:11], a[176:179], a[136:139], a[8:11]
v_fma_f32 v244, -v236, v244, v244
v_fma_f32 v245, -v237, v245, v245
v_mfma_f32_16x16x32_bf16 a[8:11], a[168:171], a[132:135], a[8:11]
buffer_load_dwordx4 a[232:235], v13, s[8:11], s16 offen offset:1024 sc1
v_mfma_f32_16x16x32_bf16 a[8:11], a[160:163], a[128:131], a[8:11]
v_fma_f32 v246, -v238, v246, v246
v_fma_f32 v247, -v239, v247, v247
v_mfma_f32_16x16x32_bf16 a[16:19], a[160:163], a[132:135], a[16:19]
v_cvt_pk_bf16_f32 v248, v244, v245
v_cvt_pk_bf16_f32 v249, v246, v247
v_mfma_f32_16x16x32_bf16 a[16:19], a[168:171], a[136:139], a[16:19]
ds_read_b128 a[156:159], v8 offset:32768
v_accvgpr_read_b32 v219, a75
v_mfma_f32_16x16x32_bf16 a[16:19], a[176:179], a[140:143], a[16:19]
ds_write_b64 v9, v[248:249] offset:16384
v_mfma_f32_16x16x32_bf16 a[16:19], a[184:187], a[144:147], a[16:19]
v_accvgpr_read_b32 v220, a76
v_accvgpr_read_b32 v221, a77
v_mfma_f32_16x16x32_bf16 a[20:23], a[188:191], a[144:147], a[20:23]
v_accvgpr_read_b32 v222, a78
v_accvgpr_read_b32 v223, a79
v_mfma_f32_16x16x32_bf16 a[20:23], a[180:183], a[140:143], a[20:23]
v_fmac_f32 v216, s68, v156
v_fmac_f32 v217, s68, v157
v_mfma_f32_16x16x32_bf16 a[20:23], a[172:175], a[136:139], a[20:23]
buffer_load_dwordx4 a[236:239], v14, s[8:11], s16 offen offset:1024 sc1
v_mfma_f32_16x16x32_bf16 a[20:23], a[164:167], a[132:135], a[20:23]
v_fmac_f32 v218, s68, v158
v_fmac_f32 v219, s68, v159
v_mfma_f32_16x16x32_bf16 a[28:31], a[164:167], a[136:139], a[28:31]
v_fmac_f32 v220, s68, v160
v_fmac_f32 v221, s68, v161
v_mfma_f32_16x16x32_bf16 a[28:31], a[172:175], a[140:143], a[28:31]
ds_read_b128 a[128:131], v8 offset:34816
v_fmac_f32 v222, s68, v162
v_mfma_f32_16x16x32_bf16 a[28:31], a[180:183], a[144:147], a[28:31]
v_fmac_f32 v223, s68, v163
v_min_f32 v216, s67, v216
v_mfma_f32_16x16x32_bf16 a[28:31], a[188:191], a[148:151], a[28:31]
v_min_f32 v217, s67, v217
v_min_f32 v218, s67, v218
v_mfma_f32_16x16x32_bf16 a[24:27], a[184:187], a[148:151], a[24:27]
v_min_f32 v219, s67, v219
v_accvgpr_read_b32 v236, a80
v_mfma_f32_16x16x32_bf16 a[24:27], a[176:179], a[144:147], a[24:27]
v_exp_f32 v220, v220
v_mfma_f32_16x16x32_bf16 a[24:27], a[168:171], a[140:143], a[24:27]
buffer_load_dwordx4 a[240:243], v13, s[8:11], s16 offen offset:2048 sc1
v_mfma_f32_16x16x32_bf16 a[24:27], a[160:163], a[136:139], a[24:27]
v_exp_f32 v221, v221
v_mfma_f32_16x16x32_bf16 a[32:35], a[160:163], a[140:143], a[32:35]
v_exp_f32 v222, v222
v_mfma_f32_16x16x32_bf16 a[32:35], a[168:171], a[144:147], a[32:35]
ds_read_b128 a[132:135], v8 offset:36864
v_accvgpr_read_b32 v237, a81
v_mfma_f32_16x16x32_bf16 a[32:35], a[176:179], a[148:151], a[32:35]
v_accvgpr_read_b32 v238, a82
s_waitcnt vmcnt(9) lgkmcnt(1)
v_mfma_f32_16x16x32_bf16 a[32:35], a[184:187], a[152:155], a[32:35]
v_exp_f32 v223, v223
v_mfma_f32_16x16x32_bf16 a[36:39], a[188:191], a[152:155], a[36:39]
v_exp_f32 v216, v216
v_mfma_f32_16x16x32_bf16 a[36:39], a[180:183], a[148:151], a[36:39]
v_exp_f32 v217, v217
v_mfma_f32_16x16x32_bf16 a[36:39], a[172:175], a[144:147], a[36:39]
ds_read_b128 a[136:139], v5 offset:49152
v_accvgpr_read_b32 v239, a83
v_mfma_f32_16x16x32_bf16 a[36:39], a[164:167], a[140:143], a[36:39]
ds_read_b128 a[140:143], v5 offset:51200
v_accvgpr_read_b32 v240, a84
v_mfma_f32_16x16x32_bf16 a[44:47], a[164:167], a[144:147], a[44:47]
buffer_load_dwordx4 a[244:247], v14, s[8:11], s16 offen offset:2048 sc1
v_mfma_f32_16x16x32_bf16 a[44:47], a[172:175], a[148:151], a[44:47]
v_exp_f32 v218, v218
v_mfma_f32_16x16x32_bf16 a[44:47], a[180:183], a[152:155], a[44:47]
v_exp_f32 v219, v219
v_mfma_f32_16x16x32_bf16 a[44:47], a[188:191], a[156:159], a[44:47]
v_add_f32 v212, 1.0, v216
v_add_f32 v213, 1.0, v217
v_mfma_f32_16x16x32_bf16 a[40:43], a[184:187], a[156:159], a[40:43]
v_add_f32 v214, 1.0, v218
v_add_f32 v215, 1.0, v219
v_mfma_f32_16x16x32_bf16 a[40:43], a[176:179], a[152:155], a[40:43]
v_fmac_f32 v212, v212, v220
v_fmac_f32 v213, v213, v221
v_mfma_f32_16x16x32_bf16 a[40:43], a[168:171], a[148:151], a[40:43]
buffer_load_dwordx4 a[248:251], v13, s[8:11], s16 offen offset:3072 sc1
v_mfma_f32_16x16x32_bf16 a[40:43], a[160:163], a[144:147], a[40:43]
ds_read_b128 a[144:147], v5 offset:53248
v_fmac_f32 v214, v214, v222
v_mfma_f32_16x16x32_bf16 a[48:51], a[160:163], a[148:151], a[48:51]
v_fmac_f32 v215, v215, v223
v_accvgpr_read_b32 v241, a85
v_mfma_f32_16x16x32_bf16 a[48:51], a[168:171], a[152:155], a[48:51]
v_rcp_f32 v212, v212
v_mfma_f32_16x16x32_bf16 a[48:51], a[176:179], a[156:159], a[48:51]
v_rcp_f32 v213, v213
v_mfma_f32_16x16x32_bf16 a[48:51], a[184:187], a[128:131], a[48:51]
v_rcp_f32 v214, v214
v_mfma_f32_16x16x32_bf16 a[52:55], a[188:191], a[128:131], a[52:55]
v_rcp_f32 v215, v215
v_mfma_f32_16x16x32_bf16 a[52:55], a[180:183], a[156:159], a[52:55]
v_fma_f32 v212, -v216, v212, v212
v_fma_f32 v213, -v217, v213, v213
v_mfma_f32_16x16x32_bf16 a[52:55], a[172:175], a[152:155], a[52:55]
buffer_load_dwordx4 a[252:255], v14, s[8:11], s16 offen offset:3072 sc1
v_mfma_f32_16x16x32_bf16 a[52:55], a[164:167], a[148:151], a[52:55]
ds_read_b128 a[148:151], v5 offset:55296
s_add_u32 s16, s16, 1052672
v_mfma_f32_16x16x32_bf16 a[60:63], a[164:167], a[152:155], a[60:63]
v_fma_f32 v214, -v218, v214, v214
v_fma_f32 v215, -v219, v215, v215
v_mfma_f32_16x16x32_bf16 a[60:63], a[172:175], a[156:159], a[60:63]
v_cvt_pk_bf16_f32 v224, v212, v213
v_cvt_pk_bf16_f32 v225, v214, v215
v_mfma_f32_16x16x32_bf16 a[60:63], a[180:183], a[128:131], a[60:63]
v_accvgpr_read_b32 v242, a86
s_waitcnt vmcnt(10) lgkmcnt(1)
v_mfma_f32_16x16x32_bf16 a[60:63], a[188:191], a[132:135], a[60:63]
ds_write_b64 v9, v[224:225] offset:18432
v_mfma_f32_16x16x32_bf16 a[56:59], a[184:187], a[132:135], a[56:59]
v_accvgpr_read_b32 v243, a87
v_fmac_f32 v236, s68, v164
v_mfma_f32_16x16x32_bf16 a[56:59], a[176:179], a[128:131], a[56:59]
v_fmac_f32 v237, s68, v165
v_fmac_f32 v238, s68, v166
v_mfma_f32_16x16x32_bf16 a[56:59], a[168:171], a[156:159], a[56:59]
v_fmac_f32 v239, s68, v167
v_fmac_f32 v240, s68, v168
v_mfma_f32_16x16x32_bf16 a[56:59], a[160:163], a[152:155], a[56:59]
ds_read_b128 a[152:155], v5 offset:57344
v_fmac_f32 v241, s68, v169
v_mfma_f32_16x16x32_bf16 a[0:3], a[192:195], a[136:139], a[0:3]
ds_read_b128 a[156:159], v5 offset:59392
v_fmac_f32 v242, s68, v170
v_mfma_f32_16x16x32_bf16 a[0:3], a[200:203], a[140:143], a[0:3]
ds_read_b128 a[128:131], v5 offset:61440
v_fmac_f32 v243, s68, v171
v_mfma_f32_16x16x32_bf16 a[0:3], a[208:211], a[144:147], a[0:3]
v_min_f32 v236, s67, v236
s_waitcnt lgkmcnt(4)
v_mfma_f32_16x16x32_bf16 a[0:3], a[216:219], a[148:151], a[0:3]
buffer_load_dwordx4 a[160:163], v13, s[8:11], s16 offen offset:0 sc1
v_mfma_f32_16x16x32_bf16 a[4:7], a[220:223], a[148:151], a[4:7]
v_min_f32 v237, s67, v237
v_min_f32 v238, s67, v238
v_mfma_f32_16x16x32_bf16 a[4:7], a[212:215], a[144:147], a[4:7]
v_min_f32 v239, s67, v239
v_accvgpr_read_b32 v216, a88
v_mfma_f32_16x16x32_bf16 a[4:7], a[204:207], a[140:143], a[4:7]
buffer_load_dwordx4 a[164:167], v14, s[8:11], s16 offen offset:0 sc1
v_mfma_f32_16x16x32_bf16 a[4:7], a[196:199], a[136:139], a[4:7]
v_exp_f32 v240, v240
v_mfma_f32_16x16x32_bf16 a[12:15], a[196:199], a[140:143], a[12:15]
v_exp_f32 v241, v241
v_mfma_f32_16x16x32_bf16 a[12:15], a[204:207], a[144:147], a[12:15]
ds_read_b128 a[132:135], v5 offset:63488
v_accvgpr_read_b32 v217, a89
v_mfma_f32_16x16x32_bf16 a[12:15], a[212:215], a[148:151], a[12:15]
v_accvgpr_read_b32 v218, a90
s_waitcnt lgkmcnt(1)
v_mfma_f32_16x16x32_bf16 a[12:15], a[220:223], a[152:155], a[12:15]
v_exp_f32 v242, v242
v_mfma_f32_16x16x32_bf16 a[8:11], a[216:219], a[152:155], a[8:11]
v_exp_f32 v243, v243
v_mfma_f32_16x16x32_bf16 a[8:11], a[208:211], a[148:151], a[8:11]
v_exp_f32 v236, v236
v_mfma_f32_16x16x32_bf16 a[8:11], a[200:203], a[144:147], a[8:11]
buffer_load_dwordx4 a[168:171], v13, s[8:11], s16 offen offset:1024 sc1
v_mfma_f32_16x16x32_bf16 a[8:11], a[192:195], a[140:143], a[8:11]
v_exp_f32 v237, v237
v_mfma_f32_16x16x32_bf16 a[16:19], a[192:195], a[144:147], a[16:19]
v_exp_f32 v238, v238
v_mfma_f32_16x16x32_bf16 a[16:19], a[200:203], a[148:151], a[16:19]
ds_read_b128 a[136:139], v7 offset:49152
v_accvgpr_read_b32 v219, a91
v_mfma_f32_16x16x32_bf16 a[16:19], a[208:211], a[152:155], a[16:19]
v_exp_f32 v239, v239
v_mfma_f32_16x16x32_bf16 a[16:19], a[216:219], a[156:159], a[16:19]
v_add_f32 v244, 1.0, v236
v_add_f32 v245, 1.0, v237
v_mfma_f32_16x16x32_bf16 a[20:23], a[220:223], a[156:159], a[20:23]
v_add_f32 v246, 1.0, v238
v_add_f32 v247, 1.0, v239
v_mfma_f32_16x16x32_bf16 a[20:23], a[212:215], a[152:155], a[20:23]
v_fmac_f32 v244, v244, v240
v_fmac_f32 v245, v245, v241
v_mfma_f32_16x16x32_bf16 a[20:23], a[204:207], a[148:151], a[20:23]
buffer_load_dwordx4 a[172:175], v14, s[8:11], s16 offen offset:1024 sc1
v_mfma_f32_16x16x32_bf16 a[20:23], a[196:199], a[144:147], a[20:23]
v_fmac_f32 v246, v246, v242
v_fmac_f32 v247, v247, v243
v_mfma_f32_16x16x32_bf16 a[28:31], a[196:199], a[148:151], a[28:31]
v_rcp_f32 v244, v244
v_mfma_f32_16x16x32_bf16 a[28:31], a[204:207], a[152:155], a[28:31]
ds_read_b128 a[140:143], v7 offset:51200
v_accvgpr_read_b32 v220, a92
v_mfma_f32_16x16x32_bf16 a[28:31], a[212:215], a[156:159], a[28:31]
v_rcp_f32 v245, v245
v_mfma_f32_16x16x32_bf16 a[28:31], a[220:223], a[128:131], a[28:31]
v_rcp_f32 v246, v246
v_mfma_f32_16x16x32_bf16 a[24:27], a[216:219], a[128:131], a[24:27]
v_rcp_f32 v247, v247
v_mfma_f32_16x16x32_bf16 a[24:27], a[208:211], a[156:159], a[24:27]
v_fma_f32 v244, -v236, v244, v244
v_fma_f32 v245, -v237, v245, v245
v_mfma_f32_16x16x32_bf16 a[24:27], a[200:203], a[152:155], a[24:27]
buffer_load_dwordx4 a[176:179], v13, s[8:11], s16 offen offset:2048 sc1
v_mfma_f32_16x16x32_bf16 a[24:27], a[192:195], a[148:151], a[24:27]
v_fma_f32 v246, -v238, v246, v246
v_fma_f32 v247, -v239, v247, v247
v_mfma_f32_16x16x32_bf16 a[32:35], a[192:195], a[152:155], a[32:35]
v_cvt_pk_bf16_f32 v250, v244, v245
v_cvt_pk_bf16_f32 v251, v246, v247
v_mfma_f32_16x16x32_bf16 a[32:35], a[200:203], a[156:159], a[32:35]
ds_read_b128 a[144:147], v7 offset:53248
v_accvgpr_read_b32 v221, a93
v_mfma_f32_16x16x32_bf16 a[32:35], a[208:211], a[128:131], a[32:35]
v_accvgpr_read_b32 v222, a94
s_waitcnt lgkmcnt(1)
v_mfma_f32_16x16x32_bf16 a[32:35], a[216:219], a[132:135], a[32:35]
ds_write_b64 v9, v[250:251] offset:20480
v_mfma_f32_16x16x32_bf16 a[36:39], a[220:223], a[132:135], a[36:39]
v_accvgpr_read_b32 v223, a95
v_fmac_f32 v216, s68, v172
v_mfma_f32_16x16x32_bf16 a[36:39], a[212:215], a[128:131], a[36:39]
v_fmac_f32 v217, s68, v173
v_fmac_f32 v218, s68, v174
v_mfma_f32_16x16x32_bf16 a[36:39], a[204:207], a[156:159], a[36:39]
ds_read_b128 a[148:151], v6 offset:49152
v_fmac_f32 v219, s68, v175
v_mfma_f32_16x16x32_bf16 a[36:39], a[196:199], a[152:155], a[36:39]
ds_read_b128 a[152:155], v6 offset:51200
v_fmac_f32 v220, s68, v176
v_mfma_f32_16x16x32_bf16 a[44:47], a[196:199], a[156:159], a[44:47]
buffer_load_dwordx4 a[180:183], v14, s[8:11], s16 offen offset:2048 sc1
v_mfma_f32_16x16x32_bf16 a[44:47], a[204:207], a[128:131], a[44:47]
v_fmac_f32 v221, s68, v177
v_fmac_f32 v222, s68, v178
v_mfma_f32_16x16x32_bf16 a[44:47], a[212:215], a[132:135], a[44:47]
v_fmac_f32 v223, s68, v179
v_min_f32 v216, s67, v216
v_mfma_f32_16x16x32_bf16 a[44:47], a[220:223], a[136:139], a[44:47]
v_min_f32 v217, s67, v217
v_min_f32 v218, s67, v218
v_mfma_f32_16x16x32_bf16 a[40:43], a[216:219], a[136:139], a[40:43]
v_min_f32 v219, s67, v219
v_accvgpr_read_b32 v236, a96
v_mfma_f32_16x16x32_bf16 a[40:43], a[208:211], a[132:135], a[40:43]
v_exp_f32 v220, v220
v_mfma_f32_16x16x32_bf16 a[40:43], a[200:203], a[128:131], a[40:43]
buffer_load_dwordx4 a[184:187], v13, s[8:11], s16 offen offset:3072 sc1
v_mfma_f32_16x16x32_bf16 a[40:43], a[192:195], a[156:159], a[40:43]
ds_read_b128 a[156:159], v6 offset:53248
v_accvgpr_read_b32 v237, a97
v_mfma_f32_16x16x32_bf16 a[48:51], a[192:195], a[128:131], a[48:51]
v_exp_f32 v221, v221
v_mfma_f32_16x16x32_bf16 a[48:51], a[200:203], a[132:135], a[48:51]
v_exp_f32 v222, v222
v_mfma_f32_16x16x32_bf16 a[48:51], a[208:211], a[136:139], a[48:51]
v_exp_f32 v223, v223
v_mfma_f32_16x16x32_bf16 a[48:51], a[216:219], a[140:143], a[48:51]
v_exp_f32 v216, v216
v_mfma_f32_16x16x32_bf16 a[52:55], a[220:223], a[140:143], a[52:55]
v_exp_f32 v217, v217
v_mfma_f32_16x16x32_bf16 a[52:55], a[212:215], a[136:139], a[52:55]
v_exp_f32 v218, v218
v_mfma_f32_16x16x32_bf16 a[52:55], a[204:207], a[132:135], a[52:55]
buffer_load_dwordx4 a[188:191], v14, s[8:11], s16 offen offset:3072 sc1
v_mfma_f32_16x16x32_bf16 a[52:55], a[196:199], a[128:131], a[52:55]
ds_read_b128 a[128:131], v6 offset:55296
s_add_u32 s16, s16, 4096
v_mfma_f32_16x16x32_bf16 a[60:63], a[196:199], a[132:135], a[60:63]
v_exp_f32 v219, v219
v_mfma_f32_16x16x32_bf16 a[60:63], a[204:207], a[136:139], a[60:63]
v_add_f32 v212, 1.0, v216
v_add_f32 v213, 1.0, v217
v_mfma_f32_16x16x32_bf16 a[60:63], a[212:215], a[140:143], a[60:63]
v_add_f32 v214, 1.0, v218
s_waitcnt vmcnt(8) lgkmcnt(1)
v_mfma_f32_16x16x32_bf16 a[60:63], a[220:223], a[144:147], a[60:63]
v_add_f32 v215, 1.0, v219
v_fmac_f32 v212, v212, v220
v_mfma_f32_16x16x32_bf16 a[56:59], a[216:219], a[144:147], a[56:59]
v_fmac_f32 v213, v213, v221
v_fmac_f32 v214, v214, v222
v_mfma_f32_16x16x32_bf16 a[56:59], a[208:211], a[140:143], a[56:59]
v_fmac_f32 v215, v215, v223
v_accvgpr_read_b32 v238, a98
v_mfma_f32_16x16x32_bf16 a[56:59], a[200:203], a[136:139], a[56:59]
v_rcp_f32 v212, v212
v_mfma_f32_16x16x32_bf16 a[56:59], a[192:195], a[132:135], a[56:59]
ds_read_b128 a[132:135], v6 offset:57344
v_accvgpr_read_b32 v239, a99
v_mfma_f32_16x16x32_bf16 a[0:3], a[224:227], a[148:151], a[0:3]
ds_read_b128 a[136:139], v6 offset:59392
v_accvgpr_read_b32 v240, a100
v_mfma_f32_16x16x32_bf16 a[0:3], a[232:235], a[152:155], a[0:3]
ds_read_b128 a[140:143], v6 offset:61440
v_accvgpr_read_b32 v241, a101
v_mfma_f32_16x16x32_bf16 a[0:3], a[240:243], a[156:159], a[0:3]
v_accvgpr_read_b32 v242, a102
s_waitcnt vmcnt(6) lgkmcnt(3)
v_mfma_f32_16x16x32_bf16 a[0:3], a[248:251], a[128:131], a[0:3]
buffer_load_dwordx4 a[192:195], v13, s[8:11], s16 offen offset:0 sc1
v_mfma_f32_16x16x32_bf16 a[4:7], a[252:255], a[128:131], a[4:7]
v_rcp_f32 v213, v213
v_mfma_f32_16x16x32_bf16 a[4:7], a[244:247], a[156:159], a[4:7]
v_rcp_f32 v214, v214
v_mfma_f32_16x16x32_bf16 a[4:7], a[236:239], a[152:155], a[4:7]
buffer_load_dwordx4 a[196:199], v14, s[8:11], s16 offen offset:0 sc1
v_mfma_f32_16x16x32_bf16 a[4:7], a[228:231], a[148:151], a[4:7]
v_rcp_f32 v215, v215
v_mfma_f32_16x16x32_bf16 a[12:15], a[228:231], a[152:155], a[12:15]
v_fma_f32 v212, -v216, v212, v212
v_fma_f32 v213, -v217, v213, v213
v_mfma_f32_16x16x32_bf16 a[12:15], a[236:239], a[156:159], a[12:15]
ds_read_b128 a[144:147], v6 offset:63488
v_fma_f32 v214, -v218, v214, v214
v_mfma_f32_16x16x32_bf16 a[12:15], a[244:247], a[128:131], a[12:15]
v_fma_f32 v215, -v219, v215, v215
s_waitcnt vmcnt(7) lgkmcnt(1)
v_mfma_f32_16x16x32_bf16 a[12:15], a[252:255], a[132:135], a[12:15]
v_cvt_pk_bf16_f32 v226, v212, v213
v_cvt_pk_bf16_f32 v227, v214, v215
v_mfma_f32_16x16x32_bf16 a[8:11], a[248:251], a[132:135], a[8:11]
ds_write_b64 v9, v[226:227] offset:22528
v_mfma_f32_16x16x32_bf16 a[8:11], a[240:243], a[128:131], a[8:11]
v_accvgpr_read_b32 v243, a103
v_fmac_f32 v236, s68, v180
v_mfma_f32_16x16x32_bf16 a[8:11], a[232:235], a[156:159], a[8:11]
buffer_load_dwordx4 a[200:203], v13, s[8:11], s16 offen offset:1024 sc1
v_mfma_f32_16x16x32_bf16 a[8:11], a[224:227], a[152:155], a[8:11]
v_fmac_f32 v237, s68, v181
v_fmac_f32 v238, s68, v182
v_mfma_f32_16x16x32_bf16 a[16:19], a[224:227], a[156:159], a[16:19]
v_fmac_f32 v239, s68, v183
v_fmac_f32 v240, s68, v184
v_mfma_f32_16x16x32_bf16 a[16:19], a[232:235], a[128:131], a[16:19]
ds_read_b128 a[148:151], v8 offset:49152
v_fmac_f32 v241, s68, v185
v_mfma_f32_16x16x32_bf16 a[16:19], a[240:243], a[132:135], a[16:19]
v_fmac_f32 v242, s68, v186
v_fmac_f32 v243, s68, v187
v_mfma_f32_16x16x32_bf16 a[16:19], a[248:251], a[136:139], a[16:19]
v_min_f32 v236, s67, v236
v_min_f32 v237, s67, v237
v_mfma_f32_16x16x32_bf16 a[20:23], a[252:255], a[136:139], a[20:23]
v_min_f32 v238, s67, v238
v_min_f32 v239, s67, v239
v_mfma_f32_16x16x32_bf16 a[20:23], a[244:247], a[132:135], a[20:23]
s_waitcnt vmcnt(7) lgkmcnt(1)
s_barrier
v_mfma_f32_16x16x32_bf16 a[20:23], a[236:239], a[128:131], a[20:23]
buffer_load_dwordx4 a[204:207], v14, s[8:11], s16 offen offset:1024 sc1
v_mfma_f32_16x16x32_bf16 a[20:23], a[228:231], a[156:159], a[20:23]
ds_read_b128 v[228:231], v10 offset:16384
v_accvgpr_read_b32 v216, a104
v_mfma_f32_16x16x32_bf16 a[28:31], a[228:231], a[128:131], a[28:31]
ds_read_b128 v[232:235], v10 offset:20480
v_accvgpr_read_b32 v217, a105
v_mfma_f32_16x16x32_bf16 a[28:31], a[236:239], a[132:135], a[28:31]
ds_read_b128 a[152:155], v8 offset:51200
v_accvgpr_read_b32 v218, a106
v_mfma_f32_16x16x32_bf16 a[28:31], a[244:247], a[136:139], a[28:31]
v_exp_f32 v240, v240
v_mfma_f32_16x16x32_bf16 a[28:31], a[252:255], a[140:143], a[28:31]
v_exp_f32 v241, v241
v_mfma_f32_16x16x32_bf16 a[24:27], a[248:251], a[140:143], a[24:27]
v_exp_f32 v242, v242
v_mfma_f32_16x16x32_bf16 a[24:27], a[240:243], a[136:139], a[24:27]
v_exp_f32 v243, v243
v_mfma_f32_16x16x32_bf16 a[24:27], a[232:235], a[132:135], a[24:27]
buffer_load_dwordx4 a[208:211], v13, s[8:11], s16 offen offset:2048 sc1
v_mfma_f32_16x16x32_bf16 a[24:27], a[224:227], a[128:131], a[24:27]
v_exp_f32 v236, v236
v_mfma_f32_16x16x32_bf16 a[32:35], a[224:227], a[132:135], a[32:35]
s_waitcnt vmcnt(7) lgkmcnt(2)
buffer_store_dwordx4 v[228:231], v17, s[12:15], s24 offen offset:2048 sc1
v_mfma_f32_16x16x32_bf16 a[32:35], a[232:235], a[136:139], a[32:35]
ds_read_b128 a[156:159], v8 offset:53248
v_accvgpr_read_b32 v219, a107
v_mfma_f32_16x16x32_bf16 a[32:35], a[240:243], a[140:143], a[32:35]
s_waitcnt lgkmcnt(1)
buffer_store_dwordx4 v[232:235], v17, s[12:15], s26 offen offset:2048 sc1
v_mfma_f32_16x16x32_bf16 a[32:35], a[248:251], a[144:147], a[32:35]
v_exp_f32 v237, v237
v_mfma_f32_16x16x32_bf16 a[36:39], a[252:255], a[144:147], a[36:39]
v_exp_f32 v238, v238
v_mfma_f32_16x16x32_bf16 a[36:39], a[244:247], a[140:143], a[36:39]
v_exp_f32 v239, v239
v_mfma_f32_16x16x32_bf16 a[36:39], a[236:239], a[136:139], a[36:39]
buffer_load_dwordx4 a[212:215], v14, s[8:11], s16 offen offset:2048 sc1
v_mfma_f32_16x16x32_bf16 a[36:39], a[228:231], a[132:135], a[36:39]
v_add_f32 v244, 1.0, v236
v_add_f32 v245, 1.0, v237
v_mfma_f32_16x16x32_bf16 a[44:47], a[228:231], a[136:139], a[44:47]
s_waitcnt lgkmcnt(0)
s_barrier
v_mfma_f32_16x16x32_bf16 a[44:47], a[236:239], a[140:143], a[44:47]
ds_read_b128 a[128:131], v1 offset:0
v_add_f32 v246, 1.0, v238
v_mfma_f32_16x16x32_bf16 a[44:47], a[244:247], a[144:147], a[44:47]
ds_read_b128 a[132:135], v1 offset:2048
v_add_f32 v247, 1.0, v239
v_mfma_f32_16x16x32_bf16 a[44:47], a[252:255], a[148:151], a[44:47]
v_fmac_f32 v244, v244, v240
v_fmac_f32 v245, v245, v241
v_mfma_f32_16x16x32_bf16 a[40:43], a[248:251], a[148:151], a[40:43]
v_fmac_f32 v246, v246, v242
v_fmac_f32 v247, v247, v243
v_mfma_f32_16x16x32_bf16 a[40:43], a[240:243], a[144:147], a[40:43]
v_rcp_f32 v244, v244
v_mfma_f32_16x16x32_bf16 a[40:43], a[232:235], a[140:143], a[40:43]
buffer_load_dwordx4 a[216:219], v13, s[8:11], s16 offen offset:3072 sc1
v_mfma_f32_16x16x32_bf16 a[40:43], a[224:227], a[136:139], a[40:43]
ds_read_b128 a[136:139], v1 offset:4096
v_accvgpr_read_b32 v220, a108
v_mfma_f32_16x16x32_bf16 a[48:51], a[224:227], a[140:143], a[48:51]
v_rcp_f32 v245, v245
v_mfma_f32_16x16x32_bf16 a[48:51], a[232:235], a[144:147], a[48:51]
v_rcp_f32 v246, v246
v_mfma_f32_16x16x32_bf16 a[48:51], a[240:243], a[148:151], a[48:51]
v_rcp_f32 v247, v247
v_mfma_f32_16x16x32_bf16 a[48:51], a[248:251], a[152:155], a[48:51]
v_fma_f32 v244, -v236, v244, v244
v_fma_f32 v245, -v237, v245, v245
v_mfma_f32_16x16x32_bf16 a[52:55], a[252:255], a[152:155], a[52:55]
v_fma_f32 v246, -v238, v246, v246
v_fma_f32 v247, -v239, v247, v247
v_mfma_f32_16x16x32_bf16 a[52:55], a[244:247], a[148:151], a[52:55]
v_cvt_pk_bf16_f32 v248, v244, v245
v_cvt_pk_bf16_f32 v249, v246, v247
v_mfma_f32_16x16x32_bf16 a[52:55], a[236:239], a[144:147], a[52:55]
buffer_load_dwordx4 a[220:223], v14, s[8:11], s16 offen offset:3072 sc1
v_mfma_f32_16x16x32_bf16 a[52:55], a[228:231], a[140:143], a[52:55]
ds_read_b128 a[140:143], v1 offset:6144
s_add_u32 s16, s16, 4096
v_mfma_f32_16x16x32_bf16 a[60:63], a[228:231], a[144:147], a[60:63]
ds_write_b64 v9, v[248:249] offset:24576
v_mfma_f32_16x16x32_bf16 a[60:63], a[236:239], a[148:151], a[60:63]
v_accvgpr_read_b32 v221, a109
v_accvgpr_read_b32 v222, a110
v_mfma_f32_16x16x32_bf16 a[60:63], a[244:247], a[152:155], a[60:63]
v_accvgpr_read_b32 v223, a111
v_fmac_f32 v216, s68, v188
v_mfma_f32_16x16x32_bf16 a[60:63], a[252:255], a[156:159], a[60:63]
v_fmac_f32 v217, s68, v189
v_fmac_f32 v218, s68, v190
v_mfma_f32_16x16x32_bf16 a[56:59], a[248:251], a[156:159], a[56:59]
v_fmac_f32 v219, s68, v191
v_fmac_f32 v220, s68, v192
v_mfma_f32_16x16x32_bf16 a[56:59], a[240:243], a[152:155], a[56:59]
v_fmac_f32 v221, s68, v193
v_fmac_f32 v222, s68, v194
v_mfma_f32_16x16x32_bf16 a[56:59], a[232:235], a[148:151], a[56:59]
v_fmac_f32 v223, s68, v195
v_min_f32 v216, s67, v216
v_mfma_f32_16x16x32_bf16 a[56:59], a[224:227], a[144:147], a[56:59]
ds_read_b128 a[144:147], v1 offset:8192
s_waitcnt vmcnt(8) lgkmcnt(3)
v_mfma_f32_16x16x32_bf16 v[84:87], a[160:163], a[128:131], v[84:87]
ds_read_b128 a[148:151], v1 offset:10240
v_min_f32 v217, s67, v217
v_mfma_f32_16x16x32_bf16 v[84:87], a[168:171], a[132:135], v[84:87]
ds_read_b128 a[152:155], v1 offset:12288
v_min_f32 v218, s67, v218
v_mfma_f32_16x16x32_bf16 v[84:87], a[176:179], a[136:139], v[84:87]
buffer_load_dwordx4 a[224:227], v13, s[8:11], s16 offen offset:0 sc1
v_mfma_f32_16x16x32_bf16 v[88:91], a[180:183], a[136:139], v[88:91]
v_min_f32 v219, s67, v219
v_accvgpr_read_b32 v236, a112
v_mfma_f32_16x16x32_bf16 v[88:91], a[172:175], a[132:135], v[88:91]
v_exp_f32 v220, v220
v_mfma_f32_16x16x32_bf16 v[88:91], a[164:167], a[128:131], v[88:91]
v_exp_f32 v221, v221
v_mfma_f32_16x16x32_bf16 v[96:99], a[164:167], a[132:135], v[96:99]
ds_read_b128 a[156:159], v1 offset:14336
v_accvgpr_read_b32 v237, a113
v_mfma_f32_16x16x32_bf16 v[96:99], a[172:175], a[136:139], v[96:99]
v_accvgpr_read_b32 v238, a114
s_waitcnt vmcnt(8) lgkmcnt(4)
v_mfma_f32_16x16x32_bf16 v[96:99], a[180:183], a[140:143], v[96:99]
buffer_load_dwordx4 a[228:231], v14, s[8:11], s16 offen offset:0 sc1
v_mfma_f32_16x16x32_bf16 v[92:95], a[176:179], a[140:143], v[92:95]
v_exp_f32 v222, v222
v_mfma_f32_16x16x32_bf16 v[92:95], a[168:171], a[136:139], v[92:95]
v_exp_f32 v223, v223
v_mfma_f32_16x16x32_bf16 v[92:95], a[160:163], a[132:135], v[92:95]
v_exp_f32 v216, v216
v_mfma_f32_16x16x32_bf16 v[100:103], a[160:163], a[136:139], v[100:103]
ds_read_b128 a[128:131], v3 offset:0
v_accvgpr_read_b32 v239, a115
v_mfma_f32_16x16x32_bf16 v[100:103], a[168:171], a[140:143], v[100:103]
v_accvgpr_read_b32 v240, a116
s_waitcnt lgkmcnt(2)
v_mfma_f32_16x16x32_bf16 v[100:103], a[176:179], a[144:147], v[100:103]
buffer_load_dwordx4 a[232:235], v13, s[8:11], s16 offen offset:1024 sc1
v_mfma_f32_16x16x32_bf16 v[104:107], a[180:183], a[144:147], v[104:107]
v_exp_f32 v217, v217
v_mfma_f32_16x16x32_bf16 v[104:107], a[172:175], a[140:143], v[104:107]
v_exp_f32 v218, v218
v_mfma_f32_16x16x32_bf16 v[104:107], a[164:167], a[136:139], v[104:107]
v_exp_f32 v219, v219
v_mfma_f32_16x16x32_bf16 v[112:115], a[164:167], a[140:143], v[112:115]
ds_read_b128 a[132:135], v3 offset:2048
v_add_f32 v212, 1.0, v216
v_mfma_f32_16x16x32_bf16 v[112:115], a[172:175], a[144:147], v[112:115]
v_add_f32 v213, 1.0, v217
v_add_f32 v214, 1.0, v218
v_mfma_f32_16x16x32_bf16 v[112:115], a[180:183], a[148:151], v[112:115]
v_add_f32 v215, 1.0, v219
v_fmac_f32 v212, v212, v220
v_mfma_f32_16x16x32_bf16 v[108:111], a[176:179], a[148:151], v[108:111]
v_fmac_f32 v213, v213, v221
v_fmac_f32 v214, v214, v222
v_mfma_f32_16x16x32_bf16 v[108:111], a[168:171], a[144:147], v[108:111]
ds_read_b128 a[136:139], v2 offset:0
v_fmac_f32 v215, v215, v223
v_mfma_f32_16x16x32_bf16 v[108:111], a[160:163], a[140:143], v[108:111]
ds_read_b128 a[140:143], v2 offset:2048
v_accvgpr_read_b32 v241, a117
v_mfma_f32_16x16x32_bf16 v[116:119], a[160:163], a[144:147], v[116:119]
buffer_load_dwordx4 a[236:239], v14, s[8:11], s16 offen offset:1024 sc1
v_mfma_f32_16x16x32_bf16 v[116:119], a[168:171], a[148:151], v[116:119]
v_rcp_f32 v212, v212
v_mfma_f32_16x16x32_bf16 v[116:119], a[176:179], a[152:155], v[116:119]
v_rcp_f32 v213, v213
v_mfma_f32_16x16x32_bf16 v[120:123], a[180:183], a[152:155], v[120:123]
v_rcp_f32 v214, v214
v_mfma_f32_16x16x32_bf16 v[120:123], a[172:175], a[148:151], v[120:123]
v_rcp_f32 v215, v215
v_mfma_f32_16x16x32_bf16 v[120:123], a[164:167], a[144:147], v[120:123]
ds_read_b128 a[144:147], v2 offset:4096
v_fma_f32 v212, -v216, v212, v212
v_mfma_f32_16x16x32_bf16 v[128:131], a[164:167], a[148:151], v[128:131]
buffer_load_dwordx4 a[240:243], v13, s[8:11], s16 offen offset:2048 sc1
v_mfma_f32_16x16x32_bf16 v[128:131], a[172:175], a[152:155], v[128:131]
v_fma_f32 v213, -v217, v213, v213
s_waitcnt vmcnt(10) lgkmcnt(2)
v_mfma_f32_16x16x32_bf16 v[128:131], a[180:183], a[156:159], v[128:131]
v_fma_f32 v214, -v218, v214, v214
v_fma_f32 v215, -v219, v215, v215
v_mfma_f32_16x16x32_bf16 v[124:127], a[176:179], a[156:159], v[124:127]
v_cvt_pk_bf16_f32 v224, v212, v213
v_cvt_pk_bf16_f32 v225, v214, v215
v_mfma_f32_16x16x32_bf16 v[124:127], a[168:171], a[152:155], v[124:127]
ds_write_b64 v9, v[224:225] offset:26624
v_mfma_f32_16x16x32_bf16 v[124:127], a[160:163], a[148:151], v[124:127]
ds_read_b128 a[148:151], v2 offset:6144
v_accvgpr_read_b32 v242, a118
v_mfma_f32_16x16x32_bf16 v[132:135], a[160:163], a[152:155], v[132:135]
v_accvgpr_read_b32 v243, a119
v_fmac_f32 v236, s68, v196
v_mfma_f32_16x16x32_bf16 v[132:135], a[168:171], a[156:159], v[132:135]
v_fmac_f32 v237, s68, v197
v_fmac_f32 v238, s68, v198
v_mfma_f32_16x16x32_bf16 v[132:135], a[176:179], a[128:131], v[132:135]
buffer_load_dwordx4 a[244:247], v14, s[8:11], s16 offen offset:2048 sc1
v_mfma_f32_16x16x32_bf16 v[136:139], a[180:183], a[128:131], v[136:139]
v_fmac_f32 v239, s68, v199
v_fmac_f32 v240, s68, v200
v_mfma_f32_16x16x32_bf16 v[136:139], a[172:175], a[156:159], v[136:139]
v_fmac_f32 v241, s68, v201
v_fmac_f32 v242, s68, v202
v_mfma_f32_16x16x32_bf16 v[136:139], a[164:167], a[152:155], v[136:139]
ds_read_b128 a[152:155], v2 offset:8192
v_fmac_f32 v243, s68, v203
v_mfma_f32_16x16x32_bf16 v[144:147], a[164:167], a[156:159], v[144:147]
v_min_f32 v236, s67, v236
v_min_f32 v237, s67, v237
v_mfma_f32_16x16x32_bf16 v[144:147], a[172:175], a[128:131], v[144:147]
v_min_f32 v238, s67, v238
v_min_f32 v239, s67, v239
v_mfma_f32_16x16x32_bf16 v[144:147], a[180:183], a[132:135], v[144:147]
v_exp_f32 v240, v240
v_mfma_f32_16x16x32_bf16 v[140:143], a[176:179], a[132:135], v[140:143]
v_exp_f32 v241, v241
v_mfma_f32_16x16x32_bf16 v[140:143], a[168:171], a[128:131], v[140:143]
buffer_load_dwordx4 a[248:251], v13, s[8:11], s16 offen offset:3072 sc1
v_mfma_f32_16x16x32_bf16 v[140:143], a[160:163], a[156:159], v[140:143]
ds_read_b128 a[156:159], v2 offset:10240
v_accvgpr_read_b32 v216, a120
v_mfma_f32_16x16x32_bf16 v[84:87], a[184:187], a[136:139], v[84:87]
ds_read_b128 a[128:131], v2 offset:12288
s_waitcnt lgkmcnt(3)
v_mfma_f32_16x16x32_bf16 v[84:87], a[192:195], a[140:143], v[84:87]
v_exp_f32 v242, v242
v_mfma_f32_16x16x32_bf16 v[84:87], a[200:203], a[144:147], v[84:87]
v_exp_f32 v243, v243
v_mfma_f32_16x16x32_bf16 v[88:91], a[204:207], a[144:147], v[88:91]
v_exp_f32 v236, v236
v_mfma_f32_16x16x32_bf16 v[88:91], a[196:199], a[140:143], v[88:91]
v_exp_f32 v237, v237
v_mfma_f32_16x16x32_bf16 v[88:91], a[188:191], a[136:139], v[88:91]
v_exp_f32 v238, v238
v_mfma_f32_16x16x32_bf16 v[96:99], a[188:191], a[140:143], v[96:99]
ds_read_b128 a[132:135], v2 offset:14336
v_accvgpr_read_b32 v217, a121
v_mfma_f32_16x16x32_bf16 v[96:99], a[196:199], a[144:147], v[96:99]
buffer_load_dwordx4 a[252:255], v14, s[8:11], s16 offen offset:3072 sc1
v_mfma_f32_16x16x32_bf16 v[96:99], a[204:207], a[148:151], v[96:99]
s_add_u32 s16, s16, 4096
v_accvgpr_read_b32 v218, a122
v_mfma_f32_16x16x32_bf16 v[92:95], a[200:203], a[148:151], v[92:95]
v_exp_f32 v239, v239
v_mfma_f32_16x16x32_bf16 v[92:95], a[192:195], a[144:147], v[92:95]
v_add_f32 v244, 1.0, v236
v_add_f32 v245, 1.0, v237
v_mfma_f32_16x16x32_bf16 v[92:95], a[184:187], a[140:143], v[92:95]
v_add_f32 v246, 1.0, v238
v_add_f32 v247, 1.0, v239
v_mfma_f32_16x16x32_bf16 v[100:103], a[184:187], a[144:147], v[100:103]
ds_read_b128 a[136:139], v4 offset:0
v_fmac_f32 v244, v244, v240
v_mfma_f32_16x16x32_bf16 v[100:103], a[192:195], a[148:151], v[100:103]
v_fmac_f32 v245, v245, v241
s_waitcnt lgkmcnt(2)
v_mfma_f32_16x16x32_bf16 v[100:103], a[200:203], a[152:155], v[100:103]
buffer_load_dwordx4 a[160:163], v13, s[8:11], s16 offen offset:0 sc1
v_mfma_f32_16x16x32_bf16 v[104:107], a[204:207], a[152:155], v[104:107]
v_fmac_f32 v246, v246, v242
v_fmac_f32 v247, v247, v243
v_mfma_f32_16x16x32_bf16 v[104:107], a[196:199], a[148:151], v[104:107]
v_rcp_f32 v244, v244
v_mfma_f32_16x16x32_bf16 v[104:107], a[188:191], a[144:147], v[104:107]
v_rcp_f32 v245, v245
v_mfma_f32_16x16x32_bf16 v[112:115], a[188:191], a[148:151], v[112:115]
ds_read_b128 a[140:143], v4 offset:2048
v_accvgpr_read_b32 v219, a123
v_mfma_f32_16x16x32_bf16 v[112:115], a[196:199], a[152:155], v[112:115]
v_rcp_f32 v246, v246
v_mfma_f32_16x16x32_bf16 v[112:115], a[204:207], a[156:159], v[112:115]
v_rcp_f32 v247, v247
v_mfma_f32_16x16x32_bf16 v[108:111], a[200:203], a[156:159], v[108:111]
v_fma_f32 v244, -v236, v244, v244
v_fma_f32 v245, -v237, v245, v245
v_mfma_f32_16x16x32_bf16 v[108:111], a[192:195], a[152:155], v[108:111]
ds_read_b128 a[144:147], v1 offset:16384
v_fma_f32 v246, -v238, v246, v246
v_mfma_f32_16x16x32_bf16 v[108:111], a[184:187], a[148:151], v[108:111]
ds_read_b128 a[148:151], v1 offset:18432
v_fma_f32 v247, -v239, v247, v247
v_mfma_f32_16x16x32_bf16 v[116:119], a[184:187], a[152:155], v[116:119]
buffer_load_dwordx4 a[164:167], v14, s[8:11], s16 offen offset:0 sc1
v_mfma_f32_16x16x32_bf16 v[116:119], a[192:195], a[156:159], v[116:119]
v_cvt_pk_bf16_f32 v250, v244, v245
v_cvt_pk_bf16_f32 v251, v246, v247
v_mfma_f32_16x16x32_bf16 v[116:119], a[200:203], a[128:131], v[116:119]
ds_write_b64 v9, v[250:251] offset:28672
v_mfma_f32_16x16x32_bf16 v[120:123], a[204:207], a[128:131], v[120:123]
v_accvgpr_read_b32 v220, a124
v_accvgpr_read_b32 v221, a125
v_mfma_f32_16x16x32_bf16 v[120:123], a[196:199], a[156:159], v[120:123]
v_accvgpr_read_b32 v222, a126
v_accvgpr_read_b32 v223, a127
v_mfma_f32_16x16x32_bf16 v[120:123], a[188:191], a[152:155], v[120:123]
ds_read_b128 a[152:155], v1 offset:20480
v_fmac_f32 v216, s68, v204
v_mfma_f32_16x16x32_bf16 v[128:131], a[188:191], a[156:159], v[128:131]
buffer_load_dwordx4 a[168:171], v13, s[8:11], s16 offen offset:1024 sc1
v_mfma_f32_16x16x32_bf16 v[128:131], a[196:199], a[128:131], v[128:131]
v_fmac_f32 v217, s68, v205
s_waitcnt vmcnt(15) lgkmcnt(3)
v_mfma_f32_16x16x32_bf16 v[128:131], a[204:207], a[132:135], v[128:131]
v_fmac_f32 v218, s68, v206
v_fmac_f32 v219, s68, v207
v_mfma_f32_16x16x32_bf16 v[124:127], a[200:203], a[132:135], v[124:127]
v_fmac_f32 v220, s68, v208
v_fmac_f32 v221, s68, v209
v_mfma_f32_16x16x32_bf16 v[124:127], a[192:195], a[128:131], v[124:127]
v_fmac_f32 v222, s68, v210
v_fmac_f32 v223, s68, v211
v_mfma_f32_16x16x32_bf16 v[124:127], a[184:187], a[156:159], v[124:127]
ds_read_b128 a[156:159], v1 offset:22528
v_min_f32 v216, s67, v216
v_mfma_f32_16x16x32_bf16 v[132:135], a[184:187], a[128:131], v[132:135]
v_min_f32 v217, s67, v217
v_min_f32 v218, s67, v218
v_mfma_f32_16x16x32_bf16 v[132:135], a[192:195], a[132:135], v[132:135]
v_min_f32 v219, s67, v219
v_accvgpr_read_b32 v236, a0
v_mfma_f32_16x16x32_bf16 v[132:135], a[200:203], a[136:139], v[132:135]
buffer_load_dwordx4 a[172:175], v14, s[8:11], s16 offen offset:1024 sc1
v_mfma_f32_16x16x32_bf16 v[136:139], a[204:207], a[136:139], v[136:139]
v_exp_f32 v220, v220
v_mfma_f32_16x16x32_bf16 v[136:139], a[196:199], a[132:135], v[136:139]
v_exp_f32 v221, v221
v_mfma_f32_16x16x32_bf16 v[136:139], a[188:191], a[128:131], v[136:139]
ds_read_b128 a[128:131], v1 offset:24576
v_accvgpr_read_b32 v237, a1
v_mfma_f32_16x16x32_bf16 v[144:147], a[188:191], a[132:135], v[144:147]
v_exp_f32 v222, v222
v_mfma_f32_16x16x32_bf16 v[144:147], a[196:199], a[136:139], v[144:147]
v_exp_f32 v223, v223
v_mfma_f32_16x16x32_bf16 v[144:147], a[204:207], a[140:143], v[144:147]
v_exp_f32 v216, v216
v_mfma_f32_16x16x32_bf16 v[140:143], a[200:203], a[140:143], v[140:143]
v_exp_f32 v217, v217
v_mfma_f32_16x16x32_bf16 v[140:143], a[192:195], a[136:139], v[140:143]
buffer_load_dwordx4 a[176:179], v13, s[8:11], s16 offen offset:2048 sc1
v_mfma_f32_16x16x32_bf16 v[140:143], a[184:187], a[132:135], v[140:143]
ds_read_b128 a[132:135], v1 offset:26624
v_accvgpr_read_b32 v238, a2
v_mfma_f32_16x16x32_bf16 v[84:87], a[208:211], a[144:147], v[84:87]
ds_read_b128 a[136:139], v1 offset:28672
s_waitcnt vmcnt(7) lgkmcnt(3)
v_mfma_f32_16x16x32_bf16 v[84:87], a[216:219], a[148:151], v[84:87]
v_exp_f32 v218, v218
v_mfma_f32_16x16x32_bf16 v[84:87], a[224:227], a[152:155], v[84:87]
v_exp_f32 v219, v219
v_mfma_f32_16x16x32_bf16 v[88:91], a[228:231], a[152:155], v[88:91]
v_add_f32 v212, 1.0, v216
v_add_f32 v213, 1.0, v217
v_mfma_f32_16x16x32_bf16 v[88:91], a[220:223], a[148:151], v[88:91]
v_add_f32 v214, 1.0, v218
v_add_f32 v215, 1.0, v219
v_mfma_f32_16x16x32_bf16 v[88:91], a[212:215], a[144:147], v[88:91]
v_fmac_f32 v212, v212, v220
v_fmac_f32 v213, v213, v221
v_mfma_f32_16x16x32_bf16 v[96:99], a[212:215], a[148:151], v[96:99]
ds_read_b128 a[140:143], v1 offset:30720
v_fmac_f32 v214, v214, v222
v_mfma_f32_16x16x32_bf16 v[96:99], a[220:223], a[152:155], v[96:99]
buffer_load_dwordx4 a[180:183], v14, s[8:11], s16 offen offset:2048 sc1
v_mfma_f32_16x16x32_bf16 v[96:99], a[228:231], a[156:159], v[96:99]
v_fmac_f32 v215, v215, v223
v_accvgpr_read_b32 v239, a3
v_mfma_f32_16x16x32_bf16 v[92:95], a[224:227], a[156:159], v[92:95]
v_rcp_f32 v212, v212
v_mfma_f32_16x16x32_bf16 v[92:95], a[216:219], a[152:155], v[92:95]
v_rcp_f32 v213, v213
v_mfma_f32_16x16x32_bf16 v[92:95], a[208:211], a[148:151], v[92:95]
v_rcp_f32 v214, v214
v_mfma_f32_16x16x32_bf16 v[100:103], a[208:211], a[152:155], v[100:103]
ds_read_b128 a[144:147], v3 offset:16384
v_accvgpr_read_b32 v240, a4
v_mfma_f32_16x16x32_bf16 v[100:103], a[216:219], a[156:159], v[100:103]
v_accvgpr_read_b32 v241, a5
s_waitcnt vmcnt(7) lgkmcnt(2)
v_mfma_f32_16x16x32_bf16 v[100:103], a[224:227], a[128:131], v[100:103]
buffer_load_dwordx4 a[184:187], v13, s[8:11], s16 offen offset:3072 sc1
v_mfma_f32_16x16x32_bf16 v[104:107], a[228:231], a[128:131], v[104:107]
v_rcp_f32 v215, v215
v_mfma_f32_16x16x32_bf16 v[104:107], a[220:223], a[156:159], v[104:107]
v_fma_f32 v212, -v216, v212, v212
v_fma_f32 v213, -v217, v213, v213
v_mfma_f32_16x16x32_bf16 v[104:107], a[212:215], a[152:155], v[104:107]
v_fma_f32 v214, -v218, v214, v214
v_fma_f32 v215, -v219, v215, v215
v_mfma_f32_16x16x32_bf16 v[112:115], a[212:215], a[156:159], v[112:115]
ds_read_b128 a[148:151], v3 offset:18432
v_cvt_pk_bf16_f32 v226, v212, v213
v_mfma_f32_16x16x32_bf16 v[112:115], a[220:223], a[128:131], v[112:115]
v_cvt_pk_bf16_f32 v227, v214, v215
v_accvgpr_read_b32 v242, a6
v_mfma_f32_16x16x32_bf16 v[112:115], a[228:231], a[132:135], v[112:115]
ds_write_b64 v9, v[226:227] offset:30720
v_mfma_f32_16x16x32_bf16 v[108:111], a[224:227], a[132:135], v[108:111]
v_accvgpr_read_b32 v243, a7
v_fmac_f32 v236, s55, v148
v_mfma_f32_16x16x32_bf16 v[108:111], a[216:219], a[128:131], v[108:111]
ds_read_b128 a[152:155], v2 offset:16384
v_fmac_f32 v237, s55, v149
v_mfma_f32_16x16x32_bf16 v[108:111], a[208:211], a[156:159], v[108:111]
ds_read_b128 a[156:159], v2 offset:18432
v_fmac_f32 v238, s55, v150
v_mfma_f32_16x16x32_bf16 v[116:119], a[208:211], a[128:131], v[116:119]
buffer_load_dwordx4 a[188:191], v14, s[8:11], s16 offen offset:3072 sc1
v_mfma_f32_16x16x32_bf16 v[116:119], a[216:219], a[132:135], v[116:119]
s_add_u32 s16, s16, 4096
v_fmac_f32 v239, s55, v151
v_mfma_f32_16x16x32_bf16 v[116:119], a[224:227], a[136:139], v[116:119]
v_fmac_f32 v240, s55, v152
v_fmac_f32 v241, s55, v153
v_mfma_f32_16x16x32_bf16 v[120:123], a[228:231], a[136:139], v[120:123]
v_fmac_f32 v242, s55, v154
v_fmac_f32 v243, s55, v155
v_mfma_f32_16x16x32_bf16 v[120:123], a[220:223], a[132:135], v[120:123]
v_min_f32 v236, s67, v236
v_min_f32 v237, s67, v237
v_mfma_f32_16x16x32_bf16 v[120:123], a[212:215], a[128:131], v[120:123]
ds_read_b128 a[128:131], v2 offset:20480
v_min_f32 v238, s67, v238
v_mfma_f32_16x16x32_bf16 v[128:131], a[212:215], a[132:135], v[128:131]
buffer_load_dwordx4 a[192:195], v13, s[8:11], s16 offen offset:0 sc1
v_mfma_f32_16x16x32_bf16 v[128:131], a[220:223], a[136:139], v[128:131]
v_min_f32 v239, s67, v239
s_waitcnt vmcnt(8) lgkmcnt(2)
v_mfma_f32_16x16x32_bf16 v[128:131], a[228:231], a[140:143], v[128:131]
s_barrier
v_accvgpr_read_b32 v216, a8
v_mfma_f32_16x16x32_bf16 v[124:127], a[224:227], a[140:143], v[124:127]
ds_read_b128 v[228:231], v10 offset:24576
v_accvgpr_read_b32 v217, a9
v_mfma_f32_16x16x32_bf16 v[124:127], a[216:219], a[136:139], v[124:127]
ds_read_b128 v[232:235], v10 offset:28672
v_accvgpr_read_b32 v218, a10
v_mfma_f32_16x16x32_bf16 v[124:127], a[208:211], a[132:135], v[124:127]
ds_read_b128 a[132:135], v2 offset:22528
v_accvgpr_read_b32 v219, a11
v_mfma_f32_16x16x32_bf16 v[132:135], a[208:211], a[136:139], v[132:135]
v_exp_f32 v240, v240
v_mfma_f32_16x16x32_bf16 v[132:135], a[216:219], a[140:143], v[132:135]
v_exp_f32 v241, v241
v_mfma_f32_16x16x32_bf16 v[132:135], a[224:227], a[144:147], v[132:135]
buffer_load_dwordx4 a[196:199], v14, s[8:11], s16 offen offset:0 sc1
v_mfma_f32_16x16x32_bf16 v[136:139], a[228:231], a[144:147], v[136:139]
v_exp_f32 v242, v242
v_mfma_f32_16x16x32_bf16 v[136:139], a[220:223], a[140:143], v[136:139]
v_exp_f32 v243, v243
v_mfma_f32_16x16x32_bf16 v[136:139], a[212:215], a[136:139], v[136:139]
ds_read_b128 a[136:139], v2 offset:24576
v_accvgpr_read_b32 v220, a12
v_mfma_f32_16x16x32_bf16 v[144:147], a[212:215], a[140:143], v[144:147]
s_waitcnt vmcnt(7) lgkmcnt(3)
buffer_store_dwordx4 v[228:231], v17, s[12:15], s28 offen offset:2048 sc1
v_mfma_f32_16x16x32_bf16 v[144:147], a[220:223], a[144:147], v[144:147]
s_waitcnt lgkmcnt(2)
buffer_store_dwordx4 v[232:235], v17, s[12:15], s30 offen offset:2048 sc1
v_mfma_f32_16x16x32_bf16 v[144:147], a[228:231], a[148:151], v[144:147]
v_exp_f32 v236, v236
v_mfma_f32_16x16x32_bf16 v[140:143], a[224:227], a[148:151], v[140:143]
v_exp_f32 v237, v237
v_mfma_f32_16x16x32_bf16 v[140:143], a[216:219], a[144:147], v[140:143]
buffer_load_dwordx4 a[200:203], v13, s[8:11], s16 offen offset:1024 sc1
v_mfma_f32_16x16x32_bf16 v[140:143], a[208:211], a[140:143], v[140:143]
ds_read_b128 a[140:143], v2 offset:26624
v_accvgpr_read_b32 v221, a13
v_mfma_f32_16x16x32_bf16 v[84:87], a[232:235], a[152:155], v[84:87]
ds_read_b128 a[144:147], v2 offset:28672
v_accvgpr_read_b32 v222, a14
v_mfma_f32_16x16x32_bf16 v[84:87], a[240:243], a[156:159], v[84:87]
v_exp_f32 v238, v238
v_mfma_f32_16x16x32_bf16 v[84:87], a[248:251], a[128:131], v[84:87]
v_exp_f32 v239, v239
v_mfma_f32_16x16x32_bf16 v[88:91], a[252:255], a[128:131], v[88:91]
v_add_f32 v244, 1.0, v236
v_add_f32 v245, 1.0, v237
v_mfma_f32_16x16x32_bf16 v[88:91], a[244:247], a[156:159], v[88:91]
v_add_f32 v246, 1.0, v238
v_add_f32 v247, 1.0, v239
v_mfma_f32_16x16x32_bf16 v[88:91], a[236:239], a[152:155], v[88:91]
v_fmac_f32 v244, v244, v240
v_fmac_f32 v245, v245, v241
v_mfma_f32_16x16x32_bf16 v[96:99], a[236:239], a[156:159], v[96:99]
ds_read_b128 a[148:151], v2 offset:30720
v_fmac_f32 v246, v246, v242
v_mfma_f32_16x16x32_bf16 v[96:99], a[244:247], a[128:131], v[96:99]
v_fmac_f32 v247, v247, v243
s_waitcnt vmcnt(8) lgkmcnt(3)
v_mfma_f32_16x16x32_bf16 v[96:99], a[252:255], a[132:135], v[96:99]
buffer_load_dwordx4 a[204:207], v14, s[8:11], s16 offen offset:1024 sc1
v_mfma_f32_16x16x32_bf16 v[92:95], a[248:251], a[132:135], v[92:95]
v_rcp_f32 v244, v244
v_mfma_f32_16x16x32_bf16 v[92:95], a[240:243], a[128:131], v[92:95]
v_rcp_f32 v245, v245
v_mfma_f32_16x16x32_bf16 v[92:95], a[232:235], a[156:159], v[92:95]
v_rcp_f32 v246, v246
v_mfma_f32_16x16x32_bf16 v[100:103], a[232:235], a[128:131], v[100:103]
ds_read_b128 a[152:155], v4 offset:16384
v_accvgpr_read_b32 v223, a15
v_mfma_f32_16x16x32_bf16 v[100:103], a[240:243], a[132:135], v[100:103]
v_rcp_f32 v247, v247
v_mfma_f32_16x16x32_bf16 v[100:103], a[248:251], a[136:139], v[100:103]
buffer_load_dwordx4 a[208:211], v13, s[8:11], s16 offen offset:2048 sc1
v_mfma_f32_16x16x32_bf16 v[104:107], a[252:255], a[136:139], v[104:107]
v_fma_f32 v244, -v236, v244, v244
v_fma_f32 v245, -v237, v245, v245
v_mfma_f32_16x16x32_bf16 v[104:107], a[244:247], a[132:135], v[104:107]
v_fma_f32 v246, -v238, v246, v246
v_fma_f32 v247, -v239, v247, v247
v_mfma_f32_16x16x32_bf16 v[104:107], a[236:239], a[128:131], v[104:107]
v_cvt_pk_bf16_f32 v248, v244, v245
v_cvt_pk_bf16_f32 v249, v246, v247
v_mfma_f32_16x16x32_bf16 v[112:115], a[236:239], a[132:135], v[112:115]
ds_read_b128 a[156:159], v4 offset:18432
v_fmac_f32 v216, s55, v156
v_mfma_f32_16x16x32_bf16 v[112:115], a[244:247], a[136:139], v[112:115]
v_fmac_f32 v217, s55, v157
s_waitcnt vmcnt(9) lgkmcnt(2)
v_mfma_f32_16x16x32_bf16 v[112:115], a[252:255], a[140:143], v[112:115]
ds_write_b64 v9, v[248:249] offset:0
v_mfma_f32_16x16x32_bf16 v[108:111], a[248:251], a[140:143], v[108:111]
v_fmac_f32 v218, s55, v158
v_fmac_f32 v219, s55, v159
v_mfma_f32_16x16x32_bf16 v[108:111], a[240:243], a[136:139], v[108:111]
ds_read_b128 a[128:131], v1 offset:32768
v_fmac_f32 v220, s55, v160
v_mfma_f32_16x16x32_bf16 v[108:111], a[232:235], a[132:135], v[108:111]
ds_read_b128 a[132:135], v1 offset:34816
v_fmac_f32 v221, s55, v161
v_mfma_f32_16x16x32_bf16 v[116:119], a[232:235], a[136:139], v[116:119]
buffer_load_dwordx4 a[212:215], v14, s[8:11], s16 offen offset:2048 sc1
v_mfma_f32_16x16x32_bf16 v[116:119], a[240:243], a[140:143], v[116:119]
v_fmac_f32 v222, s55, v162
v_fmac_f32 v223, s55, v163
v_mfma_f32_16x16x32_bf16 v[116:119], a[248:251], a[144:147], v[116:119]
v_min_f32 v216, s67, v216
v_min_f32 v217, s67, v217
v_mfma_f32_16x16x32_bf16 v[120:123], a[252:255], a[144:147], v[120:123]
v_min_f32 v218, s67, v218
v_min_f32 v219, s67, v219
v_mfma_f32_16x16x32_bf16 v[120:123], a[244:247], a[140:143], v[120:123]
v_exp_f32 v220, v220
v_mfma_f32_16x16x32_bf16 v[120:123], a[236:239], a[136:139], v[120:123]
ds_read_b128 a[136:139], v1 offset:36864
v_accvgpr_read_b32 v236, a16
v_mfma_f32_16x16x32_bf16 v[128:131], a[236:239], a[140:143], v[128:131]
buffer_load_dwordx4 a[216:219], v13, s[8:11], s16 offen offset:3072 sc1
v_mfma_f32_16x16x32_bf16 v[128:131], a[244:247], a[144:147], v[128:131]
v_exp_f32 v221, v221
v_mfma_f32_16x16x32_bf16 v[128:131], a[252:255], a[148:151], v[128:131]
v_exp_f32 v222, v222
v_mfma_f32_16x16x32_bf16 v[124:127], a[248:251], a[148:151], v[124:127]
v_exp_f32 v223, v223
v_mfma_f32_16x16x32_bf16 v[124:127], a[240:243], a[144:147], v[124:127]
v_exp_f32 v216, v216
v_mfma_f32_16x16x32_bf16 v[124:127], a[232:235], a[140:143], v[124:127]
ds_read_b128 a[140:143], v1 offset:38912
v_accvgpr_read_b32 v237, a17
v_mfma_f32_16x16x32_bf16 v[132:135], a[232:235], a[144:147], v[132:135]
v_exp_f32 v217, v217
v_mfma_f32_16x16x32_bf16 v[132:135], a[240:243], a[148:151], v[132:135]
v_accvgpr_read_b32 v238, a18
s_waitcnt vmcnt(9) lgkmcnt(2)
v_mfma_f32_16x16x32_bf16 v[132:135], a[248:251], a[152:155], v[132:135]
buffer_load_dwordx4 a[220:223], v14, s[8:11], s16 offen offset:3072 sc1
v_mfma_f32_16x16x32_bf16 v[136:139], a[252:255], a[152:155], v[136:139]
s_add_u32 s16, s16, 4096
v_accvgpr_read_b32 v239, a19
v_mfma_f32_16x16x32_bf16 v[136:139], a[244:247], a[148:151], v[136:139]
v_exp_f32 v218, v218
v_mfma_f32_16x16x32_bf16 v[136:139], a[236:239], a[144:147], v[136:139]
ds_read_b128 a[144:147], v1 offset:40960
v_accvgpr_read_b32 v240, a20
v_mfma_f32_16x16x32_bf16 v[144:147], a[236:239], a[148:151], v[144:147]
v_exp_f32 v219, v219
v_mfma_f32_16x16x32_bf16 v[144:147], a[244:247], a[152:155], v[144:147]
v_add_f32 v212, 1.0, v216
v_add_f32 v213, 1.0, v217
v_mfma_f32_16x16x32_bf16 v[144:147], a[252:255], a[156:159], v[144:147]
v_add_f32 v214, 1.0, v218
v_add_f32 v215, 1.0, v219
v_mfma_f32_16x16x32_bf16 v[140:143], a[248:251], a[156:159], v[140:143]
v_fmac_f32 v212, v212, v220
v_fmac_f32 v213, v213, v221
v_mfma_f32_16x16x32_bf16 v[140:143], a[240:243], a[152:155], v[140:143]
buffer_load_dwordx4 a[224:227], v13, s[8:11], s16 offen offset:0 sc1
v_mfma_f32_16x16x32_bf16 v[140:143], a[232:235], a[148:151], v[140:143]
ds_read_b128 a[148:151], v1 offset:43008
v_fmac_f32 v214, v214, v222
v_mfma_f32_16x16x32_bf16 v[84:87], a[160:163], a[128:131], v[84:87]
ds_read_b128 a[152:155], v1 offset:45056
v_fmac_f32 v215, v215, v223
v_mfma_f32_16x16x32_bf16 v[84:87], a[168:171], a[132:135], v[84:87]
v_accvgpr_read_b32 v241, a21
s_waitcnt vmcnt(9) lgkmcnt(3)
v_mfma_f32_16x16x32_bf16 v[84:87], a[176:179], a[136:139], v[84:87]
v_rcp_f32 v212, v212
v_mfma_f32_16x16x32_bf16 v[88:91], a[180:183], a[136:139], v[88:91]
v_rcp_f32 v213, v213
v_mfma_f32_16x16x32_bf16 v[88:91], a[172:175], a[132:135], v[88:91]
v_rcp_f32 v214, v214
v_mfma_f32_16x16x32_bf16 v[88:91], a[164:167], a[128:131], v[88:91]
v_rcp_f32 v215, v215
v_mfma_f32_16x16x32_bf16 v[96:99], a[164:167], a[132:135], v[96:99]
ds_read_b128 a[156:159], v1 offset:47104
v_fma_f32 v212, -v216, v212, v212
v_mfma_f32_16x16x32_bf16 v[96:99], a[172:175], a[136:139], v[96:99]
buffer_load_dwordx4 a[228:231], v14, s[8:11], s16 offen offset:0 sc1
v_mfma_f32_16x16x32_bf16 v[96:99], a[180:183], a[140:143], v[96:99]
v_fma_f32 v213, -v217, v213, v213
v_fma_f32 v214, -v218, v214, v214
v_mfma_f32_16x16x32_bf16 v[92:95], a[176:179], a[140:143], v[92:95]
v_fma_f32 v215, -v219, v215, v215
v_cvt_pk_bf16_f32 v224, v212, v213
v_mfma_f32_16x16x32_bf16 v[92:95], a[168:171], a[136:139], v[92:95]
v_cvt_pk_bf16_f32 v225, v214, v215
v_accvgpr_read_b32 v242, a22
v_mfma_f32_16x16x32_bf16 v[92:95], a[160:163], a[132:135], v[92:95]
ds_write_b64 v9, v[224:225] offset:2048
v_mfma_f32_16x16x32_bf16 v[100:103], a[160:163], a[136:139], v[100:103]
ds_read_b128 a[128:131], v3 offset:32768
v_accvgpr_read_b32 v243, a23
v_mfma_f32_16x16x32_bf16 v[100:103], a[168:171], a[140:143], v[100:103]
v_fmac_f32 v236, s55, v164
s_waitcnt lgkmcnt(3)
v_mfma_f32_16x16x32_bf16 v[100:103], a[176:179], a[144:147], v[100:103]
buffer_load_dwordx4 a[232:235], v13, s[8:11], s16 offen offset:1024 sc1
v_mfma_f32_16x16x32_bf16 v[104:107], a[180:183], a[144:147], v[104:107]
v_fmac_f32 v237, s55, v165
v_fmac_f32 v238, s55, v166
v_mfma_f32_16x16x32_bf16 v[104:107], a[172:175], a[140:143], v[104:107]
v_fmac_f32 v239, s55, v167
v_fmac_f32 v240, s55, v168
v_mfma_f32_16x16x32_bf16 v[104:107], a[164:167], a[136:139], v[104:107]
v_fmac_f32 v241, s55, v169
v_fmac_f32 v242, s55, v170
v_mfma_f32_16x16x32_bf16 v[112:115], a[164:167], a[140:143], v[112:115]
ds_read_b128 a[132:135], v3 offset:34816
v_fmac_f32 v243, s55, v171
v_mfma_f32_16x16x32_bf16 v[112:115], a[172:175], a[144:147], v[112:115]
v_min_f32 v236, s67, v236
v_min_f32 v237, s67, v237
v_mfma_f32_16x16x32_bf16 v[112:115], a[180:183], a[148:151], v[112:115]
v_min_f32 v238, s67, v238
v_min_f32 v239, s67, v239
v_mfma_f32_16x16x32_bf16 v[108:111], a[176:179], a[148:151], v[108:111]
v_exp_f32 v240, v240
v_mfma_f32_16x16x32_bf16 v[108:111], a[168:171], a[144:147], v[108:111]
ds_read_b128 a[136:139], v2 offset:32768
v_accvgpr_read_b32 v216, a24
v_mfma_f32_16x16x32_bf16 v[108:111], a[160:163], a[140:143], v[108:111]
ds_read_b128 a[140:143], v2 offset:34816
v_accvgpr_read_b32 v217, a25
v_mfma_f32_16x16x32_bf16 v[116:119], a[160:163], a[144:147], v[116:119]
buffer_load_dwordx4 a[236:239], v14, s[8:11], s16 offen offset:1024 sc1
v_mfma_f32_16x16x32_bf16 v[116:119], a[168:171], a[148:151], v[116:119]
v_exp_f32 v241, v241
v_mfma_f32_16x16x32_bf16 v[116:119], a[176:179], a[152:155], v[116:119]
v_exp_f32 v242, v242
v_mfma_f32_16x16x32_bf16 v[120:123], a[180:183], a[152:155], v[120:123]
v_exp_f32 v243, v243
v_mfma_f32_16x16x32_bf16 v[120:123], a[172:175], a[148:151], v[120:123]
v_exp_f32 v236, v236
v_mfma_f32_16x16x32_bf16 v[120:123], a[164:167], a[144:147], v[120:123]
ds_read_b128 a[144:147], v2 offset:36864
v_accvgpr_read_b32 v218, a26
v_mfma_f32_16x16x32_bf16 v[128:131], a[164:167], a[148:151], v[128:131]
buffer_load_dwordx4 a[240:243], v13, s[8:11], s16 offen offset:2048 sc1
v_mfma_f32_16x16x32_bf16 v[128:131], a[172:175], a[152:155], v[128:131]
v_accvgpr_read_b32 v219, a27
s_waitcnt lgkmcnt(2)
v_mfma_f32_16x16x32_bf16 v[128:131], a[180:183], a[156:159], v[128:131]
v_exp_f32 v237, v237
v_mfma_f32_16x16x32_bf16 v[124:127], a[176:179], a[156:159], v[124:127]
v_exp_f32 v238, v238
v_mfma_f32_16x16x32_bf16 v[124:127], a[168:171], a[152:155], v[124:127]
v_exp_f32 v239, v239
v_mfma_f32_16x16x32_bf16 v[124:127], a[160:163], a[148:151], v[124:127]
ds_read_b128 a[148:151], v2 offset:38912
v_add_f32 v244, 1.0, v236
v_mfma_f32_16x16x32_bf16 v[132:135], a[160:163], a[152:155], v[132:135]
v_add_f32 v245, 1.0, v237
v_add_f32 v246, 1.0, v238
v_mfma_f32_16x16x32_bf16 v[132:135], a[168:171], a[156:159], v[132:135]
v_add_f32 v247, 1.0, v239
v_fmac_f32 v244, v244, v240
v_mfma_f32_16x16x32_bf16 v[132:135], a[176:179], a[128:131], v[132:135]
buffer_load_dwordx4 a[244:247], v14, s[8:11], s16 offen offset:2048 sc1
v_mfma_f32_16x16x32_bf16 v[136:139], a[180:183], a[128:131], v[136:139]
v_fmac_f32 v245, v245, v241
v_fmac_f32 v246, v246, v242
v_mfma_f32_16x16x32_bf16 v[136:139], a[172:175], a[156:159], v[136:139]
v_fmac_f32 v247, v247, v243
v_accvgpr_read_b32 v220, a28
v_mfma_f32_16x16x32_bf16 v[136:139], a[164:167], a[152:155], v[136:139]
ds_read_b128 a[152:155], v2 offset:40960
v_accvgpr_read_b32 v221, a29
v_mfma_f32_16x16x32_bf16 v[144:147], a[164:167], a[156:159], v[144:147]
v_rcp_f32 v244, v244
v_mfma_f32_16x16x32_bf16 v[144:147], a[172:175], a[128:131], v[144:147]
v_rcp_f32 v245, v245
v_mfma_f32_16x16x32_bf16 v[144:147], a[180:183], a[132:135], v[144:147]
v_rcp_f32 v246, v246
v_mfma_f32_16x16x32_bf16 v[140:143], a[176:179], a[132:135], v[140:143]
v_rcp_f32 v247, v247
v_mfma_f32_16x16x32_bf16 v[140:143], a[168:171], a[128:131], v[140:143]
buffer_load_dwordx4 a[248:251], v13, s[8:11], s16 offen offset:3072 sc1
v_mfma_f32_16x16x32_bf16 v[140:143], a[160:163], a[156:159], v[140:143]
ds_read_b128 a[156:159], v2 offset:43008
v_fma_f32 v244, -v236, v244, v244
v_mfma_f32_16x16x32_bf16 v[84:87], a[184:187], a[136:139], v[84:87]
ds_read_b128 a[128:131], v2 offset:45056
s_waitcnt lgkmcnt(3)
v_mfma_f32_16x16x32_bf16 v[84:87], a[192:195], a[140:143], v[84:87]
v_fma_f32 v245, -v237, v245, v245
s_waitcnt vmcnt(7)
v_mfma_f32_16x16x32_bf16 v[84:87], a[200:203], a[144:147], v[84:87]
v_fma_f32 v246, -v238, v246, v246
v_fma_f32 v247, -v239, v247, v247
v_mfma_f32_16x16x32_bf16 v[88:91], a[204:207], a[144:147], v[88:91]
v_cvt_pk_bf16_f32 v250, v244, v245
v_cvt_pk_bf16_f32 v251, v246, v247
v_mfma_f32_16x16x32_bf16 v[88:91], a[196:199], a[140:143], v[88:91]
ds_write_b64 v9, v[250:251] offset:4096
v_mfma_f32_16x16x32_bf16 v[88:91], a[188:191], a[136:139], v[88:91]
v_accvgpr_read_b32 v222, a30
v_accvgpr_read_b32 v223, a31
v_mfma_f32_16x16x32_bf16 v[96:99], a[188:191], a[140:143], v[96:99]
ds_read_b128 a[132:135], v2 offset:47104
v_fmac_f32 v216, s55, v172
v_mfma_f32_16x16x32_bf16 v[96:99], a[196:199], a[144:147], v[96:99]
buffer_load_dwordx4 a[252:255], v14, s[8:11], s16 offen offset:3072 sc1
v_mfma_f32_16x16x32_bf16 v[96:99], a[204:207], a[148:151], v[96:99]
v_fmac_f32 v217, s55, v173
v_fmac_f32 v218, s55, v174
v_mfma_f32_16x16x32_bf16 v[92:95], a[200:203], a[148:151], v[92:95]
v_fmac_f32 v219, s55, v175
v_fmac_f32 v220, s55, v176
v_mfma_f32_16x16x32_bf16 v[92:95], a[192:195], a[144:147], v[92:95]
v_fmac_f32 v221, s55, v177
v_fmac_f32 v222, s55, v178
v_mfma_f32_16x16x32_bf16 v[92:95], a[184:187], a[140:143], v[92:95]
v_fmac_f32 v223, s55, v179
v_min_f32 v216, s67, v216
v_mfma_f32_16x16x32_bf16 v[100:103], a[184:187], a[144:147], v[100:103]
ds_read_b128 a[136:139], v4 offset:32768
v_min_f32 v217, s67, v217
v_mfma_f32_16x16x32_bf16 v[100:103], a[192:195], a[148:151], v[100:103]
v_min_f32 v218, s67, v218
s_waitcnt vmcnt(7) lgkmcnt(2)
v_mfma_f32_16x16x32_bf16 v[100:103], a[200:203], a[152:155], v[100:103]
v_min_f32 v219, s67, v219
v_accvgpr_read_b32 v236, a32
v_mfma_f32_16x16x32_bf16 v[104:107], a[204:207], a[152:155], v[104:107]
v_exp_f32 v220, v220
v_mfma_f32_16x16x32_bf16 v[104:107], a[196:199], a[148:151], v[104:107]
v_exp_f32 v221, v221
v_mfma_f32_16x16x32_bf16 v[104:107], a[188:191], a[144:147], v[104:107]
v_exp_f32 v222, v222
v_mfma_f32_16x16x32_bf16 v[112:115], a[188:191], a[148:151], v[112:115]
ds_read_b128 a[140:143], v4 offset:34816
v_accvgpr_read_b32 v237, a33
v_mfma_f32_16x16x32_bf16 v[112:115], a[196:199], a[152:155], v[112:115]
v_exp_f32 v223, v223
v_mfma_f32_16x16x32_bf16 v[112:115], a[204:207], a[156:159], v[112:115]
v_exp_f32 v216, v216
v_mfma_f32_16x16x32_bf16 v[108:111], a[200:203], a[156:159], v[108:111]
v_exp_f32 v217, v217
v_mfma_f32_16x16x32_bf16 v[108:111], a[192:195], a[152:155], v[108:111]
ds_read_b128 a[144:147], v1 offset:49152
v_accvgpr_read_b32 v238, a34
v_mfma_f32_16x16x32_bf16 v[108:111], a[184:187], a[148:151], v[108:111]
ds_read_b128 a[148:151], v1 offset:51200
v_accvgpr_read_b32 v239, a35
v_mfma_f32_16x16x32_bf16 v[116:119], a[184:187], a[152:155], v[116:119]
v_exp_f32 v218, v218
v_mfma_f32_16x16x32_bf16 v[116:119], a[192:195], a[156:159], v[116:119]
v_exp_f32 v219, v219
v_mfma_f32_16x16x32_bf16 v[116:119], a[200:203], a[128:131], v[116:119]
v_add_f32 v212, 1.0, v216
v_add_f32 v213, 1.0, v217
v_mfma_f32_16x16x32_bf16 v[120:123], a[204:207], a[128:131], v[120:123]
v_add_f32 v214, 1.0, v218
v_add_f32 v215, 1.0, v219
v_mfma_f32_16x16x32_bf16 v[120:123], a[196:199], a[156:159], v[120:123]
v_fmac_f32 v212, v212, v220
v_fmac_f32 v213, v213, v221
v_mfma_f32_16x16x32_bf16 v[120:123], a[188:191], a[152:155], v[120:123]
ds_read_b128 a[152:155], v1 offset:53248
v_fmac_f32 v214, v214, v222
v_mfma_f32_16x16x32_bf16 v[128:131], a[188:191], a[156:159], v[128:131]
v_fmac_f32 v215, v215, v223
v_accvgpr_read_b32 v240, a36
v_mfma_f32_16x16x32_bf16 v[128:131], a[196:199], a[128:131], v[128:131]
v_accvgpr_read_b32 v241, a37
s_waitcnt vmcnt(5) lgkmcnt(2)
v_mfma_f32_16x16x32_bf16 v[128:131], a[204:207], a[132:135], v[128:131]
v_rcp_f32 v212, v212
v_mfma_f32_16x16x32_bf16 v[124:127], a[200:203], a[132:135], v[124:127]
v_rcp_f32 v213, v213
v_mfma_f32_16x16x32_bf16 v[124:127], a[192:195], a[128:131], v[124:127]
v_rcp_f32 v214, v214
v_mfma_f32_16x16x32_bf16 v[124:127], a[184:187], a[156:159], v[124:127]
ds_read_b128 a[156:159], v1 offset:55296
v_accvgpr_read_b32 v242, a38
v_mfma_f32_16x16x32_bf16 v[132:135], a[184:187], a[128:131], v[132:135]
v_rcp_f32 v215, v215
v_mfma_f32_16x16x32_bf16 v[132:135], a[192:195], a[132:135], v[132:135]
v_fma_f32 v212, -v216, v212, v212
v_fma_f32 v213, -v217, v213, v213
v_mfma_f32_16x16x32_bf16 v[132:135], a[200:203], a[136:139], v[132:135]
v_fma_f32 v214, -v218, v214, v214
v_fma_f32 v215, -v219, v215, v215
v_mfma_f32_16x16x32_bf16 v[136:139], a[204:207], a[136:139], v[136:139]
v_cvt_pk_bf16_f32 v226, v212, v213
v_cvt_pk_bf16_f32 v227, v214, v215
v_mfma_f32_16x16x32_bf16 v[136:139], a[196:199], a[132:135], v[136:139]
ds_write_b64 v9, v[226:227] offset:6144
v_mfma_f32_16x16x32_bf16 v[136:139], a[188:191], a[128:131], v[136:139]
ds_read_b128 a[128:131], v1 offset:57344
v_accvgpr_read_b32 v243, a39
v_mfma_f32_16x16x32_bf16 v[144:147], a[188:191], a[132:135], v[144:147]
v_fmac_f32 v236, s55, v180
v_fmac_f32 v237, s55, v181
v_mfma_f32_16x16x32_bf16 v[144:147], a[196:199], a[136:139], v[144:147]
v_fmac_f32 v238, s55, v182
v_fmac_f32 v239, s55, v183
v_mfma_f32_16x16x32_bf16 v[144:147], a[204:207], a[140:143], v[144:147]
v_fmac_f32 v240, s55, v184
v_fmac_f32 v241, s55, v185
v_mfma_f32_16x16x32_bf16 v[140:143], a[200:203], a[140:143], v[140:143]
v_fmac_f32 v242, s55, v186
v_fmac_f32 v243, s55, v187
v_mfma_f32_16x16x32_bf16 v[140:143], a[192:195], a[136:139], v[140:143]
v_min_f32 v236, s67, v236
v_min_f32 v237, s67, v237
v_mfma_f32_16x16x32_bf16 v[140:143], a[184:187], a[132:135], v[140:143]
ds_read_b128 a[132:135], v1 offset:59392
v_min_f32 v238, s67, v238
v_mfma_f32_16x16x32_bf16 v[84:87], a[208:211], a[144:147], v[84:87]
ds_read_b128 a[136:139], v1 offset:61440
s_waitcnt vmcnt(2) lgkmcnt(4)
v_mfma_f32_16x16x32_bf16 v[84:87], a[216:219], a[148:151], v[84:87]
s_waitcnt lgkmcnt(3)
s_barrier
v_mfma_f32_16x16x32_bf16 v[84:87], a[224:227], a[152:155], v[84:87]
ds_read_b128 v[228:231], v10 offset:0
v_min_f32 v239, s67, v239
v_mfma_f32_16x16x32_bf16 v[88:91], a[228:231], a[152:155], v[88:91]
ds_read_b128 v[232:235], v10 offset:4096
v_accvgpr_read_b32 v216, a40
v_mfma_f32_16x16x32_bf16 v[88:91], a[220:223], a[148:151], v[88:91]
v_exp_f32 v240, v240
v_mfma_f32_16x16x32_bf16 v[88:91], a[212:215], a[144:147], v[88:91]
v_exp_f32 v241, v241
v_mfma_f32_16x16x32_bf16 v[96:99], a[212:215], a[148:151], v[96:99]
ds_read_b128 a[140:143], v1 offset:63488
v_accvgpr_read_b32 v217, a41
v_mfma_f32_16x16x32_bf16 v[96:99], a[220:223], a[152:155], v[96:99]
v_exp_f32 v242, v242
v_mfma_f32_16x16x32_bf16 v[96:99], a[228:231], a[156:159], v[96:99]
v_exp_f32 v243, v243
v_mfma_f32_16x16x32_bf16 v[92:95], a[224:227], a[156:159], v[92:95]
v_exp_f32 v236, v236
v_mfma_f32_16x16x32_bf16 v[92:95], a[216:219], a[152:155], v[92:95]
v_exp_f32 v237, v237
v_mfma_f32_16x16x32_bf16 v[92:95], a[208:211], a[148:151], v[92:95]
s_waitcnt vmcnt(1) lgkmcnt(2)
buffer_store_dwordx4 v[228:231], v17, s[12:15], s24 offen offset:0 sc1
v_mfma_f32_16x16x32_bf16 v[100:103], a[208:211], a[152:155], v[100:103]
ds_read_b128 a[144:147], v3 offset:49152
v_accvgpr_read_b32 v218, a42
v_mfma_f32_16x16x32_bf16 v[100:103], a[216:219], a[156:159], v[100:103]
s_waitcnt lgkmcnt(2)
buffer_store_dwordx4 v[232:235], v17, s[12:15], s26 offen offset:0 sc1
v_mfma_f32_16x16x32_bf16 v[100:103], a[224:227], a[128:131], v[100:103]
v_exp_f32 v238, v238
v_mfma_f32_16x16x32_bf16 v[104:107], a[228:231], a[128:131], v[104:107]
v_exp_f32 v239, v239
v_mfma_f32_16x16x32_bf16 v[104:107], a[220:223], a[156:159], v[104:107]
v_add_f32 v244, 1.0, v236
v_add_f32 v245, 1.0, v237
v_mfma_f32_16x16x32_bf16 v[104:107], a[212:215], a[152:155], v[104:107]
v_add_f32 v246, 1.0, v238
v_add_f32 v247, 1.0, v239
v_mfma_f32_16x16x32_bf16 v[112:115], a[212:215], a[156:159], v[112:115]
ds_read_b128 a[148:151], v3 offset:51200
v_fmac_f32 v244, v244, v240
v_mfma_f32_16x16x32_bf16 v[112:115], a[220:223], a[128:131], v[112:115]
v_fmac_f32 v245, v245, v241
v_fmac_f32 v246, v246, v242
v_mfma_f32_16x16x32_bf16 v[112:115], a[228:231], a[132:135], v[112:115]
v_fmac_f32 v247, v247, v243
v_accvgpr_read_b32 v219, a43
v_mfma_f32_16x16x32_bf16 v[108:111], a[224:227], a[132:135], v[108:111]
v_rcp_f32 v244, v244
v_mfma_f32_16x16x32_bf16 v[108:111], a[216:219], a[128:131], v[108:111]
ds_read_b128 a[152:155], v2 offset:49152
v_accvgpr_read_b32 v220, a44
v_mfma_f32_16x16x32_bf16 v[108:111], a[208:211], a[156:159], v[108:111]
ds_read_b128 a[156:159], v2 offset:51200
v_accvgpr_read_b32 v221, a45
v_mfma_f32_16x16x32_bf16 v[116:119], a[208:211], a[128:131], v[116:119]
v_rcp_f32 v245, v245
v_mfma_f32_16x16x32_bf16 v[116:119], a[216:219], a[132:135], v[116:119]
v_rcp_f32 v246, v246
v_mfma_f32_16x16x32_bf16 v[116:119], a[224:227], a[136:139], v[116:119]
v_rcp_f32 v247, v247
v_mfma_f32_16x16x32_bf16 v[120:123], a[228:231], a[136:139], v[120:123]
v_fma_f32 v244, -v236, v244, v244
v_fma_f32 v245, -v237, v245, v245
v_mfma_f32_16x16x32_bf16 v[120:123], a[220:223], a[132:135], v[120:123]
v_fma_f32 v246, -v238, v246, v246
v_fma_f32 v247, -v239, v247, v247
v_mfma_f32_16x16x32_bf16 v[120:123], a[212:215], a[128:131], v[120:123]
ds_read_b128 a[128:131], v2 offset:53248
v_cvt_pk_bf16_f32 v248, v244, v245
v_mfma_f32_16x16x32_bf16 v[128:131], a[212:215], a[132:135], v[128:131]
v_cvt_pk_bf16_f32 v249, v246, v247
v_accvgpr_read_b32 v222, a46
v_mfma_f32_16x16x32_bf16 v[128:131], a[220:223], a[136:139], v[128:131]
v_accvgpr_read_b32 v223, a47
s_waitcnt vmcnt(2) lgkmcnt(2)
v_mfma_f32_16x16x32_bf16 v[128:131], a[228:231], a[140:143], v[128:131]
ds_write_b64 v9, v[248:249] offset:8192
v_mfma_f32_16x16x32_bf16 v[124:127], a[224:227], a[140:143], v[124:127]
v_fmac_f32 v216, s55, v188
v_fmac_f32 v217, s55, v189
v_mfma_f32_16x16x32_bf16 v[124:127], a[216:219], a[136:139], v[124:127]
v_fmac_f32 v218, s55, v190
v_fmac_f32 v219, s55, v191
v_mfma_f32_16x16x32_bf16 v[124:127], a[208:211], a[132:135], v[124:127]
ds_read_b128 a[132:135], v2 offset:55296
v_fmac_f32 v220, s55, v192
v_mfma_f32_16x16x32_bf16 v[132:135], a[208:211], a[136:139], v[132:135]
v_fmac_f32 v221, s55, v193
v_fmac_f32 v222, s55, v194
v_mfma_f32_16x16x32_bf16 v[132:135], a[216:219], a[140:143], v[132:135]
v_fmac_f32 v223, s55, v195
v_min_f32 v216, s67, v216
v_mfma_f32_16x16x32_bf16 v[132:135], a[224:227], a[144:147], v[132:135]
v_min_f32 v217, s67, v217
v_min_f32 v218, s67, v218
v_mfma_f32_16x16x32_bf16 v[136:139], a[228:231], a[144:147], v[136:139]
v_min_f32 v219, s67, v219
v_accvgpr_read_b32 v236, a48
v_mfma_f32_16x16x32_bf16 v[136:139], a[220:223], a[140:143], v[136:139]
v_exp_f32 v220, v220
v_mfma_f32_16x16x32_bf16 v[136:139], a[212:215], a[136:139], v[136:139]
ds_read_b128 a[136:139], v2 offset:57344
v_accvgpr_read_b32 v237, a49
v_mfma_f32_16x16x32_bf16 v[144:147], a[212:215], a[140:143], v[144:147]
v_exp_f32 v221, v221
v_mfma_f32_16x16x32_bf16 v[144:147], a[220:223], a[144:147], v[144:147]
v_exp_f32 v222, v222
v_mfma_f32_16x16x32_bf16 v[144:147], a[228:231], a[148:151], v[144:147]
v_exp_f32 v223, v223
v_mfma_f32_16x16x32_bf16 v[140:143], a[224:227], a[148:151], v[140:143]
v_exp_f32 v216, v216
v_mfma_f32_16x16x32_bf16 v[140:143], a[216:219], a[144:147], v[140:143]
v_exp_f32 v217, v217
v_mfma_f32_16x16x32_bf16 v[140:143], a[208:211], a[140:143], v[140:143]
ds_read_b128 a[140:143], v2 offset:59392
v_accvgpr_read_b32 v238, a50
v_mfma_f32_16x16x32_bf16 v[84:87], a[232:235], a[152:155], v[84:87]
ds_read_b128 a[144:147], v2 offset:61440
s_waitcnt lgkmcnt(3)
v_mfma_f32_16x16x32_bf16 v[84:87], a[240:243], a[156:159], v[84:87]
v_exp_f32 v218, v218
v_mfma_f32_16x16x32_bf16 v[84:87], a[248:251], a[128:131], v[84:87]
v_exp_f32 v219, v219
v_mfma_f32_16x16x32_bf16 v[88:91], a[252:255], a[128:131], v[88:91]
v_add_f32 v212, 1.0, v216
v_add_f32 v213, 1.0, v217
v_mfma_f32_16x16x32_bf16 v[88:91], a[244:247], a[156:159], v[88:91]
v_add_f32 v214, 1.0, v218
v_add_f32 v215, 1.0, v219
v_mfma_f32_16x16x32_bf16 v[88:91], a[236:239], a[152:155], v[88:91]
v_fmac_f32 v212, v212, v220
v_fmac_f32 v213, v213, v221
v_mfma_f32_16x16x32_bf16 v[96:99], a[236:239], a[156:159], v[96:99]
ds_read_b128 a[148:151], v2 offset:63488
v_fmac_f32 v214, v214, v222
v_mfma_f32_16x16x32_bf16 v[96:99], a[244:247], a[128:131], v[96:99]
v_fmac_f32 v215, v215, v223
v_accvgpr_read_b32 v239, a51
v_mfma_f32_16x16x32_bf16 v[96:99], a[252:255], a[132:135], v[96:99]
v_rcp_f32 v212, v212
v_mfma_f32_16x16x32_bf16 v[92:95], a[248:251], a[132:135], v[92:95]
v_rcp_f32 v213, v213
v_mfma_f32_16x16x32_bf16 v[92:95], a[240:243], a[128:131], v[92:95]
v_rcp_f32 v214, v214
v_mfma_f32_16x16x32_bf16 v[92:95], a[232:235], a[156:159], v[92:95]
v_rcp_f32 v215, v215
v_mfma_f32_16x16x32_bf16 v[100:103], a[232:235], a[128:131], v[100:103]
ds_read_b128 a[152:155], v4 offset:49152
v_fma_f32 v212, -v216, v212, v212
v_mfma_f32_16x16x32_bf16 v[100:103], a[240:243], a[132:135], v[100:103]
v_fma_f32 v213, -v217, v213, v213
s_waitcnt lgkmcnt(2)
v_mfma_f32_16x16x32_bf16 v[100:103], a[248:251], a[136:139], v[100:103]
v_fma_f32 v214, -v218, v214, v214
v_fma_f32 v215, -v219, v215, v215
v_mfma_f32_16x16x32_bf16 v[104:107], a[252:255], a[136:139], v[104:107]
v_cvt_pk_bf16_f32 v224, v212, v213
v_cvt_pk_bf16_f32 v225, v214, v215
v_mfma_f32_16x16x32_bf16 v[104:107], a[244:247], a[132:135], v[104:107]
ds_write_b64 v9, v[224:225] offset:10240
v_mfma_f32_16x16x32_bf16 v[104:107], a[236:239], a[128:131], v[104:107]
v_accvgpr_read_b32 v240, a52
v_accvgpr_read_b32 v241, a53
v_mfma_f32_16x16x32_bf16 v[112:115], a[236:239], a[132:135], v[112:115]
ds_read_b128 a[156:159], v4 offset:51200
v_accvgpr_read_b32 v242, a54
v_mfma_f32_16x16x32_bf16 v[112:115], a[244:247], a[136:139], v[112:115]
v_accvgpr_read_b32 v243, a55
v_fmac_f32 v236, s55, v196
v_mfma_f32_16x16x32_bf16 v[112:115], a[252:255], a[140:143], v[112:115]
v_fmac_f32 v237, s55, v197
v_fmac_f32 v238, s55, v198
v_mfma_f32_16x16x32_bf16 v[108:111], a[248:251], a[140:143], v[108:111]
v_fmac_f32 v239, s55, v199
v_fmac_f32 v240, s55, v200
v_mfma_f32_16x16x32_bf16 v[108:111], a[240:243], a[136:139], v[108:111]
v_fmac_f32 v241, s55, v201
v_fmac_f32 v242, s55, v202
v_mfma_f32_16x16x32_bf16 v[108:111], a[232:235], a[132:135], v[108:111]
v_fmac_f32 v243, s55, v203
v_min_f32 v236, s67, v236
v_mfma_f32_16x16x32_bf16 v[116:119], a[232:235], a[136:139], v[116:119]
v_min_f32 v237, s67, v237
v_min_f32 v238, s67, v238
v_mfma_f32_16x16x32_bf16 v[116:119], a[240:243], a[140:143], v[116:119]
v_min_f32 v239, s67, v239
v_accvgpr_read_b32 v216, a56
v_mfma_f32_16x16x32_bf16 v[116:119], a[248:251], a[144:147], v[116:119]
v_exp_f32 v240, v240
v_mfma_f32_16x16x32_bf16 v[120:123], a[252:255], a[144:147], v[120:123]
v_exp_f32 v241, v241
v_mfma_f32_16x16x32_bf16 v[120:123], a[244:247], a[140:143], v[120:123]
v_exp_f32 v242, v242
v_mfma_f32_16x16x32_bf16 v[120:123], a[236:239], a[136:139], v[120:123]
v_exp_f32 v243, v243
v_mfma_f32_16x16x32_bf16 v[128:131], a[236:239], a[140:143], v[128:131]
v_exp_f32 v236, v236
v_mfma_f32_16x16x32_bf16 v[128:131], a[244:247], a[144:147], v[128:131]
v_accvgpr_read_b32 v217, a57
s_waitcnt lgkmcnt(0)
v_mfma_f32_16x16x32_bf16 v[128:131], a[252:255], a[148:151], v[128:131]
v_exp_f32 v237, v237
v_mfma_f32_16x16x32_bf16 v[124:127], a[248:251], a[148:151], v[124:127]
v_exp_f32 v238, v238
v_mfma_f32_16x16x32_bf16 v[124:127], a[240:243], a[144:147], v[124:127]
v_exp_f32 v239, v239
v_mfma_f32_16x16x32_bf16 v[124:127], a[232:235], a[140:143], v[124:127]
v_add_f32 v244, 1.0, v236
v_add_f32 v245, 1.0, v237
v_mfma_f32_16x16x32_bf16 v[132:135], a[232:235], a[144:147], v[132:135]
v_add_f32 v246, 1.0, v238
v_add_f32 v247, 1.0, v239
v_mfma_f32_16x16x32_bf16 v[132:135], a[240:243], a[148:151], v[132:135]
v_fmac_f32 v244, v244, v240
v_fmac_f32 v245, v245, v241
v_mfma_f32_16x16x32_bf16 v[132:135], a[248:251], a[152:155], v[132:135]
v_fmac_f32 v246, v246, v242
v_fmac_f32 v247, v247, v243
v_mfma_f32_16x16x32_bf16 v[136:139], a[252:255], a[152:155], v[136:139]
v_rcp_f32 v244, v244
v_mfma_f32_16x16x32_bf16 v[136:139], a[244:247], a[148:151], v[136:139]
v_rcp_f32 v245, v245
v_mfma_f32_16x16x32_bf16 v[136:139], a[236:239], a[144:147], v[136:139]
v_rcp_f32 v246, v246
v_mfma_f32_16x16x32_bf16 v[144:147], a[236:239], a[148:151], v[144:147]
v_rcp_f32 v247, v247
v_mfma_f32_16x16x32_bf16 v[144:147], a[244:247], a[152:155], v[144:147]
v_fma_f32 v244, -v236, v244, v244
v_fma_f32 v245, -v237, v245, v245
v_mfma_f32_16x16x32_bf16 v[144:147], a[252:255], a[156:159], v[144:147]
v_fma_f32 v246, -v238, v246, v246
v_fma_f32 v247, -v239, v247, v247
v_mfma_f32_16x16x32_bf16 v[140:143], a[248:251], a[156:159], v[140:143]
v_cvt_pk_bf16_f32 v250, v244, v245
v_cvt_pk_bf16_f32 v251, v246, v247
v_mfma_f32_16x16x32_bf16 v[140:143], a[240:243], a[152:155], v[140:143]
ds_write_b64 v9, v[250:251] offset:12288
v_mfma_f32_16x16x32_bf16 v[140:143], a[232:235], a[148:151], v[140:143]
v_accvgpr_read_b32 v218, a58
v_accvgpr_read_b32 v219, a59
v_accvgpr_read_b32 v220, a60
v_accvgpr_read_b32 v221, a61
v_accvgpr_read_b32 v222, a62
v_accvgpr_read_b32 v223, a63
v_fmac_f32 v216, s55, v204
v_fmac_f32 v217, s55, v205
v_fmac_f32 v218, s55, v206
v_fmac_f32 v219, s55, v207
v_fmac_f32 v220, s55, v208
v_fmac_f32 v221, s55, v209
v_fmac_f32 v222, s55, v210
v_fmac_f32 v223, s55, v211
v_min_f32 v216, s67, v216
v_min_f32 v217, s67, v217
v_min_f32 v218, s67, v218
v_min_f32 v219, s67, v219
v_exp_f32 v220, v220
v_exp_f32 v221, v221
v_exp_f32 v222, v222
v_exp_f32 v223, v223
v_exp_f32 v216, v216
v_exp_f32 v217, v217
v_exp_f32 v218, v218
v_exp_f32 v219, v219
v_add_f32 v212, 1.0, v216
v_add_f32 v213, 1.0, v217
v_add_f32 v214, 1.0, v218
v_add_f32 v215, 1.0, v219
v_fmac_f32 v212, v212, v220
v_fmac_f32 v213, v213, v221
v_fmac_f32 v214, v214, v222
v_fmac_f32 v215, v215, v223
v_rcp_f32 v212, v212
v_rcp_f32 v213, v213
v_rcp_f32 v214, v214
v_rcp_f32 v215, v215
v_fma_f32 v212, -v216, v212, v212
v_fma_f32 v213, -v217, v213, v213
v_fma_f32 v214, -v218, v214, v214
v_fma_f32 v215, -v219, v215, v215
v_cvt_pk_bf16_f32 v226, v212, v213
v_cvt_pk_bf16_f32 v227, v214, v215
ds_write_b64 v9, v[226:227] offset:14336
s_waitcnt lgkmcnt(0)
s_barrier
ds_read_b128 v[228:231], v10 offset:8192
ds_read_b128 v[232:235], v10 offset:12288
v_fmac_f32 v84, s69, v148
v_fmac_f32 v85, s69, v149
v_fmac_f32 v86, s69, v150
v_fmac_f32 v87, s69, v151
v_fmac_f32 v88, s69, v152
v_fmac_f32 v89, s69, v153
v_fmac_f32 v90, s69, v154
v_fmac_f32 v91, s69, v155
v_min_f32 v84, s67, v84
v_min_f32 v85, s67, v85
s_waitcnt lgkmcnt(1)
buffer_store_dwordx4 v[228:231], v17, s[12:15], s28 offen offset:0 sc1
s_waitcnt lgkmcnt(0)
buffer_store_dwordx4 v[232:235], v17, s[12:15], s30 offen offset:0 sc1
v_min_f32 v86, s67, v86
v_min_f32 v87, s67, v87
v_exp_f32 v88, v88
v_exp_f32 v89, v89
v_exp_f32 v90, v90
v_exp_f32 v91, v91
v_exp_f32 v84, v84
v_exp_f32 v85, v85
v_exp_f32 v86, v86
v_exp_f32 v87, v87
v_add_f32 v236, 1.0, v84
v_add_f32 v237, 1.0, v85
v_add_f32 v238, 1.0, v86
v_add_f32 v239, 1.0, v87
v_fmac_f32 v236, v236, v88
v_fmac_f32 v237, v237, v89
v_fmac_f32 v238, v238, v90
v_fmac_f32 v239, v239, v91
v_rcp_f32 v236, v236
v_rcp_f32 v237, v237
v_rcp_f32 v238, v238
v_rcp_f32 v239, v239
v_fma_f32 v236, -v84, v236, v236
v_fma_f32 v237, -v85, v237, v237
v_fma_f32 v238, -v86, v238, v238
v_fma_f32 v239, -v87, v239, v239
v_cvt_pk_bf16_f32 v248, v236, v237
v_cvt_pk_bf16_f32 v249, v238, v239
ds_write_b64 v9, v[248:249] offset:16384
v_pk_fma_f32 v[92:93], v[156:157], s[68:69], v[92:93] op_sel:[0,1,0] op_sel_hi:[1,1,1] neg_lo:[0,0,0] neg_hi:[0,0,0]
v_pk_fma_f32 v[94:95], v[158:159], s[68:69], v[94:95] op_sel:[0,1,0] op_sel_hi:[1,1,1] neg_lo:[0,0,0] neg_hi:[0,0,0]
v_pk_fma_f32 v[96:97], v[160:161], s[68:69], v[96:97] op_sel:[0,1,0] op_sel_hi:[1,1,1] neg_lo:[0,0,0] neg_hi:[0,0,0]
v_pk_fma_f32 v[98:99], v[162:163], s[68:69], v[98:99] op_sel:[0,1,0] op_sel_hi:[1,1,1] neg_lo:[0,0,0] neg_hi:[0,0,0]
v_min_f32 v92, s67, v92
v_min_f32 v93, s67, v93
v_min_f32 v94, s67, v94
v_min_f32 v95, s67, v95
v_exp_f32 v96, v96
v_exp_f32 v97, v97
v_exp_f32 v98, v98
v_exp_f32 v99, v99
v_exp_f32 v92, v92
v_exp_f32 v93, v93
v_exp_f32 v94, v94
v_exp_f32 v95, v95
v_pk_add_f32 v[240:241], v[92:93], 1.0 op_sel_hi:[1,0]
v_pk_add_f32 v[242:243], v[94:95], 1.0 op_sel_hi:[1,0]
v_pk_fma_f32 v[240:241], v[240:241], v[96:97], v[240:241]
v_pk_fma_f32 v[242:243], v[242:243], v[98:99], v[242:243]
v_rcp_f32 v240, v240
v_rcp_f32 v241, v241
v_rcp_f32 v242, v242
v_rcp_f32 v243, v243
v_pk_fma_f32 v[240:241], v[92:93], v[240:241], v[240:241] neg_lo:[1,0,0] neg_hi:[1,0,0]
v_pk_fma_f32 v[242:243], v[94:95], v[242:243], v[242:243] neg_lo:[1,0,0] neg_hi:[1,0,0]
v_cvt_pk_bf16_f32 v250, v240, v241
v_cvt_pk_bf16_f32 v251, v242, v243
ds_write_b64 v9, v[250:251] offset:18432
v_pk_fma_f32 v[100:101], v[164:165], s[68:69], v[100:101] op_sel:[0,1,0] op_sel_hi:[1,1,1] neg_lo:[0,0,0] neg_hi:[0,0,0]
v_pk_fma_f32 v[102:103], v[166:167], s[68:69], v[102:103] op_sel:[0,1,0] op_sel_hi:[1,1,1] neg_lo:[0,0,0] neg_hi:[0,0,0]
v_pk_fma_f32 v[104:105], v[168:169], s[68:69], v[104:105] op_sel:[0,1,0] op_sel_hi:[1,1,1] neg_lo:[0,0,0] neg_hi:[0,0,0]
v_pk_fma_f32 v[106:107], v[170:171], s[68:69], v[106:107] op_sel:[0,1,0] op_sel_hi:[1,1,1] neg_lo:[0,0,0] neg_hi:[0,0,0]
v_min_f32 v100, s67, v100
v_min_f32 v101, s67, v101
v_min_f32 v102, s67, v102
v_min_f32 v103, s67, v103
v_exp_f32 v104, v104
v_exp_f32 v105, v105
v_exp_f32 v106, v106
v_exp_f32 v107, v107
v_exp_f32 v100, v100
v_exp_f32 v101, v101
v_exp_f32 v102, v102
v_exp_f32 v103, v103
v_pk_add_f32 v[244:245], v[100:101], 1.0 op_sel_hi:[1,0]
v_pk_add_f32 v[246:247], v[102:103], 1.0 op_sel_hi:[1,0]
v_pk_fma_f32 v[244:245], v[244:245], v[104:105], v[244:245]
v_pk_fma_f32 v[246:247], v[246:247], v[106:107], v[246:247]
v_rcp_f32 v244, v244
v_rcp_f32 v245, v245
v_rcp_f32 v246, v246
v_rcp_f32 v247, v247
v_pk_fma_f32 v[244:245], v[100:101], v[244:245], v[244:245] neg_lo:[1,0,0] neg_hi:[1,0,0]
v_pk_fma_f32 v[246:247], v[102:103], v[246:247], v[246:247] neg_lo:[1,0,0] neg_hi:[1,0,0]
v_cvt_pk_bf16_f32 v248, v244, v245
v_cvt_pk_bf16_f32 v249, v246, v247
ds_write_b64 v9, v[248:249] offset:20480
v_pk_fma_f32 v[108:109], v[172:173], s[68:69], v[108:109] op_sel:[0,1,0] op_sel_hi:[1,1,1] neg_lo:[0,0,0] neg_hi:[0,0,0]
v_pk_fma_f32 v[110:111], v[174:175], s[68:69], v[110:111] op_sel:[0,1,0] op_sel_hi:[1,1,1] neg_lo:[0,0,0] neg_hi:[0,0,0]
v_pk_fma_f32 v[112:113], v[176:177], s[68:69], v[112:113] op_sel:[0,1,0] op_sel_hi:[1,1,1] neg_lo:[0,0,0] neg_hi:[0,0,0]
v_pk_fma_f32 v[114:115], v[178:179], s[68:69], v[114:115] op_sel:[0,1,0] op_sel_hi:[1,1,1] neg_lo:[0,0,0] neg_hi:[0,0,0]
v_min_f32 v108, s67, v108
v_min_f32 v109, s67, v109
v_min_f32 v110, s67, v110
v_min_f32 v111, s67, v111
v_exp_f32 v112, v112
v_exp_f32 v113, v113
v_exp_f32 v114, v114
v_exp_f32 v115, v115
v_exp_f32 v108, v108
v_exp_f32 v109, v109
v_exp_f32 v110, v110
v_exp_f32 v111, v111
v_pk_add_f32 v[236:237], v[108:109], 1.0 op_sel_hi:[1,0]
v_pk_add_f32 v[238:239], v[110:111], 1.0 op_sel_hi:[1,0]
v_pk_fma_f32 v[236:237], v[236:237], v[112:113], v[236:237]
v_pk_fma_f32 v[238:239], v[238:239], v[114:115], v[238:239]
v_rcp_f32 v236, v236
v_rcp_f32 v237, v237
v_rcp_f32 v238, v238
v_rcp_f32 v239, v239
v_pk_fma_f32 v[236:237], v[108:109], v[236:237], v[236:237] neg_lo:[1,0,0] neg_hi:[1,0,0]
v_pk_fma_f32 v[238:239], v[110:111], v[238:239], v[238:239] neg_lo:[1,0,0] neg_hi:[1,0,0]
v_cvt_pk_bf16_f32 v250, v236, v237
v_cvt_pk_bf16_f32 v251, v238, v239
ds_write_b64 v9, v[250:251] offset:22528
s_waitcnt lgkmcnt(0)
s_barrier
ds_read_b128 v[228:231], v10 offset:16384
ds_read_b128 v[232:235], v10 offset:20480
v_pk_fma_f32 v[116:117], v[180:181], s[68:69], v[116:117] op_sel:[0,1,0] op_sel_hi:[1,1,1] neg_lo:[0,0,0] neg_hi:[0,0,0]
v_pk_fma_f32 v[118:119], v[182:183], s[68:69], v[118:119] op_sel:[0,1,0] op_sel_hi:[1,1,1] neg_lo:[0,0,0] neg_hi:[0,0,0]
v_pk_fma_f32 v[120:121], v[184:185], s[68:69], v[120:121] op_sel:[0,1,0] op_sel_hi:[1,1,1] neg_lo:[0,0,0] neg_hi:[0,0,0]
v_pk_fma_f32 v[122:123], v[186:187], s[68:69], v[122:123] op_sel:[0,1,0] op_sel_hi:[1,1,1] neg_lo:[0,0,0] neg_hi:[0,0,0]
v_min_f32 v116, s67, v116
v_min_f32 v117, s67, v117
v_min_f32 v118, s67, v118
v_min_f32 v119, s67, v119
v_exp_f32 v120, v120
v_exp_f32 v121, v121
s_waitcnt lgkmcnt(1)
buffer_store_dwordx4 v[228:231], v17, s[12:15], s24 offen offset:3072 sc1
s_waitcnt lgkmcnt(0)
buffer_store_dwordx4 v[232:235], v17, s[12:15], s26 offen offset:3072 sc1
v_exp_f32 v122, v122
v_exp_f32 v123, v123
v_exp_f32 v116, v116
v_exp_f32 v117, v117
v_exp_f32 v118, v118
v_exp_f32 v119, v119
v_pk_add_f32 v[240:241], v[116:117], 1.0 op_sel_hi:[1,0]
v_pk_add_f32 v[242:243], v[118:119], 1.0 op_sel_hi:[1,0]
v_pk_fma_f32 v[240:241], v[240:241], v[120:121], v[240:241]
v_pk_fma_f32 v[242:243], v[242:243], v[122:123], v[242:243]
v_rcp_f32 v240, v240
v_rcp_f32 v241, v241
v_rcp_f32 v242, v242
v_rcp_f32 v243, v243
v_pk_fma_f32 v[240:241], v[116:117], v[240:241], v[240:241] neg_lo:[1,0,0] neg_hi:[1,0,0]
v_pk_fma_f32 v[242:243], v[118:119], v[242:243], v[242:243] neg_lo:[1,0,0] neg_hi:[1,0,0]
v_cvt_pk_bf16_f32 v248, v240, v241
v_cvt_pk_bf16_f32 v249, v242, v243
ds_write_b64 v9, v[248:249] offset:24576
v_pk_fma_f32 v[124:125], v[188:189], s[68:69], v[124:125] op_sel:[0,1,0] op_sel_hi:[1,1,1] neg_lo:[0,0,0] neg_hi:[0,0,0]
v_pk_fma_f32 v[126:127], v[190:191], s[68:69], v[126:127] op_sel:[0,1,0] op_sel_hi:[1,1,1] neg_lo:[0,0,0] neg_hi:[0,0,0]
v_pk_fma_f32 v[128:129], v[192:193], s[68:69], v[128:129] op_sel:[0,1,0] op_sel_hi:[1,1,1] neg_lo:[0,0,0] neg_hi:[0,0,0]
v_pk_fma_f32 v[130:131], v[194:195], s[68:69], v[130:131] op_sel:[0,1,0] op_sel_hi:[1,1,1] neg_lo:[0,0,0] neg_hi:[0,0,0]
v_min_f32 v124, s67, v124
v_min_f32 v125, s67, v125
v_min_f32 v126, s67, v126
v_min_f32 v127, s67, v127
v_exp_f32 v128, v128
v_exp_f32 v129, v129
v_exp_f32 v130, v130
v_exp_f32 v131, v131
v_exp_f32 v124, v124
v_exp_f32 v125, v125
v_exp_f32 v126, v126
v_exp_f32 v127, v127
v_pk_add_f32 v[244:245], v[124:125], 1.0 op_sel_hi:[1,0]
v_pk_add_f32 v[246:247], v[126:127], 1.0 op_sel_hi:[1,0]
v_pk_fma_f32 v[244:245], v[244:245], v[128:129], v[244:245]
v_pk_fma_f32 v[246:247], v[246:247], v[130:131], v[246:247]
v_rcp_f32 v244, v244
v_rcp_f32 v245, v245
v_rcp_f32 v246, v246
v_rcp_f32 v247, v247
v_pk_fma_f32 v[244:245], v[124:125], v[244:245], v[244:245] neg_lo:[1,0,0] neg_hi:[1,0,0]
v_pk_fma_f32 v[246:247], v[126:127], v[246:247], v[246:247] neg_lo:[1,0,0] neg_hi:[1,0,0]
v_cvt_pk_bf16_f32 v250, v244, v245
v_cvt_pk_bf16_f32 v251, v246, v247
ds_write_b64 v9, v[250:251] offset:26624
v_pk_fma_f32 v[132:133], v[196:197], s[68:69], v[132:133] op_sel:[0,1,0] op_sel_hi:[1,1,1] neg_lo:[0,0,0] neg_hi:[0,0,0]
v_pk_fma_f32 v[134:135], v[198:199], s[68:69], v[134:135] op_sel:[0,1,0] op_sel_hi:[1,1,1] neg_lo:[0,0,0] neg_hi:[0,0,0]
v_pk_fma_f32 v[136:137], v[200:201], s[68:69], v[136:137] op_sel:[0,1,0] op_sel_hi:[1,1,1] neg_lo:[0,0,0] neg_hi:[0,0,0]
v_pk_fma_f32 v[138:139], v[202:203], s[68:69], v[138:139] op_sel:[0,1,0] op_sel_hi:[1,1,1] neg_lo:[0,0,0] neg_hi:[0,0,0]
v_min_f32 v132, s67, v132
v_min_f32 v133, s67, v133
v_min_f32 v134, s67, v134
v_min_f32 v135, s67, v135
v_exp_f32 v136, v136
v_exp_f32 v137, v137
v_exp_f32 v138, v138
v_exp_f32 v139, v139
v_exp_f32 v132, v132
v_exp_f32 v133, v133
v_exp_f32 v134, v134
v_exp_f32 v135, v135
v_pk_add_f32 v[236:237], v[132:133], 1.0 op_sel_hi:[1,0]
v_pk_add_f32 v[238:239], v[134:135], 1.0 op_sel_hi:[1,0]
v_pk_fma_f32 v[236:237], v[236:237], v[136:137], v[236:237]
v_pk_fma_f32 v[238:239], v[238:239], v[138:139], v[238:239]
v_rcp_f32 v236, v236
v_rcp_f32 v237, v237
v_rcp_f32 v238, v238
v_rcp_f32 v239, v239
v_pk_fma_f32 v[236:237], v[132:133], v[236:237], v[236:237] neg_lo:[1,0,0] neg_hi:[1,0,0]
v_pk_fma_f32 v[238:239], v[134:135], v[238:239], v[238:239] neg_lo:[1,0,0] neg_hi:[1,0,0]
v_cvt_pk_bf16_f32 v248, v236, v237
v_cvt_pk_bf16_f32 v249, v238, v239
ds_write_b64 v9, v[248:249] offset:28672
v_pk_fma_f32 v[140:141], v[204:205], s[68:69], v[140:141] op_sel:[0,1,0] op_sel_hi:[1,1,1] neg_lo:[0,0,0] neg_hi:[0,0,0]
v_pk_fma_f32 v[142:143], v[206:207], s[68:69], v[142:143] op_sel:[0,1,0] op_sel_hi:[1,1,1] neg_lo:[0,0,0] neg_hi:[0,0,0]
v_pk_fma_f32 v[144:145], v[208:209], s[68:69], v[144:145] op_sel:[0,1,0] op_sel_hi:[1,1,1] neg_lo:[0,0,0] neg_hi:[0,0,0]
v_pk_fma_f32 v[146:147], v[210:211], s[68:69], v[146:147] op_sel:[0,1,0] op_sel_hi:[1,1,1] neg_lo:[0,0,0] neg_hi:[0,0,0]
v_min_f32 v140, s67, v140
v_min_f32 v141, s67, v141
v_min_f32 v142, s67, v142
v_min_f32 v143, s67, v143
v_exp_f32 v144, v144
v_exp_f32 v145, v145
v_exp_f32 v146, v146
v_exp_f32 v147, v147
v_exp_f32 v140, v140
v_exp_f32 v141, v141
v_exp_f32 v142, v142
v_exp_f32 v143, v143
v_pk_add_f32 v[240:241], v[140:141], 1.0 op_sel_hi:[1,0]
v_pk_add_f32 v[242:243], v[142:143], 1.0 op_sel_hi:[1,0]
v_pk_fma_f32 v[240:241], v[240:241], v[144:145], v[240:241]
v_pk_fma_f32 v[242:243], v[242:243], v[146:147], v[242:243]
v_rcp_f32 v240, v240
v_rcp_f32 v241, v241
v_rcp_f32 v242, v242
v_rcp_f32 v243, v243
v_pk_fma_f32 v[240:241], v[140:141], v[240:241], v[240:241] neg_lo:[1,0,0] neg_hi:[1,0,0]
v_pk_fma_f32 v[242:243], v[142:143], v[242:243], v[242:243] neg_lo:[1,0,0] neg_hi:[1,0,0]
v_cvt_pk_bf16_f32 v250, v240, v241
v_cvt_pk_bf16_f32 v251, v242, v243
ds_write_b64 v9, v[250:251] offset:30720
s_waitcnt lgkmcnt(0)
s_barrier
ds_read_b128 v[228:231], v10 offset:24576
ds_read_b128 v[232:235], v10 offset:28672
s_waitcnt lgkmcnt(1)
buffer_store_dwordx4 v[228:231], v17, s[12:15], s28 offen offset:3072 sc1
s_waitcnt lgkmcnt(0)
buffer_store_dwordx4 v[232:235], v17, s[12:15], s30 offen offset:3072 sc1
s_or_b32 s36, s2, s17
s_cmp_lg_u32 s36, 0
s_cbranch_scc1 Lm_nz
v_mov_b32 v212, 0
v_mov_b32 v213, 0
s_mov_b64 exec, 1
global_store_dwordx2 v212, v[212:213], s[34:35] sc1
s_mov_b64 exec, -1
Lm_nz:
Lm_end:
s_endpgm
Lu_pub:
s_cmp_lg_u32 s19, 0
s_cbranch_scc1 Lu_pubr
v_mov_b32 v248, s32
v_mov_b32 v249, s33
s_and_b32 s38, s2, 3
s_lshl_b32 s38, s38, 13
s_lshr_b32 s39, s2, 2
s_lshl_b32 s39, s39, 4
s_add_u32 s38, s38, s39
s_add_u32 s38, s38, 32768
s_mov_b64 exec, 1
buffer_store_dwordx2 v[248:249], off, s[8:11], s38 sc1
s_mov_b64 exec, -1
s_nop 1
s_branch Lu_pubr
Lu_spin:
s_cmp_lg_u32 s45, 0
s_cbranch_scc1 Lu_spinr
s_mov_b32 s42, 0
Lu_sw:
buffer_load_dwordx2 v[252:253], v254, s[8:11], s38 offen sc1
s_waitcnt vmcnt(0)
v_cmp_ne_u64 vcc, s[32:33], v[252:253]
s_nop 1
s_cmp_eq_u64 vcc, 0
s_cbranch_scc1 Lu_spinr
s_add_u32 s42, s42, 1
s_cmp_le_u32 s42, 10000
s_cbranch_scc1 Lu_sw
s_branch Lu_spinr
Lv_pub:
v_mov_b32 v212, s32
v_mov_b32 v213, s33
s_lshl_b32 s36, s18, 7
s_mov_b64 exec, 1
buffer_store_dwordx2 v[212:213], v19, s[8:11], s36 offen sc1
s_mov_b64 exec, -1
s_nop 1
s_branch Lv_pubr
Lv_spin:
s_cmp_lg_u32 s19, 0
s_cbranch_scc1 Lv_sf
s_mov_b32 s36, 0
Lv_sw:
buffer_load_dwordx2 v[218:219], v19, s[8:11], 0 offen sc1
s_waitcnt vmcnt(0)
v_cmp_ne_u64 vcc, s[32:33], v[218:219]
s_nop 1
s_cmp_eq_u64 vcc, 0
s_cbranch_scc1 Lv_spinr
s_add_u32 s36, s36, 1
s_cmp_le_u32 s36, 400
s_cbranch_scc1 Lv_sw
Lv_sf:
v_mov_b32 v218, 1
ds_write_b32 v220, v218
s_waitcnt lgkmcnt(0)
s_branch Lv_spinr
Lv_fall:
s_lshl_b32 s37, s18, 12
s_lshl_b32 s38, s18, 11
v_subrev_u32 v9, s37, v9
v_subrev_u32 v10, s37, v10
v_subrev_u32 v11, s37, v11
v_subrev_u32 v12, s38, v12
s_mov_b32 s37, 0
Lv_fl:
s_and_b32 s38, s37, 3
s_lshl_b32 s39, s38, 7
s_lshl_b32 s38, s38, 14
s_add_u32 s38, s38, s3
buffer_load_dwordx4 v[148:151], v9, s[4:7], s39 offen offset:0
buffer_load_dwordx4 v[152:155], v9, s[4:7], s39 offen offset:1024
buffer_load_dwordx4 v[156:159], v10, s[4:7], s39 offen offset:0
buffer_load_dwordx4 v[160:163], v10, s[4:7], s39 offen offset:1024
buffer_load_dwordx4 v[164:167], v10, s[4:7], s39 offen offset:2048
buffer_load_dwordx4 v[168:171], v10, s[4:7], s39 offen offset:3072
buffer_load_dwordx4 v[172:175], v11, s[4:7], s39 offen offset:0
s_waitcnt vmcnt(5)
v_lshlrev_b32 v226, 16, v152
v_and_b32 v227, s50, v152
s_waitcnt vmcnt(3)
v_lshlrev_b32 v216, 16, v160
v_and_b32 v217, s50, v160
s_waitcnt vmcnt(1)
v_lshlrev_b32 v228, 16, v168
v_and_b32 v229, s50, v168
v_pk_fma_f32 v[228:229], v[216:217], s[56:57], v[228:229] op_sel:[0,0,0] op_sel_hi:[1,0,1] neg_lo:[0,0,0] neg_hi:[0,0,0]
v_pk_fma_f32 v[228:229], v[226:227], s[54:55], v[228:229] op_sel:[0,1,0] op_sel_hi:[1,1,1] neg_lo:[0,0,0] neg_hi:[0,0,0]
v_lshlrev_b32 v218, 16, v153
v_and_b32 v219, s50, v153
v_lshlrev_b32 v234, 16, v161
v_and_b32 v235, s50, v161
v_lshlrev_b32 v220, 16, v169
v_and_b32 v221, s50, v169
v_pk_fma_f32 v[220:221], v[234:235], s[56:57], v[220:221] op_sel:[0,0,0] op_sel_hi:[1,0,1] neg_lo:[0,0,0] neg_hi:[0,0,0]
v_pk_fma_f32 v[220:221], v[218:219], s[54:55], v[220:221] op_sel:[0,1,0] op_sel_hi:[1,1,1] neg_lo:[0,0,0] neg_hi:[0,0,0]
v_lshlrev_b32 v212, 16, v154
v_and_b32 v213, s50, v154
v_lshlrev_b32 v232, 16, v162
v_and_b32 v233, s50, v162
v_lshlrev_b32 v214, 16, v170
v_and_b32 v215, s50, v170
v_pk_fma_f32 v[214:215], v[232:233], s[56:57], v[214:215] op_sel:[0,0,0] op_sel_hi:[1,0,1] neg_lo:[0,0,0] neg_hi:[0,0,0]
v_pk_fma_f32 v[214:215], v[212:213], s[54:55], v[214:215] op_sel:[0,1,0] op_sel_hi:[1,1,1] neg_lo:[0,0,0] neg_hi:[0,0,0]
v_lshlrev_b32 v230, 16, v155
v_and_b32 v231, s50, v155
v_lshlrev_b32 v222, 16, v163
v_and_b32 v223, s50, v163
v_lshlrev_b32 v224, 16, v171
v_and_b32 v225, s50, v171
v_pk_fma_f32 v[224:225], v[222:223], s[56:57], v[224:225] op_sel:[0,0,0] op_sel_hi:[1,0,1] neg_lo:[0,0,0] neg_hi:[0,0,0]
v_pk_fma_f32 v[224:225], v[230:231], s[54:55], v[224:225] op_sel:[0,1,0] op_sel_hi:[1,1,1] neg_lo:[0,0,0] neg_hi:[0,0,0]
s_waitcnt vmcnt(0)
v_lshlrev_b32 v226, 16, v172
v_and_b32 v227, s50, v172
v_lshlrev_b32 v216, 16, v164
v_and_b32 v217, s50, v164
v_pk_fma_f32 v[226:227], v[226:227], s[58:59], v[228:229] op_sel:[0,0,0] op_sel_hi:[1,0,1] neg_lo:[0,0,0] neg_hi:[0,0,0]
v_pk_fma_f32 v[226:227], v[216:217], s[56:57], v[226:227] op_sel:[0,1,0] op_sel_hi:[1,1,1] neg_lo:[0,0,0] neg_hi:[0,0,0]
v_pk_fma_f32 v[216:217], v[228:229], s[58:59], v[216:217] op_sel:[0,0,0] op_sel_hi:[1,0,1] neg_lo:[0,0,0] neg_hi:[0,0,0]
v_cvt_pk_bf16_f32 v196, v228, v229
v_lshlrev_b32 v218, 16, v156
v_and_b32 v219, s50, v156
v_lshlrev_b32 v234, 16, v148
v_and_b32 v235, s50, v148
v_pk_fma_f32 v[226:227], v[218:219], s[58:59], v[226:227] op_sel:[0,1,0] op_sel_hi:[1,1,1] neg_lo:[0,0,0] neg_hi:[0,0,0]
v_pk_fma_f32 v[216:217], v[218:219], s[56:57], v[216:217] op_sel:[0,0,0] op_sel_hi:[1,0,1] neg_lo:[0,0,0] neg_hi:[0,0,0]
v_pk_fma_f32 v[216:217], v[234:235], s[54:55], v[216:217] op_sel:[0,1,0] op_sel_hi:[1,1,1] neg_lo:[0,0,0] neg_hi:[0,0,0]
v_cvt_pk_bf16_f32 v200, v216, v217
v_cvt_pk_bf16_f32 v204, v226, v227
v_lshlrev_b32 v212, 16, v173
v_and_b32 v213, s50, v173
v_lshlrev_b32 v232, 16, v165
v_and_b32 v233, s50, v165
v_pk_fma_f32 v[212:213], v[212:213], s[58:59], v[220:221] op_sel:[0,0,0] op_sel_hi:[1,0,1] neg_lo:[0,0,0] neg_hi:[0,0,0]
v_pk_fma_f32 v[212:213], v[232:233], s[56:57], v[212:213] op_sel:[0,1,0] op_sel_hi:[1,1,1] neg_lo:[0,0,0] neg_hi:[0,0,0]
v_pk_fma_f32 v[232:233], v[220:221], s[58:59], v[232:233] op_sel:[0,0,0] op_sel_hi:[1,0,1] neg_lo:[0,0,0] neg_hi:[0,0,0]
v_cvt_pk_bf16_f32 v197, v220, v221
v_lshlrev_b32 v230, 16, v157
v_and_b32 v231, s50, v157
v_lshlrev_b32 v222, 16, v149
v_and_b32 v223, s50, v149
v_pk_fma_f32 v[212:213], v[230:231], s[58:59], v[212:213] op_sel:[0,1,0] op_sel_hi:[1,1,1] neg_lo:[0,0,0] neg_hi:[0,0,0]
v_pk_fma_f32 v[232:233], v[230:231], s[56:57], v[232:233] op_sel:[0,0,0] op_sel_hi:[1,0,1] neg_lo:[0,0,0] neg_hi:[0,0,0]
v_pk_fma_f32 v[232:233], v[222:223], s[54:55], v[232:233] op_sel:[0,1,0] op_sel_hi:[1,1,1] neg_lo:[0,0,0] neg_hi:[0,0,0]
v_cvt_pk_bf16_f32 v201, v232, v233
v_cvt_pk_bf16_f32 v205, v212, v213
v_lshlrev_b32 v228, 16, v174
v_and_b32 v229, s50, v174
v_lshlrev_b32 v234, 16, v166
v_and_b32 v235, s50, v166
v_pk_fma_f32 v[228:229], v[228:229], s[58:59], v[214:215] op_sel:[0,0,0] op_sel_hi:[1,0,1] neg_lo:[0,0,0] neg_hi:[0,0,0]
v_pk_fma_f32 v[228:229], v[234:235], s[56:57], v[228:229] op_sel:[0,1,0] op_sel_hi:[1,1,1] neg_lo:[0,0,0] neg_hi:[0,0,0]
v_pk_fma_f32 v[234:235], v[214:215], s[58:59], v[234:235] op_sel:[0,0,0] op_sel_hi:[1,0,1] neg_lo:[0,0,0] neg_hi:[0,0,0]
v_cvt_pk_bf16_f32 v198, v214, v215
v_lshlrev_b32 v218, 16, v158
v_and_b32 v219, s50, v158
v_lshlrev_b32 v216, 16, v150
v_and_b32 v217, s50, v150
v_pk_fma_f32 v[228:229], v[218:219], s[58:59], v[228:229] op_sel:[0,1,0] op_sel_hi:[1,1,1] neg_lo:[0,0,0] neg_hi:[0,0,0]
v_pk_fma_f32 v[234:235], v[218:219], s[56:57], v[234:235] op_sel:[0,0,0] op_sel_hi:[1,0,1] neg_lo:[0,0,0] neg_hi:[0,0,0]
v_pk_fma_f32 v[234:235], v[216:217], s[54:55], v[234:235] op_sel:[0,1,0] op_sel_hi:[1,1,1] neg_lo:[0,0,0] neg_hi:[0,0,0]
v_cvt_pk_bf16_f32 v202, v234, v235
v_cvt_pk_bf16_f32 v206, v228, v229
v_lshlrev_b32 v226, 16, v175
v_and_b32 v227, s50, v175
v_lshlrev_b32 v220, 16, v167
v_and_b32 v221, s50, v167
v_pk_fma_f32 v[226:227], v[226:227], s[58:59], v[224:225] op_sel:[0,0,0] op_sel_hi:[1,0,1] neg_lo:[0,0,0] neg_hi:[0,0,0]
v_pk_fma_f32 v[226:227], v[220:221], s[56:57], v[226:227] op_sel:[0,1,0] op_sel_hi:[1,1,1] neg_lo:[0,0,0] neg_hi:[0,0,0]
v_pk_fma_f32 v[220:221], v[224:225], s[58:59], v[220:221] op_sel:[0,0,0] op_sel_hi:[1,0,1] neg_lo:[0,0,0] neg_hi:[0,0,0]
v_cvt_pk_bf16_f32 v199, v224, v225
v_lshlrev_b32 v222, 16, v159
v_and_b32 v223, s50, v159
v_lshlrev_b32 v230, 16, v151
v_and_b32 v231, s50, v151
v_pk_fma_f32 v[226:227], v[222:223], s[58:59], v[226:227] op_sel:[0,1,0] op_sel_hi:[1,1,1] neg_lo:[0,0,0] neg_hi:[0,0,0]
v_pk_fma_f32 v[220:221], v[222:223], s[56:57], v[220:221] op_sel:[0,0,0] op_sel_hi:[1,0,1] neg_lo:[0,0,0] neg_hi:[0,0,0]
v_pk_fma_f32 v[220:221], v[230:231], s[54:55], v[220:221] op_sel:[0,1,0] op_sel_hi:[1,1,1] neg_lo:[0,0,0] neg_hi:[0,0,0]
v_cvt_pk_bf16_f32 v203, v220, v221
v_cvt_pk_bf16_f32 v207, v226, v227
s_add_u32 s36, s38, 0
buffer_store_dwordx4 v[196:199], v12, s[8:11], s36 offen sc1
s_add_u32 s36, s38, 65536
buffer_store_dwordx4 v[200:203], v12, s[8:11], s36 offen sc1
s_add_u32 s36, s38, 131072
buffer_store_dwordx4 v[204:207], v12, s[8:11], s36 offen sc1
s_waitcnt vmcnt(0)
s_add_u32 s37, s37, 1
s_and_b32 s38, s37, 3
s_cbranch_scc1 Lv_fl
v_add_u32 v9, 4096, v9
v_add_u32 v10, 4096, v10
v_add_u32 v11, 4096, v11
v_add_u32 v12, 2048, v12
s_cmp_lt_u32 s37, 16
s_cbranch_scc1 Lv_fl
s_barrier
s_branch Lv_fallr
Lm_fall:
s_waitcnt vmcnt(0)
v_mov_b32 v250, 1
ds_write_b32 v251, v250
buffer_store_dwordx4 v[108:111], v255, s[8:11], s24 offen sc1
buffer_store_dwordx4 v[112:115], v255, s[8:11], s25 offen sc1
buffer_store_dwordx4 v[116:119], v255, s[8:11], s26 offen sc1
buffer_store_dwordx4 v[120:123], v255, s[8:11], s27 offen sc1
buffer_store_dwordx4 v[124:127], v255, s[8:11], s28 offen sc1
buffer_store_dwordx4 v[128:131], v255, s[8:11], s29 offen sc1
buffer_store_dwordx4 v[132:135], v255, s[8:11], s30 offen sc1
v_accvgpr_write_b32 a64, v88
v_accvgpr_write_b32 a65, v89
v_accvgpr_write_b32 a66, v90
v_accvgpr_write_b32 a67, v91
v_accvgpr_write_b32 a68, v92
v_accvgpr_write_b32 a69, v93
v_accvgpr_write_b32 a70, v94
v_accvgpr_write_b32 a71, v95
v_accvgpr_write_b32 a72, v96
v_accvgpr_write_b32 a73, v97
v_accvgpr_write_b32 a74, v98
v_accvgpr_write_b32 a75, v99
s_mov_b32 s48, s18
Lm_fl:
s_and_b32 s36, s48, 3
s_lshl_b32 s36, s36, 7
s_bfe_u32 s37, s48, 0x10003
s_lshl_b32 s37, s37, 6
s_add_u32 s36, s36, s37
s_lshr_b32 s37, s48, 5
s_lshl_b32 s37, s37, 13
s_add_u32 s36, s36, s37
s_and_b32 s37, s48, 4
s_lshl_b32 s37, s37, 18
s_add_u32 s36, s36, s37
s_and_b32 s37, s48, 16
s_lshl_b32 s37, s37, 17
s_add_u32 s36, s36, s37
s_add_u32 m0, s49, 132224
s_nop 0
buffer_load_dwordx4 v244, s[20:23], s36 offen offset:0 lds
s_add_u32 s36, s36, 261120
buffer_load_dwordx4 v244, s[20:23], s36 offen offset:1024 lds
s_add_u32 s36, s36, 261120
buffer_load_dwordx4 v244, s[20:23], s36 offen offset:2048 lds
s_add_u32 s36, s36, 261120
buffer_load_dwordx4 v244, s[20:23], s36 offen offset:3072 lds
s_and_b32 s36, s48, 3
s_lshl_b32 s36, s36, 1
s_bfe_u32 s37, s48, 0x10003
s_add_u32 s36, s36, s37
s_mul_i32 s36, s36, 135168
s_bfe_u32 s37, s48, 0x20005
s_lshl_b32 s37, s37, 8
s_add_u32 s36, s36, s37
s_and_b32 s37, s48, 4
s_lshl_b32 s37, s37, 8
s_add_u32 s36, s36, s37
s_and_b32 s37, s48, 16
s_lshl_b32 s37, s37, 7
s_add_u32 s36, s36, s37
s_lshr_b32 s37, s48, 7
s_mul_i32 s39, s31, 1081344
s_mul_i32 s40, s37, 4096
s_add_u32 s39, s39, s40
s_add_u32 s39, s39, s36
s_add_u32 s24, s39, 131072
s_add_u32 s25, s39, 139264
s_add_u32 s26, s39, 147456
s_add_u32 s27, s39, 155648
s_mul_i32 s39, s31, 8192
s_mul_i32 s40, s37, 4096
s_add_u32 s39, s39, s40
s_add_u32 s39, s39, s36
s_add_u32 s28, s39, 4456448
s_add_u32 s29, s39, 5537792
s_mul_i32 s39, s31, 6144
s_mul_i32 s40, s37, 3072
s_add_u32 s39, s39, s40
s_add_u32 s39, s39, s36
s_add_u32 s30, s39, 6619136
s_and_b32 s37, s48, 20
s_cmp_eq_u32 s37, 20
s_cselect_b32 s30, 0x40000000, s30
s_waitcnt vmcnt(0)
s_call_b64 s[46:47], Lu_sub
buffer_store_dwordx4 v[108:111], v255, s[8:11], s24 offen sc1
buffer_store_dwordx4 v[112:115], v255, s[8:11], s25 offen sc1
buffer_store_dwordx4 v[116:119], v255, s[8:11], s26 offen sc1
buffer_store_dwordx4 v[120:123], v255, s[8:11], s27 offen sc1
buffer_store_dwordx4 v[124:127], v255, s[8:11], s28 offen sc1
buffer_store_dwordx4 v[128:131], v255, s[8:11], s29 offen sc1
buffer_store_dwordx4 v[132:135], v255, s[8:11], s30 offen sc1
s_add_u32 s48, s48, 4
s_cmp_lt_u32 s48, 256
s_cbranch_scc1 Lm_fl
v_accvgpr_read_b32 v88, a64
v_accvgpr_read_b32 v89, a65
v_accvgpr_read_b32 v90, a66
v_accvgpr_read_b32 v91, a67
v_accvgpr_read_b32 v92, a68
v_accvgpr_read_b32 v93, a69
v_accvgpr_read_b32 v94, a70
v_accvgpr_read_b32 v95, a71
v_accvgpr_read_b32 v96, a72
v_accvgpr_read_b32 v97, a73
v_accvgpr_read_b32 v98, a74
v_accvgpr_read_b32 v99, a75
s_waitcnt vmcnt(0) lgkmcnt(0)
s_barrier
s_mov_b32 s16, 131072
buffer_load_dwordx4 a[160:163], v13, s[8:11], s16 offen offset:0 sc1
buffer_load_dwordx4 a[164:167], v14, s[8:11], s16 offen offset:0 sc1
buffer_load_dwordx4 a[168:171], v13, s[8:11], s16 offen offset:1024 sc1
buffer_load_dwordx4 a[172:175], v14, s[8:11], s16 offen offset:1024 sc1
buffer_load_dwordx4 a[176:179], v13, s[8:11], s16 offen offset:2048 sc1
buffer_load_dwordx4 a[180:183], v14, s[8:11], s16 offen offset:2048 sc1
buffer_load_dwordx4 a[184:187], v13, s[8:11], s16 offen offset:3072 sc1
buffer_load_dwordx4 a[188:191], v14, s[8:11], s16 offen offset:3072 sc1
s_add_u32 s16, s16, 4096
buffer_load_dwordx4 a[192:195], v13, s[8:11], s16 offen offset:0 sc1
buffer_load_dwordx4 a[196:199], v14, s[8:11], s16 offen offset:0 sc1
buffer_load_dwordx4 a[200:203], v13, s[8:11], s16 offen offset:1024 sc1
buffer_load_dwordx4 a[204:207], v14, s[8:11], s16 offen offset:1024 sc1
buffer_load_dwordx4 a[208:211], v13, s[8:11], s16 offen offset:2048 sc1
buffer_load_dwordx4 a[212:215], v14, s[8:11], s16 offen offset:2048 sc1
buffer_load_dwordx4 a[216:219], v13, s[8:11], s16 offen offset:3072 sc1
buffer_load_dwordx4 a[220:223], v14, s[8:11], s16 offen offset:3072 sc1
s_add_u32 s16, s16, 4096
s_waitcnt vmcnt(0)
s_branch Lm_resume
Lm_last:
s_endpgm
.fill 9216, 4, 0xbf800000
s_endpgm
.section .rodata,"a"
.p2align 6
.amdhsa_kernel standalone__autoregressive_conv_wavernn__speech_kernel
  .amdhsa_next_free_vgpr 512
  .amdhsa_next_free_sgpr 102
  .amdhsa_accum_offset 256
  .amdhsa_group_segment_fixed_size 0
  .amdhsa_kernarg_size 40
  .amdhsa_user_sgpr_count 2
  .amdhsa_user_sgpr_kernarg_segment_ptr 1
  .amdhsa_system_sgpr_workgroup_id_x 1
.end_amdhsa_kernel
```
